```python
import torch

def _softmax(x, axis=-1):
    return torch.softmax(x, dim=axis)
def _gelu(x):
    return torch.nn.functional.gelu(x, approximate="tanh")
def _silu(x):
    return torch.nn.functional.silu(x)
def _sigmoid(x):
    return torch.sigmoid(x)
def _layernorm(x, axis=-1, eps=1e-5):
    m = x.mean(dim=axis, keepdim=True)
    v = x.var(dim=axis, keepdim=True, unbiased=False)
    return (x - m) / torch.sqrt(v + eps)
def _scatter_add(tgt, idx, src, axis=0):
    return tgt.clone().index_add_(axis, idx, src)
def _segment_sum(src, seg, n):
    out = torch.zeros((n,) + src.shape[1:], dtype=src.dtype)
    return out.index_add_(0, seg, src)
def _pad(x, pw):
    flat = tuple(v for pair in reversed(pw) for v in pair)
    return torch.nn.functional.pad(x, flat)

kernel_name = 'concat_heads__mha_block_cached__gqa_block_cached__near_ridge'

def setup_inputs():

    _w = (lambda a: (lambda t: t.to(torch.bfloat16) if t.is_floating_point() else t)(torch.as_tensor(a)))
    def _A_setup():
        B, Sq, D = 8, 256, 512
        H, Sk, Dh = 32, 1024, 128
        return {
            "x": _w((lambda *s: torch.randn(*s, dtype=torch.bfloat16) * 0.8)(B, Sq, D)),
            "k_cache": _w((lambda *s: torch.randn(*s, dtype=torch.bfloat16) * 0.8)(B, H, Sk, Dh)),
            "v_cache": _w((lambda *s: torch.randn(*s, dtype=torch.bfloat16) * 0.05)(B, H, Sk, Dh)),
            "wq": _w((lambda *s: torch.randn(*s, dtype=torch.bfloat16) * 0.8)(D, H * Dh) * (D ** -0.5)),
            "wo": _w((lambda *s: torch.randn(*s, dtype=torch.bfloat16) * 0.05)(H * Dh, D) * ((H * Dh) ** -0.5)),
        }
    _A_in = _A_setup()

    def _B_setup():
        B, Sq, D = 8, 256, 512
        Hq, Hkv, Sk, Dh = 32, 32, 1024, 128
        assert Hq % Hkv == 0, (Hq, Hkv)
        return {
            "x": _w((lambda *s: torch.randn(*s, dtype=torch.bfloat16) * 0.8)(B, Sq, D)),
            "k_cache": _w((lambda *s: torch.randn(*s, dtype=torch.bfloat16) * 0.8)(B, Hkv, Sk, Dh)),
            "v_cache": _w((lambda *s: torch.randn(*s, dtype=torch.bfloat16) * 0.05)(B, Hkv, Sk, Dh)),
            "wq": _w((lambda *s: torch.randn(*s, dtype=torch.bfloat16) * 0.8)(D, Hq * Dh) * (D ** -0.5)),
            "wo": _w((lambda *s: torch.randn(*s, dtype=torch.bfloat16) * 0.05)(Hq * Dh, D) * ((Hq * Dh) ** -0.5)),
        }
    _B_in = _B_setup()

    return {
        "A_x": _A_in["x"],
        "A_k_cache": _A_in["k_cache"],
        "A_v_cache": _A_in["v_cache"],
        "A_wq": _A_in["wq"],
        "A_wo": _A_in["wo"],
        "B_x": _B_in["x"],
        "B_k_cache": _B_in["k_cache"],
        "B_v_cache": _B_in["v_cache"],
        "B_wq": _B_in["wq"],
        "B_wo": _B_in["wo"],
    }

def reference(A_x, A_k_cache, A_v_cache, A_wq, A_wo, B_x, B_k_cache, B_v_cache, B_wq, B_wo):
    def _A_ref(x, k_cache, v_cache, wq, wo):
        B, Sq, D = x.shape
        H, Dh = 32, 128
        q = (lambda x, *d: x.permute(*d))((x @ wq).reshape(B, Sq, H, Dh), 0, 2, 1, 3)
        scores = torch.einsum("bhqd,bhkd->bhqk", q, k_cache) * (Dh ** -0.5)
        p = _softmax(scores, axis=-1)
        o = torch.einsum("bhqk,bhkd->bhqd", p, v_cache)
        return (lambda x, *d: x.permute(*d))(o, 0, 2, 1, 3).reshape(B, Sq, H * Dh) @ wo

    def _B_ref(x, k_cache, v_cache, wq, wo):
        B, Sq, D = x.shape
        Hq, Dh = 32, 128
        Hkv = k_cache.shape[1]
        rep = Hq // Hkv
        q = (lambda x, *d: x.permute(*d))((x @ wq).reshape(B, Sq, Hq, Dh), 0, 2, 1, 3)
        k = (lambda x, n, axis: torch.repeat_interleave(x, n, dim=axis))(k_cache, rep, axis=1)
        v = (lambda x, n, axis: torch.repeat_interleave(x, n, dim=axis))(v_cache, rep, axis=1)
        scores = torch.einsum("bhqd,bhkd->bhqk", q, k) * (Dh ** -0.5)
        p = _softmax(scores, axis=-1)
        o = torch.einsum("bhqk,bhkd->bhqd", p, v)
        return (lambda x, *d: x.permute(*d))(o, 0, 2, 1, 3).reshape(B, Sq, Hq * Dh) @ wo

    a = _A_ref(A_x, A_k_cache, A_v_cache, A_wq, A_wo)
    b = _B_ref(B_x, B_k_cache, B_v_cache, B_wq, B_wo)
    return torch.concatenate([a, b], axis=-1)
```

```asm
; @launch grid=(256,1,1) block=(256,1,1) lds=163840
.amdgcn_target "amdgcn-amd-amdhsa--gfx950"
.text
.globl concat_heads__mha_block_cached__gqa_block_cached__near_ridge_kernel
.p2align 8
.type concat_heads__mha_block_cached__gqa_block_cached__near_ridge_kernel,@function
concat_heads__mha_block_cached__gqa_block_cached__near_ridge_kernel:
    s_cmp_ge_u32 s2, 256
    s_cbranch_scc1 L_k1_end
    s_load_dwordx16 s[36:51], s[0:1], 0
    s_load_dwordx8 s[52:59], s[0:1], 64
    s_load_dwordx2 s[60:61], s[0:1], 96
    v_and_b32 v1, 63, v0
    v_lshrrev_b32 v2, 6, v0
    v_and_b32 v3, 15, v0
    v_readfirstlane_b32 s28, v2
    v_lshrrev_b32 v4, 4, v1
    v_bfe_u32 v5, v1, 2, 2
    v_and_b32 v6, 3, v1
    s_and_b32 s3, s2, 7
    s_lshr_b32 s4, s2, 3
    s_lshr_b32 s5, s3, 2
    s_bfe_u32 s6, s3, 65537
    s_lshl_b32 s6, s6, 2
    s_and_b32 s7, s4, 3
    s_add_u32 s6, s6, s7
    s_and_b32 s7, s3, 1
    s_lshl_b32 s7, s7, 3
    s_lshr_b32 s4, s4, 2
    s_add_u32 s7, s7, s4
    s_lshl_b32 s29, s28, 12
    v_lshrrev_b32 v7, 3, v1
    v_bfe_u32 v244, v1, 4, 1
    v_lshlrev_b32 v244, 2, v244
    v_and_b32 v245, 7, v1
    v_xor_b32 v244, v244, v245
    v_lshl_add_u32 v7, v2, 5, v7
    v_lshlrev_b32 v7, 13, v7
    v_lshl_add_u32 v29, v244, 4, v7
    v_lshlrev_b32 v7, 6, v2
    v_add_u32 v7, v7, v4
    v_lshlrev_b32 v7, 10, v7
    v_add_u32 v244, 0, v4
    v_xor_b32 v244, v244, v3
    v_lshl_add_u32 v32, v244, 4, v7
    v_add_u32 v244, 4, v4
    v_xor_b32 v244, v244, v3
    v_lshl_add_u32 v33, v244, 4, v7
    v_add_u32 v33, 4096, v33
    v_add_u32 v244, 8, v4
    v_xor_b32 v244, v244, v3
    v_lshl_add_u32 v34, v244, 4, v7
    v_add_u32 v34, 8192, v34
    v_add_u32 v244, 12, v4
    v_xor_b32 v244, v244, v3
    v_lshl_add_u32 v35, v244, 4, v7
    v_add_u32 v35, 12288, v35
    s_getpc_b64 s[92:93]
L_pc:
    s_sub_u32 s92, s92, L_pc-concat_heads__mha_block_cached__gqa_block_cached__near_ridge_kernel
    s_subb_u32 s93, s93, 0
    s_mov_b32 s94, L_k1_end-concat_heads__mha_block_cached__gqa_block_cached__near_ridge_kernel
    s_mov_b32 s95, 0x00020000
    s_lshr_b32 s68, s2, 3
    s_lshl_b32 s68, s68, 2
    s_add_u32 s68, s68, s28
    s_and_b32 s68, s68, 15
    s_lshl_b32 s68, s68, 13
    v_lshlrev_b32 v252, 7, v1
    buffer_load_dword v255, v252, s[92:95], s68 offen
    s_waitcnt lgkmcnt(0)
    s_cmp_eq_u32 s5, 0
    s_cselect_b64 s[20:21], s[36:37], s[46:47]
    s_cselect_b64 s[8:9], s[38:39], s[48:49]
    s_cselect_b64 s[12:13], s[40:41], s[50:51]
    s_cselect_b64 s[16:17], s[42:43], s[52:53]
    s_lshl_b32 s66, s6, 18
    s_add_u32 s20, s20, s66
    s_addc_u32 s21, s21, 0
    s_mov_b32 s22, 262144
    s_mov_b32 s23, 0x00020000
    s_lshl_b32 s66, s7, 9
    s_add_u32 s16, s16, s66
    s_addc_u32 s17, s17, 0
    s_sub_u32 s18, 4194304, s66
    s_mov_b32 s19, 0x00020000
    s_add_u32 m0, s29, 49152
    s_mov_b32 s66, 0
    buffer_load_dwordx4 v29, s[16:19], s66 offen lds
    s_add_u32 m0, s29, 50176
    s_mov_b32 s67, 65536
    buffer_load_dwordx4 v29, s[16:19], s67 offen lds
    s_add_u32 m0, s29, 51200
    s_mov_b32 s66, 131072
    buffer_load_dwordx4 v29, s[16:19], s66 offen lds
    s_add_u32 m0, s29, 52224
    s_mov_b32 s67, 196608
    buffer_load_dwordx4 v29, s[16:19], s67 offen lds
    s_add_u32 m0, s29, 16384
    s_mov_b32 s74, 0
    buffer_load_dwordx4 v32, s[20:23], s74 offen nt lds
    s_add_u32 m0, s29, 17408
    s_nop 0
    buffer_load_dwordx4 v33, s[20:23], s74 offen nt lds
    s_add_u32 m0, s29, 18432
    s_nop 0
    buffer_load_dwordx4 v34, s[20:23], s74 offen nt lds
    s_add_u32 m0, s29, 19456
    s_nop 0
    buffer_load_dwordx4 v35, s[20:23], s74 offen nt lds
    v_lshrrev_b32 v253, 1, v1
    v_lshlrev_b32 v253, 10, v253
    v_and_b32 v252, 1, v1
    v_lshl_add_u32 v253, v252, 7, v253
    s_lshl_b32 s68, s4, 2
    s_add_u32 s68, s68, s28
    s_bfe_u32 s66, s68, 65538
    s_xor_b32 s66, s66, 1
    s_lshl_b32 s66, s66, 8
    s_lshl_b32 s68, s68, 13
    s_add_u32 s68, s68, s66
    v_cmp_gt_u32 vcc, 16, v1
    s_nop 1
    v_cndmask_b32 v253, 0x40000000, v253, vcc
    buffer_load_dword v246, v253, s[20:23], s68 offen nt
    v_lshlrev_b32 v252, 13, v1
    v_cmp_gt_u32 vcc, 8, v1
    s_bfe_u32 s68, s2, 131075
    s_lshl_b32 s68, s68, 2
    s_add_u32 s68, s68, s28
    s_lshl_b32 s68, s68, 16
    v_cndmask_b32 v252, 0x40000000, v252, vcc
    buffer_load_dword v247, v252, s[16:19], s68 offen offset:128
    s_add_u32 m0, s29, 32768
    s_mov_b32 s74, 16384
    buffer_load_dwordx4 v32, s[20:23], s74 offen nt lds
    v_xor_b32 v7, v4, v3
    v_lshlrev_b32 v7, 4, v7
    v_lshl_add_u32 v8, v3, 8, v7
    v_xor_b32 v9, 64, v8
    v_xor_b32 v10, 128, v8
    v_xor_b32 v11, 192, v8
    v_lshl_add_u32 v7, v4, 2, v5
    v_and_b32 v244, 7, v7
    v_lshlrev_b32 v244, 5, v244
    v_lshl_add_u32 v244, v7, 8, v244
    v_lshl_add_u32 v244, v6, 3, v244
    v_xor_b32 v12, 0, v244
    v_xor_b32 v13, 32, v244
    v_xor_b32 v14, 64, v244
    v_xor_b32 v15, 96, v244
    v_xor_b32 v16, 128, v244
    v_xor_b32 v17, 160, v244
    v_xor_b32 v18, 192, v244
    v_xor_b32 v19, 224, v244
    v_add_u32 v12, 98304, v12
    v_add_u32 v13, 98304, v13
    v_add_u32 v14, 98304, v14
    v_add_u32 v15, 98304, v15
    v_add_u32 v16, 98304, v16
    v_add_u32 v17, 98304, v17
    v_add_u32 v18, 98304, v18
    v_add_u32 v19, 98304, v19
    v_lshlrev_b32 v7, 12, v2
    v_lshl_add_u32 v7, v4, 8, v7
    v_add_u32 v244, 0, v4
    v_xor_b32 v244, v244, v3
    v_lshl_add_u32 v20, v244, 4, v7
    v_add_u32 v244, 4, v4
    v_xor_b32 v244, v244, v3
    v_lshl_add_u32 v21, v244, 4, v7
    v_add_u32 v244, 8, v4
    v_xor_b32 v244, v244, v3
    v_lshl_add_u32 v22, v244, 4, v7
    v_add_u32 v244, 12, v4
    v_xor_b32 v244, v244, v3
    v_lshl_add_u32 v23, v244, 4, v7
    v_add_u32 v244, 0, v4
    v_lshlrev_b32 v244, 1, v244
    v_xor_b32 v244, v244, v3
    v_lshl_add_u32 v24, v244, 4, v7
    v_add_u32 v244, 4, v4
    v_lshlrev_b32 v244, 1, v244
    v_xor_b32 v244, v244, v3
    v_lshl_add_u32 v25, v244, 4, v7
    v_lshlrev_b32 v7, 19, v2
    v_lshl_add_u32 v26, v1, 4, v7
    v_lshl_add_u32 v7, v4, 3, v5
    v_lshlrev_b32 v7, 7, v7
    v_lshrrev_b32 v244, 1, v5
    v_lshlrev_b32 v244, 2, v244
    v_xor_b32 v244, v244, v6
    v_lshl_add_u32 v7, v244, 4, v7
    v_add_u32 v27, 49152, v7
    v_xor_b32 v7, 64, v7
    v_add_u32 v28, 49152, v7
    v_lshlrev_b32 v7, 12, v2
    v_add_u32 v36, v8, v7
    v_add_u32 v37, v9, v7
    v_add_u32 v38, v10, v7
    v_add_u32 v39, v11, v7
    v_add_u32 v40, 114688, v36
    v_add_u32 v41, 114688, v37
    v_add_u32 v42, 114688, v38
    v_add_u32 v43, 114688, v39
    v_mov_b32 v224, 0x3f803f80
    v_mov_b32 v225, 0x3f803f80
    v_mov_b32 v226, 0x3f803f80
    v_mov_b32 v227, 0x3f803f80
    s_lshl_b32 s66, s6, 4
    s_add_u32 s66, s66, s7
    s_lshl_b32 s66, s66, 19
    s_add_u32 s8, s8, s66
    s_addc_u32 s9, s9, 0
    s_mov_b32 s10, 524288
    s_mov_b32 s11, 0x00020000
    s_add_u32 s12, s12, s66
    s_addc_u32 s13, s13, 0
    s_mov_b32 s14, 524288
    s_mov_b32 s15, 0x00020000
    s_lshl_b32 s66, s5, 3
    s_add_u32 s66, s66, s6
    s_lshl_b32 s66, s66, 21
    s_lshl_b32 s71, s7, 13
    s_add_u32 s66, s66, s71
    s_add_u32 s24, s60, s66
    s_addc_u32 s25, s61, 0
    s_sub_u32 s26, 2097152, s71
    s_mov_b32 s27, 0x00020000
    s_mov_b32 s88, s24
    s_mov_b32 s89, s25
    s_mov_b32 s90, 0
    s_mov_b32 s91, 0x00020000
    s_cmp_eq_u32 s5, 0
    s_cselect_b64 s[80:81], s[44:45], s[54:55]
    s_lshl_b32 s66, s6, 4
    s_add_u32 s66, s66, s7
    s_lshl_b32 s66, s66, 15
    s_add_u32 s80, s80, s66
    s_addc_u32 s81, s81, 0
    s_mov_b32 s82, 32768
    s_mov_b32 s83, 0x00020000
    s_mov_b32 s62, 0x3e0293ee
    s_mov_b32 s63, 0x3e0293ee
    s_mov_b32 s72, 0x5f800000
    s_mov_b32 s70, 0
    s_mov_b32 s73, 16384
    s_cmp_eq_u32 s5, 0
    s_cselect_b64 s[48:49], s[44:45], s[54:55]
    s_bfe_u32 s50, s7, 65539
    s_and_b32 s51, s7, 3
    s_bfe_u32 s52, s7, 65538
    s_lshl_b32 s75, s5, 3
    s_add_u32 s75, s75, s6
    s_lshl_b32 s66, s50, 21
    s_lshl_b32 s67, s51, 8
    s_add_u32 s66, s66, s67
    s_add_u32 s36, s48, s66
    s_addc_u32 s37, s49, 0
    s_sub_u32 s38, 4194304, s66
    s_mov_b32 s39, 0x00020000
    s_lshl_b32 s66, s75, 1
    s_add_u32 s66, s66, s52
    s_lshl_b32 s66, s66, 20
    s_lshl_b32 s67, s50, 16
    s_add_u32 s66, s66, s67
    s_add_u32 s40, s60, s66
    s_addc_u32 s41, s61, 0
    s_sub_u32 s42, 1048576, s67
    s_mov_b32 s43, 0x00020000
    s_lshl_b32 s66, s6, 1
    s_add_u32 s66, s66, s52
    s_lshl_b32 s66, s66, 18
    s_lshl_b32 s67, s5, 10
    s_add_u32 s66, s66, s67
    s_lshl_b32 s67, s51, 8
    s_add_u32 s66, s66, s67
    s_lshl_b32 s3, s50, 7
    s_add_u32 s66, s66, s3
    s_add_u32 s44, s56, s66
    s_addc_u32 s45, s57, 0
    s_sub_u32 s46, 4194304, s66
    s_mov_b32 s47, 0x00020000
    s_lshl_b32 s66, s75, 4
    s_add_u32 s66, s66, s7
    s_xor_b32 s67, s66, 8
    s_lshl_b32 s50, s66, 7
    s_add_u32 s50, s50, 0x3c00000
    s_lshl_b32 s51, s67, 7
    s_add_u32 s51, s51, 0x3c00000
    s_lshl_b32 s66, s66, 15
    s_add_u32 s66, s66, 0x3000000
    s_lshl_b32 s67, s67, 15
    s_add_u32 s67, s67, 0x3000000
    s_add_u32 s52, s60, s67
    s_addc_u32 s53, s61, 0
    s_mov_b32 s54, 32768
    s_mov_b32 s55, 0x00020000
    s_add_u32 s4, s60, s66
    s_addc_u32 s5, s61, 0
    s_mov_b32 s6, 32768
    s_mov_b32 s7, 0x00020000
    s_lshl_b32 s75, s75, 2
    s_mov_b32 s84, 0
    s_mov_b32 s85, 131072
    s_mov_b32 s86, 262144
    s_mov_b32 s87, 393216
    v_mov_b32 v30, s75
    v_mov_b32 v31, s50
    v_mov_b32 v7, 1
    s_mov_b64 exec, 0
    s_cmp_eq_u32 s28, 0
    s_cbranch_scc1 L_hop0
    s_cmp_eq_u32 s28, 1
    s_cbranch_scc1 L_hop1
    s_cmp_eq_u32 s28, 2
    s_cbranch_scc1 L_hop2
    s_branch L_hop3
L_hopret:
    s_mov_b64 exec, -1
    s_add_u32 m0, s29, 33792
    s_mov_b32 s74, 16384
    buffer_load_dwordx4 v33, s[20:23], s74 offen nt lds
    s_add_u32 m0, s29, 34816
    s_nop 0
    buffer_load_dwordx4 v34, s[20:23], s74 offen nt lds
    s_add_u32 m0, s29, 35840
    s_nop 0
    buffer_load_dwordx4 v35, s[20:23], s74 offen nt lds
    s_add_u32 m0, s29, 131072
    s_mov_b32 s74, 32768
    buffer_load_dwordx4 v32, s[20:23], s74 offen nt lds
    s_add_u32 m0, s29, 132096
    s_nop 0
    buffer_load_dwordx4 v33, s[20:23], s74 offen nt lds
    s_add_u32 m0, s29, 133120
    s_nop 0
    buffer_load_dwordx4 v34, s[20:23], s74 offen nt lds
    s_add_u32 m0, s29, 134144
    s_nop 0
    buffer_load_dwordx4 v35, s[20:23], s74 offen nt lds
    s_add_u32 m0, s29, 147456
    s_mov_b32 s74, 49152
    buffer_load_dwordx4 v32, s[20:23], s74 offen nt lds
    s_add_u32 m0, s29, 148480
    s_nop 0
    buffer_load_dwordx4 v33, s[20:23], s74 offen nt lds
    s_add_u32 m0, s29, 149504
    s_nop 0
    buffer_load_dwordx4 v34, s[20:23], s74 offen nt lds
    s_add_u32 m0, s29, 150528
    s_nop 0
    buffer_load_dwordx4 v35, s[20:23], s74 offen nt lds
    s_waitcnt vmcnt(14)
    s_barrier
    ds_read_b64_tr_b16 v[64:65], v27
    ds_read_b64_tr_b16 v[66:67], v27 offset:512
    ds_read_b64_tr_b16 v[68:69], v27 offset:4096
    ds_read_b64_tr_b16 v[70:71], v27 offset:4608
    ds_read_b64_tr_b16 v[72:73], v27 offset:8192
    ds_read_b64_tr_b16 v[74:75], v27 offset:8704
    ds_read_b64_tr_b16 v[76:77], v27 offset:12288
    ds_read_b64_tr_b16 v[78:79], v27 offset:12800
    ds_read_b128 v[96:99], v36 offset:16384
    ds_read_b128 v[100:103], v37 offset:16384
    ds_read_b128 v[104:107], v38 offset:16384
    ds_read_b128 v[108:111], v39 offset:16384
    s_add_u32 m0, s29, 65536
    s_mov_b32 s66, 128
    buffer_load_dwordx4 v29, s[16:19], s66 offen lds
    s_add_u32 m0, s29, 66560
    s_mov_b32 s67, 65664
    buffer_load_dwordx4 v29, s[16:19], s67 offen lds
    s_add_u32 m0, s29, 67584
    s_mov_b32 s66, 131200
    buffer_load_dwordx4 v29, s[16:19], s66 offen lds
    s_waitcnt vmcnt(11)
    s_waitcnt lgkmcnt(4)
    ds_read_b128 v[112:115], v36 offset:32768
    ds_read_b128 v[116:119], v37 offset:32768
    ds_read_b128 v[120:123], v38 offset:32768
    ds_read_b128 v[124:127], v39 offset:32768
    s_add_u32 m0, s29, 68608
    s_mov_b32 s67, 196736
    buffer_load_dwordx4 v29, s[16:19], s67 offen lds
    s_add_u32 m0, s29, 0
    s_mov_b32 s74, 256
    buffer_load_dwordx4 v32, s[20:23], s74 offen nt lds
    s_add_u32 m0, s29, 1024
    s_nop 0
    buffer_load_dwordx4 v33, s[20:23], s74 offen nt lds
    s_waitcnt vmcnt(10)
    ds_read_b128 v[128:131], v40 offset:16384
    ds_read_b128 v[132:135], v41 offset:16384
    ds_read_b128 v[136:139], v42 offset:16384
    ds_read_b128 v[140:143], v43 offset:16384
    s_add_u32 m0, s29, 2048
    s_nop 0
    buffer_load_dwordx4 v34, s[20:23], s74 offen nt lds
    s_add_u32 m0, s29, 3072
    s_nop 0
    buffer_load_dwordx4 v35, s[20:23], s74 offen nt lds
    s_add_u32 m0, s29, 114688
    s_mov_b32 s74, 16640
    buffer_load_dwordx4 v32, s[20:23], s74 offen nt lds
    s_waitcnt vmcnt(9)
    s_waitcnt lgkmcnt(8)
    ds_read_b128 v[144:147], v40 offset:32768
    ds_read_b128 v[148:151], v41 offset:32768
    ds_read_b128 v[152:155], v42 offset:32768
    ds_read_b128 v[156:159], v43 offset:32768
    s_add_u32 m0, s29, 115712
    s_nop 0
    buffer_load_dwordx4 v33, s[20:23], s74 offen nt lds
    s_add_u32 m0, s29, 116736
    s_nop 0
    buffer_load_dwordx4 v34, s[20:23], s74 offen nt lds
    s_add_u32 m0, s29, 117760
    s_nop 0
    buffer_load_dwordx4 v35, s[20:23], s74 offen nt lds
    s_waitcnt lgkmcnt(0)
    v_mfma_f32_16x16x32_bf16 a[0:3], v[64:67], v[96:99], 0
    s_add_u32 m0, s29, 81920
    v_mfma_f32_16x16x32_bf16 a[0:3], v[68:71], v[100:103], a[0:3]
    s_mov_b32 s66, 256
    buffer_load_dwordx4 v29, s[16:19], s66 offen lds
    s_add_u32 m0, s29, 82944
    v_mfma_f32_16x16x32_bf16 a[0:3], v[72:75], v[104:107], a[0:3]
    s_mov_b32 s67, 65792
    buffer_load_dwordx4 v29, s[16:19], s67 offen lds
    s_add_u32 m0, s29, 83968
    v_mfma_f32_16x16x32_bf16 a[0:3], v[76:79], v[108:111], a[0:3]
    s_mov_b32 s66, 131328
    buffer_load_dwordx4 v29, s[16:19], s66 offen lds
    v_mfma_f32_16x16x32_bf16 a[32:35], v[64:67], v[112:115], 0
    ds_read_b64_tr_b16 v[80:81], v27 offset:8
    v_mfma_f32_16x16x32_bf16 a[32:35], v[68:71], v[116:119], a[32:35]
    ds_read_b64_tr_b16 v[82:83], v27 offset:520
    v_mfma_f32_16x16x32_bf16 a[32:35], v[72:75], v[120:123], a[32:35]
    ds_read_b64_tr_b16 v[84:85], v27 offset:4104
    v_mfma_f32_16x16x32_bf16 a[32:35], v[76:79], v[124:127], a[32:35]
    ds_read_b64_tr_b16 v[86:87], v27 offset:4616
    v_mfma_f32_16x16x32_bf16 a[64:67], v[64:67], v[128:131], 0
    ds_read_b64_tr_b16 v[88:89], v27 offset:8200
    v_mfma_f32_16x16x32_bf16 a[64:67], v[68:71], v[132:135], a[64:67]
    ds_read_b64_tr_b16 v[90:91], v27 offset:8712
    v_mfma_f32_16x16x32_bf16 a[64:67], v[72:75], v[136:139], a[64:67]
    ds_read_b64_tr_b16 v[92:93], v27 offset:12296
    v_mfma_f32_16x16x32_bf16 a[64:67], v[76:79], v[140:143], a[64:67]
    ds_read_b64_tr_b16 v[94:95], v27 offset:12808
    s_add_u32 m0, s29, 84992
    v_mfma_f32_16x16x32_bf16 a[96:99], v[64:67], v[144:147], 0
    s_mov_b32 s67, 196864
    buffer_load_dwordx4 v29, s[16:19], s67 offen lds
    s_add_u32 m0, s29, 98304
    v_mfma_f32_16x16x32_bf16 a[96:99], v[68:71], v[148:151], a[96:99]
    s_mov_b32 s66, 384
    buffer_load_dwordx4 v29, s[16:19], s66 offen lds
    s_add_u32 m0, s29, 99328
    v_mfma_f32_16x16x32_bf16 a[96:99], v[72:75], v[152:155], a[96:99]
    s_mov_b32 s67, 65920
    buffer_load_dwordx4 v29, s[16:19], s67 offen lds
    s_add_u32 m0, s29, 100352
    v_mfma_f32_16x16x32_bf16 a[96:99], v[76:79], v[156:159], a[96:99]
    s_waitcnt lgkmcnt(4)
    s_mov_b32 s66, 131456
    buffer_load_dwordx4 v29, s[16:19], s66 offen lds
    s_add_u32 m0, s29, 16384
    v_mfma_f32_16x16x32_bf16 a[4:7], v[80:83], v[96:99], 0
    s_mov_b32 s74, 33024
    buffer_load_dwordx4 v32, s[20:23], s74 offen nt lds
    v_mfma_f32_16x16x32_bf16 a[4:7], v[84:87], v[100:103], a[4:7]
    s_waitcnt lgkmcnt(0)
    s_add_u32 m0, s29, 17408
    v_mfma_f32_16x16x32_bf16 a[4:7], v[88:91], v[104:107], a[4:7]
    buffer_load_dwordx4 v33, s[20:23], s74 offen nt lds
    v_mfma_f32_16x16x32_bf16 a[4:7], v[92:95], v[108:111], a[4:7]
    s_add_u32 m0, s29, 101376
    v_mfma_f32_16x16x32_bf16 a[36:39], v[80:83], v[112:115], 0
    s_mov_b32 s67, 196992
    ds_read_b64_tr_b16 v[64:65], v28
    buffer_load_dwordx4 v29, s[16:19], s67 offen lds
    v_mfma_f32_16x16x32_bf16 a[36:39], v[84:87], v[116:119], a[36:39]
    v_mov_b32 v1, 0
    ds_read_b64_tr_b16 v[66:67], v28 offset:512
    buffer_load_dword v2, v1, s[8:11], 0 offen nt
    v_mfma_f32_16x16x32_bf16 a[36:39], v[88:91], v[120:123], a[36:39]
    ds_read_b64_tr_b16 v[68:69], v28 offset:4096
    buffer_load_dword v3, v1, s[12:15], 0 offen nt
    v_mfma_f32_16x16x32_bf16 a[36:39], v[92:95], v[124:127], a[36:39]
    ds_read_b64_tr_b16 v[70:71], v28 offset:4608
    v_mfma_f32_16x16x32_bf16 a[68:71], v[80:83], v[128:131], 0
    ds_read_b64_tr_b16 v[72:73], v28 offset:8192
    v_mfma_f32_16x16x32_bf16 a[68:71], v[84:87], v[132:135], a[68:71]
    ds_read_b64_tr_b16 v[74:75], v28 offset:8704
    v_mfma_f32_16x16x32_bf16 a[68:71], v[88:91], v[136:139], a[68:71]
    ds_read_b64_tr_b16 v[76:77], v28 offset:12288
    v_mfma_f32_16x16x32_bf16 a[68:71], v[92:95], v[140:143], a[68:71]
    ds_read_b64_tr_b16 v[78:79], v28 offset:12800
    s_add_u32 m0, s29, 18432
    v_mfma_f32_16x16x32_bf16 a[100:103], v[80:83], v[144:147], 0
    buffer_load_dwordx4 v34, s[20:23], s74 offen nt lds
    v_mfma_f32_16x16x32_bf16 a[100:103], v[84:87], v[148:151], a[100:103]
    s_add_u32 m0, s29, 19456
    v_mfma_f32_16x16x32_bf16 a[100:103], v[88:91], v[152:155], a[100:103]
    buffer_load_dwordx4 v35, s[20:23], s74 offen nt lds
    v_mfma_f32_16x16x32_bf16 a[100:103], v[92:95], v[156:159], a[100:103]
    s_waitcnt lgkmcnt(4)
    s_add_u32 m0, s29, 32768
    v_mfma_f32_16x16x32_bf16 a[8:11], v[64:67], v[96:99], 0
    s_mov_b32 s74, 49408
    buffer_load_dwordx4 v32, s[20:23], s74 offen nt lds
    v_mfma_f32_16x16x32_bf16 a[8:11], v[68:71], v[100:103], a[8:11]
    s_waitcnt lgkmcnt(0)
    s_add_u32 m0, s29, 33792
    v_mfma_f32_16x16x32_bf16 a[8:11], v[72:75], v[104:107], a[8:11]
    buffer_load_dwordx4 v33, s[20:23], s74 offen nt lds
    v_mfma_f32_16x16x32_bf16 a[8:11], v[76:79], v[108:111], a[8:11]
    v_mfma_f32_16x16x32_bf16 a[40:43], v[64:67], v[112:115], 0
    ds_read_b64_tr_b16 v[80:81], v28 offset:8
    v_mfma_f32_16x16x32_bf16 a[40:43], v[68:71], v[116:119], a[40:43]
    ds_read_b64_tr_b16 v[82:83], v28 offset:520
    v_mfma_f32_16x16x32_bf16 a[40:43], v[72:75], v[120:123], a[40:43]
    ds_read_b64_tr_b16 v[84:85], v28 offset:4104
    v_mfma_f32_16x16x32_bf16 a[40:43], v[76:79], v[124:127], a[40:43]
    ds_read_b64_tr_b16 v[86:87], v28 offset:4616
    v_mfma_f32_16x16x32_bf16 a[72:75], v[64:67], v[128:131], 0
    ds_read_b64_tr_b16 v[88:89], v28 offset:8200
    v_mfma_f32_16x16x32_bf16 a[72:75], v[68:71], v[132:135], a[72:75]
    ds_read_b64_tr_b16 v[90:91], v28 offset:8712
    v_mfma_f32_16x16x32_bf16 a[72:75], v[72:75], v[136:139], a[72:75]
    ds_read_b64_tr_b16 v[92:93], v28 offset:12296
    v_mfma_f32_16x16x32_bf16 a[72:75], v[76:79], v[140:143], a[72:75]
    ds_read_b64_tr_b16 v[94:95], v28 offset:12808
    s_add_u32 m0, s29, 34816
    v_mfma_f32_16x16x32_bf16 a[104:107], v[64:67], v[144:147], 0
L_hop0:
    s_cbranch_execz L_hop4
    buffer_load_dwordx4 v34, s[20:23], s74 offen nt lds
    v_mfma_f32_16x16x32_bf16 a[104:107], v[68:71], v[148:151], a[104:107]
    s_add_u32 m0, s29, 35840
    v_mfma_f32_16x16x32_bf16 a[104:107], v[72:75], v[152:155], a[104:107]
    buffer_load_dwordx4 v35, s[20:23], s74 offen nt lds
    v_mfma_f32_16x16x32_bf16 a[104:107], v[76:79], v[156:159], a[104:107]
    s_waitcnt lgkmcnt(4)
    v_mfma_f32_16x16x32_bf16 a[12:15], v[80:83], v[96:99], 0
    v_mfma_f32_16x16x32_bf16 a[12:15], v[84:87], v[100:103], a[12:15]
    s_waitcnt lgkmcnt(0)
    v_mfma_f32_16x16x32_bf16 a[12:15], v[88:91], v[104:107], a[12:15]
    v_mfma_f32_16x16x32_bf16 a[12:15], v[92:95], v[108:111], a[12:15]
    s_waitcnt vmcnt(18)
    s_barrier
    v_mfma_f32_16x16x32_bf16 a[44:47], v[80:83], v[112:115], 0
    ds_read_b64_tr_b16 v[64:65], v27 offset:16384
    v_mfma_f32_16x16x32_bf16 a[44:47], v[84:87], v[116:119], a[44:47]
    ds_read_b64_tr_b16 v[66:67], v27 offset:16896
    v_mfma_f32_16x16x32_bf16 a[44:47], v[88:91], v[120:123], a[44:47]
    ds_read_b64_tr_b16 v[68:69], v27 offset:20480
    v_mfma_f32_16x16x32_bf16 a[44:47], v[92:95], v[124:127], a[44:47]
    ds_read_b64_tr_b16 v[70:71], v27 offset:20992
    v_mfma_f32_16x16x32_bf16 a[76:79], v[80:83], v[128:131], 0
    ds_read_b64_tr_b16 v[72:73], v27 offset:24576
    v_mfma_f32_16x16x32_bf16 a[76:79], v[84:87], v[132:135], a[76:79]
    ds_read_b64_tr_b16 v[74:75], v27 offset:25088
    v_mfma_f32_16x16x32_bf16 a[76:79], v[88:91], v[136:139], a[76:79]
    ds_read_b64_tr_b16 v[76:77], v27 offset:28672
    v_mfma_f32_16x16x32_bf16 a[76:79], v[92:95], v[140:143], a[76:79]
    ds_read_b64_tr_b16 v[78:79], v27 offset:29184
    v_mfma_f32_16x16x32_bf16 a[108:111], v[80:83], v[144:147], 0
    v_mfma_f32_16x16x32_bf16 a[108:111], v[84:87], v[148:151], a[108:111]
    v_mfma_f32_16x16x32_bf16 a[108:111], v[88:91], v[152:155], a[108:111]
    v_mfma_f32_16x16x32_bf16 a[108:111], v[92:95], v[156:159], a[108:111]
    s_waitcnt lgkmcnt(4)
    v_mfma_f32_16x16x32_bf16 a[16:19], v[64:67], v[96:99], 0
    ds_read_b128 v[160:163], v36
    v_mfma_f32_16x16x32_bf16 a[16:19], v[68:71], v[100:103], a[16:19]
    s_waitcnt lgkmcnt(1)
    ds_read_b128 v[164:167], v37
    v_mfma_f32_16x16x32_bf16 a[16:19], v[72:75], v[104:107], a[16:19]
    ds_read_b128 v[168:171], v38
    v_mfma_f32_16x16x32_bf16 a[16:19], v[76:79], v[108:111], a[16:19]
    ds_read_b128 v[172:175], v39
    v_mfma_f32_16x16x32_bf16 a[48:51], v[64:67], v[112:115], 0
    ds_read_b64_tr_b16 v[80:81], v27 offset:16392
    v_mfma_f32_16x16x32_bf16 a[48:51], v[68:71], v[116:119], a[48:51]
    ds_read_b64_tr_b16 v[82:83], v27 offset:16904
    v_mfma_f32_16x16x32_bf16 a[48:51], v[72:75], v[120:123], a[48:51]
    ds_read_b64_tr_b16 v[84:85], v27 offset:20488
    v_mfma_f32_16x16x32_bf16 a[48:51], v[76:79], v[124:127], a[48:51]
    ds_read_b64_tr_b16 v[86:87], v27 offset:21000
    v_mfma_f32_16x16x32_bf16 a[80:83], v[64:67], v[128:131], 0
    ds_read_b64_tr_b16 v[88:89], v27 offset:24584
    v_mfma_f32_16x16x32_bf16 a[80:83], v[68:71], v[132:135], a[80:83]
    ds_read_b64_tr_b16 v[90:91], v27 offset:25096
    v_mfma_f32_16x16x32_bf16 a[80:83], v[72:75], v[136:139], a[80:83]
    ds_read_b64_tr_b16 v[92:93], v27 offset:28680
    v_mfma_f32_16x16x32_bf16 a[80:83], v[76:79], v[140:143], a[80:83]
    ds_read_b64_tr_b16 v[94:95], v27 offset:29192
    v_mfma_f32_16x16x32_bf16 a[112:115], v[64:67], v[144:147], 0
    ds_read_b128 v[176:179], v40
    v_mfma_f32_16x16x32_bf16 a[112:115], v[68:71], v[148:151], a[112:115]
    ds_read_b128 v[180:183], v41
    v_mfma_f32_16x16x32_bf16 a[112:115], v[72:75], v[152:155], a[112:115]
    ds_read_b128 v[184:187], v42
    v_mfma_f32_16x16x32_bf16 a[112:115], v[76:79], v[156:159], a[112:115]
    s_waitcnt lgkmcnt(7)
    ds_read_b128 v[188:191], v43
    s_add_u32 m0, s29, 49152
    v_mfma_f32_16x16x32_bf16 a[20:23], v[80:83], v[96:99], 0
    s_mov_b32 s66, 1048576
    buffer_load_dwordx4 v29, s[16:19], s66 offen lds
    v_mfma_f32_16x16x32_bf16 a[20:23], v[84:87], v[100:103], a[20:23]
    s_waitcnt lgkmcnt(4)
    s_add_u32 m0, s29, 50176
    v_mfma_f32_16x16x32_bf16 a[20:23], v[88:91], v[104:107], a[20:23]
    s_mov_b32 s67, 1114112
    buffer_load_dwordx4 v29, s[16:19], s67 offen lds
    v_mfma_f32_16x16x32_bf16 a[20:23], v[92:95], v[108:111], a[20:23]
    v_mfma_f32_16x16x32_bf16 a[52:55], v[80:83], v[112:115], 0
    ds_read_b64_tr_b16 v[64:65], v28 offset:16384
    v_mfma_f32_16x16x32_bf16 a[52:55], v[84:87], v[116:119], a[52:55]
    ds_read_b64_tr_b16 v[66:67], v28 offset:16896
    v_mfma_f32_16x16x32_bf16 a[52:55], v[88:91], v[120:123], a[52:55]
    ds_read_b64_tr_b16 v[68:69], v28 offset:20480
    v_mfma_f32_16x16x32_bf16 a[52:55], v[92:95], v[124:127], a[52:55]
    ds_read_b64_tr_b16 v[70:71], v28 offset:20992
    v_mfma_f32_16x16x32_bf16 a[84:87], v[80:83], v[128:131], 0
    ds_read_b64_tr_b16 v[72:73], v28 offset:24576
    v_mfma_f32_16x16x32_bf16 a[84:87], v[84:87], v[132:135], a[84:87]
    ds_read_b64_tr_b16 v[74:75], v28 offset:25088
    v_mfma_f32_16x16x32_bf16 a[84:87], v[88:91], v[136:139], a[84:87]
    ds_read_b64_tr_b16 v[76:77], v28 offset:28672
    v_mfma_f32_16x16x32_bf16 a[84:87], v[92:95], v[140:143], a[84:87]
    ds_read_b64_tr_b16 v[78:79], v28 offset:29184
    s_add_u32 m0, s29, 51200
    v_mfma_f32_16x16x32_bf16 a[116:119], v[80:83], v[144:147], 0
    s_mov_b32 s66, 1179648
    buffer_load_dwordx4 v29, s[16:19], s66 offen lds
    v_mfma_f32_16x16x32_bf16 a[116:119], v[84:87], v[148:151], a[116:119]
    s_add_u32 m0, s29, 52224
    v_mfma_f32_16x16x32_bf16 a[116:119], v[88:91], v[152:155], a[116:119]
    s_mov_b32 s67, 1245184
    buffer_load_dwordx4 v29, s[16:19], s67 offen lds
    v_mfma_f32_16x16x32_bf16 a[116:119], v[92:95], v[156:159], a[116:119]
    s_waitcnt lgkmcnt(4)
    s_add_u32 m0, s29, 131072
    v_mfma_f32_16x16x32_bf16 a[24:27], v[64:67], v[96:99], 0
    s_mov_b32 s74, 512
    buffer_load_dwordx4 v32, s[20:23], s74 offen nt lds
    v_mfma_f32_16x16x32_bf16 a[24:27], v[68:71], v[100:103], a[24:27]
    s_waitcnt lgkmcnt(0)
    s_add_u32 m0, s29, 132096
    v_mfma_f32_16x16x32_bf16 a[24:27], v[72:75], v[104:107], a[24:27]
    buffer_load_dwordx4 v33, s[20:23], s74 offen nt lds
    v_mfma_f32_16x16x32_bf16 a[24:27], v[76:79], v[108:111], a[24:27]
    v_mfma_f32_16x16x32_bf16 a[56:59], v[64:67], v[112:115], 0
    ds_read_b64_tr_b16 v[80:81], v28 offset:16392
    v_mfma_f32_16x16x32_bf16 a[56:59], v[68:71], v[116:119], a[56:59]
    ds_read_b64_tr_b16 v[82:83], v28 offset:16904
    v_mfma_f32_16x16x32_bf16 a[56:59], v[72:75], v[120:123], a[56:59]
    ds_read_b64_tr_b16 v[84:85], v28 offset:20488
    v_mfma_f32_16x16x32_bf16 a[56:59], v[76:79], v[124:127], a[56:59]
    ds_read_b64_tr_b16 v[86:87], v28 offset:21000
    v_mfma_f32_16x16x32_bf16 a[88:91], v[64:67], v[128:131], 0
    ds_read_b64_tr_b16 v[88:89], v28 offset:24584
    v_mfma_f32_16x16x32_bf16 a[88:91], v[68:71], v[132:135], a[88:91]
    ds_read_b64_tr_b16 v[90:91], v28 offset:25096
    v_mfma_f32_16x16x32_bf16 a[88:91], v[72:75], v[136:139], a[88:91]
    ds_read_b64_tr_b16 v[92:93], v28 offset:28680
    v_mfma_f32_16x16x32_bf16 a[88:91], v[76:79], v[140:143], a[88:91]
    ds_read_b64_tr_b16 v[94:95], v28 offset:29192
    s_add_u32 m0, s29, 133120
    v_mfma_f32_16x16x32_bf16 a[120:123], v[64:67], v[144:147], 0
    buffer_load_dwordx4 v34, s[20:23], s74 offen nt lds
    v_mfma_f32_16x16x32_bf16 a[120:123], v[68:71], v[148:151], a[120:123]
    s_add_u32 m0, s29, 134144
    v_mfma_f32_16x16x32_bf16 a[120:123], v[72:75], v[152:155], a[120:123]
    buffer_load_dwordx4 v35, s[20:23], s74 offen nt lds
    v_mfma_f32_16x16x32_bf16 a[120:123], v[76:79], v[156:159], a[120:123]
    s_waitcnt lgkmcnt(4)
    v_mfma_f32_16x16x32_bf16 a[28:31], v[80:83], v[96:99], 0
    v_mfma_f32_16x16x32_bf16 a[28:31], v[84:87], v[100:103], a[28:31]
    s_waitcnt lgkmcnt(0)
    v_mfma_f32_16x16x32_bf16 a[28:31], v[88:91], v[104:107], a[28:31]
    v_mfma_f32_16x16x32_bf16 a[28:31], v[92:95], v[108:111], a[28:31]
    s_waitcnt vmcnt(12)
    s_barrier
    v_mfma_f32_16x16x32_bf16 a[60:63], v[80:83], v[112:115], 0
    ds_read_b64_tr_b16 v[64:65], v27 offset:32768
    v_mfma_f32_16x16x32_bf16 a[60:63], v[84:87], v[116:119], a[60:63]
    ds_read_b64_tr_b16 v[66:67], v27 offset:33280
    v_mfma_f32_16x16x32_bf16 a[60:63], v[88:91], v[120:123], a[60:63]
    ds_read_b64_tr_b16 v[68:69], v27 offset:36864
    v_mfma_f32_16x16x32_bf16 a[60:63], v[92:95], v[124:127], a[60:63]
    ds_read_b64_tr_b16 v[70:71], v27 offset:37376
    v_mfma_f32_16x16x32_bf16 a[92:95], v[80:83], v[128:131], 0
    ds_read_b64_tr_b16 v[72:73], v27 offset:40960
    v_mfma_f32_16x16x32_bf16 a[92:95], v[84:87], v[132:135], a[92:95]
    ds_read_b64_tr_b16 v[74:75], v27 offset:41472
    v_mfma_f32_16x16x32_bf16 a[92:95], v[88:91], v[136:139], a[92:95]
    ds_read_b64_tr_b16 v[76:77], v27 offset:45056
    v_mfma_f32_16x16x32_bf16 a[92:95], v[92:95], v[140:143], a[92:95]
    ds_read_b64_tr_b16 v[78:79], v27 offset:45568
    v_mfma_f32_16x16x32_bf16 a[124:127], v[80:83], v[144:147], 0
    v_mfma_f32_16x16x32_bf16 a[124:127], v[84:87], v[148:151], a[124:127]
    v_mfma_f32_16x16x32_bf16 a[124:127], v[88:91], v[152:155], a[124:127]
    v_mfma_f32_16x16x32_bf16 a[124:127], v[92:95], v[156:159], a[124:127]
    s_waitcnt lgkmcnt(4)
    v_mfma_f32_16x16x32_bf16 a[128:131], v[64:67], v[96:99], 0
    ds_read_b128 v[192:195], v36 offset:16384
    v_mfma_f32_16x16x32_bf16 a[128:131], v[68:71], v[100:103], a[128:131]
    s_waitcnt lgkmcnt(1)
    ds_read_b128 v[196:199], v37 offset:16384
    v_mfma_f32_16x16x32_bf16 a[128:131], v[72:75], v[104:107], a[128:131]
    ds_read_b128 v[200:203], v38 offset:16384
    v_mfma_f32_16x16x32_bf16 a[128:131], v[76:79], v[108:111], a[128:131]
    ds_read_b128 v[204:207], v39 offset:16384
    v_mfma_f32_16x16x32_bf16 a[160:163], v[64:67], v[112:115], 0
    ds_read_b64_tr_b16 v[80:81], v27 offset:32776
    v_mfma_f32_16x16x32_bf16 a[160:163], v[68:71], v[116:119], a[160:163]
    ds_read_b64_tr_b16 v[82:83], v27 offset:33288
    v_mfma_f32_16x16x32_bf16 a[160:163], v[72:75], v[120:123], a[160:163]
    ds_read_b64_tr_b16 v[84:85], v27 offset:36872
    v_mfma_f32_16x16x32_bf16 a[160:163], v[76:79], v[124:127], a[160:163]
    ds_read_b64_tr_b16 v[86:87], v27 offset:37384
    v_mfma_f32_16x16x32_bf16 a[192:195], v[64:67], v[128:131], 0
    ds_read_b64_tr_b16 v[88:89], v27 offset:40968
    v_mfma_f32_16x16x32_bf16 a[192:195], v[68:71], v[132:135], a[192:195]
    ds_read_b64_tr_b16 v[90:91], v27 offset:41480
    v_mfma_f32_16x16x32_bf16 a[192:195], v[72:75], v[136:139], a[192:195]
    ds_read_b64_tr_b16 v[92:93], v27 offset:45064
    v_mfma_f32_16x16x32_bf16 a[192:195], v[76:79], v[140:143], a[192:195]
    ds_read_b64_tr_b16 v[94:95], v27 offset:45576
    v_mfma_f32_16x16x32_bf16 a[224:227], v[64:67], v[144:147], 0
    v_mfma_f32_16x16x32_bf16 a[224:227], v[68:71], v[148:151], a[224:227]
    v_mfma_f32_16x16x32_bf16 a[224:227], v[72:75], v[152:155], a[224:227]
    v_mfma_f32_16x16x32_bf16 a[224:227], v[76:79], v[156:159], a[224:227]
    s_waitcnt lgkmcnt(4)
    s_add_u32 m0, s29, 65536
    v_mfma_f32_16x16x32_bf16 a[132:135], v[80:83], v[96:99], 0
    s_mov_b32 s66, 1048704
    buffer_load_dwordx4 v29, s[16:19], s66 offen lds
    v_mfma_f32_16x16x32_bf16 a[132:135], v[84:87], v[100:103], a[132:135]
    s_waitcnt lgkmcnt(0)
    s_add_u32 m0, s29, 66560
    v_mfma_f32_16x16x32_bf16 a[132:135], v[88:91], v[104:107], a[132:135]
    s_mov_b32 s67, 1114240
    buffer_load_dwordx4 v29, s[16:19], s67 offen lds
    v_mfma_f32_16x16x32_bf16 a[132:135], v[92:95], v[108:111], a[132:135]
    v_mfma_f32_16x16x32_bf16 a[164:167], v[80:83], v[112:115], 0
    ds_read_b64_tr_b16 v[64:65], v28 offset:32768
    v_mfma_f32_16x16x32_bf16 a[164:167], v[84:87], v[116:119], a[164:167]
    ds_read_b64_tr_b16 v[66:67], v28 offset:33280
    v_mfma_f32_16x16x32_bf16 a[164:167], v[88:91], v[120:123], a[164:167]
    ds_read_b64_tr_b16 v[68:69], v28 offset:36864
    v_mfma_f32_16x16x32_bf16 a[164:167], v[92:95], v[124:127], a[164:167]
    ds_read_b64_tr_b16 v[70:71], v28 offset:37376
    v_mfma_f32_16x16x32_bf16 a[196:199], v[80:83], v[128:131], 0
    ds_read_b64_tr_b16 v[72:73], v28 offset:40960
    v_mfma_f32_16x16x32_bf16 a[196:199], v[84:87], v[132:135], a[196:199]
    ds_read_b64_tr_b16 v[74:75], v28 offset:41472
    v_mfma_f32_16x16x32_bf16 a[196:199], v[88:91], v[136:139], a[196:199]
    ds_read_b64_tr_b16 v[76:77], v28 offset:45056
    v_mfma_f32_16x16x32_bf16 a[196:199], v[92:95], v[140:143], a[196:199]
    ds_read_b64_tr_b16 v[78:79], v28 offset:45568
    s_add_u32 m0, s29, 67584
    v_mfma_f32_16x16x32_bf16 a[228:231], v[80:83], v[144:147], 0
    s_mov_b32 s66, 1179776
    buffer_load_dwordx4 v29, s[16:19], s66 offen lds
    v_mfma_f32_16x16x32_bf16 a[228:231], v[84:87], v[148:151], a[228:231]
    s_add_u32 m0, s29, 68608
    v_mfma_f32_16x16x32_bf16 a[228:231], v[88:91], v[152:155], a[228:231]
    s_mov_b32 s67, 1245312
    buffer_load_dwordx4 v29, s[16:19], s67 offen lds
    v_mfma_f32_16x16x32_bf16 a[228:231], v[92:95], v[156:159], a[228:231]
    s_waitcnt lgkmcnt(4)
    s_add_u32 m0, s29, 147456
    v_mfma_f32_16x16x32_bf16 a[136:139], v[64:67], v[96:99], 0
    s_mov_b32 s74, 16896
    buffer_load_dwordx4 v32, s[20:23], s74 offen nt lds
    v_mfma_f32_16x16x32_bf16 a[136:139], v[68:71], v[100:103], a[136:139]
    s_waitcnt lgkmcnt(0)
    s_add_u32 m0, s29, 148480
    v_mfma_f32_16x16x32_bf16 a[136:139], v[72:75], v[104:107], a[136:139]
    buffer_load_dwordx4 v33, s[20:23], s74 offen nt lds
    v_mfma_f32_16x16x32_bf16 a[136:139], v[76:79], v[108:111], a[136:139]
    v_mfma_f32_16x16x32_bf16 a[168:171], v[64:67], v[112:115], 0
    ds_read_b64_tr_b16 v[80:81], v28 offset:32776
    v_mfma_f32_16x16x32_bf16 a[168:171], v[68:71], v[116:119], a[168:171]
    ds_read_b64_tr_b16 v[82:83], v28 offset:33288
    v_mfma_f32_16x16x32_bf16 a[168:171], v[72:75], v[120:123], a[168:171]
    ds_read_b64_tr_b16 v[84:85], v28 offset:36872
    v_mfma_f32_16x16x32_bf16 a[168:171], v[76:79], v[124:127], a[168:171]
    ds_read_b64_tr_b16 v[86:87], v28 offset:37384
    v_mfma_f32_16x16x32_bf16 a[200:203], v[64:67], v[128:131], 0
    ds_read_b64_tr_b16 v[88:89], v28 offset:40968
    v_mfma_f32_16x16x32_bf16 a[200:203], v[68:71], v[132:135], a[200:203]
    ds_read_b64_tr_b16 v[90:91], v28 offset:41480
    v_mfma_f32_16x16x32_bf16 a[200:203], v[72:75], v[136:139], a[200:203]
    ds_read_b64_tr_b16 v[92:93], v28 offset:45064
    v_mfma_f32_16x16x32_bf16 a[200:203], v[76:79], v[140:143], a[200:203]
    ds_read_b64_tr_b16 v[94:95], v28 offset:45576
    s_add_u32 m0, s29, 149504
    v_mfma_f32_16x16x32_bf16 a[232:235], v[64:67], v[144:147], 0
    buffer_load_dwordx4 v34, s[20:23], s74 offen nt lds
    v_mfma_f32_16x16x32_bf16 a[232:235], v[68:71], v[148:151], a[232:235]
    s_add_u32 m0, s29, 150528
    v_mfma_f32_16x16x32_bf16 a[232:235], v[72:75], v[152:155], a[232:235]
    buffer_load_dwordx4 v35, s[20:23], s74 offen nt lds
    v_mfma_f32_16x16x32_bf16 a[232:235], v[76:79], v[156:159], a[232:235]
    s_waitcnt lgkmcnt(4)
    v_mfma_f32_16x16x32_bf16 a[140:143], v[80:83], v[96:99], 0
    v_mfma_f32_16x16x32_bf16 a[140:143], v[84:87], v[100:103], a[140:143]
    s_waitcnt lgkmcnt(0)
    v_mfma_f32_16x16x32_bf16 a[140:143], v[88:91], v[104:107], a[140:143]
    v_mfma_f32_16x16x32_bf16 a[140:143], v[92:95], v[108:111], a[140:143]
    s_waitcnt vmcnt(16)
    s_barrier
    v_mfma_f32_16x16x32_bf16 a[172:175], v[80:83], v[112:115], 0
    ds_read_b64_tr_b16 v[64:65], v27 offset:49152
    v_mfma_f32_16x16x32_bf16 a[172:175], v[84:87], v[116:119], a[172:175]
    ds_read_b64_tr_b16 v[66:67], v27 offset:49664
    v_mfma_f32_16x16x32_bf16 a[172:175], v[88:91], v[120:123], a[172:175]
    ds_read_b64_tr_b16 v[68:69], v27 offset:53248
    v_mfma_f32_16x16x32_bf16 a[172:175], v[92:95], v[124:127], a[172:175]
    ds_read_b64_tr_b16 v[70:71], v27 offset:53760
    v_mfma_f32_16x16x32_bf16 a[204:207], v[80:83], v[128:131], 0
    ds_read_b64_tr_b16 v[72:73], v27 offset:57344
    v_mfma_f32_16x16x32_bf16 a[204:207], v[84:87], v[132:135], a[204:207]
    ds_read_b64_tr_b16 v[74:75], v27 offset:57856
    v_mfma_f32_16x16x32_bf16 a[204:207], v[88:91], v[136:139], a[204:207]
    ds_read_b64_tr_b16 v[76:77], v27 offset:61440
    v_mfma_f32_16x16x32_bf16 a[204:207], v[92:95], v[140:143], a[204:207]
    ds_read_b64_tr_b16 v[78:79], v27 offset:61952
    v_mfma_f32_16x16x32_bf16 a[236:239], v[80:83], v[144:147], 0
    v_mfma_f32_16x16x32_bf16 a[236:239], v[84:87], v[148:151], a[236:239]
    v_mfma_f32_16x16x32_bf16 a[236:239], v[88:91], v[152:155], a[236:239]
    v_mfma_f32_16x16x32_bf16 a[236:239], v[92:95], v[156:159], a[236:239]
    s_waitcnt lgkmcnt(4)
    v_mfma_f32_16x16x32_bf16 a[144:147], v[64:67], v[96:99], 0
    ds_read_b128 v[208:211], v36 offset:32768
    v_mfma_f32_16x16x32_bf16 a[144:147], v[68:71], v[100:103], a[144:147]
    s_waitcnt lgkmcnt(1)
    ds_read_b128 v[212:215], v37 offset:32768
    v_mfma_f32_16x16x32_bf16 a[144:147], v[72:75], v[104:107], a[144:147]
    ds_read_b128 v[216:219], v38 offset:32768
    v_mfma_f32_16x16x32_bf16 a[144:147], v[76:79], v[108:111], a[144:147]
    ds_read_b128 v[220:223], v39 offset:32768
    v_mfma_f32_16x16x32_bf16 a[176:179], v[64:67], v[112:115], 0
    ds_read_b64_tr_b16 v[80:81], v27 offset:49160
    v_mfma_f32_16x16x32_bf16 a[176:179], v[68:71], v[116:119], a[176:179]
    ds_read_b64_tr_b16 v[82:83], v27 offset:49672
    v_mfma_f32_16x16x32_bf16 a[176:179], v[72:75], v[120:123], a[176:179]
    ds_read_b64_tr_b16 v[84:85], v27 offset:53256
    v_mfma_f32_16x16x32_bf16 a[176:179], v[76:79], v[124:127], a[176:179]
    ds_read_b64_tr_b16 v[86:87], v27 offset:53768
    v_mfma_f32_16x16x32_bf16 a[208:211], v[64:67], v[128:131], 0
    ds_read_b64_tr_b16 v[88:89], v27 offset:57352
    v_mfma_f32_16x16x32_bf16 a[208:211], v[68:71], v[132:135], a[208:211]
    ds_read_b64_tr_b16 v[90:91], v27 offset:57864
    v_mfma_f32_16x16x32_bf16 a[208:211], v[72:75], v[136:139], a[208:211]
    ds_read_b64_tr_b16 v[92:93], v27 offset:61448
    v_mfma_f32_16x16x32_bf16 a[208:211], v[76:79], v[140:143], a[208:211]
    ds_read_b64_tr_b16 v[94:95], v27 offset:61960
    v_mfma_f32_16x16x32_bf16 a[240:243], v[64:67], v[144:147], 0
    v_mfma_f32_16x16x32_bf16 a[240:243], v[68:71], v[148:151], a[240:243]
    v_mfma_f32_16x16x32_bf16 a[240:243], v[72:75], v[152:155], a[240:243]
    v_mfma_f32_16x16x32_bf16 a[240:243], v[76:79], v[156:159], a[240:243]
    s_waitcnt lgkmcnt(4)
    s_add_u32 m0, s29, 81920
    v_mfma_f32_16x16x32_bf16 a[148:151], v[80:83], v[96:99], 0
    s_mov_b32 s66, 1048832
    buffer_load_dwordx4 v29, s[16:19], s66 offen lds
    v_mfma_f32_16x16x32_bf16 a[148:151], v[84:87], v[100:103], a[148:151]
    s_waitcnt lgkmcnt(0)
    s_add_u32 m0, s29, 82944
    v_mfma_f32_16x16x32_bf16 a[148:151], v[88:91], v[104:107], a[148:151]
    s_mov_b32 s67, 1114368
    buffer_load_dwordx4 v29, s[16:19], s67 offen lds
    v_mfma_f32_16x16x32_bf16 a[148:151], v[92:95], v[108:111], a[148:151]
    v_mfma_f32_16x16x32_bf16 a[180:183], v[80:83], v[112:115], 0
    ds_read_b64_tr_b16 v[64:65], v28 offset:49152
    v_mfma_f32_16x16x32_bf16 a[180:183], v[84:87], v[116:119], a[180:183]
    ds_read_b64_tr_b16 v[66:67], v28 offset:49664
    v_mfma_f32_16x16x32_bf16 a[180:183], v[88:91], v[120:123], a[180:183]
    ds_read_b64_tr_b16 v[68:69], v28 offset:53248
    v_mfma_f32_16x16x32_bf16 a[180:183], v[92:95], v[124:127], a[180:183]
    ds_read_b64_tr_b16 v[70:71], v28 offset:53760
    v_mfma_f32_16x16x32_bf16 a[212:215], v[80:83], v[128:131], 0
    ds_read_b64_tr_b16 v[72:73], v28 offset:57344
    v_mfma_f32_16x16x32_bf16 a[212:215], v[84:87], v[132:135], a[212:215]
    ds_read_b64_tr_b16 v[74:75], v28 offset:57856
    v_mfma_f32_16x16x32_bf16 a[212:215], v[88:91], v[136:139], a[212:215]
    ds_read_b64_tr_b16 v[76:77], v28 offset:61440
    v_mfma_f32_16x16x32_bf16 a[212:215], v[92:95], v[140:143], a[212:215]
    ds_read_b64_tr_b16 v[78:79], v28 offset:61952
    s_add_u32 m0, s29, 83968
    v_mfma_f32_16x16x32_bf16 a[244:247], v[80:83], v[144:147], 0
    s_mov_b32 s66, 1179904
    buffer_load_dwordx4 v29, s[16:19], s66 offen lds
    v_mfma_f32_16x16x32_bf16 a[244:247], v[84:87], v[148:151], a[244:247]
    s_add_u32 m0, s29, 84992
    v_mfma_f32_16x16x32_bf16 a[244:247], v[88:91], v[152:155], a[244:247]
    s_mov_b32 s67, 1245440
    buffer_load_dwordx4 v29, s[16:19], s67 offen lds
    v_mfma_f32_16x16x32_bf16 a[244:247], v[92:95], v[156:159], a[244:247]
    s_waitcnt lgkmcnt(4)
    s_add_u32 m0, s29, 0
    v_mfma_f32_16x16x32_bf16 a[152:155], v[64:67], v[96:99], 0
    s_mov_b32 s74, 33280
    buffer_load_dwordx4 v32, s[20:23], s74 offen nt lds
    v_mfma_f32_16x16x32_bf16 a[152:155], v[68:71], v[100:103], a[152:155]
    s_waitcnt lgkmcnt(0)
    s_add_u32 m0, s29, 1024
    v_mfma_f32_16x16x32_bf16 a[152:155], v[72:75], v[104:107], a[152:155]
    buffer_load_dwordx4 v33, s[20:23], s74 offen nt lds
    v_mfma_f32_16x16x32_bf16 a[152:155], v[76:79], v[108:111], a[152:155]
    v_mfma_f32_16x16x32_bf16 a[184:187], v[64:67], v[112:115], 0
    ds_read_b64_tr_b16 v[80:81], v28 offset:49160
    v_mfma_f32_16x16x32_bf16 a[184:187], v[68:71], v[116:119], a[184:187]
    ds_read_b64_tr_b16 v[82:83], v28 offset:49672
    v_mfma_f32_16x16x32_bf16 a[184:187], v[72:75], v[120:123], a[184:187]
    ds_read_b64_tr_b16 v[84:85], v28 offset:53256
    v_mfma_f32_16x16x32_bf16 a[184:187], v[76:79], v[124:127], a[184:187]
    ds_read_b64_tr_b16 v[86:87], v28 offset:53768
    v_mfma_f32_16x16x32_bf16 a[216:219], v[64:67], v[128:131], 0
    ds_read_b64_tr_b16 v[88:89], v28 offset:57352
    v_mfma_f32_16x16x32_bf16 a[216:219], v[68:71], v[132:135], a[216:219]
    ds_read_b64_tr_b16 v[90:91], v28 offset:57864
    v_mfma_f32_16x16x32_bf16 a[216:219], v[72:75], v[136:139], a[216:219]
    ds_read_b64_tr_b16 v[92:93], v28 offset:61448
    v_mfma_f32_16x16x32_bf16 a[216:219], v[76:79], v[140:143], a[216:219]
    ds_read_b64_tr_b16 v[94:95], v28 offset:61960
    s_add_u32 m0, s29, 2048
    v_mfma_f32_16x16x32_bf16 a[248:251], v[64:67], v[144:147], 0
    buffer_load_dwordx4 v34, s[20:23], s74 offen nt lds
    v_mfma_f32_16x16x32_bf16 a[248:251], v[68:71], v[148:151], a[248:251]
    s_add_u32 m0, s29, 3072
    v_mfma_f32_16x16x32_bf16 a[248:251], v[72:75], v[152:155], a[248:251]
    buffer_load_dwordx4 v35, s[20:23], s74 offen nt lds
    v_mfma_f32_16x16x32_bf16 a[248:251], v[76:79], v[156:159], a[248:251]
    s_waitcnt lgkmcnt(4)
    v_mfma_f32_16x16x32_bf16 a[156:159], v[80:83], v[96:99], 0
    v_mfma_f32_16x16x32_bf16 a[156:159], v[84:87], v[100:103], a[156:159]
    s_waitcnt lgkmcnt(0)
    v_mfma_f32_16x16x32_bf16 a[156:159], v[88:91], v[104:107], a[156:159]
    v_mfma_f32_16x16x32_bf16 a[156:159], v[92:95], v[108:111], a[156:159]
    s_waitcnt vmcnt(16)
    s_barrier
    v_mfma_f32_16x16x32_bf16 a[188:191], v[80:83], v[112:115], 0
    ds_read_b64_tr_b16 v[64:65], v27
    v_mfma_f32_16x16x32_bf16 a[188:191], v[84:87], v[116:119], a[188:191]
    ds_read_b64_tr_b16 v[66:67], v27 offset:512
    v_mfma_f32_16x16x32_bf16 a[188:191], v[88:91], v[120:123], a[188:191]
    ds_read_b64_tr_b16 v[68:69], v27 offset:4096
    v_mfma_f32_16x16x32_bf16 a[188:191], v[92:95], v[124:127], a[188:191]
    ds_read_b64_tr_b16 v[70:71], v27 offset:4608
    v_mfma_f32_16x16x32_bf16 a[220:223], v[80:83], v[128:131], 0
    ds_read_b64_tr_b16 v[72:73], v27 offset:8192
    v_mfma_f32_16x16x32_bf16 a[220:223], v[84:87], v[132:135], a[220:223]
    ds_read_b64_tr_b16 v[74:75], v27 offset:8704
    v_mfma_f32_16x16x32_bf16 a[220:223], v[88:91], v[136:139], a[220:223]
    ds_read_b64_tr_b16 v[76:77], v27 offset:12288
    v_mfma_f32_16x16x32_bf16 a[220:223], v[92:95], v[140:143], a[220:223]
    ds_read_b64_tr_b16 v[78:79], v27 offset:12800
    v_mfma_f32_16x16x32_bf16 a[252:255], v[80:83], v[144:147], 0
    v_mfma_f32_16x16x32_bf16 a[252:255], v[84:87], v[148:151], a[252:255]
    v_mfma_f32_16x16x32_bf16 a[252:255], v[88:91], v[152:155], a[252:255]
    v_mfma_f32_16x16x32_bf16 a[252:255], v[92:95], v[156:159], a[252:255]
    s_waitcnt lgkmcnt(4)
    v_mfma_f32_16x16x32_bf16 a[0:3], v[64:67], v[160:163], a[0:3]
    ds_read_b128 v[96:99], v40 offset:16384
    v_mfma_f32_16x16x32_bf16 a[0:3], v[68:71], v[164:167], a[0:3]
    s_waitcnt lgkmcnt(1)
    ds_read_b128 v[100:103], v41 offset:16384
    v_mfma_f32_16x16x32_bf16 a[0:3], v[72:75], v[168:171], a[0:3]
    ds_read_b128 v[104:107], v42 offset:16384
    v_mfma_f32_16x16x32_bf16 a[0:3], v[76:79], v[172:175], a[0:3]
    ds_read_b128 v[108:111], v43 offset:16384
    v_mfma_f32_16x16x32_bf16 a[32:35], v[64:67], v[176:179], a[32:35]
    ds_read_b64_tr_b16 v[80:81], v27 offset:8
    v_mfma_f32_16x16x32_bf16 a[32:35], v[68:71], v[180:183], a[32:35]
    ds_read_b64_tr_b16 v[82:83], v27 offset:520
    v_mfma_f32_16x16x32_bf16 a[32:35], v[72:75], v[184:187], a[32:35]
    ds_read_b64_tr_b16 v[84:85], v27 offset:4104
    v_mfma_f32_16x16x32_bf16 a[32:35], v[76:79], v[188:191], a[32:35]
    ds_read_b64_tr_b16 v[86:87], v27 offset:4616
    v_mfma_f32_16x16x32_bf16 a[64:67], v[64:67], v[192:195], a[64:67]
    ds_read_b64_tr_b16 v[88:89], v27 offset:8200
    v_mfma_f32_16x16x32_bf16 a[64:67], v[68:71], v[196:199], a[64:67]
    ds_read_b64_tr_b16 v[90:91], v27 offset:8712
    v_mfma_f32_16x16x32_bf16 a[64:67], v[72:75], v[200:203], a[64:67]
    ds_read_b64_tr_b16 v[92:93], v27 offset:12296
    v_mfma_f32_16x16x32_bf16 a[64:67], v[76:79], v[204:207], a[64:67]
    ds_read_b64_tr_b16 v[94:95], v27 offset:12808
    v_mfma_f32_16x16x32_bf16 a[96:99], v[64:67], v[208:211], a[96:99]
    v_mfma_f32_16x16x32_bf16 a[96:99], v[68:71], v[212:215], a[96:99]
    v_mfma_f32_16x16x32_bf16 a[96:99], v[72:75], v[216:219], a[96:99]
    v_mfma_f32_16x16x32_bf16 a[96:99], v[76:79], v[220:223], a[96:99]
    s_waitcnt lgkmcnt(4)
    s_add_u32 m0, s29, 98304
    v_mfma_f32_16x16x32_bf16 a[4:7], v[80:83], v[160:163], a[4:7]
    s_mov_b32 s66, 1048960
    buffer_load_dwordx4 v29, s[16:19], s66 offen lds
    v_mfma_f32_16x16x32_bf16 a[4:7], v[84:87], v[164:167], a[4:7]
    s_waitcnt lgkmcnt(0)
    s_add_u32 m0, s29, 99328
    v_mfma_f32_16x16x32_bf16 a[4:7], v[88:91], v[168:171], a[4:7]
    s_mov_b32 s67, 1114496
    buffer_load_dwordx4 v29, s[16:19], s67 offen lds
    v_mfma_f32_16x16x32_bf16 a[4:7], v[92:95], v[172:175], a[4:7]
    v_mfma_f32_16x16x32_bf16 a[36:39], v[80:83], v[176:179], a[36:39]
    ds_read_b64_tr_b16 v[64:65], v28
    v_mfma_f32_16x16x32_bf16 a[36:39], v[84:87], v[180:183], a[36:39]
    ds_read_b64_tr_b16 v[66:67], v28 offset:512
    v_mfma_f32_16x16x32_bf16 a[36:39], v[88:91], v[184:187], a[36:39]
    ds_read_b64_tr_b16 v[68:69], v28 offset:4096
    v_mfma_f32_16x16x32_bf16 a[36:39], v[92:95], v[188:191], a[36:39]
    ds_read_b64_tr_b16 v[70:71], v28 offset:4608
    v_mfma_f32_16x16x32_bf16 a[68:71], v[80:83], v[192:195], a[68:71]
    ds_read_b64_tr_b16 v[72:73], v28 offset:8192
    v_mfma_f32_16x16x32_bf16 a[68:71], v[84:87], v[196:199], a[68:71]
    ds_read_b64_tr_b16 v[74:75], v28 offset:8704
    v_mfma_f32_16x16x32_bf16 a[68:71], v[88:91], v[200:203], a[68:71]
    ds_read_b64_tr_b16 v[76:77], v28 offset:12288
    v_mfma_f32_16x16x32_bf16 a[68:71], v[92:95], v[204:207], a[68:71]
    ds_read_b64_tr_b16 v[78:79], v28 offset:12800
    s_add_u32 m0, s29, 100352
    v_mfma_f32_16x16x32_bf16 a[100:103], v[80:83], v[208:211], a[100:103]
    s_mov_b32 s66, 1180032
    buffer_load_dwordx4 v29, s[16:19], s66 offen lds
    v_mfma_f32_16x16x32_bf16 a[100:103], v[84:87], v[212:215], a[100:103]
    s_add_u32 m0, s29, 101376
    v_mfma_f32_16x16x32_bf16 a[100:103], v[88:91], v[216:219], a[100:103]
    s_mov_b32 s67, 1245568
    buffer_load_dwordx4 v29, s[16:19], s67 offen lds
    v_mfma_f32_16x16x32_bf16 a[100:103], v[92:95], v[220:223], a[100:103]
    s_waitcnt lgkmcnt(4)
    s_add_u32 m0, s29, 114688
    v_mfma_f32_16x16x32_bf16 a[8:11], v[64:67], v[160:163], a[8:11]
    s_mov_b32 s74, 49664
    buffer_load_dwordx4 v32, s[20:23], s74 offen nt lds
    v_mfma_f32_16x16x32_bf16 a[8:11], v[68:71], v[164:167], a[8:11]
    s_waitcnt lgkmcnt(0)
    s_add_u32 m0, s29, 115712
    v_mfma_f32_16x16x32_bf16 a[8:11], v[72:75], v[168:171], a[8:11]
    buffer_load_dwordx4 v33, s[20:23], s74 offen nt lds
    v_mfma_f32_16x16x32_bf16 a[8:11], v[76:79], v[172:175], a[8:11]
    v_mfma_f32_16x16x32_bf16 a[40:43], v[64:67], v[176:179], a[40:43]
    ds_read_b64_tr_b16 v[80:81], v28 offset:8
    v_mfma_f32_16x16x32_bf16 a[40:43], v[68:71], v[180:183], a[40:43]
    ds_read_b64_tr_b16 v[82:83], v28 offset:520
    v_mfma_f32_16x16x32_bf16 a[40:43], v[72:75], v[184:187], a[40:43]
    ds_read_b64_tr_b16 v[84:85], v28 offset:4104
    v_mfma_f32_16x16x32_bf16 a[40:43], v[76:79], v[188:191], a[40:43]
    ds_read_b64_tr_b16 v[86:87], v28 offset:4616
    v_mfma_f32_16x16x32_bf16 a[72:75], v[64:67], v[192:195], a[72:75]
    ds_read_b64_tr_b16 v[88:89], v28 offset:8200
    v_mfma_f32_16x16x32_bf16 a[72:75], v[68:71], v[196:199], a[72:75]
    ds_read_b64_tr_b16 v[90:91], v28 offset:8712
    v_mfma_f32_16x16x32_bf16 a[72:75], v[72:75], v[200:203], a[72:75]
    ds_read_b64_tr_b16 v[92:93], v28 offset:12296
    v_mfma_f32_16x16x32_bf16 a[72:75], v[76:79], v[204:207], a[72:75]
    ds_read_b64_tr_b16 v[94:95], v28 offset:12808
    s_add_u32 m0, s29, 116736
    v_mfma_f32_16x16x32_bf16 a[104:107], v[64:67], v[208:211], a[104:107]
    buffer_load_dwordx4 v34, s[20:23], s74 offen nt lds
    v_mfma_f32_16x16x32_bf16 a[104:107], v[68:71], v[212:215], a[104:107]
L_hop1:
    s_cbranch_execz L_hop5
    s_add_u32 m0, s29, 117760
    v_mfma_f32_16x16x32_bf16 a[104:107], v[72:75], v[216:219], a[104:107]
    buffer_load_dwordx4 v35, s[20:23], s74 offen nt lds
    v_mfma_f32_16x16x32_bf16 a[104:107], v[76:79], v[220:223], a[104:107]
    s_waitcnt lgkmcnt(4)
    v_mfma_f32_16x16x32_bf16 a[12:15], v[80:83], v[160:163], a[12:15]
    v_mfma_f32_16x16x32_bf16 a[12:15], v[84:87], v[164:167], a[12:15]
    s_waitcnt lgkmcnt(0)
    v_mfma_f32_16x16x32_bf16 a[12:15], v[88:91], v[168:171], a[12:15]
    v_mfma_f32_16x16x32_bf16 a[12:15], v[92:95], v[172:175], a[12:15]
    s_waitcnt vmcnt(16)
    s_barrier
    v_mfma_f32_16x16x32_bf16 a[44:47], v[80:83], v[176:179], a[44:47]
    ds_read_b64_tr_b16 v[64:65], v27 offset:16384
    v_mfma_f32_16x16x32_bf16 a[44:47], v[84:87], v[180:183], a[44:47]
    ds_read_b64_tr_b16 v[66:67], v27 offset:16896
    v_mfma_f32_16x16x32_bf16 a[44:47], v[88:91], v[184:187], a[44:47]
    ds_read_b64_tr_b16 v[68:69], v27 offset:20480
    v_mfma_f32_16x16x32_bf16 a[44:47], v[92:95], v[188:191], a[44:47]
    ds_read_b64_tr_b16 v[70:71], v27 offset:20992
    v_mfma_f32_16x16x32_bf16 a[76:79], v[80:83], v[192:195], a[76:79]
    ds_read_b64_tr_b16 v[72:73], v27 offset:24576
    v_mfma_f32_16x16x32_bf16 a[76:79], v[84:87], v[196:199], a[76:79]
    ds_read_b64_tr_b16 v[74:75], v27 offset:25088
    v_mfma_f32_16x16x32_bf16 a[76:79], v[88:91], v[200:203], a[76:79]
    ds_read_b64_tr_b16 v[76:77], v27 offset:28672
    v_mfma_f32_16x16x32_bf16 a[76:79], v[92:95], v[204:207], a[76:79]
    ds_read_b64_tr_b16 v[78:79], v27 offset:29184
    v_mfma_f32_16x16x32_bf16 a[108:111], v[80:83], v[208:211], a[108:111]
    v_mfma_f32_16x16x32_bf16 a[108:111], v[84:87], v[212:215], a[108:111]
    v_mfma_f32_16x16x32_bf16 a[108:111], v[88:91], v[216:219], a[108:111]
    v_mfma_f32_16x16x32_bf16 a[108:111], v[92:95], v[220:223], a[108:111]
    s_waitcnt lgkmcnt(4)
    v_mfma_f32_16x16x32_bf16 a[16:19], v[64:67], v[160:163], a[16:19]
    ds_read_b128 v[112:115], v40 offset:32768
    v_mfma_f32_16x16x32_bf16 a[16:19], v[68:71], v[164:167], a[16:19]
    s_waitcnt lgkmcnt(1)
    ds_read_b128 v[116:119], v41 offset:32768
    v_mfma_f32_16x16x32_bf16 a[16:19], v[72:75], v[168:171], a[16:19]
    ds_read_b128 v[120:123], v42 offset:32768
    v_mfma_f32_16x16x32_bf16 a[16:19], v[76:79], v[172:175], a[16:19]
    ds_read_b128 v[124:127], v43 offset:32768
    v_mfma_f32_16x16x32_bf16 a[48:51], v[64:67], v[176:179], a[48:51]
    ds_read_b64_tr_b16 v[80:81], v27 offset:16392
    v_mfma_f32_16x16x32_bf16 a[48:51], v[68:71], v[180:183], a[48:51]
    ds_read_b64_tr_b16 v[82:83], v27 offset:16904
    v_mfma_f32_16x16x32_bf16 a[48:51], v[72:75], v[184:187], a[48:51]
    ds_read_b64_tr_b16 v[84:85], v27 offset:20488
    v_mfma_f32_16x16x32_bf16 a[48:51], v[76:79], v[188:191], a[48:51]
    ds_read_b64_tr_b16 v[86:87], v27 offset:21000
    v_mfma_f32_16x16x32_bf16 a[80:83], v[64:67], v[192:195], a[80:83]
    ds_read_b64_tr_b16 v[88:89], v27 offset:24584
    v_mfma_f32_16x16x32_bf16 a[80:83], v[68:71], v[196:199], a[80:83]
    ds_read_b64_tr_b16 v[90:91], v27 offset:25096
    v_mfma_f32_16x16x32_bf16 a[80:83], v[72:75], v[200:203], a[80:83]
    ds_read_b64_tr_b16 v[92:93], v27 offset:28680
    v_mfma_f32_16x16x32_bf16 a[80:83], v[76:79], v[204:207], a[80:83]
    ds_read_b64_tr_b16 v[94:95], v27 offset:29192
    v_mfma_f32_16x16x32_bf16 a[112:115], v[64:67], v[208:211], a[112:115]
    v_mfma_f32_16x16x32_bf16 a[112:115], v[68:71], v[212:215], a[112:115]
    v_mfma_f32_16x16x32_bf16 a[112:115], v[72:75], v[216:219], a[112:115]
    v_mfma_f32_16x16x32_bf16 a[112:115], v[76:79], v[220:223], a[112:115]
    s_waitcnt lgkmcnt(4)
    s_add_u32 m0, s29, 49152
    v_mfma_f32_16x16x32_bf16 a[20:23], v[80:83], v[160:163], a[20:23]
    s_mov_b32 s66, 2097408
    buffer_load_dwordx4 v29, s[16:19], s66 offen lds
    v_mfma_f32_16x16x32_bf16 a[20:23], v[84:87], v[164:167], a[20:23]
    s_waitcnt lgkmcnt(0)
    s_add_u32 m0, s29, 50176
    v_mfma_f32_16x16x32_bf16 a[20:23], v[88:91], v[168:171], a[20:23]
    s_mov_b32 s67, 2162944
    buffer_load_dwordx4 v29, s[16:19], s67 offen lds
    v_mfma_f32_16x16x32_bf16 a[20:23], v[92:95], v[172:175], a[20:23]
    v_mfma_f32_16x16x32_bf16 a[52:55], v[80:83], v[176:179], a[52:55]
    ds_read_b64_tr_b16 v[64:65], v28 offset:16384
    v_mfma_f32_16x16x32_bf16 a[52:55], v[84:87], v[180:183], a[52:55]
    ds_read_b64_tr_b16 v[66:67], v28 offset:16896
    v_mfma_f32_16x16x32_bf16 a[52:55], v[88:91], v[184:187], a[52:55]
    ds_read_b64_tr_b16 v[68:69], v28 offset:20480
    v_mfma_f32_16x16x32_bf16 a[52:55], v[92:95], v[188:191], a[52:55]
    ds_read_b64_tr_b16 v[70:71], v28 offset:20992
    v_mfma_f32_16x16x32_bf16 a[84:87], v[80:83], v[192:195], a[84:87]
    ds_read_b64_tr_b16 v[72:73], v28 offset:24576
    v_mfma_f32_16x16x32_bf16 a[84:87], v[84:87], v[196:199], a[84:87]
    ds_read_b64_tr_b16 v[74:75], v28 offset:25088
    v_mfma_f32_16x16x32_bf16 a[84:87], v[88:91], v[200:203], a[84:87]
    ds_read_b64_tr_b16 v[76:77], v28 offset:28672
    v_mfma_f32_16x16x32_bf16 a[84:87], v[92:95], v[204:207], a[84:87]
    ds_read_b64_tr_b16 v[78:79], v28 offset:29184
    s_add_u32 m0, s29, 51200
    v_mfma_f32_16x16x32_bf16 a[116:119], v[80:83], v[208:211], a[116:119]
    s_mov_b32 s66, 2228480
    buffer_load_dwordx4 v29, s[16:19], s66 offen lds
    v_mfma_f32_16x16x32_bf16 a[116:119], v[84:87], v[212:215], a[116:119]
    s_add_u32 m0, s29, 52224
    v_mfma_f32_16x16x32_bf16 a[116:119], v[88:91], v[216:219], a[116:119]
    s_mov_b32 s67, 2294016
    buffer_load_dwordx4 v29, s[16:19], s67 offen lds
    v_mfma_f32_16x16x32_bf16 a[116:119], v[92:95], v[220:223], a[116:119]
    s_waitcnt lgkmcnt(4)
    s_add_u32 m0, s29, 16384
    v_mfma_f32_16x16x32_bf16 a[24:27], v[64:67], v[160:163], a[24:27]
    s_mov_b32 s74, 768
    buffer_load_dwordx4 v32, s[20:23], s74 offen nt lds
    v_mfma_f32_16x16x32_bf16 a[24:27], v[68:71], v[164:167], a[24:27]
    s_waitcnt lgkmcnt(0)
    s_add_u32 m0, s29, 17408
    v_mfma_f32_16x16x32_bf16 a[24:27], v[72:75], v[168:171], a[24:27]
    buffer_load_dwordx4 v33, s[20:23], s74 offen nt lds
    v_mfma_f32_16x16x32_bf16 a[24:27], v[76:79], v[172:175], a[24:27]
    v_mfma_f32_16x16x32_bf16 a[56:59], v[64:67], v[176:179], a[56:59]
    ds_read_b64_tr_b16 v[80:81], v28 offset:16392
    v_mfma_f32_16x16x32_bf16 a[56:59], v[68:71], v[180:183], a[56:59]
    ds_read_b64_tr_b16 v[82:83], v28 offset:16904
    v_mfma_f32_16x16x32_bf16 a[56:59], v[72:75], v[184:187], a[56:59]
    ds_read_b64_tr_b16 v[84:85], v28 offset:20488
    v_mfma_f32_16x16x32_bf16 a[56:59], v[76:79], v[188:191], a[56:59]
    ds_read_b64_tr_b16 v[86:87], v28 offset:21000
    v_mfma_f32_16x16x32_bf16 a[88:91], v[64:67], v[192:195], a[88:91]
    ds_read_b64_tr_b16 v[88:89], v28 offset:24584
    v_mfma_f32_16x16x32_bf16 a[88:91], v[68:71], v[196:199], a[88:91]
    ds_read_b64_tr_b16 v[90:91], v28 offset:25096
    v_mfma_f32_16x16x32_bf16 a[88:91], v[72:75], v[200:203], a[88:91]
    ds_read_b64_tr_b16 v[92:93], v28 offset:28680
    v_mfma_f32_16x16x32_bf16 a[88:91], v[76:79], v[204:207], a[88:91]
    ds_read_b64_tr_b16 v[94:95], v28 offset:29192
    s_add_u32 m0, s29, 18432
    v_mfma_f32_16x16x32_bf16 a[120:123], v[64:67], v[208:211], a[120:123]
    buffer_load_dwordx4 v34, s[20:23], s74 offen nt lds
    v_mfma_f32_16x16x32_bf16 a[120:123], v[68:71], v[212:215], a[120:123]
    s_add_u32 m0, s29, 19456
    v_mfma_f32_16x16x32_bf16 a[120:123], v[72:75], v[216:219], a[120:123]
    buffer_load_dwordx4 v35, s[20:23], s74 offen nt lds
    v_mfma_f32_16x16x32_bf16 a[120:123], v[76:79], v[220:223], a[120:123]
    s_waitcnt lgkmcnt(4)
    s_add_u32 m0, s29, 32768
    v_mfma_f32_16x16x32_bf16 a[28:31], v[80:83], v[160:163], a[28:31]
    s_mov_b32 s74, 17152
    buffer_load_dwordx4 v32, s[20:23], s74 offen nt lds
    v_mfma_f32_16x16x32_bf16 a[28:31], v[84:87], v[164:167], a[28:31]
    s_waitcnt lgkmcnt(0)
    s_add_u32 m0, s29, 33792
    v_mfma_f32_16x16x32_bf16 a[28:31], v[88:91], v[168:171], a[28:31]
    buffer_load_dwordx4 v33, s[20:23], s74 offen nt lds
    v_mfma_f32_16x16x32_bf16 a[28:31], v[92:95], v[172:175], a[28:31]
    s_waitcnt vmcnt(18)
    s_barrier
    v_mfma_f32_16x16x32_bf16 a[60:63], v[80:83], v[176:179], a[60:63]
    ds_read_b64_tr_b16 v[64:65], v27 offset:32768
    v_mfma_f32_16x16x32_bf16 a[60:63], v[84:87], v[180:183], a[60:63]
    ds_read_b64_tr_b16 v[66:67], v27 offset:33280
    v_mfma_f32_16x16x32_bf16 a[60:63], v[88:91], v[184:187], a[60:63]
    ds_read_b64_tr_b16 v[68:69], v27 offset:36864
    v_mfma_f32_16x16x32_bf16 a[60:63], v[92:95], v[188:191], a[60:63]
    ds_read_b64_tr_b16 v[70:71], v27 offset:37376
    v_mfma_f32_16x16x32_bf16 a[92:95], v[80:83], v[192:195], a[92:95]
    ds_read_b64_tr_b16 v[72:73], v27 offset:40960
    v_mfma_f32_16x16x32_bf16 a[92:95], v[84:87], v[196:199], a[92:95]
    ds_read_b64_tr_b16 v[74:75], v27 offset:41472
    v_mfma_f32_16x16x32_bf16 a[92:95], v[88:91], v[200:203], a[92:95]
    ds_read_b64_tr_b16 v[76:77], v27 offset:45056
    v_mfma_f32_16x16x32_bf16 a[92:95], v[92:95], v[204:207], a[92:95]
    ds_read_b64_tr_b16 v[78:79], v27 offset:45568
    s_add_u32 m0, s29, 34816
    v_mfma_f32_16x16x32_bf16 a[124:127], v[80:83], v[208:211], a[124:127]
    buffer_load_dwordx4 v34, s[20:23], s74 offen nt lds
    v_mfma_f32_16x16x32_bf16 a[124:127], v[84:87], v[212:215], a[124:127]
    s_add_u32 m0, s29, 35840
    v_mfma_f32_16x16x32_bf16 a[124:127], v[88:91], v[216:219], a[124:127]
    buffer_load_dwordx4 v35, s[20:23], s74 offen nt lds
    v_mfma_f32_16x16x32_bf16 a[124:127], v[92:95], v[220:223], a[124:127]
    s_waitcnt lgkmcnt(4)
    v_mfma_f32_16x16x32_bf16 a[128:131], v[64:67], v[160:163], a[128:131]
    ds_read_b128 v[128:131], v36
    v_mfma_f32_16x16x32_bf16 a[128:131], v[68:71], v[164:167], a[128:131]
    s_waitcnt lgkmcnt(1)
    ds_read_b128 v[132:135], v37
    v_mfma_f32_16x16x32_bf16 a[128:131], v[72:75], v[168:171], a[128:131]
    ds_read_b128 v[136:139], v38
    v_mfma_f32_16x16x32_bf16 a[128:131], v[76:79], v[172:175], a[128:131]
    ds_read_b128 v[140:143], v39
    v_mfma_f32_16x16x32_bf16 a[160:163], v[64:67], v[176:179], a[160:163]
    ds_read_b64_tr_b16 v[80:81], v27 offset:32776
    v_mfma_f32_16x16x32_bf16 a[160:163], v[68:71], v[180:183], a[160:163]
    ds_read_b64_tr_b16 v[82:83], v27 offset:33288
    v_mfma_f32_16x16x32_bf16 a[160:163], v[72:75], v[184:187], a[160:163]
    ds_read_b64_tr_b16 v[84:85], v27 offset:36872
    v_mfma_f32_16x16x32_bf16 a[160:163], v[76:79], v[188:191], a[160:163]
    ds_read_b64_tr_b16 v[86:87], v27 offset:37384
    v_mfma_f32_16x16x32_bf16 a[192:195], v[64:67], v[192:195], a[192:195]
    ds_read_b64_tr_b16 v[88:89], v27 offset:40968
    v_mfma_f32_16x16x32_bf16 a[192:195], v[68:71], v[196:199], a[192:195]
    ds_read_b64_tr_b16 v[90:91], v27 offset:41480
    v_mfma_f32_16x16x32_bf16 a[192:195], v[72:75], v[200:203], a[192:195]
    ds_read_b64_tr_b16 v[92:93], v27 offset:45064
    v_mfma_f32_16x16x32_bf16 a[192:195], v[76:79], v[204:207], a[192:195]
    ds_read_b64_tr_b16 v[94:95], v27 offset:45576
    v_mfma_f32_16x16x32_bf16 a[224:227], v[64:67], v[208:211], a[224:227]
    v_mfma_f32_16x16x32_bf16 a[224:227], v[68:71], v[212:215], a[224:227]
    v_mfma_f32_16x16x32_bf16 a[224:227], v[72:75], v[216:219], a[224:227]
    v_mfma_f32_16x16x32_bf16 a[224:227], v[76:79], v[220:223], a[224:227]
    s_waitcnt lgkmcnt(4)
    s_add_u32 m0, s29, 65536
    v_mfma_f32_16x16x32_bf16 a[132:135], v[80:83], v[160:163], a[132:135]
    s_mov_b32 s66, 2097536
    buffer_load_dwordx4 v29, s[16:19], s66 offen lds
    v_mfma_f32_16x16x32_bf16 a[132:135], v[84:87], v[164:167], a[132:135]
    s_waitcnt lgkmcnt(0)
    s_add_u32 m0, s29, 66560
    v_mfma_f32_16x16x32_bf16 a[132:135], v[88:91], v[168:171], a[132:135]
    s_mov_b32 s67, 2163072
    buffer_load_dwordx4 v29, s[16:19], s67 offen lds
    v_mfma_f32_16x16x32_bf16 a[132:135], v[92:95], v[172:175], a[132:135]
    v_mfma_f32_16x16x32_bf16 a[164:167], v[80:83], v[176:179], a[164:167]
    ds_read_b64_tr_b16 v[64:65], v28 offset:32768
    v_mfma_f32_16x16x32_bf16 a[164:167], v[84:87], v[180:183], a[164:167]
    ds_read_b64_tr_b16 v[66:67], v28 offset:33280
    v_mfma_f32_16x16x32_bf16 a[164:167], v[88:91], v[184:187], a[164:167]
    ds_read_b64_tr_b16 v[68:69], v28 offset:36864
    v_mfma_f32_16x16x32_bf16 a[164:167], v[92:95], v[188:191], a[164:167]
    ds_read_b64_tr_b16 v[70:71], v28 offset:37376
    v_mfma_f32_16x16x32_bf16 a[196:199], v[80:83], v[192:195], a[196:199]
    ds_read_b64_tr_b16 v[72:73], v28 offset:40960
    v_mfma_f32_16x16x32_bf16 a[196:199], v[84:87], v[196:199], a[196:199]
    ds_read_b64_tr_b16 v[74:75], v28 offset:41472
    v_mfma_f32_16x16x32_bf16 a[196:199], v[88:91], v[200:203], a[196:199]
    ds_read_b64_tr_b16 v[76:77], v28 offset:45056
    v_mfma_f32_16x16x32_bf16 a[196:199], v[92:95], v[204:207], a[196:199]
    ds_read_b64_tr_b16 v[78:79], v28 offset:45568
    s_add_u32 m0, s29, 67584
    v_mfma_f32_16x16x32_bf16 a[228:231], v[80:83], v[208:211], a[228:231]
    s_mov_b32 s66, 2228608
    buffer_load_dwordx4 v29, s[16:19], s66 offen lds
    v_mfma_f32_16x16x32_bf16 a[228:231], v[84:87], v[212:215], a[228:231]
    s_add_u32 m0, s29, 68608
    v_mfma_f32_16x16x32_bf16 a[228:231], v[88:91], v[216:219], a[228:231]
    s_mov_b32 s67, 2294144
    buffer_load_dwordx4 v29, s[16:19], s67 offen lds
    v_mfma_f32_16x16x32_bf16 a[228:231], v[92:95], v[220:223], a[228:231]
    s_waitcnt lgkmcnt(4)
    s_add_u32 m0, s29, 131072
    v_mfma_f32_16x16x32_bf16 a[136:139], v[64:67], v[160:163], a[136:139]
    s_mov_b32 s74, 33536
    buffer_load_dwordx4 v32, s[20:23], s74 offen nt lds
    v_mfma_f32_16x16x32_bf16 a[136:139], v[68:71], v[164:167], a[136:139]
    s_waitcnt lgkmcnt(0)
    s_add_u32 m0, s29, 132096
    v_mfma_f32_16x16x32_bf16 a[136:139], v[72:75], v[168:171], a[136:139]
    buffer_load_dwordx4 v33, s[20:23], s74 offen nt lds
    v_mfma_f32_16x16x32_bf16 a[136:139], v[76:79], v[172:175], a[136:139]
    v_mfma_f32_16x16x32_bf16 a[168:171], v[64:67], v[176:179], a[168:171]
    ds_read_b64_tr_b16 v[80:81], v28 offset:32776
    v_mfma_f32_16x16x32_bf16 a[168:171], v[68:71], v[180:183], a[168:171]
    ds_read_b64_tr_b16 v[82:83], v28 offset:33288
    v_mfma_f32_16x16x32_bf16 a[168:171], v[72:75], v[184:187], a[168:171]
    ds_read_b64_tr_b16 v[84:85], v28 offset:36872
    v_mfma_f32_16x16x32_bf16 a[168:171], v[76:79], v[188:191], a[168:171]
    ds_read_b64_tr_b16 v[86:87], v28 offset:37384
    v_mfma_f32_16x16x32_bf16 a[200:203], v[64:67], v[192:195], a[200:203]
    ds_read_b64_tr_b16 v[88:89], v28 offset:40968
    v_mfma_f32_16x16x32_bf16 a[200:203], v[68:71], v[196:199], a[200:203]
    ds_read_b64_tr_b16 v[90:91], v28 offset:41480
    v_mfma_f32_16x16x32_bf16 a[200:203], v[72:75], v[200:203], a[200:203]
    ds_read_b64_tr_b16 v[92:93], v28 offset:45064
    v_mfma_f32_16x16x32_bf16 a[200:203], v[76:79], v[204:207], a[200:203]
    ds_read_b64_tr_b16 v[94:95], v28 offset:45576
    s_add_u32 m0, s29, 133120
    v_mfma_f32_16x16x32_bf16 a[232:235], v[64:67], v[208:211], a[232:235]
    buffer_load_dwordx4 v34, s[20:23], s74 offen nt lds
    v_mfma_f32_16x16x32_bf16 a[232:235], v[68:71], v[212:215], a[232:235]
    s_add_u32 m0, s29, 134144
    v_mfma_f32_16x16x32_bf16 a[232:235], v[72:75], v[216:219], a[232:235]
    buffer_load_dwordx4 v35, s[20:23], s74 offen nt lds
    v_mfma_f32_16x16x32_bf16 a[232:235], v[76:79], v[220:223], a[232:235]
    s_waitcnt lgkmcnt(4)
    v_mfma_f32_16x16x32_bf16 a[140:143], v[80:83], v[160:163], a[140:143]
    v_mfma_f32_16x16x32_bf16 a[140:143], v[84:87], v[164:167], a[140:143]
    s_waitcnt lgkmcnt(0)
    v_mfma_f32_16x16x32_bf16 a[140:143], v[88:91], v[168:171], a[140:143]
    v_mfma_f32_16x16x32_bf16 a[140:143], v[92:95], v[172:175], a[140:143]
    s_waitcnt vmcnt(20)
    s_barrier
    v_mfma_f32_16x16x32_bf16 a[172:175], v[80:83], v[176:179], a[172:175]
    ds_read_b64_tr_b16 v[64:65], v27 offset:49152
    v_mfma_f32_16x16x32_bf16 a[172:175], v[84:87], v[180:183], a[172:175]
    ds_read_b64_tr_b16 v[66:67], v27 offset:49664
    v_mfma_f32_16x16x32_bf16 a[172:175], v[88:91], v[184:187], a[172:175]
    ds_read_b64_tr_b16 v[68:69], v27 offset:53248
    v_mfma_f32_16x16x32_bf16 a[172:175], v[92:95], v[188:191], a[172:175]
    ds_read_b64_tr_b16 v[70:71], v27 offset:53760
    v_mfma_f32_16x16x32_bf16 a[204:207], v[80:83], v[192:195], a[204:207]
    ds_read_b64_tr_b16 v[72:73], v27 offset:57344
    v_mfma_f32_16x16x32_bf16 a[204:207], v[84:87], v[196:199], a[204:207]
    ds_read_b64_tr_b16 v[74:75], v27 offset:57856
    v_mfma_f32_16x16x32_bf16 a[204:207], v[88:91], v[200:203], a[204:207]
    ds_read_b64_tr_b16 v[76:77], v27 offset:61440
    v_mfma_f32_16x16x32_bf16 a[204:207], v[92:95], v[204:207], a[204:207]
    ds_read_b64_tr_b16 v[78:79], v27 offset:61952
    v_mfma_f32_16x16x32_bf16 a[236:239], v[80:83], v[208:211], a[236:239]
    v_mfma_f32_16x16x32_bf16 a[236:239], v[84:87], v[212:215], a[236:239]
    v_mfma_f32_16x16x32_bf16 a[236:239], v[88:91], v[216:219], a[236:239]
    v_mfma_f32_16x16x32_bf16 a[236:239], v[92:95], v[220:223], a[236:239]
    s_waitcnt lgkmcnt(4)
    v_mfma_f32_16x16x32_bf16 a[144:147], v[64:67], v[160:163], a[144:147]
    ds_read_b128 v[144:147], v40
    v_mfma_f32_16x16x32_bf16 a[144:147], v[68:71], v[164:167], a[144:147]
    s_waitcnt lgkmcnt(1)
    ds_read_b128 v[148:151], v41
    v_mfma_f32_16x16x32_bf16 a[144:147], v[72:75], v[168:171], a[144:147]
    ds_read_b128 v[152:155], v42
    v_mfma_f32_16x16x32_bf16 a[144:147], v[76:79], v[172:175], a[144:147]
    ds_read_b128 v[156:159], v43
    v_mfma_f32_16x16x32_bf16 a[176:179], v[64:67], v[176:179], a[176:179]
    ds_read_b64_tr_b16 v[80:81], v27 offset:49160
    v_mfma_f32_16x16x32_bf16 a[176:179], v[68:71], v[180:183], a[176:179]
    ds_read_b64_tr_b16 v[82:83], v27 offset:49672
    v_mfma_f32_16x16x32_bf16 a[176:179], v[72:75], v[184:187], a[176:179]
    ds_read_b64_tr_b16 v[84:85], v27 offset:53256
    v_mfma_f32_16x16x32_bf16 a[176:179], v[76:79], v[188:191], a[176:179]
    ds_read_b64_tr_b16 v[86:87], v27 offset:53768
    v_mfma_f32_16x16x32_bf16 a[208:211], v[64:67], v[192:195], a[208:211]
    ds_read_b64_tr_b16 v[88:89], v27 offset:57352
    v_mfma_f32_16x16x32_bf16 a[208:211], v[68:71], v[196:199], a[208:211]
    ds_read_b64_tr_b16 v[90:91], v27 offset:57864
    v_mfma_f32_16x16x32_bf16 a[208:211], v[72:75], v[200:203], a[208:211]
    ds_read_b64_tr_b16 v[92:93], v27 offset:61448
    v_mfma_f32_16x16x32_bf16 a[208:211], v[76:79], v[204:207], a[208:211]
    ds_read_b64_tr_b16 v[94:95], v27 offset:61960
    v_mfma_f32_16x16x32_bf16 a[240:243], v[64:67], v[208:211], a[240:243]
    v_mfma_f32_16x16x32_bf16 a[240:243], v[68:71], v[212:215], a[240:243]
    v_mfma_f32_16x16x32_bf16 a[240:243], v[72:75], v[216:219], a[240:243]
    v_mfma_f32_16x16x32_bf16 a[240:243], v[76:79], v[220:223], a[240:243]
    s_waitcnt lgkmcnt(4)
    s_add_u32 m0, s29, 81920
    v_mfma_f32_16x16x32_bf16 a[148:151], v[80:83], v[160:163], a[148:151]
    s_mov_b32 s66, 3145984
    buffer_load_dwordx4 v29, s[16:19], s66 offen lds
    v_mfma_f32_16x16x32_bf16 a[148:151], v[84:87], v[164:167], a[148:151]
    s_waitcnt lgkmcnt(0)
    s_add_u32 m0, s29, 82944
    v_mfma_f32_16x16x32_bf16 a[148:151], v[88:91], v[168:171], a[148:151]
    s_mov_b32 s67, 3211520
    buffer_load_dwordx4 v29, s[16:19], s67 offen lds
    v_mfma_f32_16x16x32_bf16 a[148:151], v[92:95], v[172:175], a[148:151]
    v_mfma_f32_16x16x32_bf16 a[180:183], v[80:83], v[176:179], a[180:183]
    ds_read_b64_tr_b16 v[64:65], v28 offset:49152
    v_mfma_f32_16x16x32_bf16 a[180:183], v[84:87], v[180:183], a[180:183]
    ds_read_b64_tr_b16 v[66:67], v28 offset:49664
    v_mfma_f32_16x16x32_bf16 a[180:183], v[88:91], v[184:187], a[180:183]
    ds_read_b64_tr_b16 v[68:69], v28 offset:53248
    v_mfma_f32_16x16x32_bf16 a[180:183], v[92:95], v[188:191], a[180:183]
    ds_read_b64_tr_b16 v[70:71], v28 offset:53760
    v_mfma_f32_16x16x32_bf16 a[212:215], v[80:83], v[192:195], a[212:215]
    ds_read_b64_tr_b16 v[72:73], v28 offset:57344
    v_mfma_f32_16x16x32_bf16 a[212:215], v[84:87], v[196:199], a[212:215]
    ds_read_b64_tr_b16 v[74:75], v28 offset:57856
    v_mfma_f32_16x16x32_bf16 a[212:215], v[88:91], v[200:203], a[212:215]
    ds_read_b64_tr_b16 v[76:77], v28 offset:61440
    v_mfma_f32_16x16x32_bf16 a[212:215], v[92:95], v[204:207], a[212:215]
    ds_read_b64_tr_b16 v[78:79], v28 offset:61952
    s_add_u32 m0, s29, 83968
    v_mfma_f32_16x16x32_bf16 a[244:247], v[80:83], v[208:211], a[244:247]
    s_mov_b32 s66, 3277056
    buffer_load_dwordx4 v29, s[16:19], s66 offen lds
    v_mfma_f32_16x16x32_bf16 a[244:247], v[84:87], v[212:215], a[244:247]
    s_add_u32 m0, s29, 84992
    v_mfma_f32_16x16x32_bf16 a[244:247], v[88:91], v[216:219], a[244:247]
    s_mov_b32 s67, 3342592
    buffer_load_dwordx4 v29, s[16:19], s67 offen lds
    v_mfma_f32_16x16x32_bf16 a[244:247], v[92:95], v[220:223], a[244:247]
    s_waitcnt lgkmcnt(4)
    s_add_u32 m0, s29, 147456
    v_mfma_f32_16x16x32_bf16 a[152:155], v[64:67], v[160:163], a[152:155]
    s_mov_b32 s74, 49920
    buffer_load_dwordx4 v32, s[20:23], s74 offen nt lds
    v_mfma_f32_16x16x32_bf16 a[152:155], v[68:71], v[164:167], a[152:155]
    s_waitcnt lgkmcnt(0)
    s_add_u32 m0, s29, 148480
    v_mfma_f32_16x16x32_bf16 a[152:155], v[72:75], v[168:171], a[152:155]
    buffer_load_dwordx4 v33, s[20:23], s74 offen nt lds
    v_mfma_f32_16x16x32_bf16 a[152:155], v[76:79], v[172:175], a[152:155]
    v_mfma_f32_16x16x32_bf16 a[184:187], v[64:67], v[176:179], a[184:187]
    ds_read_b64_tr_b16 v[80:81], v28 offset:49160
    v_mfma_f32_16x16x32_bf16 a[184:187], v[68:71], v[180:183], a[184:187]
    ds_read_b64_tr_b16 v[82:83], v28 offset:49672
    v_mfma_f32_16x16x32_bf16 a[184:187], v[72:75], v[184:187], a[184:187]
    ds_read_b64_tr_b16 v[84:85], v28 offset:53256
    v_mfma_f32_16x16x32_bf16 a[184:187], v[76:79], v[188:191], a[184:187]
    ds_read_b64_tr_b16 v[86:87], v28 offset:53768
    v_mfma_f32_16x16x32_bf16 a[216:219], v[64:67], v[192:195], a[216:219]
    ds_read_b64_tr_b16 v[88:89], v28 offset:57352
    v_mfma_f32_16x16x32_bf16 a[216:219], v[68:71], v[196:199], a[216:219]
    ds_read_b64_tr_b16 v[90:91], v28 offset:57864
    v_mfma_f32_16x16x32_bf16 a[216:219], v[72:75], v[200:203], a[216:219]
    ds_read_b64_tr_b16 v[92:93], v28 offset:61448
    v_mfma_f32_16x16x32_bf16 a[216:219], v[76:79], v[204:207], a[216:219]
    ds_read_b64_tr_b16 v[94:95], v28 offset:61960
    s_add_u32 m0, s29, 149504
    v_mfma_f32_16x16x32_bf16 a[248:251], v[64:67], v[208:211], a[248:251]
    buffer_load_dwordx4 v34, s[20:23], s74 offen nt lds
    v_mfma_f32_16x16x32_bf16 a[248:251], v[68:71], v[212:215], a[248:251]
    s_add_u32 m0, s29, 150528
    v_mfma_f32_16x16x32_bf16 a[248:251], v[72:75], v[216:219], a[248:251]
    buffer_load_dwordx4 v35, s[20:23], s74 offen nt lds
    v_mfma_f32_16x16x32_bf16 a[248:251], v[76:79], v[220:223], a[248:251]
    s_waitcnt lgkmcnt(4)
    v_mfma_f32_16x16x32_bf16 a[156:159], v[80:83], v[160:163], a[156:159]
    v_mfma_f32_16x16x32_bf16 a[156:159], v[84:87], v[164:167], a[156:159]
    s_waitcnt lgkmcnt(0)
    v_mfma_f32_16x16x32_bf16 a[156:159], v[88:91], v[168:171], a[156:159]
    v_mfma_f32_16x16x32_bf16 a[156:159], v[92:95], v[172:175], a[156:159]
    s_waitcnt vmcnt(16)
    s_barrier
    v_mfma_f32_16x16x32_bf16 a[188:191], v[80:83], v[176:179], a[188:191]
    ds_read_b64_tr_b16 v[64:65], v27
    v_mfma_f32_16x16x32_bf16 a[188:191], v[84:87], v[180:183], a[188:191]
    ds_read_b64_tr_b16 v[66:67], v27 offset:512
    v_mfma_f32_16x16x32_bf16 a[188:191], v[88:91], v[184:187], a[188:191]
    ds_read_b64_tr_b16 v[68:69], v27 offset:4096
    v_mfma_f32_16x16x32_bf16 a[188:191], v[92:95], v[188:191], a[188:191]
    ds_read_b64_tr_b16 v[70:71], v27 offset:4608
    v_mfma_f32_16x16x32_bf16 a[220:223], v[80:83], v[192:195], a[220:223]
    ds_read_b64_tr_b16 v[72:73], v27 offset:8192
    v_mfma_f32_16x16x32_bf16 a[220:223], v[84:87], v[196:199], a[220:223]
    ds_read_b64_tr_b16 v[74:75], v27 offset:8704
    v_mfma_f32_16x16x32_bf16 a[220:223], v[88:91], v[200:203], a[220:223]
    ds_read_b64_tr_b16 v[76:77], v27 offset:12288
    v_mfma_f32_16x16x32_bf16 a[220:223], v[92:95], v[204:207], a[220:223]
    ds_read_b64_tr_b16 v[78:79], v27 offset:12800
    v_mfma_f32_16x16x32_bf16 a[252:255], v[80:83], v[208:211], a[252:255]
    v_mfma_f32_16x16x32_bf16 a[252:255], v[84:87], v[212:215], a[252:255]
    v_mfma_f32_16x16x32_bf16 a[252:255], v[88:91], v[216:219], a[252:255]
    v_mfma_f32_16x16x32_bf16 a[252:255], v[92:95], v[220:223], a[252:255]
    s_waitcnt lgkmcnt(4)
    v_mfma_f32_16x16x32_bf16 a[128:131], v[64:67], v[96:99], a[128:131]
    ds_read_b128 v[160:163], v36 offset:16384
    v_mfma_f32_16x16x32_bf16 a[128:131], v[68:71], v[100:103], a[128:131]
    s_waitcnt lgkmcnt(1)
    ds_read_b128 v[164:167], v37 offset:16384
    v_mfma_f32_16x16x32_bf16 a[128:131], v[72:75], v[104:107], a[128:131]
    ds_read_b128 v[168:171], v38 offset:16384
    v_mfma_f32_16x16x32_bf16 a[128:131], v[76:79], v[108:111], a[128:131]
    ds_read_b128 v[172:175], v39 offset:16384
    v_mfma_f32_16x16x32_bf16 a[160:163], v[64:67], v[112:115], a[160:163]
    ds_read_b64_tr_b16 v[80:81], v27 offset:8
    v_mfma_f32_16x16x32_bf16 a[160:163], v[68:71], v[116:119], a[160:163]
    ds_read_b64_tr_b16 v[82:83], v27 offset:520
    v_mfma_f32_16x16x32_bf16 a[160:163], v[72:75], v[120:123], a[160:163]
    ds_read_b64_tr_b16 v[84:85], v27 offset:4104
    v_mfma_f32_16x16x32_bf16 a[160:163], v[76:79], v[124:127], a[160:163]
    ds_read_b64_tr_b16 v[86:87], v27 offset:4616
    v_mfma_f32_16x16x32_bf16 a[192:195], v[64:67], v[128:131], a[192:195]
    ds_read_b64_tr_b16 v[88:89], v27 offset:8200
    v_mfma_f32_16x16x32_bf16 a[192:195], v[68:71], v[132:135], a[192:195]
    ds_read_b64_tr_b16 v[90:91], v27 offset:8712
    v_mfma_f32_16x16x32_bf16 a[192:195], v[72:75], v[136:139], a[192:195]
    ds_read_b64_tr_b16 v[92:93], v27 offset:12296
    v_mfma_f32_16x16x32_bf16 a[192:195], v[76:79], v[140:143], a[192:195]
    ds_read_b64_tr_b16 v[94:95], v27 offset:12808
    v_mfma_f32_16x16x32_bf16 a[224:227], v[64:67], v[144:147], a[224:227]
    ds_read_b128 v[176:179], v36 offset:32768
    v_mfma_f32_16x16x32_bf16 a[224:227], v[68:71], v[148:151], a[224:227]
    ds_read_b128 v[180:183], v37 offset:32768
    v_mfma_f32_16x16x32_bf16 a[224:227], v[72:75], v[152:155], a[224:227]
    ds_read_b128 v[184:187], v38 offset:32768
    v_mfma_f32_16x16x32_bf16 a[224:227], v[76:79], v[156:159], a[224:227]
    s_waitcnt lgkmcnt(7)
    ds_read_b128 v[188:191], v39 offset:32768
    s_add_u32 m0, s29, 98304
    v_mfma_f32_16x16x32_bf16 a[132:135], v[80:83], v[96:99], a[132:135]
    s_mov_b32 s66, 3146112
    buffer_load_dwordx4 v29, s[16:19], s66 offen lds
    v_mfma_f32_16x16x32_bf16 a[132:135], v[84:87], v[100:103], a[132:135]
    s_waitcnt lgkmcnt(4)
    s_add_u32 m0, s29, 99328
    v_mfma_f32_16x16x32_bf16 a[132:135], v[88:91], v[104:107], a[132:135]
    s_mov_b32 s67, 3211648
    buffer_load_dwordx4 v29, s[16:19], s67 offen lds
    v_mfma_f32_16x16x32_bf16 a[132:135], v[92:95], v[108:111], a[132:135]
    v_mfma_f32_16x16x32_bf16 a[164:167], v[80:83], v[112:115], a[164:167]
    ds_read_b64_tr_b16 v[64:65], v28
    v_mfma_f32_16x16x32_bf16 a[164:167], v[84:87], v[116:119], a[164:167]
    ds_read_b64_tr_b16 v[66:67], v28 offset:512
    v_mfma_f32_16x16x32_bf16 a[164:167], v[88:91], v[120:123], a[164:167]
    ds_read_b64_tr_b16 v[68:69], v28 offset:4096
    v_mfma_f32_16x16x32_bf16 a[164:167], v[92:95], v[124:127], a[164:167]
    ds_read_b64_tr_b16 v[70:71], v28 offset:4608
    v_mfma_f32_16x16x32_bf16 a[196:199], v[80:83], v[128:131], a[196:199]
    ds_read_b64_tr_b16 v[72:73], v28 offset:8192
    v_mfma_f32_16x16x32_bf16 a[196:199], v[84:87], v[132:135], a[196:199]
    ds_read_b64_tr_b16 v[74:75], v28 offset:8704
    v_mfma_f32_16x16x32_bf16 a[196:199], v[88:91], v[136:139], a[196:199]
    ds_read_b64_tr_b16 v[76:77], v28 offset:12288
    v_mfma_f32_16x16x32_bf16 a[196:199], v[92:95], v[140:143], a[196:199]
    ds_read_b64_tr_b16 v[78:79], v28 offset:12800
    s_add_u32 m0, s29, 100352
    v_mfma_f32_16x16x32_bf16 a[228:231], v[80:83], v[144:147], a[228:231]
    s_mov_b32 s66, 3277184
    buffer_load_dwordx4 v29, s[16:19], s66 offen lds
    v_mfma_f32_16x16x32_bf16 a[228:231], v[84:87], v[148:151], a[228:231]
    s_add_u32 m0, s29, 101376
    v_mfma_f32_16x16x32_bf16 a[228:231], v[88:91], v[152:155], a[228:231]
    s_mov_b32 s67, 3342720
    buffer_load_dwordx4 v29, s[16:19], s67 offen lds
    v_mfma_f32_16x16x32_bf16 a[228:231], v[92:95], v[156:159], a[228:231]
    s_waitcnt lgkmcnt(4)
    s_add_u32 m0, s29, 0
    v_mfma_f32_16x16x32_bf16 a[136:139], v[64:67], v[96:99], a[136:139]
    s_mov_b32 s68, 0
    buffer_load_dwordx4 v20, s[8:11], s68 offen nt lds
    v_mfma_f32_16x16x32_bf16 a[136:139], v[68:71], v[100:103], a[136:139]
    s_waitcnt lgkmcnt(0)
    v_mfma_f32_16x16x32_bf16 a[136:139], v[72:75], v[104:107], a[136:139]
    buffer_load_dwordx4 v21, s[8:11], s68 offen offset:1024 nt lds
    v_mfma_f32_16x16x32_bf16 a[136:139], v[76:79], v[108:111], a[136:139]
    v_mfma_f32_16x16x32_bf16 a[168:171], v[64:67], v[112:115], a[168:171]
    ds_read_b64_tr_b16 v[80:81], v28 offset:8
    v_mfma_f32_16x16x32_bf16 a[168:171], v[68:71], v[116:119], a[168:171]
    ds_read_b64_tr_b16 v[82:83], v28 offset:520
    v_mfma_f32_16x16x32_bf16 a[168:171], v[72:75], v[120:123], a[168:171]
    ds_read_b64_tr_b16 v[84:85], v28 offset:4104
    v_mfma_f32_16x16x32_bf16 a[168:171], v[76:79], v[124:127], a[168:171]
    ds_read_b64_tr_b16 v[86:87], v28 offset:4616
    v_mfma_f32_16x16x32_bf16 a[200:203], v[64:67], v[128:131], a[200:203]
    ds_read_b64_tr_b16 v[88:89], v28 offset:8200
    v_mfma_f32_16x16x32_bf16 a[200:203], v[68:71], v[132:135], a[200:203]
    ds_read_b64_tr_b16 v[90:91], v28 offset:8712
    v_mfma_f32_16x16x32_bf16 a[200:203], v[72:75], v[136:139], a[200:203]
    ds_read_b64_tr_b16 v[92:93], v28 offset:12296
    v_mfma_f32_16x16x32_bf16 a[200:203], v[76:79], v[140:143], a[200:203]
    ds_read_b64_tr_b16 v[94:95], v28 offset:12808
    v_mfma_f32_16x16x32_bf16 a[232:235], v[64:67], v[144:147], a[232:235]
L_hop2:
    s_cbranch_execz L_hop6
    buffer_load_dwordx4 v22, s[8:11], s68 offen offset:2048 nt lds
    v_mfma_f32_16x16x32_bf16 a[232:235], v[68:71], v[148:151], a[232:235]
    v_mfma_f32_16x16x32_bf16 a[232:235], v[72:75], v[152:155], a[232:235]
    buffer_load_dwordx4 v23, s[8:11], s68 offen offset:3072 nt lds
    v_mfma_f32_16x16x32_bf16 a[232:235], v[76:79], v[156:159], a[232:235]
    s_waitcnt lgkmcnt(4)
    v_mfma_f32_16x16x32_bf16 a[140:143], v[80:83], v[96:99], a[140:143]
    v_mfma_f32_16x16x32_bf16 a[140:143], v[84:87], v[100:103], a[140:143]
    s_waitcnt lgkmcnt(0)
    v_mfma_f32_16x16x32_bf16 a[140:143], v[88:91], v[104:107], a[140:143]
    v_mfma_f32_16x16x32_bf16 a[140:143], v[92:95], v[108:111], a[140:143]
    s_waitcnt vmcnt(8)
    s_barrier
    v_mfma_f32_16x16x32_bf16 a[172:175], v[80:83], v[112:115], a[172:175]
    ds_read_b64_tr_b16 v[64:65], v27 offset:16384
    v_mfma_f32_16x16x32_bf16 a[172:175], v[84:87], v[116:119], a[172:175]
    ds_read_b64_tr_b16 v[66:67], v27 offset:16896
    v_mfma_f32_16x16x32_bf16 a[172:175], v[88:91], v[120:123], a[172:175]
    ds_read_b64_tr_b16 v[68:69], v27 offset:20480
    v_mfma_f32_16x16x32_bf16 a[172:175], v[92:95], v[124:127], a[172:175]
    ds_read_b64_tr_b16 v[70:71], v27 offset:20992
    v_mfma_f32_16x16x32_bf16 a[204:207], v[80:83], v[128:131], a[204:207]
    ds_read_b64_tr_b16 v[72:73], v27 offset:24576
    v_mfma_f32_16x16x32_bf16 a[204:207], v[84:87], v[132:135], a[204:207]
    ds_read_b64_tr_b16 v[74:75], v27 offset:25088
    v_mfma_f32_16x16x32_bf16 a[204:207], v[88:91], v[136:139], a[204:207]
    ds_read_b64_tr_b16 v[76:77], v27 offset:28672
    v_mfma_f32_16x16x32_bf16 a[204:207], v[92:95], v[140:143], a[204:207]
    ds_read_b64_tr_b16 v[78:79], v27 offset:29184
    v_mfma_f32_16x16x32_bf16 a[236:239], v[80:83], v[144:147], a[236:239]
    v_mfma_f32_16x16x32_bf16 a[236:239], v[84:87], v[148:151], a[236:239]
    v_mfma_f32_16x16x32_bf16 a[236:239], v[88:91], v[152:155], a[236:239]
    v_mfma_f32_16x16x32_bf16 a[236:239], v[92:95], v[156:159], a[236:239]
    s_waitcnt lgkmcnt(4)
    v_mfma_f32_16x16x32_bf16 a[144:147], v[64:67], v[96:99], a[144:147]
    ds_read_b128 v[192:195], v40 offset:16384
    v_mfma_f32_16x16x32_bf16 a[144:147], v[68:71], v[100:103], a[144:147]
    s_waitcnt lgkmcnt(1)
    ds_read_b128 v[196:199], v41 offset:16384
    v_mfma_f32_16x16x32_bf16 a[144:147], v[72:75], v[104:107], a[144:147]
    ds_read_b128 v[200:203], v42 offset:16384
    v_mfma_f32_16x16x32_bf16 a[144:147], v[76:79], v[108:111], a[144:147]
    ds_read_b128 v[204:207], v43 offset:16384
    v_mfma_f32_16x16x32_bf16 a[176:179], v[64:67], v[112:115], a[176:179]
    ds_read_b64_tr_b16 v[80:81], v27 offset:16392
    v_mfma_f32_16x16x32_bf16 a[176:179], v[68:71], v[116:119], a[176:179]
    ds_read_b64_tr_b16 v[82:83], v27 offset:16904
    v_mfma_f32_16x16x32_bf16 a[176:179], v[72:75], v[120:123], a[176:179]
    ds_read_b64_tr_b16 v[84:85], v27 offset:20488
    v_mfma_f32_16x16x32_bf16 a[176:179], v[76:79], v[124:127], a[176:179]
    ds_read_b64_tr_b16 v[86:87], v27 offset:21000
    v_mfma_f32_16x16x32_bf16 a[208:211], v[64:67], v[128:131], a[208:211]
    ds_read_b64_tr_b16 v[88:89], v27 offset:24584
    v_mfma_f32_16x16x32_bf16 a[208:211], v[68:71], v[132:135], a[208:211]
    ds_read_b64_tr_b16 v[90:91], v27 offset:25096
    v_mfma_f32_16x16x32_bf16 a[208:211], v[72:75], v[136:139], a[208:211]
    ds_read_b64_tr_b16 v[92:93], v27 offset:28680
    v_mfma_f32_16x16x32_bf16 a[208:211], v[76:79], v[140:143], a[208:211]
    ds_read_b64_tr_b16 v[94:95], v27 offset:29192
    v_mfma_f32_16x16x32_bf16 a[240:243], v[64:67], v[144:147], a[240:243]
    ds_read_b128 v[208:211], v40 offset:32768
    v_mfma_f32_16x16x32_bf16 a[240:243], v[68:71], v[148:151], a[240:243]
    ds_read_b128 v[212:215], v41 offset:32768
    v_mfma_f32_16x16x32_bf16 a[240:243], v[72:75], v[152:155], a[240:243]
    ds_read_b128 v[216:219], v42 offset:32768
    v_mfma_f32_16x16x32_bf16 a[240:243], v[76:79], v[156:159], a[240:243]
    s_waitcnt lgkmcnt(7)
    ds_read_b128 v[220:223], v43 offset:32768
    s_add_u32 m0, s29, 49152
    v_mfma_f32_16x16x32_bf16 a[148:151], v[80:83], v[96:99], a[148:151]
    s_mov_b32 s66, 3145728
    buffer_load_dwordx4 v29, s[16:19], s66 offen lds
    v_mfma_f32_16x16x32_bf16 a[148:151], v[84:87], v[100:103], a[148:151]
    s_waitcnt lgkmcnt(4)
    s_add_u32 m0, s29, 50176
    v_mfma_f32_16x16x32_bf16 a[148:151], v[88:91], v[104:107], a[148:151]
    s_mov_b32 s67, 3211264
    buffer_load_dwordx4 v29, s[16:19], s67 offen lds
    v_mfma_f32_16x16x32_bf16 a[148:151], v[92:95], v[108:111], a[148:151]
    v_mfma_f32_16x16x32_bf16 a[180:183], v[80:83], v[112:115], a[180:183]
    ds_read_b64_tr_b16 v[64:65], v28 offset:16384
    v_mfma_f32_16x16x32_bf16 a[180:183], v[84:87], v[116:119], a[180:183]
    ds_read_b64_tr_b16 v[66:67], v28 offset:16896
    v_mfma_f32_16x16x32_bf16 a[180:183], v[88:91], v[120:123], a[180:183]
    ds_read_b64_tr_b16 v[68:69], v28 offset:20480
    v_mfma_f32_16x16x32_bf16 a[180:183], v[92:95], v[124:127], a[180:183]
    ds_read_b64_tr_b16 v[70:71], v28 offset:20992
    v_mfma_f32_16x16x32_bf16 a[212:215], v[80:83], v[128:131], a[212:215]
    ds_read_b64_tr_b16 v[72:73], v28 offset:24576
    v_mfma_f32_16x16x32_bf16 a[212:215], v[84:87], v[132:135], a[212:215]
    ds_read_b64_tr_b16 v[74:75], v28 offset:25088
    v_mfma_f32_16x16x32_bf16 a[212:215], v[88:91], v[136:139], a[212:215]
    ds_read_b64_tr_b16 v[76:77], v28 offset:28672
    v_mfma_f32_16x16x32_bf16 a[212:215], v[92:95], v[140:143], a[212:215]
    ds_read_b64_tr_b16 v[78:79], v28 offset:29184
    s_add_u32 m0, s29, 51200
    v_mfma_f32_16x16x32_bf16 a[244:247], v[80:83], v[144:147], a[244:247]
    s_mov_b32 s66, 3276800
    buffer_load_dwordx4 v29, s[16:19], s66 offen lds
    v_mfma_f32_16x16x32_bf16 a[244:247], v[84:87], v[148:151], a[244:247]
    s_add_u32 m0, s29, 52224
    v_mfma_f32_16x16x32_bf16 a[244:247], v[88:91], v[152:155], a[244:247]
    s_mov_b32 s67, 3342336
    buffer_load_dwordx4 v29, s[16:19], s67 offen lds
    v_mfma_f32_16x16x32_bf16 a[244:247], v[92:95], v[156:159], a[244:247]
    s_waitcnt lgkmcnt(4)
    s_add_u32 m0, s29, 114688
    v_mfma_f32_16x16x32_bf16 a[152:155], v[64:67], v[96:99], a[152:155]
    s_mov_b32 s68, 0
    buffer_load_dwordx4 v24, s[12:15], s68 offen nt lds
    v_mfma_f32_16x16x32_bf16 a[152:155], v[68:71], v[100:103], a[152:155]
    s_waitcnt lgkmcnt(0)
    v_mfma_f32_16x16x32_bf16 a[152:155], v[72:75], v[104:107], a[152:155]
    buffer_load_dwordx4 v25, s[12:15], s68 offen offset:1024 nt lds
    v_mfma_f32_16x16x32_bf16 a[152:155], v[76:79], v[108:111], a[152:155]
    v_mfma_f32_16x16x32_bf16 a[184:187], v[64:67], v[112:115], a[184:187]
    ds_read_b64_tr_b16 v[80:81], v28 offset:16392
    v_mfma_f32_16x16x32_bf16 a[184:187], v[68:71], v[116:119], a[184:187]
    ds_read_b64_tr_b16 v[82:83], v28 offset:16904
    v_mfma_f32_16x16x32_bf16 a[184:187], v[72:75], v[120:123], a[184:187]
    ds_read_b64_tr_b16 v[84:85], v28 offset:20488
    v_mfma_f32_16x16x32_bf16 a[184:187], v[76:79], v[124:127], a[184:187]
    ds_read_b64_tr_b16 v[86:87], v28 offset:21000
    v_mfma_f32_16x16x32_bf16 a[216:219], v[64:67], v[128:131], a[216:219]
    ds_read_b64_tr_b16 v[88:89], v28 offset:24584
    v_mfma_f32_16x16x32_bf16 a[216:219], v[68:71], v[132:135], a[216:219]
    ds_read_b64_tr_b16 v[90:91], v28 offset:25096
    v_mfma_f32_16x16x32_bf16 a[216:219], v[72:75], v[136:139], a[216:219]
    ds_read_b64_tr_b16 v[92:93], v28 offset:28680
    v_mfma_f32_16x16x32_bf16 a[216:219], v[76:79], v[140:143], a[216:219]
    ds_read_b64_tr_b16 v[94:95], v28 offset:29192
    v_mfma_f32_16x16x32_bf16 a[248:251], v[64:67], v[144:147], a[248:251]
    buffer_load_dwordx4 v24, s[12:15], s68 offen offset:2048 nt lds
    v_mfma_f32_16x16x32_bf16 a[248:251], v[68:71], v[148:151], a[248:251]
    v_mfma_f32_16x16x32_bf16 a[248:251], v[72:75], v[152:155], a[248:251]
    buffer_load_dwordx4 v25, s[12:15], s68 offen offset:3072 nt lds
    v_mfma_f32_16x16x32_bf16 a[248:251], v[76:79], v[156:159], a[248:251]
    s_waitcnt lgkmcnt(4)
    v_mfma_f32_16x16x32_bf16 a[156:159], v[80:83], v[96:99], a[156:159]
    v_mfma_f32_16x16x32_bf16 a[156:159], v[84:87], v[100:103], a[156:159]
    s_waitcnt lgkmcnt(0)
    v_mfma_f32_16x16x32_bf16 a[156:159], v[88:91], v[104:107], a[156:159]
    v_mfma_f32_16x16x32_bf16 a[156:159], v[92:95], v[108:111], a[156:159]
    s_waitcnt vmcnt(20)
    s_barrier
    v_mfma_f32_16x16x32_bf16 a[188:191], v[80:83], v[112:115], a[188:191]
    ds_read_b64_tr_b16 v[64:65], v27 offset:32768
    v_mfma_f32_16x16x32_bf16 a[188:191], v[84:87], v[116:119], a[188:191]
    ds_read_b64_tr_b16 v[66:67], v27 offset:33280
    v_mfma_f32_16x16x32_bf16 a[188:191], v[88:91], v[120:123], a[188:191]
    ds_read_b64_tr_b16 v[68:69], v27 offset:36864
    v_mfma_f32_16x16x32_bf16 a[188:191], v[92:95], v[124:127], a[188:191]
    ds_read_b64_tr_b16 v[70:71], v27 offset:37376
    v_mfma_f32_16x16x32_bf16 a[220:223], v[80:83], v[128:131], a[220:223]
    ds_read_b64_tr_b16 v[72:73], v27 offset:40960
    v_mfma_f32_16x16x32_bf16 a[220:223], v[84:87], v[132:135], a[220:223]
    ds_read_b64_tr_b16 v[74:75], v27 offset:41472
    v_mfma_f32_16x16x32_bf16 a[220:223], v[88:91], v[136:139], a[220:223]
    ds_read_b64_tr_b16 v[76:77], v27 offset:45056
    v_mfma_f32_16x16x32_bf16 a[220:223], v[92:95], v[140:143], a[220:223]
    ds_read_b64_tr_b16 v[78:79], v27 offset:45568
    v_mfma_f32_16x16x32_bf16 a[252:255], v[80:83], v[144:147], a[252:255]
    v_mfma_f32_16x16x32_bf16 a[252:255], v[84:87], v[148:151], a[252:255]
    v_mfma_f32_16x16x32_bf16 a[252:255], v[88:91], v[152:155], a[252:255]
    v_mfma_f32_16x16x32_bf16 a[252:255], v[92:95], v[156:159], a[252:255]
    s_waitcnt lgkmcnt(4)
    v_mfma_f32_16x16x32_bf16 a[128:131], v[64:67], v[160:163], a[128:131]
    v_mfma_f32_16x16x32_bf16 a[128:131], v[68:71], v[164:167], a[128:131]
    s_waitcnt lgkmcnt(0)
    v_mfma_f32_16x16x32_bf16 a[128:131], v[72:75], v[168:171], a[128:131]
    v_mfma_f32_16x16x32_bf16 a[128:131], v[76:79], v[172:175], a[128:131]
    v_mfma_f32_16x16x32_bf16 a[160:163], v[64:67], v[176:179], a[160:163]
    ds_read_b64_tr_b16 v[80:81], v27 offset:32776
    v_mfma_f32_16x16x32_bf16 a[160:163], v[68:71], v[180:183], a[160:163]
    ds_read_b64_tr_b16 v[82:83], v27 offset:33288
    v_mfma_f32_16x16x32_bf16 a[160:163], v[72:75], v[184:187], a[160:163]
    ds_read_b64_tr_b16 v[84:85], v27 offset:36872
    v_mfma_f32_16x16x32_bf16 a[160:163], v[76:79], v[188:191], a[160:163]
    ds_read_b64_tr_b16 v[86:87], v27 offset:37384
    v_mfma_f32_16x16x32_bf16 a[192:195], v[64:67], v[192:195], a[192:195]
    ds_read_b64_tr_b16 v[88:89], v27 offset:40968
    v_mfma_f32_16x16x32_bf16 a[192:195], v[68:71], v[196:199], a[192:195]
    ds_read_b64_tr_b16 v[90:91], v27 offset:41480
    v_mfma_f32_16x16x32_bf16 a[192:195], v[72:75], v[200:203], a[192:195]
    ds_read_b64_tr_b16 v[92:93], v27 offset:45064
    v_mfma_f32_16x16x32_bf16 a[192:195], v[76:79], v[204:207], a[192:195]
    ds_read_b64_tr_b16 v[94:95], v27 offset:45576
    v_mfma_f32_16x16x32_bf16 a[224:227], v[64:67], v[208:211], a[224:227]
    v_mfma_f32_16x16x32_bf16 a[224:227], v[68:71], v[212:215], a[224:227]
    v_mfma_f32_16x16x32_bf16 a[224:227], v[72:75], v[216:219], a[224:227]
    v_mfma_f32_16x16x32_bf16 a[224:227], v[76:79], v[220:223], a[224:227]
    s_waitcnt lgkmcnt(4)
    s_add_u32 m0, s29, 65536
    v_mfma_f32_16x16x32_bf16 a[132:135], v[80:83], v[160:163], a[132:135]
    s_mov_b32 s66, 3145856
    buffer_load_dwordx4 v29, s[16:19], s66 offen lds
    v_mfma_f32_16x16x32_bf16 a[132:135], v[84:87], v[164:167], a[132:135]
    s_waitcnt lgkmcnt(0)
    s_add_u32 m0, s29, 66560
    v_mfma_f32_16x16x32_bf16 a[132:135], v[88:91], v[168:171], a[132:135]
    s_mov_b32 s67, 3211392
    buffer_load_dwordx4 v29, s[16:19], s67 offen lds
    v_mfma_f32_16x16x32_bf16 a[132:135], v[92:95], v[172:175], a[132:135]
    v_mfma_f32_16x16x32_bf16 a[164:167], v[80:83], v[176:179], a[164:167]
    ds_read_b64_tr_b16 v[64:65], v28 offset:32768
    v_mfma_f32_16x16x32_bf16 a[164:167], v[84:87], v[180:183], a[164:167]
    ds_read_b64_tr_b16 v[66:67], v28 offset:33280
    v_mfma_f32_16x16x32_bf16 a[164:167], v[88:91], v[184:187], a[164:167]
    ds_read_b64_tr_b16 v[68:69], v28 offset:36864
    v_mfma_f32_16x16x32_bf16 a[164:167], v[92:95], v[188:191], a[164:167]
    ds_read_b64_tr_b16 v[70:71], v28 offset:37376
    v_mfma_f32_16x16x32_bf16 a[196:199], v[80:83], v[192:195], a[196:199]
    ds_read_b64_tr_b16 v[72:73], v28 offset:40960
    v_mfma_f32_16x16x32_bf16 a[196:199], v[84:87], v[196:199], a[196:199]
    ds_read_b64_tr_b16 v[74:75], v28 offset:41472
    v_mfma_f32_16x16x32_bf16 a[196:199], v[88:91], v[200:203], a[196:199]
    ds_read_b64_tr_b16 v[76:77], v28 offset:45056
    v_mfma_f32_16x16x32_bf16 a[196:199], v[92:95], v[204:207], a[196:199]
    ds_read_b64_tr_b16 v[78:79], v28 offset:45568
    s_add_u32 m0, s29, 67584
    v_mfma_f32_16x16x32_bf16 a[228:231], v[80:83], v[208:211], a[228:231]
    s_mov_b32 s66, 3276928
    buffer_load_dwordx4 v29, s[16:19], s66 offen lds
    v_mfma_f32_16x16x32_bf16 a[228:231], v[84:87], v[212:215], a[228:231]
    s_add_u32 m0, s29, 68608
    v_mfma_f32_16x16x32_bf16 a[228:231], v[88:91], v[216:219], a[228:231]
    s_mov_b32 s67, 3342464
    buffer_load_dwordx4 v29, s[16:19], s67 offen lds
    v_mfma_f32_16x16x32_bf16 a[228:231], v[92:95], v[220:223], a[228:231]
    s_waitcnt lgkmcnt(4)
    s_add_u32 m0, s29, 16384
    v_mfma_f32_16x16x32_bf16 a[136:139], v[64:67], v[160:163], a[136:139]
    s_mov_b32 s68, 16384
    buffer_load_dwordx4 v20, s[8:11], s68 offen nt lds
    v_mfma_f32_16x16x32_bf16 a[136:139], v[68:71], v[164:167], a[136:139]
    s_waitcnt lgkmcnt(0)
    v_mfma_f32_16x16x32_bf16 a[136:139], v[72:75], v[168:171], a[136:139]
    buffer_load_dwordx4 v21, s[8:11], s68 offen offset:1024 nt lds
    v_mfma_f32_16x16x32_bf16 a[136:139], v[76:79], v[172:175], a[136:139]
    v_mfma_f32_16x16x32_bf16 a[168:171], v[64:67], v[176:179], a[168:171]
    ds_read_b64_tr_b16 v[80:81], v28 offset:32776
    v_mfma_f32_16x16x32_bf16 a[168:171], v[68:71], v[180:183], a[168:171]
    ds_read_b64_tr_b16 v[82:83], v28 offset:33288
    v_mfma_f32_16x16x32_bf16 a[168:171], v[72:75], v[184:187], a[168:171]
    ds_read_b64_tr_b16 v[84:85], v28 offset:36872
    v_mfma_f32_16x16x32_bf16 a[168:171], v[76:79], v[188:191], a[168:171]
    ds_read_b64_tr_b16 v[86:87], v28 offset:37384
    v_mfma_f32_16x16x32_bf16 a[200:203], v[64:67], v[192:195], a[200:203]
    ds_read_b64_tr_b16 v[88:89], v28 offset:40968
    v_mfma_f32_16x16x32_bf16 a[200:203], v[68:71], v[196:199], a[200:203]
    ds_read_b64_tr_b16 v[90:91], v28 offset:41480
    v_mfma_f32_16x16x32_bf16 a[200:203], v[72:75], v[200:203], a[200:203]
    ds_read_b64_tr_b16 v[92:93], v28 offset:45064
    v_mfma_f32_16x16x32_bf16 a[200:203], v[76:79], v[204:207], a[200:203]
    ds_read_b64_tr_b16 v[94:95], v28 offset:45576
    v_mfma_f32_16x16x32_bf16 a[232:235], v[64:67], v[208:211], a[232:235]
    buffer_load_dwordx4 v22, s[8:11], s68 offen offset:2048 nt lds
    v_mfma_f32_16x16x32_bf16 a[232:235], v[68:71], v[212:215], a[232:235]
    v_mfma_f32_16x16x32_bf16 a[232:235], v[72:75], v[216:219], a[232:235]
    buffer_load_dwordx4 v23, s[8:11], s68 offen offset:3072 nt lds
    v_mfma_f32_16x16x32_bf16 a[232:235], v[76:79], v[220:223], a[232:235]
    s_waitcnt lgkmcnt(4)
    v_mfma_f32_16x16x32_bf16 a[140:143], v[80:83], v[160:163], a[140:143]
    v_mfma_f32_16x16x32_bf16 a[140:143], v[84:87], v[164:167], a[140:143]
    s_waitcnt lgkmcnt(0)
    v_mfma_f32_16x16x32_bf16 a[140:143], v[88:91], v[168:171], a[140:143]
    v_mfma_f32_16x16x32_bf16 a[140:143], v[92:95], v[172:175], a[140:143]
    s_waitcnt vmcnt(20)
    s_barrier
    v_mfma_f32_16x16x32_bf16 a[172:175], v[80:83], v[176:179], a[172:175]
    ds_read_b64_tr_b16 v[64:65], v27 offset:49152
    v_mfma_f32_16x16x32_bf16 a[172:175], v[84:87], v[180:183], a[172:175]
    ds_read_b64_tr_b16 v[66:67], v27 offset:49664
    v_mfma_f32_16x16x32_bf16 a[172:175], v[88:91], v[184:187], a[172:175]
    ds_read_b64_tr_b16 v[68:69], v27 offset:53248
    v_mfma_f32_16x16x32_bf16 a[172:175], v[92:95], v[188:191], a[172:175]
    ds_read_b64_tr_b16 v[70:71], v27 offset:53760
    v_mfma_f32_16x16x32_bf16 a[204:207], v[80:83], v[192:195], a[204:207]
    ds_read_b64_tr_b16 v[72:73], v27 offset:57344
    v_mfma_f32_16x16x32_bf16 a[204:207], v[84:87], v[196:199], a[204:207]
    ds_read_b64_tr_b16 v[74:75], v27 offset:57856
    v_mfma_f32_16x16x32_bf16 a[204:207], v[88:91], v[200:203], a[204:207]
    ds_read_b64_tr_b16 v[76:77], v27 offset:61440
    v_mfma_f32_16x16x32_bf16 a[204:207], v[92:95], v[204:207], a[204:207]
    ds_read_b64_tr_b16 v[78:79], v27 offset:61952
    v_mfma_f32_16x16x32_bf16 a[236:239], v[80:83], v[208:211], a[236:239]
    v_mfma_f32_16x16x32_bf16 a[236:239], v[84:87], v[212:215], a[236:239]
    v_mfma_f32_16x16x32_bf16 a[236:239], v[88:91], v[216:219], a[236:239]
    v_mfma_f32_16x16x32_bf16 a[236:239], v[92:95], v[220:223], a[236:239]
    s_waitcnt lgkmcnt(4)
    v_mfma_f32_16x16x32_bf16 a[144:147], v[64:67], v[160:163], a[144:147]
    v_mfma_f32_16x16x32_bf16 a[144:147], v[68:71], v[164:167], a[144:147]
    s_waitcnt lgkmcnt(0)
    v_mfma_f32_16x16x32_bf16 a[144:147], v[72:75], v[168:171], a[144:147]
    v_mfma_f32_16x16x32_bf16 a[144:147], v[76:79], v[172:175], a[144:147]
    v_mfma_f32_16x16x32_bf16 a[176:179], v[64:67], v[176:179], a[176:179]
    ds_read_b64_tr_b16 v[80:81], v27 offset:49160
    v_mfma_f32_16x16x32_bf16 a[176:179], v[68:71], v[180:183], a[176:179]
    ds_read_b64_tr_b16 v[82:83], v27 offset:49672
    v_mfma_f32_16x16x32_bf16 a[176:179], v[72:75], v[184:187], a[176:179]
    ds_read_b64_tr_b16 v[84:85], v27 offset:53256
    v_accvgpr_read_b32 v48, a128
    v_mfma_f32_16x16x32_bf16 a[176:179], v[76:79], v[188:191], a[176:179]
    ds_read_b64_tr_b16 v[86:87], v27 offset:53768
    v_accvgpr_read_b32 v49, a129
    v_mfma_f32_16x16x32_bf16 a[208:211], v[64:67], v[192:195], a[208:211]
    ds_read_b64_tr_b16 v[88:89], v27 offset:57352
    v_accvgpr_read_b32 v50, a130
    v_mfma_f32_16x16x32_bf16 a[208:211], v[68:71], v[196:199], a[208:211]
    ds_read_b64_tr_b16 v[90:91], v27 offset:57864
    v_accvgpr_read_b32 v51, a131
    v_mfma_f32_16x16x32_bf16 a[208:211], v[72:75], v[200:203], a[208:211]
    ds_read_b64_tr_b16 v[92:93], v27 offset:61448
    v_accvgpr_read_b32 v52, a132
    v_mfma_f32_16x16x32_bf16 a[208:211], v[76:79], v[204:207], a[208:211]
    ds_read_b64_tr_b16 v[94:95], v27 offset:61960
    v_accvgpr_read_b32 v53, a133
    v_mfma_f32_16x16x32_bf16 a[240:243], v[64:67], v[208:211], a[240:243]
    v_accvgpr_read_b32 v54, a134
    v_accvgpr_read_b32 v55, a135
    v_mfma_f32_16x16x32_bf16 a[240:243], v[68:71], v[212:215], a[240:243]
    v_mul_f32 v48, s62, v48
    v_mul_f32 v49, s62, v49
    v_mfma_f32_16x16x32_bf16 a[240:243], v[72:75], v[216:219], a[240:243]
    v_mul_f32 v50, s62, v50
    v_mul_f32 v51, s62, v51
    v_mfma_f32_16x16x32_bf16 a[240:243], v[76:79], v[220:223], a[240:243]
    s_waitcnt lgkmcnt(4)
    s_add_u32 m0, s29, 81920
    v_mul_f32 v52, s62, v52
    v_mfma_f32_16x16x32_bf16 a[148:151], v[80:83], v[160:163], a[148:151]
    s_mov_b32 s66, 2097152
    buffer_load_dwordx4 v29, s[16:19], s66 offen lds
    v_mul_f32 v53, s62, v53
    v_mfma_f32_16x16x32_bf16 a[148:151], v[84:87], v[164:167], a[148:151]
    s_waitcnt lgkmcnt(0)
    s_add_u32 m0, s29, 82944
    v_mul_f32 v54, s62, v54
    v_mfma_f32_16x16x32_bf16 a[148:151], v[88:91], v[168:171], a[148:151]
    s_mov_b32 s67, 2162688
    buffer_load_dwordx4 v29, s[16:19], s67 offen lds
    v_mul_f32 v55, s62, v55
    v_mfma_f32_16x16x32_bf16 a[148:151], v[92:95], v[172:175], a[148:151]
    v_cvt_pk_bf16_f32 v48, v48, v49
    v_cvt_pk_bf16_f32 v49, v50, v51
    v_mfma_f32_16x16x32_bf16 a[180:183], v[80:83], v[176:179], a[180:183]
    ds_read_b64_tr_b16 v[64:65], v28 offset:49152
    v_cvt_pk_bf16_f32 v50, v52, v53
    v_mfma_f32_16x16x32_bf16 a[180:183], v[84:87], v[180:183], a[180:183]
    ds_read_b64_tr_b16 v[66:67], v28 offset:49664
    v_cvt_pk_bf16_f32 v51, v54, v55
    v_mfma_f32_16x16x32_bf16 a[180:183], v[88:91], v[184:187], a[180:183]
    ds_read_b64_tr_b16 v[68:69], v28 offset:53248
    v_accvgpr_write_b32 a128, v48
    v_mfma_f32_16x16x32_bf16 a[180:183], v[92:95], v[188:191], a[180:183]
    ds_read_b64_tr_b16 v[70:71], v28 offset:53760
    v_accvgpr_write_b32 a129, v49
    v_mfma_f32_16x16x32_bf16 a[212:215], v[80:83], v[192:195], a[212:215]
    ds_read_b64_tr_b16 v[72:73], v28 offset:57344
    v_accvgpr_write_b32 a130, v50
    v_mfma_f32_16x16x32_bf16 a[212:215], v[84:87], v[196:199], a[212:215]
    ds_read_b64_tr_b16 v[74:75], v28 offset:57856
    v_accvgpr_write_b32 a131, v51
    v_mfma_f32_16x16x32_bf16 a[212:215], v[88:91], v[200:203], a[212:215]
    ds_read_b64_tr_b16 v[76:77], v28 offset:61440
    v_accvgpr_read_b32 v56, a136
    v_mfma_f32_16x16x32_bf16 a[212:215], v[92:95], v[204:207], a[212:215]
    ds_read_b64_tr_b16 v[78:79], v28 offset:61952
    s_add_u32 m0, s29, 83968
    v_mfma_f32_16x16x32_bf16 a[244:247], v[80:83], v[208:211], a[244:247]
    s_mov_b32 s66, 2228224
    buffer_load_dwordx4 v29, s[16:19], s66 offen lds
    v_accvgpr_read_b32 v57, a137
    v_mfma_f32_16x16x32_bf16 a[244:247], v[84:87], v[212:215], a[244:247]
    s_add_u32 m0, s29, 84992
    v_accvgpr_read_b32 v58, a138
    v_mfma_f32_16x16x32_bf16 a[244:247], v[88:91], v[216:219], a[244:247]
    s_mov_b32 s67, 2293760
    buffer_load_dwordx4 v29, s[16:19], s67 offen lds
    v_accvgpr_read_b32 v59, a139
    v_mfma_f32_16x16x32_bf16 a[244:247], v[92:95], v[220:223], a[244:247]
    s_waitcnt lgkmcnt(4)
    s_add_u32 m0, s29, 131072
    v_accvgpr_read_b32 v60, a140
    v_mfma_f32_16x16x32_bf16 a[152:155], v[64:67], v[160:163], a[152:155]
    s_mov_b32 s68, 16384
    buffer_load_dwordx4 v24, s[12:15], s68 offen nt lds
    v_accvgpr_read_b32 v61, a141
    v_mfma_f32_16x16x32_bf16 a[152:155], v[68:71], v[164:167], a[152:155]
    s_waitcnt lgkmcnt(0)
    v_accvgpr_read_b32 v62, a142
    v_accvgpr_read_b32 v63, a143
    v_mfma_f32_16x16x32_bf16 a[152:155], v[72:75], v[168:171], a[152:155]
    buffer_load_dwordx4 v25, s[12:15], s68 offen offset:1024 nt lds
    v_mul_f32 v56, s62, v56
    v_mfma_f32_16x16x32_bf16 a[152:155], v[76:79], v[172:175], a[152:155]
    v_mul_f32 v57, s62, v57
    v_mul_f32 v58, s62, v58
    v_mfma_f32_16x16x32_bf16 a[184:187], v[64:67], v[176:179], a[184:187]
    ds_read_b64_tr_b16 v[80:81], v28 offset:49160
    v_mul_f32 v59, s62, v59
    v_mfma_f32_16x16x32_bf16 a[184:187], v[68:71], v[180:183], a[184:187]
    ds_read_b64_tr_b16 v[82:83], v28 offset:49672
    v_mul_f32 v60, s62, v60
    v_mfma_f32_16x16x32_bf16 a[184:187], v[72:75], v[184:187], a[184:187]
    ds_read_b64_tr_b16 v[84:85], v28 offset:53256
    v_mul_f32 v61, s62, v61
    v_mfma_f32_16x16x32_bf16 a[184:187], v[76:79], v[188:191], a[184:187]
    ds_read_b64_tr_b16 v[86:87], v28 offset:53768
    v_mul_f32 v62, s62, v62
    v_mfma_f32_16x16x32_bf16 a[216:219], v[64:67], v[192:195], a[216:219]
    ds_read_b64_tr_b16 v[88:89], v28 offset:57352
    v_mul_f32 v63, s62, v63
    v_mfma_f32_16x16x32_bf16 a[216:219], v[68:71], v[196:199], a[216:219]
    ds_read_b64_tr_b16 v[90:91], v28 offset:57864
    v_cvt_pk_bf16_f32 v56, v56, v57
    v_mfma_f32_16x16x32_bf16 a[216:219], v[72:75], v[200:203], a[216:219]
    ds_read_b64_tr_b16 v[92:93], v28 offset:61448
    v_cvt_pk_bf16_f32 v57, v58, v59
    v_mfma_f32_16x16x32_bf16 a[216:219], v[76:79], v[204:207], a[216:219]
    ds_read_b64_tr_b16 v[94:95], v28 offset:61960
    v_cvt_pk_bf16_f32 v58, v60, v61
    v_mfma_f32_16x16x32_bf16 a[248:251], v[64:67], v[208:211], a[248:251]
    buffer_load_dwordx4 v24, s[12:15], s68 offen offset:2048 nt lds
    v_cvt_pk_bf16_f32 v59, v62, v63
    v_mfma_f32_16x16x32_bf16 a[248:251], v[68:71], v[212:215], a[248:251]
    v_accvgpr_write_b32 a136, v56
    v_accvgpr_write_b32 a137, v57
    v_mfma_f32_16x16x32_bf16 a[248:251], v[72:75], v[216:219], a[248:251]
    buffer_load_dwordx4 v25, s[12:15], s68 offen offset:3072 nt lds
    v_accvgpr_write_b32 a138, v58
    v_mfma_f32_16x16x32_bf16 a[248:251], v[76:79], v[220:223], a[248:251]
    s_waitcnt lgkmcnt(4)
    v_accvgpr_write_b32 a139, v59
    v_accvgpr_read_b32 v48, a160
    v_mfma_f32_16x16x32_bf16 a[156:159], v[80:83], v[160:163], a[156:159]
    v_accvgpr_read_b32 v49, a161
    v_accvgpr_read_b32 v50, a162
    v_mfma_f32_16x16x32_bf16 a[156:159], v[84:87], v[164:167], a[156:159]
    s_waitcnt lgkmcnt(0)
    v_accvgpr_read_b32 v51, a163
    v_accvgpr_read_b32 v52, a164
    v_mfma_f32_16x16x32_bf16 a[156:159], v[88:91], v[168:171], a[156:159]
    v_accvgpr_read_b32 v53, a165
    v_accvgpr_read_b32 v54, a166
    v_mfma_f32_16x16x32_bf16 a[156:159], v[92:95], v[172:175], a[156:159]
    s_waitcnt vmcnt(20)
    s_barrier
    v_accvgpr_read_b32 v55, a167
    v_mul_f32 v48, s62, v48
    v_mfma_f32_16x16x32_bf16 a[188:191], v[80:83], v[176:179], a[188:191]
    ds_read_b64_tr_b16 v[64:65], v27
    v_mul_f32 v49, s62, v49
    v_mfma_f32_16x16x32_bf16 a[188:191], v[84:87], v[180:183], a[188:191]
    ds_read_b64_tr_b16 v[66:67], v27 offset:512
    v_mul_f32 v50, s62, v50
    v_mfma_f32_16x16x32_bf16 a[188:191], v[88:91], v[184:187], a[188:191]
    ds_read_b64_tr_b16 v[68:69], v27 offset:4096
    v_mul_f32 v51, s62, v51
    v_mfma_f32_16x16x32_bf16 a[188:191], v[92:95], v[188:191], a[188:191]
    ds_read_b64_tr_b16 v[70:71], v27 offset:4608
    v_mul_f32 v52, s62, v52
    v_mfma_f32_16x16x32_bf16 a[220:223], v[80:83], v[192:195], a[220:223]
    ds_read_b64_tr_b16 v[72:73], v27 offset:8192
    v_mul_f32 v53, s62, v53
    v_mfma_f32_16x16x32_bf16 a[220:223], v[84:87], v[196:199], a[220:223]
    ds_read_b64_tr_b16 v[74:75], v27 offset:8704
    v_mul_f32 v54, s62, v54
    v_mfma_f32_16x16x32_bf16 a[220:223], v[88:91], v[200:203], a[220:223]
    ds_read_b64_tr_b16 v[76:77], v27 offset:12288
    v_mul_f32 v55, s62, v55
    v_mfma_f32_16x16x32_bf16 a[220:223], v[92:95], v[204:207], a[220:223]
    ds_read_b64_tr_b16 v[78:79], v27 offset:12800
    v_cvt_pk_bf16_f32 v48, v48, v49
    v_mfma_f32_16x16x32_bf16 a[252:255], v[80:83], v[208:211], a[252:255]
    v_cvt_pk_bf16_f32 v49, v50, v51
    v_cvt_pk_bf16_f32 v50, v52, v53
    v_mfma_f32_16x16x32_bf16 a[252:255], v[84:87], v[212:215], a[252:255]
    v_cvt_pk_bf16_f32 v51, v54, v55
    v_accvgpr_write_b32 a160, v48
    v_mfma_f32_16x16x32_bf16 a[252:255], v[88:91], v[216:219], a[252:255]
    v_accvgpr_write_b32 a161, v49
    v_accvgpr_write_b32 a162, v50
    v_mfma_f32_16x16x32_bf16 a[252:255], v[92:95], v[220:223], a[252:255]
    s_waitcnt lgkmcnt(4)
    v_accvgpr_write_b32 a163, v51
    v_accvgpr_read_b32 v56, a168
    v_mfma_f32_16x16x32_bf16 a[0:3], v[64:67], v[160:163], a[0:3]
    v_accvgpr_read_b32 v57, a169
    v_accvgpr_read_b32 v58, a170
    v_mfma_f32_16x16x32_bf16 a[0:3], v[68:71], v[164:167], a[0:3]
    s_waitcnt lgkmcnt(0)
    v_accvgpr_read_b32 v59, a171
    v_accvgpr_read_b32 v60, a172
    v_mfma_f32_16x16x32_bf16 a[0:3], v[72:75], v[168:171], a[0:3]
    v_accvgpr_read_b32 v61, a173
    v_accvgpr_read_b32 v62, a174
    v_mfma_f32_16x16x32_bf16 a[0:3], v[76:79], v[172:175], a[0:3]
    v_accvgpr_read_b32 v63, a175
    v_mul_f32 v56, s62, v56
    v_mfma_f32_16x16x32_bf16 a[32:35], v[64:67], v[176:179], a[32:35]
    ds_read_b64_tr_b16 v[80:81], v27 offset:8
    v_mul_f32 v57, s62, v57
    v_mfma_f32_16x16x32_bf16 a[32:35], v[68:71], v[180:183], a[32:35]
    ds_read_b64_tr_b16 v[82:83], v27 offset:520
    v_mul_f32 v58, s62, v58
    v_mfma_f32_16x16x32_bf16 a[32:35], v[72:75], v[184:187], a[32:35]
    ds_read_b64_tr_b16 v[84:85], v27 offset:4104
    v_mul_f32 v59, s62, v59
    v_mfma_f32_16x16x32_bf16 a[32:35], v[76:79], v[188:191], a[32:35]
    ds_read_b64_tr_b16 v[86:87], v27 offset:4616
    v_mul_f32 v60, s62, v60
    v_mfma_f32_16x16x32_bf16 a[64:67], v[64:67], v[192:195], a[64:67]
    ds_read_b64_tr_b16 v[88:89], v27 offset:8200
    v_mul_f32 v61, s62, v61
    v_mfma_f32_16x16x32_bf16 a[64:67], v[68:71], v[196:199], a[64:67]
    ds_read_b64_tr_b16 v[90:91], v27 offset:8712
    v_mul_f32 v62, s62, v62
    v_mfma_f32_16x16x32_bf16 a[64:67], v[72:75], v[200:203], a[64:67]
    ds_read_b64_tr_b16 v[92:93], v27 offset:12296
    v_mul_f32 v63, s62, v63
    v_mfma_f32_16x16x32_bf16 a[64:67], v[76:79], v[204:207], a[64:67]
    ds_read_b64_tr_b16 v[94:95], v27 offset:12808
    v_cvt_pk_bf16_f32 v56, v56, v57
    v_mfma_f32_16x16x32_bf16 a[96:99], v[64:67], v[208:211], a[96:99]
    v_cvt_pk_bf16_f32 v57, v58, v59
    v_cvt_pk_bf16_f32 v58, v60, v61
    v_mfma_f32_16x16x32_bf16 a[96:99], v[68:71], v[212:215], a[96:99]
    v_cvt_pk_bf16_f32 v59, v62, v63
    v_accvgpr_write_b32 a168, v56
    v_mfma_f32_16x16x32_bf16 a[96:99], v[72:75], v[216:219], a[96:99]
    v_accvgpr_write_b32 a169, v57
    v_accvgpr_write_b32 a170, v58
    v_mfma_f32_16x16x32_bf16 a[96:99], v[76:79], v[220:223], a[96:99]
    s_waitcnt lgkmcnt(4)
    s_add_u32 m0, s29, 98304
    v_accvgpr_write_b32 a171, v59
    v_mfma_f32_16x16x32_bf16 a[4:7], v[80:83], v[160:163], a[4:7]
    s_mov_b32 s66, 2097280
    buffer_load_dwordx4 v29, s[16:19], s66 offen lds
    v_accvgpr_read_b32 v48, a192
    v_mfma_f32_16x16x32_bf16 a[4:7], v[84:87], v[164:167], a[4:7]
    s_waitcnt lgkmcnt(0)
    s_add_u32 m0, s29, 99328
    v_accvgpr_read_b32 v49, a193
    v_mfma_f32_16x16x32_bf16 a[4:7], v[88:91], v[168:171], a[4:7]
L_hop3:
    s_cbranch_execz L_hop7
    s_mov_b32 s67, 2162816
    buffer_load_dwordx4 v29, s[16:19], s67 offen lds
    v_accvgpr_read_b32 v50, a194
    v_mfma_f32_16x16x32_bf16 a[4:7], v[92:95], v[172:175], a[4:7]
    v_accvgpr_read_b32 v51, a195
    v_accvgpr_read_b32 v52, a196
    v_mfma_f32_16x16x32_bf16 a[36:39], v[80:83], v[176:179], a[36:39]
    ds_read_b64_tr_b16 v[64:65], v28
    v_accvgpr_read_b32 v53, a197
    v_mfma_f32_16x16x32_bf16 a[36:39], v[84:87], v[180:183], a[36:39]
    ds_read_b64_tr_b16 v[66:67], v28 offset:512
    v_accvgpr_read_b32 v54, a198
    v_mfma_f32_16x16x32_bf16 a[36:39], v[88:91], v[184:187], a[36:39]
    ds_read_b64_tr_b16 v[68:69], v28 offset:4096
    v_accvgpr_read_b32 v55, a199
    v_mfma_f32_16x16x32_bf16 a[36:39], v[92:95], v[188:191], a[36:39]
    ds_read_b64_tr_b16 v[70:71], v28 offset:4608
    v_mul_f32 v48, s62, v48
    v_mfma_f32_16x16x32_bf16 a[68:71], v[80:83], v[192:195], a[68:71]
    ds_read_b64_tr_b16 v[72:73], v28 offset:8192
    v_mul_f32 v49, s62, v49
    v_mfma_f32_16x16x32_bf16 a[68:71], v[84:87], v[196:199], a[68:71]
    ds_read_b64_tr_b16 v[74:75], v28 offset:8704
    v_mul_f32 v50, s62, v50
    v_mfma_f32_16x16x32_bf16 a[68:71], v[88:91], v[200:203], a[68:71]
    ds_read_b64_tr_b16 v[76:77], v28 offset:12288
    v_mul_f32 v51, s62, v51
    v_mfma_f32_16x16x32_bf16 a[68:71], v[92:95], v[204:207], a[68:71]
    ds_read_b64_tr_b16 v[78:79], v28 offset:12800
    s_add_u32 m0, s29, 100352
    v_mfma_f32_16x16x32_bf16 a[100:103], v[80:83], v[208:211], a[100:103]
    s_mov_b32 s66, 2228352
    buffer_load_dwordx4 v29, s[16:19], s66 offen lds
    v_mul_f32 v52, s62, v52
    v_mfma_f32_16x16x32_bf16 a[100:103], v[84:87], v[212:215], a[100:103]
    s_add_u32 m0, s29, 101376
    v_mul_f32 v53, s62, v53
    v_mfma_f32_16x16x32_bf16 a[100:103], v[88:91], v[216:219], a[100:103]
    s_mov_b32 s67, 2293888
    buffer_load_dwordx4 v29, s[16:19], s67 offen lds
    v_mul_f32 v54, s62, v54
    v_mfma_f32_16x16x32_bf16 a[100:103], v[92:95], v[220:223], a[100:103]
    s_waitcnt lgkmcnt(4)
    s_add_u32 m0, s29, 32768
    v_mul_f32 v55, s62, v55
    v_mfma_f32_16x16x32_bf16 a[8:11], v[64:67], v[160:163], a[8:11]
    s_mov_b32 s68, 32768
    buffer_load_dwordx4 v20, s[8:11], s68 offen nt lds
    v_cvt_pk_bf16_f32 v48, v48, v49
    v_mfma_f32_16x16x32_bf16 a[8:11], v[68:71], v[164:167], a[8:11]
    s_waitcnt lgkmcnt(0)
    v_cvt_pk_bf16_f32 v49, v50, v51
    v_cvt_pk_bf16_f32 v50, v52, v53
    v_mfma_f32_16x16x32_bf16 a[8:11], v[72:75], v[168:171], a[8:11]
    buffer_load_dwordx4 v21, s[8:11], s68 offen offset:1024 nt lds
    v_cvt_pk_bf16_f32 v51, v54, v55
    v_mfma_f32_16x16x32_bf16 a[8:11], v[76:79], v[172:175], a[8:11]
    v_accvgpr_write_b32 a192, v48
    v_accvgpr_write_b32 a193, v49
    v_mfma_f32_16x16x32_bf16 a[40:43], v[64:67], v[176:179], a[40:43]
    ds_read_b64_tr_b16 v[80:81], v28 offset:8
    v_accvgpr_write_b32 a194, v50
    v_mfma_f32_16x16x32_bf16 a[40:43], v[68:71], v[180:183], a[40:43]
    ds_read_b64_tr_b16 v[82:83], v28 offset:520
    v_accvgpr_write_b32 a195, v51
    v_mfma_f32_16x16x32_bf16 a[40:43], v[72:75], v[184:187], a[40:43]
    ds_read_b64_tr_b16 v[84:85], v28 offset:4104
    v_accvgpr_read_b32 v56, a200
    v_mfma_f32_16x16x32_bf16 a[40:43], v[76:79], v[188:191], a[40:43]
    ds_read_b64_tr_b16 v[86:87], v28 offset:4616
    v_accvgpr_read_b32 v57, a201
    v_mfma_f32_16x16x32_bf16 a[72:75], v[64:67], v[192:195], a[72:75]
    ds_read_b64_tr_b16 v[88:89], v28 offset:8200
    v_accvgpr_read_b32 v58, a202
    v_mfma_f32_16x16x32_bf16 a[72:75], v[68:71], v[196:199], a[72:75]
    ds_read_b64_tr_b16 v[90:91], v28 offset:8712
    v_accvgpr_read_b32 v59, a203
    v_mfma_f32_16x16x32_bf16 a[72:75], v[72:75], v[200:203], a[72:75]
    ds_read_b64_tr_b16 v[92:93], v28 offset:12296
    v_accvgpr_read_b32 v60, a204
    v_mfma_f32_16x16x32_bf16 a[72:75], v[76:79], v[204:207], a[72:75]
    ds_read_b64_tr_b16 v[94:95], v28 offset:12808
    v_accvgpr_read_b32 v61, a205
    v_mfma_f32_16x16x32_bf16 a[104:107], v[64:67], v[208:211], a[104:107]
    buffer_load_dwordx4 v22, s[8:11], s68 offen offset:2048 nt lds
    v_accvgpr_read_b32 v62, a206
    v_mfma_f32_16x16x32_bf16 a[104:107], v[68:71], v[212:215], a[104:107]
    v_accvgpr_read_b32 v63, a207
    v_mul_f32 v56, s62, v56
    v_mfma_f32_16x16x32_bf16 a[104:107], v[72:75], v[216:219], a[104:107]
    buffer_load_dwordx4 v23, s[8:11], s68 offen offset:3072 nt lds
    v_mul_f32 v57, s62, v57
    v_mfma_f32_16x16x32_bf16 a[104:107], v[76:79], v[220:223], a[104:107]
    s_waitcnt lgkmcnt(4)
    v_mul_f32 v58, s62, v58
    v_mul_f32 v59, s62, v59
    v_mfma_f32_16x16x32_bf16 a[12:15], v[80:83], v[160:163], a[12:15]
    v_mul_f32 v60, s62, v60
    v_mul_f32 v61, s62, v61
    v_mfma_f32_16x16x32_bf16 a[12:15], v[84:87], v[164:167], a[12:15]
    s_waitcnt lgkmcnt(0)
    v_mul_f32 v62, s62, v62
    v_mul_f32 v63, s62, v63
    v_mfma_f32_16x16x32_bf16 a[12:15], v[88:91], v[168:171], a[12:15]
    v_cvt_pk_bf16_f32 v56, v56, v57
    v_cvt_pk_bf16_f32 v57, v58, v59
    v_mfma_f32_16x16x32_bf16 a[12:15], v[92:95], v[172:175], a[12:15]
    s_waitcnt vmcnt(20)
    s_barrier
    v_cvt_pk_bf16_f32 v58, v60, v61
    v_cvt_pk_bf16_f32 v59, v62, v63
    v_mfma_f32_16x16x32_bf16 a[44:47], v[80:83], v[176:179], a[44:47]
    ds_read_b64_tr_b16 v[64:65], v27 offset:16384
    v_accvgpr_write_b32 a200, v56
    v_mfma_f32_16x16x32_bf16 a[44:47], v[84:87], v[180:183], a[44:47]
    ds_read_b64_tr_b16 v[66:67], v27 offset:16896
    v_accvgpr_write_b32 a201, v57
    v_mfma_f32_16x16x32_bf16 a[44:47], v[88:91], v[184:187], a[44:47]
    ds_read_b64_tr_b16 v[68:69], v27 offset:20480
    v_accvgpr_write_b32 a202, v58
    v_mfma_f32_16x16x32_bf16 a[44:47], v[92:95], v[188:191], a[44:47]
    ds_read_b64_tr_b16 v[70:71], v27 offset:20992
    v_accvgpr_write_b32 a203, v59
    v_mfma_f32_16x16x32_bf16 a[76:79], v[80:83], v[192:195], a[76:79]
    ds_read_b64_tr_b16 v[72:73], v27 offset:24576
    v_accvgpr_read_b32 v48, a224
    v_mfma_f32_16x16x32_bf16 a[76:79], v[84:87], v[196:199], a[76:79]
    ds_read_b64_tr_b16 v[74:75], v27 offset:25088
    v_accvgpr_read_b32 v49, a225
    v_mfma_f32_16x16x32_bf16 a[76:79], v[88:91], v[200:203], a[76:79]
    ds_read_b64_tr_b16 v[76:77], v27 offset:28672
    v_accvgpr_read_b32 v50, a226
    v_mfma_f32_16x16x32_bf16 a[76:79], v[92:95], v[204:207], a[76:79]
    ds_read_b64_tr_b16 v[78:79], v27 offset:29184
    v_accvgpr_read_b32 v51, a227
    v_mfma_f32_16x16x32_bf16 a[108:111], v[80:83], v[208:211], a[108:111]
    v_accvgpr_read_b32 v52, a228
    v_accvgpr_read_b32 v53, a229
    v_mfma_f32_16x16x32_bf16 a[108:111], v[84:87], v[212:215], a[108:111]
    v_accvgpr_read_b32 v54, a230
    v_accvgpr_read_b32 v55, a231
    v_mfma_f32_16x16x32_bf16 a[108:111], v[88:91], v[216:219], a[108:111]
    v_mul_f32 v48, s62, v48
    v_mul_f32 v49, s62, v49
    v_mfma_f32_16x16x32_bf16 a[108:111], v[92:95], v[220:223], a[108:111]
    s_waitcnt lgkmcnt(4)
    v_mul_f32 v50, s62, v50
    v_mul_f32 v51, s62, v51
    v_mfma_f32_16x16x32_bf16 a[16:19], v[64:67], v[160:163], a[16:19]
    v_mul_f32 v52, s62, v52
    v_mul_f32 v53, s62, v53
    v_mfma_f32_16x16x32_bf16 a[16:19], v[68:71], v[164:167], a[16:19]
    s_waitcnt lgkmcnt(0)
    v_mul_f32 v54, s62, v54
    v_mul_f32 v55, s62, v55
    v_mfma_f32_16x16x32_bf16 a[16:19], v[72:75], v[168:171], a[16:19]
    v_cvt_pk_bf16_f32 v48, v48, v49
    v_cvt_pk_bf16_f32 v49, v50, v51
    v_mfma_f32_16x16x32_bf16 a[16:19], v[76:79], v[172:175], a[16:19]
    v_cvt_pk_bf16_f32 v50, v52, v53
    v_cvt_pk_bf16_f32 v51, v54, v55
    v_mfma_f32_16x16x32_bf16 a[48:51], v[64:67], v[176:179], a[48:51]
    s_mov_b32 s77, 0
    ds_read_b64_tr_b16 v[80:81], v27 offset:16392
    v_accvgpr_write_b32 a224, v48
    v_mfma_f32_16x16x32_bf16 a[48:51], v[68:71], v[180:183], a[48:51]
    ds_read_b64_tr_b16 v[82:83], v27 offset:16904
    v_accvgpr_write_b32 a225, v49
    v_mfma_f32_16x16x32_bf16 a[48:51], v[72:75], v[184:187], a[48:51]
    s_mov_b64 s[16:17], s[8:9]
    ds_read_b64_tr_b16 v[84:85], v27 offset:20488
    v_accvgpr_write_b32 a226, v50
    v_mfma_f32_16x16x32_bf16 a[48:51], v[76:79], v[188:191], a[48:51]
    ds_read_b64_tr_b16 v[86:87], v27 offset:21000
    v_accvgpr_write_b32 a227, v51
    v_mfma_f32_16x16x32_bf16 a[80:83], v[64:67], v[192:195], a[80:83]
    s_mov_b32 s18, s10
    ds_read_b64_tr_b16 v[88:89], v27 offset:24584
    v_accvgpr_read_b32 v56, a232
    v_mfma_f32_16x16x32_bf16 a[80:83], v[68:71], v[196:199], a[80:83]
    ds_read_b64_tr_b16 v[90:91], v27 offset:25096
    v_accvgpr_read_b32 v57, a233
    v_mfma_f32_16x16x32_bf16 a[80:83], v[72:75], v[200:203], a[80:83]
    s_mov_b32 s19, 0x00020000
    ds_read_b64_tr_b16 v[92:93], v27 offset:28680
    v_accvgpr_read_b32 v58, a234
    v_mfma_f32_16x16x32_bf16 a[80:83], v[76:79], v[204:207], a[80:83]
    ds_read_b64_tr_b16 v[94:95], v27 offset:29192
    v_accvgpr_read_b32 v59, a235
    v_mfma_f32_16x16x32_bf16 a[112:115], v[64:67], v[208:211], a[112:115]
    s_mov_b32 s79, 16384
    v_accvgpr_read_b32 v60, a236
    v_accvgpr_read_b32 v61, a237
    v_mfma_f32_16x16x32_bf16 a[112:115], v[68:71], v[212:215], a[112:115]
    v_accvgpr_read_b32 v62, a238
    v_accvgpr_read_b32 v63, a239
    v_mfma_f32_16x16x32_bf16 a[112:115], v[72:75], v[216:219], a[112:115]
    s_mov_b32 s20, 0x80018
    v_mul_f32 v56, s62, v56
    v_mul_f32 v57, s62, v57
    v_mfma_f32_16x16x32_bf16 a[112:115], v[76:79], v[220:223], a[112:115]
    s_waitcnt lgkmcnt(4)
    s_add_u32 m0, s29, 147456
    v_mul_f32 v58, s62, v58
    v_mfma_f32_16x16x32_bf16 a[20:23], v[80:83], v[160:163], a[20:23]
    s_mov_b32 s68, 32768
    buffer_load_dwordx4 v24, s[12:15], s68 offen nt lds
    v_mul_f32 v59, s62, v59
    v_mfma_f32_16x16x32_bf16 a[20:23], v[84:87], v[164:167], a[20:23]
    s_waitcnt lgkmcnt(0)
    v_mul_f32 v60, s62, v60
    v_mul_f32 v61, s62, v61
    v_mfma_f32_16x16x32_bf16 a[20:23], v[88:91], v[168:171], a[20:23]
    s_mov_b32 s21, 0x80018
    buffer_load_dwordx4 v25, s[12:15], s68 offen offset:1024 nt lds
    v_mul_f32 v62, s62, v62
    v_mfma_f32_16x16x32_bf16 a[20:23], v[92:95], v[172:175], a[20:23]
    v_mul_f32 v63, s62, v63
    v_cvt_pk_bf16_f32 v56, v56, v57
    v_mfma_f32_16x16x32_bf16 a[52:55], v[80:83], v[176:179], a[52:55]
    s_mov_b32 s22, 9
    ds_read_b64_tr_b16 v[64:65], v28 offset:16384
    v_cvt_pk_bf16_f32 v57, v58, v59
    v_mfma_f32_16x16x32_bf16 a[52:55], v[84:87], v[180:183], a[52:55]
    ds_read_b64_tr_b16 v[66:67], v28 offset:16896
    v_cvt_pk_bf16_f32 v58, v60, v61
    v_mfma_f32_16x16x32_bf16 a[52:55], v[88:91], v[184:187], a[52:55]
    s_mov_b32 s48, 0x80000
    ds_read_b64_tr_b16 v[68:69], v28 offset:20480
    v_cvt_pk_bf16_f32 v59, v62, v63
    v_mfma_f32_16x16x32_bf16 a[52:55], v[92:95], v[188:191], a[52:55]
    ds_read_b64_tr_b16 v[70:71], v28 offset:20992
    v_accvgpr_write_b32 a232, v56
    v_mfma_f32_16x16x32_bf16 a[84:87], v[80:83], v[192:195], a[84:87]
    s_mov_b32 s23, 32
    ds_read_b64_tr_b16 v[72:73], v28 offset:24576
    v_accvgpr_write_b32 a233, v57
    v_mfma_f32_16x16x32_bf16 a[84:87], v[84:87], v[196:199], a[84:87]
    ds_read_b64_tr_b16 v[74:75], v28 offset:25088
    v_accvgpr_write_b32 a234, v58
    v_mfma_f32_16x16x32_bf16 a[84:87], v[88:91], v[200:203], a[84:87]
    s_mov_b32 s92, 0x14181c20
    ds_read_b64_tr_b16 v[76:77], v28 offset:28672
    v_accvgpr_write_b32 a235, v59
    v_mfma_f32_16x16x32_bf16 a[84:87], v[92:95], v[204:207], a[84:87]
    ds_read_b64_tr_b16 v[78:79], v28 offset:29184
    v_accvgpr_read_b32 v48, a144
    v_mfma_f32_16x16x32_bf16 a[116:119], v[80:83], v[208:211], a[116:119]
    s_mov_b32 s93, 0x12161a1e
    buffer_load_dwordx4 v24, s[12:15], s68 offen offset:2048 nt lds
    v_accvgpr_read_b32 v49, a145
    v_mfma_f32_16x16x32_bf16 a[116:119], v[84:87], v[212:215], a[116:119]
    v_accvgpr_read_b32 v50, a146
    v_accvgpr_read_b32 v51, a147
    v_mfma_f32_16x16x32_bf16 a[116:119], v[88:91], v[216:219], a[116:119]
    s_mov_b32 s95, 0
    buffer_load_dwordx4 v25, s[12:15], s68 offen offset:3072 nt lds
    v_accvgpr_read_b32 v52, a148
    v_mfma_f32_16x16x32_bf16 a[116:119], v[92:95], v[220:223], a[116:119]
    s_waitcnt lgkmcnt(4)
    v_accvgpr_read_b32 v53, a149
    v_accvgpr_read_b32 v54, a150
    v_mfma_f32_16x16x32_bf16 a[24:27], v[64:67], v[160:163], a[24:27]
    s_mov_b32 s49, 0
    v_accvgpr_read_b32 v55, a151
    v_mul_f32 v48, s62, v48
    v_mfma_f32_16x16x32_bf16 a[24:27], v[68:71], v[164:167], a[24:27]
    s_waitcnt lgkmcnt(0)
    v_mul_f32 v49, s62, v49
    v_mul_f32 v50, s62, v50
    v_mfma_f32_16x16x32_bf16 a[24:27], v[72:75], v[168:171], a[24:27]
    s_mov_b32 s74, 9
    v_mul_f32 v51, s62, v51
    v_mul_f32 v52, s62, v52
    v_mfma_f32_16x16x32_bf16 a[24:27], v[76:79], v[172:175], a[24:27]
    v_mul_f32 v53, s62, v53
    v_mul_f32 v54, s62, v54
    v_mfma_f32_16x16x32_bf16 a[56:59], v[64:67], v[176:179], a[56:59]
    s_mov_b32 s78, 9
    ds_read_b64_tr_b16 v[80:81], v28 offset:16392
    v_mul_f32 v55, s62, v55
    v_mfma_f32_16x16x32_bf16 a[56:59], v[68:71], v[180:183], a[56:59]
    ds_read_b64_tr_b16 v[82:83], v28 offset:16904
    v_cvt_pk_bf16_f32 v48, v48, v49
    v_mfma_f32_16x16x32_bf16 a[56:59], v[72:75], v[184:187], a[56:59]
    s_mov_b32 s30, 81920
    ds_read_b64_tr_b16 v[84:85], v28 offset:20488
    v_cvt_pk_bf16_f32 v49, v50, v51
    v_mfma_f32_16x16x32_bf16 a[56:59], v[76:79], v[188:191], a[56:59]
    ds_read_b64_tr_b16 v[86:87], v28 offset:21000
    v_cvt_pk_bf16_f32 v50, v52, v53
    v_mfma_f32_16x16x32_bf16 a[88:91], v[64:67], v[192:195], a[88:91]
    s_mov_b32 s31, 49152
    ds_read_b64_tr_b16 v[88:89], v28 offset:24584
    v_cvt_pk_bf16_f32 v51, v54, v55
    v_mfma_f32_16x16x32_bf16 a[88:91], v[68:71], v[196:199], a[88:91]
    ds_read_b64_tr_b16 v[90:91], v28 offset:25096
    v_accvgpr_write_b32 a144, v48
    v_mfma_f32_16x16x32_bf16 a[88:91], v[72:75], v[200:203], a[88:91]
    s_add_u32 s32, s29, 0
    ds_read_b64_tr_b16 v[92:93], v28 offset:28680
    v_accvgpr_write_b32 a145, v49
    v_mfma_f32_16x16x32_bf16 a[88:91], v[76:79], v[204:207], a[88:91]
    ds_read_b64_tr_b16 v[94:95], v28 offset:29192
    v_accvgpr_write_b32 a146, v50
    v_mfma_f32_16x16x32_bf16 a[120:123], v[64:67], v[208:211], a[120:123]
    s_add_u32 s33, s29, 81920
    v_accvgpr_write_b32 a147, v51
    v_accvgpr_read_b32 v56, a152
    v_mfma_f32_16x16x32_bf16 a[120:123], v[68:71], v[212:215], a[120:123]
    v_accvgpr_read_b32 v57, a153
    v_accvgpr_read_b32 v58, a154
    v_mfma_f32_16x16x32_bf16 a[120:123], v[72:75], v[216:219], a[120:123]
    s_mov_b32 s34, 0
    v_accvgpr_read_b32 v59, a155
    v_accvgpr_read_b32 v60, a156
    v_mfma_f32_16x16x32_bf16 a[120:123], v[76:79], v[220:223], a[120:123]
    s_waitcnt lgkmcnt(4)
    v_accvgpr_read_b32 v61, a157
    v_accvgpr_read_b32 v62, a158
    v_mfma_f32_16x16x32_bf16 a[28:31], v[80:83], v[160:163], a[28:31]
    s_mov_b32 s35, 16384
    v_accvgpr_read_b32 v63, a159
    v_mul_f32 v56, s62, v56
    v_mfma_f32_16x16x32_bf16 a[28:31], v[84:87], v[164:167], a[28:31]
    s_waitcnt lgkmcnt(0)
    v_mul_f32 v57, s62, v57
    v_mul_f32 v58, s62, v58
    v_mfma_f32_16x16x32_bf16 a[28:31], v[88:91], v[168:171], a[28:31]
    s_and_b32 s66, s50, 1920
    v_mul_f32 v59, s62, v59
    v_mul_f32 v60, s62, v60
    v_mfma_f32_16x16x32_bf16 a[28:31], v[92:95], v[172:175], a[28:31]
    s_waitcnt vmcnt(16)
    s_barrier
    v_mul_f32 v61, s62, v61
    v_mul_f32 v62, s62, v62
    v_mfma_f32_16x16x32_bf16 a[60:63], v[80:83], v[176:179], a[60:63]
    ds_read_b64_tr_b16 v[64:65], v27 offset:32768
    v_mul_f32 v63, s62, v63
    v_mfma_f32_16x16x32_bf16 a[60:63], v[84:87], v[180:183], a[60:63]
    ds_read_b64_tr_b16 v[66:67], v27 offset:33280
    v_cvt_pk_bf16_f32 v56, v56, v57
    v_mfma_f32_16x16x32_bf16 a[60:63], v[88:91], v[184:187], a[60:63]
    ds_read_b64_tr_b16 v[68:69], v27 offset:36864
    v_cvt_pk_bf16_f32 v57, v58, v59
    v_mfma_f32_16x16x32_bf16 a[60:63], v[92:95], v[188:191], a[60:63]
    ds_read_b64_tr_b16 v[70:71], v27 offset:37376
    v_cvt_pk_bf16_f32 v58, v60, v61
    v_mfma_f32_16x16x32_bf16 a[92:95], v[80:83], v[192:195], a[92:95]
    ds_read_b64_tr_b16 v[72:73], v27 offset:40960
    v_cvt_pk_bf16_f32 v59, v62, v63
    v_mfma_f32_16x16x32_bf16 a[92:95], v[84:87], v[196:199], a[92:95]
    ds_read_b64_tr_b16 v[74:75], v27 offset:41472
    v_accvgpr_write_b32 a152, v56
    v_mfma_f32_16x16x32_bf16 a[92:95], v[88:91], v[200:203], a[92:95]
    ds_read_b64_tr_b16 v[76:77], v27 offset:45056
    v_accvgpr_write_b32 a153, v57
    v_mfma_f32_16x16x32_bf16 a[92:95], v[92:95], v[204:207], a[92:95]
    ds_read_b64_tr_b16 v[78:79], v27 offset:45568
    v_accvgpr_write_b32 a154, v58
    v_mfma_f32_16x16x32_bf16 a[124:127], v[80:83], v[208:211], a[124:127]
    v_accvgpr_write_b32 a155, v59
    v_accvgpr_read_b32 v48, a176
    v_mfma_f32_16x16x32_bf16 a[124:127], v[84:87], v[212:215], a[124:127]
    v_accvgpr_read_b32 v49, a177
    v_accvgpr_read_b32 v50, a178
    v_mfma_f32_16x16x32_bf16 a[124:127], v[88:91], v[216:219], a[124:127]
    v_accvgpr_read_b32 v51, a179
    v_accvgpr_read_b32 v52, a180
    v_mfma_f32_16x16x32_bf16 a[124:127], v[92:95], v[220:223], a[124:127]
    s_waitcnt lgkmcnt(4)
    v_accvgpr_read_b32 v53, a181
    v_accvgpr_read_b32 v54, a182
    v_mfma_f32_16x16x32_bf16 a[0:3], v[64:67], v[96:99], a[0:3]
    v_accvgpr_read_b32 v55, a183
    v_mul_f32 v48, s62, v48
    v_mfma_f32_16x16x32_bf16 a[0:3], v[68:71], v[100:103], a[0:3]
    s_waitcnt lgkmcnt(0)
    v_mul_f32 v49, s62, v49
    v_mul_f32 v50, s62, v50
    v_mfma_f32_16x16x32_bf16 a[0:3], v[72:75], v[104:107], a[0:3]
    v_mul_f32 v51, s62, v51
    v_mul_f32 v52, s62, v52
    v_mfma_f32_16x16x32_bf16 a[0:3], v[76:79], v[108:111], a[0:3]
    v_mul_f32 v53, s62, v53
    v_mul_f32 v54, s62, v54
    v_mfma_f32_16x16x32_bf16 a[32:35], v[64:67], v[112:115], a[32:35]
    ds_read_b64_tr_b16 v[80:81], v27 offset:32776
    v_mul_f32 v55, s62, v55
    v_mfma_f32_16x16x32_bf16 a[32:35], v[68:71], v[116:119], a[32:35]
    ds_read_b64_tr_b16 v[82:83], v27 offset:33288
    v_cvt_pk_bf16_f32 v48, v48, v49
    v_mfma_f32_16x16x32_bf16 a[32:35], v[72:75], v[120:123], a[32:35]
    ds_read_b64_tr_b16 v[84:85], v27 offset:36872
    v_cvt_pk_bf16_f32 v49, v50, v51
    v_mfma_f32_16x16x32_bf16 a[32:35], v[76:79], v[124:127], a[32:35]
    ds_read_b64_tr_b16 v[86:87], v27 offset:37384
    v_cvt_pk_bf16_f32 v50, v52, v53
    v_mfma_f32_16x16x32_bf16 a[64:67], v[64:67], v[128:131], a[64:67]
    ds_read_b64_tr_b16 v[88:89], v27 offset:40968
    v_cvt_pk_bf16_f32 v51, v54, v55
    v_mfma_f32_16x16x32_bf16 a[64:67], v[68:71], v[132:135], a[64:67]
    ds_read_b64_tr_b16 v[90:91], v27 offset:41480
    v_accvgpr_write_b32 a176, v48
    v_mfma_f32_16x16x32_bf16 a[64:67], v[72:75], v[136:139], a[64:67]
    ds_read_b64_tr_b16 v[92:93], v27 offset:45064
    v_accvgpr_write_b32 a177, v49
    v_mfma_f32_16x16x32_bf16 a[64:67], v[76:79], v[140:143], a[64:67]
    ds_read_b64_tr_b16 v[94:95], v27 offset:45576
    v_accvgpr_write_b32 a178, v50
    v_mfma_f32_16x16x32_bf16 a[96:99], v[64:67], v[144:147], a[96:99]
    v_accvgpr_write_b32 a179, v51
    v_accvgpr_read_b32 v56, a184
    v_mfma_f32_16x16x32_bf16 a[96:99], v[68:71], v[148:151], a[96:99]
    v_accvgpr_read_b32 v57, a185
    v_accvgpr_read_b32 v58, a186
    v_mfma_f32_16x16x32_bf16 a[96:99], v[72:75], v[152:155], a[96:99]
    v_accvgpr_read_b32 v59, a187
    v_accvgpr_read_b32 v60, a188
    v_mfma_f32_16x16x32_bf16 a[96:99], v[76:79], v[156:159], a[96:99]
    s_waitcnt lgkmcnt(4)
    s_add_u32 m0, s29, 49152
    v_accvgpr_read_b32 v61, a189
    v_mfma_f32_16x16x32_bf16 a[4:7], v[80:83], v[96:99], a[4:7]
    s_mov_b32 s68, 49152
    buffer_load_dwordx4 v20, s[8:11], s68 offen nt lds
    v_accvgpr_read_b32 v62, a190
    v_mfma_f32_16x16x32_bf16 a[4:7], v[84:87], v[100:103], a[4:7]
    s_waitcnt lgkmcnt(0)
    v_accvgpr_read_b32 v63, a191
    v_mul_f32 v56, s62, v56
    v_mfma_f32_16x16x32_bf16 a[4:7], v[88:91], v[104:107], a[4:7]
    buffer_load_dwordx4 v21, s[8:11], s68 offen offset:1024 nt lds
    v_mul_f32 v57, s62, v57
    v_mfma_f32_16x16x32_bf16 a[4:7], v[92:95], v[108:111], a[4:7]
    v_mul_f32 v58, s62, v58
    v_mul_f32 v59, s62, v59
    v_mfma_f32_16x16x32_bf16 a[36:39], v[80:83], v[112:115], a[36:39]
    ds_read_b64_tr_b16 v[64:65], v28 offset:32768
    v_mul_f32 v60, s62, v60
    v_mfma_f32_16x16x32_bf16 a[36:39], v[84:87], v[116:119], a[36:39]
    ds_read_b64_tr_b16 v[66:67], v28 offset:33280
    v_mul_f32 v61, s62, v61
    v_mfma_f32_16x16x32_bf16 a[36:39], v[88:91], v[120:123], a[36:39]
    ds_read_b64_tr_b16 v[68:69], v28 offset:36864
    v_mul_f32 v62, s62, v62
    v_mfma_f32_16x16x32_bf16 a[36:39], v[92:95], v[124:127], a[36:39]
    ds_read_b64_tr_b16 v[70:71], v28 offset:37376
    v_mul_f32 v63, s62, v63
    v_mfma_f32_16x16x32_bf16 a[68:71], v[80:83], v[128:131], a[68:71]
    ds_read_b64_tr_b16 v[72:73], v28 offset:40960
    v_cvt_pk_bf16_f32 v56, v56, v57
    v_mfma_f32_16x16x32_bf16 a[68:71], v[84:87], v[132:135], a[68:71]
    ds_read_b64_tr_b16 v[74:75], v28 offset:41472
    v_cvt_pk_bf16_f32 v57, v58, v59
    v_mfma_f32_16x16x32_bf16 a[68:71], v[88:91], v[136:139], a[68:71]
    ds_read_b64_tr_b16 v[76:77], v28 offset:45056
    v_cvt_pk_bf16_f32 v58, v60, v61
    v_mfma_f32_16x16x32_bf16 a[68:71], v[92:95], v[140:143], a[68:71]
    ds_read_b64_tr_b16 v[78:79], v28 offset:45568
    v_cvt_pk_bf16_f32 v59, v62, v63
    v_mfma_f32_16x16x32_bf16 a[100:103], v[80:83], v[144:147], a[100:103]
    buffer_load_dwordx4 v22, s[8:11], s68 offen offset:2048 nt lds
    v_accvgpr_write_b32 a184, v56
    v_mfma_f32_16x16x32_bf16 a[100:103], v[84:87], v[148:151], a[100:103]
    v_accvgpr_write_b32 a185, v57
    v_accvgpr_write_b32 a186, v58
    v_mfma_f32_16x16x32_bf16 a[100:103], v[88:91], v[152:155], a[100:103]
    buffer_load_dwordx4 v23, s[8:11], s68 offen offset:3072 nt lds
    v_accvgpr_write_b32 a187, v59
    v_mfma_f32_16x16x32_bf16 a[100:103], v[92:95], v[156:159], a[100:103]
    s_waitcnt lgkmcnt(4)
    v_accvgpr_read_b32 v48, a208
    v_accvgpr_read_b32 v49, a209
    v_mfma_f32_16x16x32_bf16 a[8:11], v[64:67], v[96:99], a[8:11]
    v_accvgpr_read_b32 v50, a210
    v_accvgpr_read_b32 v51, a211
    v_mfma_f32_16x16x32_bf16 a[8:11], v[68:71], v[100:103], a[8:11]
    s_waitcnt lgkmcnt(0)
    v_accvgpr_read_b32 v52, a212
    v_accvgpr_read_b32 v53, a213
    v_mfma_f32_16x16x32_bf16 a[8:11], v[72:75], v[104:107], a[8:11]
    v_accvgpr_read_b32 v54, a214
    v_accvgpr_read_b32 v55, a215
    v_mfma_f32_16x16x32_bf16 a[8:11], v[76:79], v[108:111], a[8:11]
    v_mul_f32 v48, s62, v48
    v_mul_f32 v49, s62, v49
    v_mfma_f32_16x16x32_bf16 a[40:43], v[64:67], v[112:115], a[40:43]
    ds_read_b64_tr_b16 v[80:81], v28 offset:32776
    v_mul_f32 v50, s62, v50
    v_mfma_f32_16x16x32_bf16 a[40:43], v[68:71], v[116:119], a[40:43]
    ds_read_b64_tr_b16 v[82:83], v28 offset:33288
    v_mul_f32 v51, s62, v51
    v_mfma_f32_16x16x32_bf16 a[40:43], v[72:75], v[120:123], a[40:43]
    ds_read_b64_tr_b16 v[84:85], v28 offset:36872
    v_mul_f32 v52, s62, v52
    v_mfma_f32_16x16x32_bf16 a[40:43], v[76:79], v[124:127], a[40:43]
    ds_read_b64_tr_b16 v[86:87], v28 offset:37384
    v_mul_f32 v53, s62, v53
    v_mfma_f32_16x16x32_bf16 a[72:75], v[64:67], v[128:131], a[72:75]
    ds_read_b64_tr_b16 v[88:89], v28 offset:40968
    v_mul_f32 v54, s62, v54
    v_mfma_f32_16x16x32_bf16 a[72:75], v[68:71], v[132:135], a[72:75]
    ds_read_b64_tr_b16 v[90:91], v28 offset:41480
    v_mul_f32 v55, s62, v55
    v_mfma_f32_16x16x32_bf16 a[72:75], v[72:75], v[136:139], a[72:75]
    ds_read_b64_tr_b16 v[92:93], v28 offset:45064
    v_cvt_pk_bf16_f32 v48, v48, v49
    v_mfma_f32_16x16x32_bf16 a[72:75], v[76:79], v[140:143], a[72:75]
    ds_read_b64_tr_b16 v[94:95], v28 offset:45576
    v_cvt_pk_bf16_f32 v49, v50, v51
    v_mfma_f32_16x16x32_bf16 a[104:107], v[64:67], v[144:147], a[104:107]
    v_cvt_pk_bf16_f32 v50, v52, v53
    v_cvt_pk_bf16_f32 v51, v54, v55
    v_mfma_f32_16x16x32_bf16 a[104:107], v[68:71], v[148:151], a[104:107]
    v_accvgpr_write_b32 a208, v48
    v_accvgpr_write_b32 a209, v49
    v_mfma_f32_16x16x32_bf16 a[104:107], v[72:75], v[152:155], a[104:107]
    v_accvgpr_write_b32 a210, v50
    v_accvgpr_write_b32 a211, v51
    v_mfma_f32_16x16x32_bf16 a[104:107], v[76:79], v[156:159], a[104:107]
    s_waitcnt lgkmcnt(4)
    v_accvgpr_read_b32 v56, a216
    v_accvgpr_read_b32 v57, a217
    v_mfma_f32_16x16x32_bf16 a[12:15], v[80:83], v[96:99], a[12:15]
    v_accvgpr_read_b32 v58, a218
    v_accvgpr_read_b32 v59, a219
    v_mfma_f32_16x16x32_bf16 a[12:15], v[84:87], v[100:103], a[12:15]
    s_waitcnt lgkmcnt(0)
    v_accvgpr_read_b32 v60, a220
    v_accvgpr_read_b32 v61, a221
    v_mfma_f32_16x16x32_bf16 a[12:15], v[88:91], v[104:107], a[12:15]
    v_accvgpr_read_b32 v62, a222
    v_accvgpr_read_b32 v63, a223
    v_mfma_f32_16x16x32_bf16 a[12:15], v[92:95], v[108:111], a[12:15]
    s_waitcnt vmcnt(12)
    s_barrier
    v_mul_f32 v56, s62, v56
    v_mul_f32 v57, s62, v57
    v_mfma_f32_16x16x32_bf16 a[44:47], v[80:83], v[112:115], a[44:47]
    ds_read_b64_tr_b16 v[64:65], v27 offset:49152
    v_mul_f32 v58, s62, v58
    v_mfma_f32_16x16x32_bf16 a[44:47], v[84:87], v[116:119], a[44:47]
    ds_read_b64_tr_b16 v[66:67], v27 offset:49664
    v_mul_f32 v59, s62, v59
    v_mfma_f32_16x16x32_bf16 a[44:47], v[88:91], v[120:123], a[44:47]
    ds_read_b64_tr_b16 v[68:69], v27 offset:53248
    v_mul_f32 v60, s62, v60
    v_mfma_f32_16x16x32_bf16 a[44:47], v[92:95], v[124:127], a[44:47]
    ds_read_b64_tr_b16 v[70:71], v27 offset:53760
    v_mul_f32 v61, s62, v61
    v_mfma_f32_16x16x32_bf16 a[76:79], v[80:83], v[128:131], a[76:79]
    ds_read_b64_tr_b16 v[72:73], v27 offset:57344
    v_mul_f32 v62, s62, v62
    v_mfma_f32_16x16x32_bf16 a[76:79], v[84:87], v[132:135], a[76:79]
    ds_read_b64_tr_b16 v[74:75], v27 offset:57856
    v_mul_f32 v63, s62, v63
    v_mfma_f32_16x16x32_bf16 a[76:79], v[88:91], v[136:139], a[76:79]
    ds_read_b64_tr_b16 v[76:77], v27 offset:61440
    v_cvt_pk_bf16_f32 v56, v56, v57
    v_mfma_f32_16x16x32_bf16 a[76:79], v[92:95], v[140:143], a[76:79]
    ds_read_b64_tr_b16 v[78:79], v27 offset:61952
    v_cvt_pk_bf16_f32 v57, v58, v59
    v_mfma_f32_16x16x32_bf16 a[108:111], v[80:83], v[144:147], a[108:111]
    v_cvt_pk_bf16_f32 v58, v60, v61
    v_cvt_pk_bf16_f32 v59, v62, v63
    v_mfma_f32_16x16x32_bf16 a[108:111], v[84:87], v[148:151], a[108:111]
    v_accvgpr_write_b32 a216, v56
    v_accvgpr_write_b32 a217, v57
    v_mfma_f32_16x16x32_bf16 a[108:111], v[88:91], v[152:155], a[108:111]
L_hop4:
    s_cbranch_execz L_hop8
    v_accvgpr_write_b32 a218, v58
    v_accvgpr_write_b32 a219, v59
    v_mfma_f32_16x16x32_bf16 a[108:111], v[92:95], v[156:159], a[108:111]
    s_waitcnt lgkmcnt(4)
    v_accvgpr_read_b32 v48, a240
    v_accvgpr_read_b32 v49, a241
    v_mfma_f32_16x16x32_bf16 a[16:19], v[64:67], v[96:99], a[16:19]
    v_accvgpr_read_b32 v50, a242
    v_accvgpr_read_b32 v51, a243
    v_mfma_f32_16x16x32_bf16 a[16:19], v[68:71], v[100:103], a[16:19]
    s_waitcnt lgkmcnt(0)
    v_accvgpr_read_b32 v52, a244
    v_accvgpr_read_b32 v53, a245
    v_mfma_f32_16x16x32_bf16 a[16:19], v[72:75], v[104:107], a[16:19]
    v_accvgpr_read_b32 v54, a246
    v_accvgpr_read_b32 v55, a247
    v_mfma_f32_16x16x32_bf16 a[16:19], v[76:79], v[108:111], a[16:19]
    v_mul_f32 v48, s62, v48
    v_mul_f32 v49, s62, v49
    v_mfma_f32_16x16x32_bf16 a[48:51], v[64:67], v[112:115], a[48:51]
    ds_read_b64_tr_b16 v[80:81], v27 offset:49160
    v_mul_f32 v50, s62, v50
    v_mfma_f32_16x16x32_bf16 a[48:51], v[68:71], v[116:119], a[48:51]
    ds_read_b64_tr_b16 v[82:83], v27 offset:49672
    v_mul_f32 v51, s62, v51
    v_mfma_f32_16x16x32_bf16 a[48:51], v[72:75], v[120:123], a[48:51]
    ds_read_b64_tr_b16 v[84:85], v27 offset:53256
    v_mul_f32 v52, s62, v52
    v_mfma_f32_16x16x32_bf16 a[48:51], v[76:79], v[124:127], a[48:51]
    ds_read_b64_tr_b16 v[86:87], v27 offset:53768
    v_mul_f32 v53, s62, v53
    v_mfma_f32_16x16x32_bf16 a[80:83], v[64:67], v[128:131], a[80:83]
    ds_read_b64_tr_b16 v[88:89], v27 offset:57352
    v_mul_f32 v54, s62, v54
    v_mfma_f32_16x16x32_bf16 a[80:83], v[68:71], v[132:135], a[80:83]
    ds_read_b64_tr_b16 v[90:91], v27 offset:57864
    v_mul_f32 v55, s62, v55
    v_mfma_f32_16x16x32_bf16 a[80:83], v[72:75], v[136:139], a[80:83]
    ds_read_b64_tr_b16 v[92:93], v27 offset:61448
    v_cvt_pk_bf16_f32 v48, v48, v49
    v_mfma_f32_16x16x32_bf16 a[80:83], v[76:79], v[140:143], a[80:83]
    ds_read_b64_tr_b16 v[94:95], v27 offset:61960
    v_cvt_pk_bf16_f32 v49, v50, v51
    v_mfma_f32_16x16x32_bf16 a[112:115], v[64:67], v[144:147], a[112:115]
    v_cvt_pk_bf16_f32 v50, v52, v53
    v_cvt_pk_bf16_f32 v51, v54, v55
    v_mfma_f32_16x16x32_bf16 a[112:115], v[68:71], v[148:151], a[112:115]
    v_accvgpr_write_b32 a240, v48
    v_accvgpr_write_b32 a241, v49
    v_mfma_f32_16x16x32_bf16 a[112:115], v[72:75], v[152:155], a[112:115]
    v_accvgpr_write_b32 a242, v50
    v_accvgpr_write_b32 a243, v51
    v_mfma_f32_16x16x32_bf16 a[112:115], v[76:79], v[156:159], a[112:115]
    s_waitcnt lgkmcnt(4)
    s_add_u32 m0, s29, 65536
    v_accvgpr_read_b32 v56, a248
    v_mfma_f32_16x16x32_bf16 a[20:23], v[80:83], v[96:99], a[20:23]
    s_mov_b32 s68, 65536
    buffer_load_dwordx4 v20, s[8:11], s68 offen nt lds
    v_accvgpr_read_b32 v57, a249
    v_mfma_f32_16x16x32_bf16 a[20:23], v[84:87], v[100:103], a[20:23]
    s_waitcnt lgkmcnt(0)
    v_accvgpr_read_b32 v58, a250
    v_accvgpr_read_b32 v59, a251
    v_mfma_f32_16x16x32_bf16 a[20:23], v[88:91], v[104:107], a[20:23]
    buffer_load_dwordx4 v21, s[8:11], s68 offen offset:1024 nt lds
    v_accvgpr_read_b32 v60, a252
    v_mfma_f32_16x16x32_bf16 a[20:23], v[92:95], v[108:111], a[20:23]
    v_accvgpr_read_b32 v61, a253
    v_accvgpr_read_b32 v62, a254
    v_mfma_f32_16x16x32_bf16 a[52:55], v[80:83], v[112:115], a[52:55]
    ds_read_b64_tr_b16 v[64:65], v28 offset:49152
    v_accvgpr_read_b32 v63, a255
    v_mfma_f32_16x16x32_bf16 a[52:55], v[84:87], v[116:119], a[52:55]
    ds_read_b64_tr_b16 v[66:67], v28 offset:49664
    v_mul_f32 v56, s62, v56
    v_mfma_f32_16x16x32_bf16 a[52:55], v[88:91], v[120:123], a[52:55]
    ds_read_b64_tr_b16 v[68:69], v28 offset:53248
    v_mul_f32 v57, s62, v57
    v_mfma_f32_16x16x32_bf16 a[52:55], v[92:95], v[124:127], a[52:55]
    ds_read_b64_tr_b16 v[70:71], v28 offset:53760
    v_mul_f32 v58, s62, v58
    v_mfma_f32_16x16x32_bf16 a[84:87], v[80:83], v[128:131], a[84:87]
    ds_read_b64_tr_b16 v[72:73], v28 offset:57344
    v_mul_f32 v59, s62, v59
    v_mfma_f32_16x16x32_bf16 a[84:87], v[84:87], v[132:135], a[84:87]
    ds_read_b64_tr_b16 v[74:75], v28 offset:57856
    v_mul_f32 v60, s62, v60
    v_mfma_f32_16x16x32_bf16 a[84:87], v[88:91], v[136:139], a[84:87]
    ds_read_b64_tr_b16 v[76:77], v28 offset:61440
    v_mul_f32 v61, s62, v61
    v_mfma_f32_16x16x32_bf16 a[84:87], v[92:95], v[140:143], a[84:87]
    ds_read_b64_tr_b16 v[78:79], v28 offset:61952
    v_mul_f32 v62, s62, v62
    v_mfma_f32_16x16x32_bf16 a[116:119], v[80:83], v[144:147], a[116:119]
    buffer_load_dwordx4 v22, s[8:11], s68 offen offset:2048 nt lds
    v_mul_f32 v63, s62, v63
    v_mfma_f32_16x16x32_bf16 a[116:119], v[84:87], v[148:151], a[116:119]
    v_cvt_pk_bf16_f32 v56, v56, v57
    v_cvt_pk_bf16_f32 v57, v58, v59
    v_mfma_f32_16x16x32_bf16 a[116:119], v[88:91], v[152:155], a[116:119]
    buffer_load_dwordx4 v23, s[8:11], s68 offen offset:3072 nt lds
    v_cvt_pk_bf16_f32 v58, v60, v61
    v_mfma_f32_16x16x32_bf16 a[116:119], v[92:95], v[156:159], a[116:119]
    s_waitcnt lgkmcnt(4)
    v_cvt_pk_bf16_f32 v59, v62, v63
    v_accvgpr_write_b32 a248, v56
    v_mfma_f32_16x16x32_bf16 a[24:27], v[64:67], v[96:99], a[24:27]
    v_accvgpr_write_b32 a249, v57
    v_accvgpr_write_b32 a250, v58
    v_mfma_f32_16x16x32_bf16 a[24:27], v[68:71], v[100:103], a[24:27]
    s_waitcnt lgkmcnt(0)
    v_accvgpr_write_b32 a251, v59
    v_accvgpr_read_b32 v48, a0
    v_mfma_f32_16x16x32_bf16 a[24:27], v[72:75], v[104:107], a[24:27]
    v_accvgpr_read_b32 v49, a1
    v_accvgpr_read_b32 v50, a2
    v_mfma_f32_16x16x32_bf16 a[24:27], v[76:79], v[108:111], a[24:27]
    v_accvgpr_read_b32 v51, a3
    v_accvgpr_read_b32 v52, a4
    v_mfma_f32_16x16x32_bf16 a[56:59], v[64:67], v[112:115], a[56:59]
    ds_read_b64_tr_b16 v[80:81], v28 offset:49160
    v_accvgpr_read_b32 v53, a5
    v_mfma_f32_16x16x32_bf16 a[56:59], v[68:71], v[116:119], a[56:59]
    ds_read_b64_tr_b16 v[82:83], v28 offset:49672
    v_accvgpr_read_b32 v54, a6
    v_mfma_f32_16x16x32_bf16 a[56:59], v[72:75], v[120:123], a[56:59]
    ds_read_b64_tr_b16 v[84:85], v28 offset:53256
    v_accvgpr_read_b32 v55, a7
    v_mfma_f32_16x16x32_bf16 a[56:59], v[76:79], v[124:127], a[56:59]
    ds_read_b64_tr_b16 v[86:87], v28 offset:53768
    v_mul_f32 v48, s62, v48
    v_mfma_f32_16x16x32_bf16 a[88:91], v[64:67], v[128:131], a[88:91]
    ds_read_b64_tr_b16 v[88:89], v28 offset:57352
    v_mul_f32 v49, s62, v49
    v_mfma_f32_16x16x32_bf16 a[88:91], v[68:71], v[132:135], a[88:91]
    ds_read_b64_tr_b16 v[90:91], v28 offset:57864
    v_mul_f32 v50, s62, v50
    v_mfma_f32_16x16x32_bf16 a[88:91], v[72:75], v[136:139], a[88:91]
    ds_read_b64_tr_b16 v[92:93], v28 offset:61448
    v_mul_f32 v51, s62, v51
    v_mfma_f32_16x16x32_bf16 a[88:91], v[76:79], v[140:143], a[88:91]
    ds_read_b64_tr_b16 v[94:95], v28 offset:61960
    v_mul_f32 v52, s62, v52
    v_mfma_f32_16x16x32_bf16 a[120:123], v[64:67], v[144:147], a[120:123]
    v_mul_f32 v53, s62, v53
    v_mul_f32 v54, s62, v54
    v_mfma_f32_16x16x32_bf16 a[120:123], v[68:71], v[148:151], a[120:123]
    v_mul_f32 v55, s62, v55
    v_cvt_pk_bf16_f32 v160, v48, v49
    v_mfma_f32_16x16x32_bf16 a[120:123], v[72:75], v[152:155], a[120:123]
    v_cvt_pk_bf16_f32 v161, v50, v51
    v_cvt_pk_bf16_f32 v162, v52, v53
    v_mfma_f32_16x16x32_bf16 a[120:123], v[76:79], v[156:159], a[120:123]
    s_waitcnt lgkmcnt(4)
    v_cvt_pk_bf16_f32 v163, v54, v55
    v_accvgpr_read_b32 v56, a8
    v_mfma_f32_16x16x32_bf16 a[28:31], v[80:83], v[96:99], a[28:31]
    v_accvgpr_read_b32 v57, a9
    v_accvgpr_read_b32 v58, a10
    v_mfma_f32_16x16x32_bf16 a[28:31], v[84:87], v[100:103], a[28:31]
    s_waitcnt lgkmcnt(0)
    v_accvgpr_read_b32 v59, a11
    v_accvgpr_read_b32 v60, a12
    v_mfma_f32_16x16x32_bf16 a[28:31], v[88:91], v[104:107], a[28:31]
    v_accvgpr_read_b32 v61, a13
    v_accvgpr_read_b32 v62, a14
    v_mfma_f32_16x16x32_bf16 a[28:31], v[92:95], v[108:111], a[28:31]
    s_waitcnt vmcnt(44)
    s_barrier
    v_accvgpr_read_b32 v63, a15
    v_mul_f32 v56, s62, v56
    v_mfma_f32_16x16x32_bf16 a[60:63], v[80:83], v[112:115], a[60:63]
    v_mul_f32 v57, s62, v57
    v_mul_f32 v58, s62, v58
    v_mfma_f32_16x16x32_bf16 a[60:63], v[84:87], v[116:119], a[60:63]
    v_mul_f32 v59, s62, v59
    v_mul_f32 v60, s62, v60
    v_mfma_f32_16x16x32_bf16 a[60:63], v[88:91], v[120:123], a[60:63]
    v_mul_f32 v61, s62, v61
    v_mul_f32 v62, s62, v62
    v_mfma_f32_16x16x32_bf16 a[60:63], v[92:95], v[124:127], a[60:63]
    v_mul_f32 v63, s62, v63
    v_cvt_pk_bf16_f32 v164, v56, v57
    v_mfma_f32_16x16x32_bf16 a[92:95], v[80:83], v[128:131], a[92:95]
    v_cvt_pk_bf16_f32 v165, v58, v59
    v_cvt_pk_bf16_f32 v166, v60, v61
    v_mfma_f32_16x16x32_bf16 a[92:95], v[84:87], v[132:135], a[92:95]
    v_cvt_pk_bf16_f32 v167, v62, v63
    v_mfma_f32_16x16x32_bf16 a[92:95], v[88:91], v[136:139], a[92:95]
    v_mfma_f32_16x16x32_bf16 a[92:95], v[92:95], v[140:143], a[92:95]
    v_mfma_f32_16x16x32_bf16 a[124:127], v[80:83], v[144:147], a[124:127]
    v_mfma_f32_16x16x32_bf16 a[124:127], v[84:87], v[148:151], a[124:127]
    v_mfma_f32_16x16x32_bf16 a[124:127], v[88:91], v[152:155], a[124:127]
    v_mfma_f32_16x16x32_bf16 a[124:127], v[92:95], v[156:159], a[124:127]
    ds_read_b128 v[64:67], v8
    ds_read_b128 v[68:71], v9
    ds_read_b128 v[72:75], v10
    ds_read_b128 v[76:79], v11
    v_mov_b32 v4, 0
    global_store_dword v31, v4, s[60:61] sc1
    v_lshlrev_b32 v28, 5, v30
    v_add_u32 v28, 0x3e00000, v28
    s_cmp_eq_u32 s66, 0
    s_cbranch_scc0 L_noinit
    global_store_dword v28, v4, s[60:61] sc1
L_noinit:
    v_accvgpr_read_b32 v96, a16
    v_accvgpr_read_b32 v97, a17
    v_accvgpr_read_b32 v98, a18
    v_accvgpr_read_b32 v99, a19
    v_accvgpr_read_b32 v100, a20
    v_accvgpr_read_b32 v101, a21
    v_accvgpr_read_b32 v102, a22
    v_accvgpr_read_b32 v103, a23
    v_pk_mul_f32 v[96:97], v[96:97], s[62:63]
    v_pk_mul_f32 v[98:99], v[98:99], s[62:63]
    v_pk_mul_f32 v[100:101], v[100:101], s[62:63]
    v_pk_mul_f32 v[102:103], v[102:103], s[62:63]
    v_cvt_pk_bf16_f32 v168, v96, v97
    v_cvt_pk_bf16_f32 v169, v98, v99
    v_cvt_pk_bf16_f32 v170, v100, v101
    v_cvt_pk_bf16_f32 v171, v102, v103
    v_accvgpr_read_b32 v104, a24
    v_accvgpr_read_b32 v105, a25
    v_accvgpr_read_b32 v106, a26
    v_accvgpr_read_b32 v107, a27
    v_accvgpr_read_b32 v108, a28
    v_accvgpr_read_b32 v109, a29
    v_accvgpr_read_b32 v110, a30
    v_accvgpr_read_b32 v111, a31
    v_pk_mul_f32 v[104:105], v[104:105], s[62:63]
    v_pk_mul_f32 v[106:107], v[106:107], s[62:63]
    v_pk_mul_f32 v[108:109], v[108:109], s[62:63]
    v_pk_mul_f32 v[110:111], v[110:111], s[62:63]
    v_cvt_pk_bf16_f32 v172, v104, v105
    v_cvt_pk_bf16_f32 v173, v106, v107
    v_cvt_pk_bf16_f32 v174, v108, v109
    v_cvt_pk_bf16_f32 v175, v110, v111
    s_waitcnt lgkmcnt(0)
    v_mfma_f32_16x16x32_bf16 v[48:51], v[64:67], v[160:163], 0
    v_accvgpr_read_b32 v112, a32
    v_accvgpr_read_b32 v113, a33
    v_mfma_f32_16x16x32_bf16 v[48:51], v[68:71], v[164:167], v[48:51]
    v_accvgpr_read_b32 v114, a34
    v_accvgpr_read_b32 v115, a35
    v_mfma_f32_16x16x32_bf16 v[48:51], v[72:75], v[168:171], v[48:51]
    v_accvgpr_read_b32 v116, a36
    v_accvgpr_read_b32 v117, a37
    v_mfma_f32_16x16x32_bf16 v[48:51], v[76:79], v[172:175], v[48:51]
    v_accvgpr_read_b32 v118, a38
    v_accvgpr_read_b32 v119, a39
    v_pk_mul_f32 v[112:113], v[112:113], s[62:63]
    v_pk_mul_f32 v[114:115], v[114:115], s[62:63]
    v_pk_mul_f32 v[116:117], v[116:117], s[62:63]
    v_pk_mul_f32 v[118:119], v[118:119], s[62:63]
    v_cvt_pk_bf16_f32 v176, v112, v113
    v_cvt_pk_bf16_f32 v177, v114, v115
    v_cvt_pk_bf16_f32 v178, v116, v117
    v_cvt_pk_bf16_f32 v179, v118, v119
    v_accvgpr_read_b32 v120, a40
    v_accvgpr_read_b32 v121, a41
    v_accvgpr_read_b32 v122, a42
    v_accvgpr_read_b32 v123, a43
    v_accvgpr_read_b32 v124, a44
    v_accvgpr_read_b32 v125, a45
    v_accvgpr_read_b32 v126, a46
    v_accvgpr_read_b32 v127, a47
    v_pk_mul_f32 v[120:121], v[120:121], s[62:63]
    v_pk_mul_f32 v[122:123], v[122:123], s[62:63]
    v_pk_mul_f32 v[124:125], v[124:125], s[62:63]
    v_pk_mul_f32 v[126:127], v[126:127], s[62:63]
    v_cvt_pk_bf16_f32 v180, v120, v121
    v_cvt_pk_bf16_f32 v181, v122, v123
    v_cvt_pk_bf16_f32 v182, v124, v125
    v_cvt_pk_bf16_f32 v183, v126, v127
    v_accvgpr_read_b32 v96, a48
    v_accvgpr_read_b32 v97, a49
    v_accvgpr_read_b32 v98, a50
    v_accvgpr_read_b32 v99, a51
    v_accvgpr_read_b32 v100, a52
    v_accvgpr_read_b32 v101, a53
    v_accvgpr_read_b32 v102, a54
    v_accvgpr_read_b32 v103, a55
    v_pk_mul_f32 v[96:97], v[96:97], s[62:63]
    v_pk_mul_f32 v[98:99], v[98:99], s[62:63]
    v_pk_mul_f32 v[100:101], v[100:101], s[62:63]
    v_pk_mul_f32 v[102:103], v[102:103], s[62:63]
    v_cvt_pk_bf16_f32 v184, v96, v97
    v_cvt_pk_bf16_f32 v185, v98, v99
    v_cvt_pk_bf16_f32 v186, v100, v101
    v_cvt_pk_bf16_f32 v187, v102, v103
    v_accvgpr_read_b32 v104, a56
    v_accvgpr_read_b32 v105, a57
    v_accvgpr_read_b32 v106, a58
    v_accvgpr_read_b32 v107, a59
    v_accvgpr_read_b32 v108, a60
    v_accvgpr_read_b32 v109, a61
    v_accvgpr_read_b32 v110, a62
    v_accvgpr_read_b32 v111, a63
    v_pk_mul_f32 v[104:105], v[104:105], s[62:63]
    v_pk_mul_f32 v[106:107], v[106:107], s[62:63]
    v_pk_mul_f32 v[108:109], v[108:109], s[62:63]
    v_pk_mul_f32 v[110:111], v[110:111], s[62:63]
    v_cvt_pk_bf16_f32 v188, v104, v105
    v_cvt_pk_bf16_f32 v189, v106, v107
    v_cvt_pk_bf16_f32 v190, v108, v109
    v_cvt_pk_bf16_f32 v191, v110, v111
    v_mfma_f32_16x16x32_bf16 v[52:55], v[64:67], v[176:179], 0
    v_accvgpr_read_b32 v112, a64
    v_accvgpr_read_b32 v113, a65
    v_mfma_f32_16x16x32_bf16 v[52:55], v[68:71], v[180:183], v[52:55]
    v_accvgpr_read_b32 v114, a66
    v_accvgpr_read_b32 v115, a67
    v_mfma_f32_16x16x32_bf16 v[52:55], v[72:75], v[184:187], v[52:55]
    v_accvgpr_read_b32 v116, a68
    v_accvgpr_read_b32 v117, a69
    v_mfma_f32_16x16x32_bf16 v[52:55], v[76:79], v[188:191], v[52:55]
    v_accvgpr_read_b32 v118, a70
    v_accvgpr_read_b32 v119, a71
    v_pk_mul_f32 v[112:113], v[112:113], s[62:63]
    v_pk_mul_f32 v[114:115], v[114:115], s[62:63]
    v_pk_mul_f32 v[116:117], v[116:117], s[62:63]
    v_pk_mul_f32 v[118:119], v[118:119], s[62:63]
    v_cvt_pk_bf16_f32 v192, v112, v113
    v_cvt_pk_bf16_f32 v193, v114, v115
    v_cvt_pk_bf16_f32 v194, v116, v117
    v_cvt_pk_bf16_f32 v195, v118, v119
    v_accvgpr_read_b32 v120, a72
    v_accvgpr_read_b32 v121, a73
    v_accvgpr_read_b32 v122, a74
    v_accvgpr_read_b32 v123, a75
    v_accvgpr_read_b32 v124, a76
    v_accvgpr_read_b32 v125, a77
    v_accvgpr_read_b32 v126, a78
    v_accvgpr_read_b32 v127, a79
    v_pk_mul_f32 v[120:121], v[120:121], s[62:63]
    v_pk_mul_f32 v[122:123], v[122:123], s[62:63]
    v_pk_mul_f32 v[124:125], v[124:125], s[62:63]
    v_pk_mul_f32 v[126:127], v[126:127], s[62:63]
    v_cvt_pk_bf16_f32 v196, v120, v121
    v_cvt_pk_bf16_f32 v197, v122, v123
    v_cvt_pk_bf16_f32 v198, v124, v125
    v_cvt_pk_bf16_f32 v199, v126, v127
    v_accvgpr_read_b32 v96, a80
    v_accvgpr_read_b32 v97, a81
    v_accvgpr_read_b32 v98, a82
    v_accvgpr_read_b32 v99, a83
    v_accvgpr_read_b32 v100, a84
    v_accvgpr_read_b32 v101, a85
    v_accvgpr_read_b32 v102, a86
    v_accvgpr_read_b32 v103, a87
    v_pk_mul_f32 v[96:97], v[96:97], s[62:63]
    v_pk_mul_f32 v[98:99], v[98:99], s[62:63]
    v_pk_mul_f32 v[100:101], v[100:101], s[62:63]
    v_pk_mul_f32 v[102:103], v[102:103], s[62:63]
    v_cvt_pk_bf16_f32 v200, v96, v97
    v_cvt_pk_bf16_f32 v201, v98, v99
    v_cvt_pk_bf16_f32 v202, v100, v101
    v_cvt_pk_bf16_f32 v203, v102, v103
    v_accvgpr_read_b32 v104, a88
    v_accvgpr_read_b32 v105, a89
    v_accvgpr_read_b32 v106, a90
    v_accvgpr_read_b32 v107, a91
    v_accvgpr_read_b32 v108, a92
    v_accvgpr_read_b32 v109, a93
    v_accvgpr_read_b32 v110, a94
    v_accvgpr_read_b32 v111, a95
    v_pk_mul_f32 v[104:105], v[104:105], s[62:63]
    v_pk_mul_f32 v[106:107], v[106:107], s[62:63]
    v_pk_mul_f32 v[108:109], v[108:109], s[62:63]
    v_pk_mul_f32 v[110:111], v[110:111], s[62:63]
    v_cvt_pk_bf16_f32 v204, v104, v105
    v_cvt_pk_bf16_f32 v205, v106, v107
    v_cvt_pk_bf16_f32 v206, v108, v109
    v_cvt_pk_bf16_f32 v207, v110, v111
    v_mfma_f32_16x16x32_bf16 v[56:59], v[64:67], v[192:195], 0
    v_accvgpr_read_b32 v112, a96
    v_accvgpr_read_b32 v113, a97
    v_mfma_f32_16x16x32_bf16 v[56:59], v[68:71], v[196:199], v[56:59]
    v_accvgpr_read_b32 v114, a98
    v_accvgpr_read_b32 v115, a99
    v_mfma_f32_16x16x32_bf16 v[56:59], v[72:75], v[200:203], v[56:59]
    v_accvgpr_read_b32 v116, a100
    v_accvgpr_read_b32 v117, a101
    v_mfma_f32_16x16x32_bf16 v[56:59], v[76:79], v[204:207], v[56:59]
    v_accvgpr_read_b32 v118, a102
    v_accvgpr_read_b32 v119, a103
    v_pk_mul_f32 v[112:113], v[112:113], s[62:63]
    v_pk_mul_f32 v[114:115], v[114:115], s[62:63]
    v_pk_mul_f32 v[116:117], v[116:117], s[62:63]
    v_pk_mul_f32 v[118:119], v[118:119], s[62:63]
    v_cvt_pk_bf16_f32 v208, v112, v113
    v_cvt_pk_bf16_f32 v209, v114, v115
    v_cvt_pk_bf16_f32 v210, v116, v117
    v_cvt_pk_bf16_f32 v211, v118, v119
    v_accvgpr_read_b32 v120, a104
    v_accvgpr_read_b32 v121, a105
    v_accvgpr_read_b32 v122, a106
    v_accvgpr_read_b32 v123, a107
    v_accvgpr_read_b32 v124, a108
    v_accvgpr_read_b32 v125, a109
    v_accvgpr_read_b32 v126, a110
    v_accvgpr_read_b32 v127, a111
    v_pk_mul_f32 v[120:121], v[120:121], s[62:63]
    v_pk_mul_f32 v[122:123], v[122:123], s[62:63]
    v_pk_mul_f32 v[124:125], v[124:125], s[62:63]
    v_pk_mul_f32 v[126:127], v[126:127], s[62:63]
    v_cvt_pk_bf16_f32 v212, v120, v121
    v_cvt_pk_bf16_f32 v213, v122, v123
    v_cvt_pk_bf16_f32 v214, v124, v125
    v_cvt_pk_bf16_f32 v215, v126, v127
    v_accvgpr_read_b32 v96, a112
    v_accvgpr_read_b32 v97, a113
    v_accvgpr_read_b32 v98, a114
    v_accvgpr_read_b32 v99, a115
    v_accvgpr_read_b32 v100, a116
    v_accvgpr_read_b32 v101, a117
    v_accvgpr_read_b32 v102, a118
    v_accvgpr_read_b32 v103, a119
    v_pk_mul_f32 v[96:97], v[96:97], s[62:63]
    v_pk_mul_f32 v[98:99], v[98:99], s[62:63]
    v_pk_mul_f32 v[100:101], v[100:101], s[62:63]
    v_pk_mul_f32 v[102:103], v[102:103], s[62:63]
    v_cvt_pk_bf16_f32 v216, v96, v97
    v_cvt_pk_bf16_f32 v217, v98, v99
    v_cvt_pk_bf16_f32 v218, v100, v101
    v_cvt_pk_bf16_f32 v219, v102, v103
    v_accvgpr_read_b32 v104, a120
    v_accvgpr_read_b32 v105, a121
    v_accvgpr_read_b32 v106, a122
    v_accvgpr_read_b32 v107, a123
    v_accvgpr_read_b32 v108, a124
    v_accvgpr_read_b32 v109, a125
    v_accvgpr_read_b32 v110, a126
    v_accvgpr_read_b32 v111, a127
    v_pk_mul_f32 v[104:105], v[104:105], s[62:63]
    v_pk_mul_f32 v[106:107], v[106:107], s[62:63]
    v_pk_mul_f32 v[108:109], v[108:109], s[62:63]
    v_pk_mul_f32 v[110:111], v[110:111], s[62:63]
    v_cvt_pk_bf16_f32 v220, v104, v105
    v_cvt_pk_bf16_f32 v221, v106, v107
    v_cvt_pk_bf16_f32 v222, v108, v109
    v_cvt_pk_bf16_f32 v223, v110, v111
    v_mfma_f32_16x16x32_bf16 v[60:63], v[64:67], v[208:211], 0
    v_mfma_f32_16x16x32_bf16 v[60:63], v[68:71], v[212:215], v[60:63]
    v_mfma_f32_16x16x32_bf16 v[60:63], v[72:75], v[216:219], v[60:63]
    v_mfma_f32_16x16x32_bf16 v[60:63], v[76:79], v[220:223], v[60:63]
    v_max3_f32 v244, v48, v49, v50
    v_max3_f32 v245, v52, v53, v54
    v_max3_f32 v246, v56, v57, v58
    s_nop 4
    v_max3_f32 v247, v60, v61, v62
    v_max_f32 v244, v244, v51
    v_max_f32 v245, v245, v55
    v_max_f32 v246, v246, v59
    v_max_f32 v247, v247, v63
    v_mov_b32 v248, v244
    v_mov_b32 v249, v245
    v_mov_b32 v250, v246
    v_mov_b32 v251, v247
    v_permlane16_swap_b32 v244, v248
    v_permlane16_swap_b32 v245, v249
    v_permlane16_swap_b32 v246, v250
    v_permlane16_swap_b32 v247, v251
    v_max_f32 v244, v244, v248
    v_max_f32 v245, v245, v249
    v_max_f32 v246, v246, v250
    v_max_f32 v247, v247, v251
    v_mov_b32 v248, v244
    v_mov_b32 v249, v245
    v_mov_b32 v250, v246
    v_mov_b32 v251, v247
    v_permlane32_swap_b32 v244, v248
    v_permlane32_swap_b32 v245, v249
    v_permlane32_swap_b32 v246, v250
    v_permlane32_swap_b32 v247, v251
    v_max_f32 v244, v244, v248
    v_max_f32 v245, v245, v249
    v_max_f32 v246, v246, v250
    v_max_f32 v247, v247, v251
    v_sub_f32 v32, 0, v244
    v_sub_f32 v33, 0, v244
    v_sub_f32 v34, 0, v244
    v_sub_f32 v35, 0, v244
    v_sub_f32 v36, 0, v245
    v_sub_f32 v37, 0, v245
    v_sub_f32 v38, 0, v245
    v_sub_f32 v39, 0, v245
    v_sub_f32 v40, 0, v246
    v_sub_f32 v41, 0, v246
    v_sub_f32 v42, 0, v246
    v_sub_f32 v43, 0, v246
    v_sub_f32 v44, 0, v247
    v_sub_f32 v45, 0, v247
    v_sub_f32 v46, 0, v247
    v_sub_f32 v47, 0, v247

L_iter0:

    v_mfma_f32_16x16x32_bf16 v[48:51], v[64:67], v[160:163], v[32:35]
    v_mfma_f32_16x16x32_bf16 v[48:51], v[68:71], v[164:167], v[48:51]
    ds_read_b128 v[128:131], v8 offset:4096
    v_mfma_f32_16x16x32_bf16 v[48:51], v[72:75], v[168:171], v[48:51]
    s_add_u32 s34, s34, 16384
    v_mfma_f32_16x16x32_bf16 v[48:51], v[76:79], v[172:175], v[48:51]
    s_cmp_eq_u32 s34, 81920
    ds_read_b128 v[132:135], v9 offset:4096
    v_mfma_f32_16x16x32_bf16 v[52:55], v[64:67], v[176:179], v[36:39]
    s_cselect_b32 s64, 0xffff0000, s73
    buffer_store_dwordx4 a[212:215], v26, s[88:91], s85 offen offset:1024 sc1
    v_mfma_f32_16x16x32_bf16 v[52:55], v[68:71], v[180:183], v[52:55]
    s_cselect_b32 s34, 0, s34
    ds_read_b128 v[136:139], v10 offset:4096
    v_mfma_f32_16x16x32_bf16 v[52:55], v[72:75], v[184:187], v[52:55]
    v_mfma_f32_16x16x32_bf16 v[52:55], v[76:79], v[188:191], v[52:55]
    ds_read_b128 v[140:143], v11 offset:4096
    v_exp_f32 v48, v48
    v_mfma_f32_16x16x32_bf16 v[56:59], v[64:67], v[192:195], v[40:43]
    s_add_u32 s35, s35, 16384
    v_exp_f32 v49, v49
    s_mov_b32 m0, s33
    v_mfma_f32_16x16x32_bf16 v[56:59], v[68:71], v[196:199], v[56:59]
    s_cmp_eq_u32 s35, 81920
    v_exp_f32 v50, v50
    v_cvt_pk_bf16_f32 v96, v48, v49
    v_mfma_f32_16x16x32_bf16 v[56:59], v[72:75], v[200:203], v[56:59]
    s_cselect_b32 s65, 0xffff0000, s73
    buffer_load_dwordx4 v24, s[12:15], s31 offen nt lds
    v_exp_f32 v51, v51
    v_mfma_f32_16x16x32_bf16 v[56:59], v[76:79], v[204:207], v[56:59]
    s_cselect_b32 s35, 0, s35
    v_cvt_pk_bf16_f32 v97, v50, v51
    v_exp_f32 v52, v52
    v_mfma_f32_16x16x32_bf16 v[60:63], v[64:67], v[208:211], v[44:47]
    s_add_u32 s23, s23, 2
    v_exp_f32 v53, v53
    v_mfma_f32_16x16x32_bf16 v[60:63], v[68:71], v[212:215], v[60:63]
    s_add_u32 s23, s23, 2
    v_exp_f32 v54, v54
    v_cvt_pk_bf16_f32 v100, v52, v53
    v_mfma_f32_16x16x32_bf16 v[60:63], v[72:75], v[216:219], v[60:63]
    s_lshl_b32 s93, s93, 8
    v_exp_f32 v55, v55
    v_mfma_f32_16x16x32_bf16 v[60:63], v[76:79], v[220:223], v[60:63]
    s_waitcnt lgkmcnt(0)
    v_cvt_pk_bf16_f32 v101, v54, v55
    v_exp_f32 v56, v56
    v_mfma_f32_16x16x32_bf16 v[48:51], v[128:131], v[160:163], v[32:35]
    s_or_b32 s93, s93, s23
    v_exp_f32 v57, v57
    v_add_u32 v12, s65, v12
    v_mfma_f32_16x16x32_bf16 v[48:51], v[132:135], v[164:167], v[48:51]
    ds_read_b128 v[64:67], v8 offset:8192
    v_exp_f32 v58, v58
    v_cvt_pk_bf16_f32 v104, v56, v57
    v_mfma_f32_16x16x32_bf16 v[48:51], v[136:139], v[168:171], v[48:51]
    s_bfe_u32 s76, s92, s20
    buffer_store_dwordx4 a[228:231], v26, s[88:91], s86 offen offset:1024 sc1
    v_exp_f32 v59, v59
    v_add_u32 v13, s65, v13
    v_mfma_f32_16x16x32_bf16 v[48:51], v[140:143], v[172:175], v[48:51]
    ds_read_b128 v[68:71], v9 offset:8192
    v_cvt_pk_bf16_f32 v105, v58, v59
    v_exp_f32 v60, v60
    v_mfma_f32_16x16x32_bf16 v[52:55], v[128:131], v[176:179], v[36:39]
    s_bfe_u32 s94, s93, s21
    v_exp_f32 v61, v61
    v_add_u32 v14, s65, v14
    v_mfma_f32_16x16x32_bf16 v[52:55], v[132:135], v[180:183], v[52:55]
    ds_read_b128 v[72:75], v10 offset:8192
    v_exp_f32 v62, v62
    v_cvt_pk_bf16_f32 v108, v60, v61
    v_mfma_f32_16x16x32_bf16 v[52:55], v[136:139], v[184:187], v[52:55]
    buffer_load_dwordx4 v25, s[12:15], s31 offen offset:1024 nt lds
    v_exp_f32 v63, v63
    v_add_u32 v15, s65, v15
    v_mfma_f32_16x16x32_bf16 v[52:55], v[140:143], v[188:191], v[52:55]
L_hop5:
    s_cbranch_execz L_hop9
    ds_read_b128 v[76:79], v11 offset:8192
    v_cvt_pk_bf16_f32 v109, v62, v63
    v_exp_f32 v48, v48
    v_mfma_f32_16x16x32_bf16 v[56:59], v[128:131], v[192:195], v[40:43]
    s_max_u32 s76, s76, s94
    v_exp_f32 v49, v49
    v_add_u32 v16, s65, v16
    v_mfma_f32_16x16x32_bf16 v[56:59], v[132:135], v[196:199], v[56:59]
    v_exp_f32 v50, v50
    v_cvt_pk_bf16_f32 v98, v48, v49
    v_mfma_f32_16x16x32_bf16 v[56:59], v[136:139], v[200:203], v[56:59]
    s_sub_u32 s76, s23, s76
    v_exp_f32 v51, v51
    v_add_u32 v17, s65, v17
    v_mfma_f32_16x16x32_bf16 v[56:59], v[140:143], v[204:207], v[56:59]
    v_cvt_pk_bf16_f32 v99, v50, v51
    v_exp_f32 v52, v52
    v_mfma_f32_16x16x32_bf16 v[60:63], v[128:131], v[208:211], v[44:47]
    s_lshl_b32 s76, s76, 1
    v_exp_f32 v53, v53
    v_add_u32 v18, s65, v18
    v_mfma_f32_16x16x32_bf16 v[60:63], v[132:135], v[212:215], v[60:63]
    v_exp_f32 v54, v54
    v_cvt_pk_bf16_f32 v102, v52, v53
    v_mfma_f32_16x16x32_bf16 v[60:63], v[136:139], v[216:219], v[60:63]
    v_exp_f32 v55, v55
    v_add_u32 v19, s65, v19
    v_mfma_f32_16x16x32_bf16 v[60:63], v[140:143], v[220:223], v[60:63]
    s_waitcnt lgkmcnt(0)
    v_cvt_pk_bf16_f32 v103, v54, v55
    v_exp_f32 v56, v56
    v_mfma_f32_16x16x32_bf16 v[48:51], v[64:67], v[160:163], v[32:35]
    buffer_store_dwordx4 a[244:247], v26, s[88:91], s87 offen offset:1024 sc1
    v_exp_f32 v57, v57
    v_mfma_f32_16x16x32_bf16 v[48:51], v[68:71], v[164:167], v[48:51]
    ds_read_b128 v[128:131], v8 offset:12288
    v_exp_f32 v58, v58
    v_cvt_pk_bf16_f32 v106, v56, v57
    v_mfma_f32_16x16x32_bf16 v[48:51], v[72:75], v[168:171], v[48:51]
    buffer_load_dwordx4 v24, s[12:15], s31 offen offset:2048 nt lds
    v_exp_f32 v59, v59
    v_mfma_f32_16x16x32_bf16 v[48:51], v[76:79], v[172:175], v[48:51]
    ds_read_b128 v[132:135], v9 offset:12288
    v_cvt_pk_bf16_f32 v107, v58, v59
    v_exp_f32 v60, v60
    v_mfma_f32_16x16x32_bf16 v[52:55], v[64:67], v[176:179], v[36:39]
    v_exp_f32 v61, v61
    v_mfma_f32_16x16x32_bf16 v[52:55], v[68:71], v[180:183], v[52:55]
    ds_read_b128 v[136:139], v10 offset:12288
    v_exp_f32 v62, v62
    v_cvt_pk_bf16_f32 v110, v60, v61
    v_mfma_f32_16x16x32_bf16 v[52:55], v[72:75], v[184:187], v[52:55]
    v_exp_f32 v63, v63
    v_mfma_f32_16x16x32_bf16 v[52:55], v[76:79], v[188:191], v[52:55]
    ds_read_b128 v[140:143], v11 offset:12288
    v_cvt_pk_bf16_f32 v111, v62, v63
    v_exp_f32 v48, v48
    v_mfma_f32_16x16x32_bf16 v[56:59], v[64:67], v[192:195], v[40:43]
    v_exp_f32 v49, v49
    v_mfma_f32_16x16x32_bf16 v[56:59], v[68:71], v[196:199], v[56:59]
    v_exp_f32 v50, v50
    v_cvt_pk_bf16_f32 v112, v48, v49
    v_mfma_f32_16x16x32_bf16 v[56:59], v[72:75], v[200:203], v[56:59]
    v_exp_f32 v51, v51
    v_add_u32 v8, s64, v8
    v_mfma_f32_16x16x32_bf16 v[56:59], v[76:79], v[204:207], v[56:59]
    v_cvt_pk_bf16_f32 v113, v50, v51
    v_exp_f32 v52, v52
    v_add_u32 v9, s64, v9
    v_mfma_f32_16x16x32_bf16 v[60:63], v[64:67], v[208:211], v[44:47]
    v_exp_f32 v53, v53
    v_add_u32 v10, s64, v10
    v_mfma_f32_16x16x32_bf16 v[60:63], v[68:71], v[212:215], v[60:63]
    v_exp_f32 v54, v54
    v_cvt_pk_bf16_f32 v116, v52, v53
    v_add_u32 v11, s64, v11
    v_mfma_f32_16x16x32_bf16 v[60:63], v[72:75], v[216:219], v[60:63]
    buffer_load_dwordx4 v25, s[12:15], s31 offen offset:3072 nt lds
    buffer_store_dwordx4 a[200:203], v26, s[88:91], s84 offen offset:2048 sc1
    v_exp_f32 v55, v55
    v_mfma_f32_16x16x32_bf16 v[60:63], v[76:79], v[220:223], v[60:63]
    s_waitcnt lgkmcnt(0)
    s_getreg_b32 s66, hwreg(HW_REG_IB_STS, 22, 2)
    s_getreg_b32 s94, hwreg(HW_REG_IB_STS, 0, 4)
    s_lshl4_add_u32 s94, s66, s94
    v_cvt_pk_bf16_f32 v117, v54, v55
    v_exp_f32 v56, v56
    v_mfma_f32_16x16x32_bf16 v[48:51], v[128:131], v[160:163], v[32:35]
    s_cmp_gt_i32 s94, s76
    v_exp_f32 v57, v57
    v_mfma_f32_16x16x32_bf16 v[48:51], v[132:135], v[164:167], v[48:51]
    s_cbranch_scc1 L_lw_it0
L_bb_it0:
    s_waitcnt vmcnt(37)
    s_barrier
    v_exp_f32 v58, v58
    v_cvt_pk_bf16_f32 v120, v56, v57
    v_mfma_f32_16x16x32_bf16 v[48:51], v[136:139], v[168:171], v[48:51]
    v_exp_f32 v59, v59
    v_mfma_f32_16x16x32_bf16 v[48:51], v[140:143], v[172:175], v[48:51]
    ds_read_b128 v[64:67], v8
    v_cvt_pk_bf16_f32 v121, v58, v59
    v_exp_f32 v60, v60
    v_mfma_f32_16x16x32_bf16 v[52:55], v[128:131], v[176:179], v[36:39]
    s_add_u32 s31, s31, 16384
    v_exp_f32 v61, v61
    v_mfma_f32_16x16x32_bf16 v[52:55], v[132:135], v[180:183], v[52:55]
    s_add_u32 s33, s33, 16384
    ds_read_b128 v[68:71], v9
    v_exp_f32 v62, v62
    v_cvt_pk_bf16_f32 v124, v60, v61
    v_mfma_f32_16x16x32_bf16 v[52:55], v[136:139], v[184:187], v[52:55]
    s_cmp_ge_u32 s33, 163840
    v_exp_f32 v63, v63
    v_mfma_f32_16x16x32_bf16 v[52:55], v[140:143], v[188:191], v[52:55]
    s_cselect_b32 s66, 81920, 0
    ds_read_b128 v[72:75], v10
    v_cvt_pk_bf16_f32 v125, v62, v63
    v_exp_f32 v48, v48
    v_mfma_f32_16x16x32_bf16 v[56:59], v[128:131], v[192:195], v[40:43]
    s_sub_u32 s33, s33, s66
    v_exp_f32 v49, v49
    v_mfma_f32_16x16x32_bf16 v[56:59], v[132:135], v[196:199], v[56:59]
    ds_read_b128 v[76:79], v11
    v_exp_f32 v50, v50
    v_cvt_pk_bf16_f32 v114, v48, v49
    v_mfma_f32_16x16x32_bf16 v[56:59], v[136:139], v[200:203], v[56:59]
    v_exp_f32 v51, v51
    v_mfma_f32_16x16x32_bf16 v[56:59], v[140:143], v[204:207], v[56:59]
    ds_read_b64_tr_b16 v[80:81], v12
    v_cvt_pk_bf16_f32 v115, v50, v51
    v_exp_f32 v52, v52
    v_mfma_f32_16x16x32_bf16 v[60:63], v[128:131], v[208:211], v[44:47]
    v_exp_f32 v53, v53
    v_mfma_f32_16x16x32_bf16 v[60:63], v[132:135], v[212:215], v[60:63]
    ds_read_b64_tr_b16 v[82:83], v12 offset:4096
    v_exp_f32 v54, v54
    v_cvt_pk_bf16_f32 v118, v52, v53
    v_mfma_f32_16x16x32_bf16 v[60:63], v[136:139], v[216:219], v[60:63]
    ds_read_b64_tr_b16 v[84:85], v12 offset:8192
    v_exp_f32 v55, v55
    v_mfma_f32_16x16x32_bf16 v[60:63], v[140:143], v[220:223], v[60:63]
    s_waitcnt lgkmcnt(3)
    v_cvt_pk_bf16_f32 v119, v54, v55
    v_exp_f32 v56, v56
    v_exp_f32 v57, v57
    v_exp_f32 v58, v58
    v_cvt_pk_bf16_f32 v122, v56, v57
    v_exp_f32 v59, v59
    s_nop 0
    v_cvt_pk_bf16_f32 v123, v58, v59
    v_exp_f32 v60, v60

    v_mfma_f32_16x16x32_bf16 v[48:51], v[64:67], v[160:163], v[32:35]
    s_getreg_b32 s94, hwreg(HW_REG_IB_STS)
    v_exp_f32 v61, v61
    v_mfma_f32_16x16x32_bf16 v[48:51], v[68:71], v[164:167], v[48:51]
    s_and_b32 s94, s94, 0xc0000f
    ds_read_b64_tr_b16 v[86:87], v12 offset:12288
    v_cvt_pk_bf16_f32 v126, v60, v61
    v_mfma_f32_16x16x32_bf16 v[48:51], v[72:75], v[168:171], v[48:51]
    s_sub_u32 s76, s94, s95
    v_exp_f32 v62, v62
    v_mfma_f32_16x16x32_bf16 v[48:51], v[76:79], v[172:175], v[48:51]
    s_add_u32 s23, s23, 1
    ds_read_b64_tr_b16 v[88:89], v13
    v_mfma_f32_16x16x32_bf16 v[52:55], v[64:67], v[176:179], v[36:39]
    s_cmp_gt_u32 s76, s74
    v_exp_f32 v63, v63
    v_mfma_f32_16x16x32_bf16 v[52:55], v[68:71], v[180:183], v[52:55]
    ds_read_b64_tr_b16 v[90:91], v13 offset:4096
    v_cvt_pk_bf16_f32 v127, v62, v63
    v_mfma_f32_16x16x32_bf16 v[52:55], v[72:75], v[184:187], v[52:55]
    s_cbranch_scc1 L_dec_b1fK
L_go_b1fK:
    v_mfma_f32_16x16x32_bf16 v[52:55], v[76:79], v[188:191], v[52:55]
    s_add_u32 s35, s35, 16384
    ds_read_b64_tr_b16 v[92:93], v13 offset:8192
    v_mfma_f32_16x16x32_bf16 v[56:59], v[64:67], v[192:195], v[40:43]
    s_cmp_eq_u32 s35, 81920
    v_exp_f32 v48, v48
    v_mfma_f32_16x16x32_bf16 v[56:59], v[68:71], v[196:199], v[56:59]
    s_cselect_b32 s65, 0xffff0000, s73
    ds_read_b64_tr_b16 v[94:95], v13 offset:12288
    v_mfma_f32_16x16x32_bf16 v[56:59], v[72:75], v[200:203], v[56:59]
    s_mov_b32 m0, s32
    v_exp_f32 v49, v49
    v_mfma_f32_16x16x32_bf16 v[56:59], v[76:79], v[204:207], v[56:59]
    buffer_load_dwordx4 v20, s[16:19], s30 offen nt lds
    v_cvt_pk_bf16_f32 v128, v48, v49
    v_mfma_f32_16x16x32_bf16 v[60:63], v[64:67], v[208:211], v[44:47]
    s_cselect_b32 s35, 0, s35
    v_exp_f32 v50, v50
    v_mfma_f32_16x16x32_bf16 v[60:63], v[68:71], v[212:215], v[60:63]
    s_add_u32 s23, s23, 2
    buffer_load_dwordx4 v21, s[16:19], s30 offen offset:1024 nt lds
    v_mfma_f32_16x16x32_bf16 v[60:63], v[72:75], v[216:219], v[60:63]
    s_waitcnt lgkmcnt(0)
    v_exp_f32 v51, v51
    v_mfma_f32_16x16x32_bf16 v[60:63], v[76:79], v[220:223], v[60:63]
    buffer_load_dwordx4 v22, s[16:19], s30 offen offset:2048 nt lds
    v_cvt_pk_bf16_f32 v129, v50, v51
    v_mfma_f32_16x16x32_bf16 a[0:3], v[80:83], v[96:99], 0
    s_lshl_b32 s92, s92, 8
    v_exp_f32 v52, v52
    v_mfma_f32_16x16x32_bf16 a[0:3], v[84:87], v[112:115], a[0:3]
    s_or_b32 s92, s92, s23
    buffer_load_dwordx4 v23, s[16:19], s30 offen offset:3072 nt lds
    v_mfma_f32_16x16x32_bf16 a[4:7], v[80:83], v[100:103], 0
    s_add_u32 s30, s30, s79
    v_exp_f32 v53, v53
    v_mfma_f32_16x16x32_bf16 a[4:7], v[84:87], v[116:119], a[4:7]
    ds_read_b128 v[64:67], v8 offset:4096
    v_cvt_pk_bf16_f32 v132, v52, v53
    v_mfma_f32_16x16x32_bf16 a[8:11], v[80:83], v[104:107], 0
    s_add_u32 s32, s32, 16384
    v_exp_f32 v54, v54
    v_mfma_f32_16x16x32_bf16 a[8:11], v[84:87], v[120:123], a[8:11]
    ds_read_b128 v[68:71], v9 offset:4096
    v_add_u32 v12, s65, v12
    v_mfma_f32_16x16x32_bf16 a[12:15], v[80:83], v[108:111], 0
    s_cmp_ge_u32 s32, 81920
    v_exp_f32 v55, v55
    v_mfma_f32_16x16x32_bf16 a[12:15], v[84:87], v[124:127], a[12:15]
    ds_read_b128 v[72:75], v10 offset:4096
    v_cvt_pk_bf16_f32 v133, v54, v55
    v_mfma_f32_16x16x32_bf16 a[16:19], v[88:91], v[96:99], 0
    s_cselect_b32 s66, 81920, 0
    v_exp_f32 v56, v56
    v_mfma_f32_16x16x32_bf16 a[16:19], v[92:95], v[112:115], a[16:19]
    ds_read_b128 v[76:79], v11 offset:4096
    v_add_u32 v13, s65, v13
    v_mfma_f32_16x16x32_bf16 a[20:23], v[88:91], v[100:103], 0
    s_sub_u32 s32, s32, s66
    v_exp_f32 v57, v57
L_end_b1fK:
    v_mfma_f32_16x16x32_bf16 a[20:23], v[92:95], v[116:119], a[20:23]
    buffer_store_dwordx4 a[216:219], v26, s[88:91], s85 offen offset:2048 sc1
    v_cvt_pk_bf16_f32 v136, v56, v57
    v_mfma_f32_16x16x32_bf16 a[24:27], v[88:91], v[104:107], 0
    v_exp_f32 v58, v58
    v_mfma_f32_16x16x32_bf16 a[24:27], v[92:95], v[120:123], a[24:27]
    ds_read_b64_tr_b16 v[80:81], v14
    v_mfma_f32_16x16x32_bf16 a[28:31], v[88:91], v[108:111], 0
    v_exp_f32 v59, v59
    v_mfma_f32_16x16x32_bf16 a[28:31], v[92:95], v[124:127], a[28:31]
    ds_read_b64_tr_b16 v[82:83], v14 offset:4096
    v_cvt_pk_bf16_f32 v137, v58, v59
    v_mfma_f32_16x16x32_bf16 v[228:231], v[224:227], v[96:99], 0
    s_waitcnt lgkmcnt(2)
    v_exp_f32 v60, v60
    v_mfma_f32_16x16x32_bf16 v[228:231], v[224:227], v[112:115], v[228:231]
    ds_read_b64_tr_b16 v[84:85], v14 offset:8192
    v_mfma_f32_16x16x32_bf16 v[48:51], v[64:67], v[160:163], v[32:35]
    v_exp_f32 v61, v61
    v_mfma_f32_16x16x32_bf16 v[48:51], v[68:71], v[164:167], v[48:51]
    ds_read_b64_tr_b16 v[86:87], v14 offset:12288
    v_cvt_pk_bf16_f32 v140, v60, v61
    v_mfma_f32_16x16x32_bf16 v[48:51], v[72:75], v[168:171], v[48:51]
    s_add_u32 s34, s34, 16384
    v_exp_f32 v62, v62
    v_mfma_f32_16x16x32_bf16 v[48:51], v[76:79], v[172:175], v[48:51]
    ds_read_b64_tr_b16 v[88:89], v15
    v_mfma_f32_16x16x32_bf16 v[52:55], v[64:67], v[176:179], v[36:39]
    s_cmp_eq_u32 s34, 81920
    v_exp_f32 v63, v63
    v_mfma_f32_16x16x32_bf16 v[52:55], v[68:71], v[180:183], v[52:55]
    ds_read_b64_tr_b16 v[90:91], v15 offset:4096
    v_cvt_pk_bf16_f32 v141, v62, v63
    v_mfma_f32_16x16x32_bf16 v[52:55], v[72:75], v[184:187], v[52:55]
    s_cselect_b32 s64, 0xffff0000, s73
    v_mfma_f32_16x16x32_bf16 v[52:55], v[76:79], v[188:191], v[52:55]
    ds_read_b64_tr_b16 v[92:93], v15 offset:8192
    v_mfma_f32_16x16x32_bf16 v[56:59], v[64:67], v[192:195], v[40:43]
    s_cselect_b32 s34, 0, s34
    v_exp_f32 v48, v48
    v_mfma_f32_16x16x32_bf16 v[56:59], v[68:71], v[196:199], v[56:59]
    ds_read_b64_tr_b16 v[94:95], v15 offset:12288
    v_mfma_f32_16x16x32_bf16 v[56:59], v[72:75], v[200:203], v[56:59]
    v_exp_f32 v49, v49
    v_mfma_f32_16x16x32_bf16 v[56:59], v[76:79], v[204:207], v[56:59]
    v_cvt_pk_bf16_f32 v130, v48, v49
    v_mfma_f32_16x16x32_bf16 v[60:63], v[64:67], v[208:211], v[44:47]
    v_exp_f32 v50, v50
    v_mfma_f32_16x16x32_bf16 v[60:63], v[68:71], v[212:215], v[60:63]
    v_mfma_f32_16x16x32_bf16 v[60:63], v[72:75], v[216:219], v[60:63]
    s_waitcnt lgkmcnt(0)
    v_exp_f32 v51, v51
    v_mfma_f32_16x16x32_bf16 v[60:63], v[76:79], v[220:223], v[60:63]
    v_cvt_pk_bf16_f32 v131, v50, v51
    v_mfma_f32_16x16x32_bf16 a[32:35], v[80:83], v[96:99], 0
    v_exp_f32 v52, v52
    v_mfma_f32_16x16x32_bf16 a[32:35], v[84:87], v[112:115], a[32:35]
    v_mfma_f32_16x16x32_bf16 a[36:39], v[80:83], v[100:103], 0
    v_exp_f32 v53, v53
    v_mfma_f32_16x16x32_bf16 a[36:39], v[84:87], v[116:119], a[36:39]
    ds_read_b128 v[64:67], v8 offset:8192
    v_cvt_pk_bf16_f32 v134, v52, v53
    v_mfma_f32_16x16x32_bf16 a[40:43], v[80:83], v[104:107], 0
    v_exp_f32 v54, v54
    v_mfma_f32_16x16x32_bf16 a[40:43], v[84:87], v[120:123], a[40:43]
    ds_read_b128 v[68:71], v9 offset:8192
    v_add_u32 v14, s65, v14
    v_mfma_f32_16x16x32_bf16 a[44:47], v[80:83], v[108:111], 0
    v_exp_f32 v55, v55
    v_mfma_f32_16x16x32_bf16 a[44:47], v[84:87], v[124:127], a[44:47]
    ds_read_b128 v[72:75], v10 offset:8192
    v_cvt_pk_bf16_f32 v135, v54, v55
    v_mfma_f32_16x16x32_bf16 a[48:51], v[88:91], v[96:99], 0
    v_exp_f32 v56, v56
    v_mfma_f32_16x16x32_bf16 a[48:51], v[92:95], v[112:115], a[48:51]
    ds_read_b128 v[76:79], v11 offset:8192
    v_add_u32 v15, s65, v15
    v_mfma_f32_16x16x32_bf16 a[52:55], v[88:91], v[100:103], 0
    v_exp_f32 v57, v57
    v_mfma_f32_16x16x32_bf16 a[52:55], v[92:95], v[116:119], a[52:55]
    buffer_store_dwordx4 a[232:235], v26, s[88:91], s86 offen offset:2048 sc1
    v_cvt_pk_bf16_f32 v138, v56, v57
    v_mfma_f32_16x16x32_bf16 a[56:59], v[88:91], v[104:107], 0
    v_exp_f32 v58, v58
    v_mfma_f32_16x16x32_bf16 a[56:59], v[92:95], v[120:123], a[56:59]
    ds_read_b64_tr_b16 v[80:81], v16
    v_mfma_f32_16x16x32_bf16 a[60:63], v[88:91], v[108:111], 0
    v_exp_f32 v59, v59
    v_mfma_f32_16x16x32_bf16 a[60:63], v[92:95], v[124:127], a[60:63]
    ds_read_b64_tr_b16 v[82:83], v16 offset:4096
    v_cvt_pk_bf16_f32 v139, v58, v59
    v_mfma_f32_16x16x32_bf16 v[232:235], v[224:227], v[100:103], 0
    s_waitcnt lgkmcnt(2)
    v_exp_f32 v60, v60
    v_mfma_f32_16x16x32_bf16 v[232:235], v[224:227], v[116:119], v[232:235]
    ds_read_b64_tr_b16 v[84:85], v16 offset:8192
    v_mfma_f32_16x16x32_bf16 v[48:51], v[64:67], v[160:163], v[32:35]
    s_getreg_b32 s94, hwreg(HW_REG_IB_STS)
    v_exp_f32 v61, v61
    v_mfma_f32_16x16x32_bf16 v[48:51], v[68:71], v[164:167], v[48:51]
    s_and_b32 s94, s94, 0xc0000f
    ds_read_b64_tr_b16 v[86:87], v16 offset:12288
    v_cvt_pk_bf16_f32 v142, v60, v61
    v_mfma_f32_16x16x32_bf16 v[48:51], v[72:75], v[168:171], v[48:51]
    s_sub_u32 s76, s94, s49
    v_exp_f32 v62, v62
    v_mfma_f32_16x16x32_bf16 v[48:51], v[76:79], v[172:175], v[48:51]
    ds_read_b64_tr_b16 v[88:89], v17
    v_mfma_f32_16x16x32_bf16 v[52:55], v[64:67], v[176:179], v[36:39]
    s_cmp_gt_u32 s76, s78
    v_exp_f32 v63, v63
    v_mfma_f32_16x16x32_bf16 v[52:55], v[68:71], v[180:183], v[52:55]
    ds_read_b64_tr_b16 v[90:91], v17 offset:4096
    v_cvt_pk_bf16_f32 v143, v62, v63
    v_mfma_f32_16x16x32_bf16 v[52:55], v[72:75], v[184:187], v[52:55]
    s_cbranch_scc1 L_dec_b1fV
L_go_b1fV:
    v_mfma_f32_16x16x32_bf16 v[52:55], v[76:79], v[188:191], v[52:55]
    ds_read_b64_tr_b16 v[92:93], v17 offset:8192
    v_mfma_f32_16x16x32_bf16 v[56:59], v[64:67], v[192:195], v[40:43]
    v_exp_f32 v48, v48
    v_mfma_f32_16x16x32_bf16 v[56:59], v[68:71], v[196:199], v[56:59]
    ds_read_b64_tr_b16 v[94:95], v17 offset:12288
    v_mfma_f32_16x16x32_bf16 v[56:59], v[72:75], v[200:203], v[56:59]
    s_mov_b32 m0, s33
    v_exp_f32 v49, v49
    v_mfma_f32_16x16x32_bf16 v[56:59], v[76:79], v[204:207], v[56:59]
    buffer_load_dwordx4 v24, s[12:15], s31 offen nt lds
    v_cvt_pk_bf16_f32 v144, v48, v49
    v_mfma_f32_16x16x32_bf16 v[60:63], v[64:67], v[208:211], v[44:47]
    v_exp_f32 v50, v50
    v_mfma_f32_16x16x32_bf16 v[60:63], v[68:71], v[212:215], v[60:63]
    s_add_u32 s23, s23, 2
    buffer_load_dwordx4 v25, s[12:15], s31 offen offset:1024 nt lds
    v_mfma_f32_16x16x32_bf16 v[60:63], v[72:75], v[216:219], v[60:63]
    s_waitcnt lgkmcnt(0)
    v_exp_f32 v51, v51
    v_mfma_f32_16x16x32_bf16 v[60:63], v[76:79], v[220:223], v[60:63]
    buffer_load_dwordx4 v24, s[12:15], s31 offen offset:2048 nt lds
    v_cvt_pk_bf16_f32 v145, v50, v51
    v_mfma_f32_16x16x32_bf16 a[64:67], v[80:83], v[96:99], 0
    s_lshl_b32 s93, s93, 8
    v_exp_f32 v52, v52
    v_mfma_f32_16x16x32_bf16 a[64:67], v[84:87], v[112:115], a[64:67]
    s_or_b32 s93, s93, s23
    buffer_load_dwordx4 v25, s[12:15], s31 offen offset:3072 nt lds
    v_mfma_f32_16x16x32_bf16 a[68:71], v[80:83], v[100:103], 0
    s_add_u32 s31, s31, 16384
    v_exp_f32 v53, v53
    v_mfma_f32_16x16x32_bf16 a[68:71], v[84:87], v[116:119], a[68:71]
    ds_read_b128 v[64:67], v8 offset:12288
    v_cvt_pk_bf16_f32 v148, v52, v53
    v_mfma_f32_16x16x32_bf16 a[72:75], v[80:83], v[104:107], 0
    s_add_u32 s33, s33, 16384
    v_exp_f32 v54, v54
    v_mfma_f32_16x16x32_bf16 a[72:75], v[84:87], v[120:123], a[72:75]
    ds_read_b128 v[68:71], v9 offset:12288
    v_add_u32 v16, s65, v16
    v_mfma_f32_16x16x32_bf16 a[76:79], v[80:83], v[108:111], 0
    s_cmp_ge_u32 s33, 163840
    v_exp_f32 v55, v55
    v_mfma_f32_16x16x32_bf16 a[76:79], v[84:87], v[124:127], a[76:79]
    ds_read_b128 v[72:75], v10 offset:12288
    v_cvt_pk_bf16_f32 v149, v54, v55
    v_mfma_f32_16x16x32_bf16 a[80:83], v[88:91], v[96:99], 0
    s_cselect_b32 s66, 81920, 0
    v_exp_f32 v56, v56
    v_mfma_f32_16x16x32_bf16 a[80:83], v[92:95], v[112:115], a[80:83]
    ds_read_b128 v[76:79], v11 offset:12288
    v_add_u32 v17, s65, v17
    v_mfma_f32_16x16x32_bf16 a[84:87], v[88:91], v[100:103], 0
    s_sub_u32 s33, s33, s66
    v_exp_f32 v57, v57
L_end_b1fV:
    v_mfma_f32_16x16x32_bf16 a[84:87], v[92:95], v[116:119], a[84:87]
    buffer_store_dwordx4 a[248:251], v26, s[88:91], s87 offen offset:2048 sc1
    v_cvt_pk_bf16_f32 v152, v56, v57
    v_mfma_f32_16x16x32_bf16 a[88:91], v[88:91], v[104:107], 0
    s_bfe_u32 s76, s92, s20
    v_exp_f32 v58, v58
    v_mfma_f32_16x16x32_bf16 a[88:91], v[92:95], v[120:123], a[88:91]
    ds_read_b64_tr_b16 v[80:81], v18
    v_mfma_f32_16x16x32_bf16 a[92:95], v[88:91], v[108:111], 0
    s_bfe_u32 s94, s93, s21
    v_exp_f32 v59, v59
    v_mfma_f32_16x16x32_bf16 a[92:95], v[92:95], v[124:127], a[92:95]
    ds_read_b64_tr_b16 v[82:83], v18 offset:4096
    v_cvt_pk_bf16_f32 v153, v58, v59
    v_mfma_f32_16x16x32_bf16 v[236:239], v[224:227], v[104:107], 0
    s_waitcnt lgkmcnt(2)
    v_exp_f32 v60, v60
    v_mfma_f32_16x16x32_bf16 v[236:239], v[224:227], v[120:123], v[236:239]
    ds_read_b64_tr_b16 v[84:85], v18 offset:8192
    v_mfma_f32_16x16x32_bf16 v[48:51], v[64:67], v[160:163], v[32:35]
    s_max_u32 s76, s76, s94
    v_exp_f32 v61, v61
    v_mfma_f32_16x16x32_bf16 v[48:51], v[68:71], v[164:167], v[48:51]
    ds_read_b64_tr_b16 v[86:87], v18 offset:12288
    v_cvt_pk_bf16_f32 v156, v60, v61
    v_mfma_f32_16x16x32_bf16 v[48:51], v[72:75], v[168:171], v[48:51]
    s_sub_u32 s76, s23, s76
    v_exp_f32 v62, v62
    v_mfma_f32_16x16x32_bf16 v[48:51], v[76:79], v[172:175], v[48:51]
    ds_read_b64_tr_b16 v[88:89], v19
    v_add_u32 v8, s64, v8
    v_mfma_f32_16x16x32_bf16 v[52:55], v[64:67], v[176:179], v[36:39]
    s_lshl_b32 s76, s76, 1
    v_exp_f32 v63, v63
    v_mfma_f32_16x16x32_bf16 v[52:55], v[68:71], v[180:183], v[52:55]
    ds_read_b64_tr_b16 v[90:91], v19 offset:4096
    v_cvt_pk_bf16_f32 v157, v62, v63
    v_mfma_f32_16x16x32_bf16 v[52:55], v[72:75], v[184:187], v[52:55]
    v_mfma_f32_16x16x32_bf16 v[52:55], v[76:79], v[188:191], v[52:55]
    ds_read_b64_tr_b16 v[92:93], v19 offset:8192
    v_add_u32 v9, s64, v9
    v_mfma_f32_16x16x32_bf16 v[56:59], v[64:67], v[192:195], v[40:43]
    v_exp_f32 v48, v48
    v_mfma_f32_16x16x32_bf16 v[56:59], v[68:71], v[196:199], v[56:59]
    ds_read_b64_tr_b16 v[94:95], v19 offset:12288
    v_add_u32 v10, s64, v10
    v_mfma_f32_16x16x32_bf16 v[56:59], v[72:75], v[200:203], v[56:59]
    v_exp_f32 v49, v49
    v_mfma_f32_16x16x32_bf16 v[56:59], v[76:79], v[204:207], v[56:59]
    v_cvt_pk_bf16_f32 v146, v48, v49
    v_mfma_f32_16x16x32_bf16 v[60:63], v[64:67], v[208:211], v[44:47]
    s_getreg_b32 s66, hwreg(HW_REG_IB_STS, 22, 2)
    v_exp_f32 v50, v50
    v_mfma_f32_16x16x32_bf16 v[60:63], v[68:71], v[212:215], v[60:63]
    s_getreg_b32 s94, hwreg(HW_REG_IB_STS, 0, 4)
    s_lshl4_add_u32 s94, s66, s94
    v_add_u32 v11, s64, v11
    v_mfma_f32_16x16x32_bf16 v[60:63], v[72:75], v[216:219], v[60:63]
    s_waitcnt lgkmcnt(0)
    v_exp_f32 v51, v51
    v_mfma_f32_16x16x32_bf16 v[60:63], v[76:79], v[220:223], v[60:63]
    v_cvt_pk_bf16_f32 v147, v50, v51
    v_mfma_f32_16x16x32_bf16 a[96:99], v[80:83], v[96:99], 0
    s_cmp_gt_i32 s94, s76
    v_exp_f32 v52, v52
    v_mfma_f32_16x16x32_bf16 a[96:99], v[84:87], v[112:115], a[96:99]
    s_cbranch_scc1 L_lw_b1f
L_bb_b1f:
    s_waitcnt vmcnt(32)
    s_barrier
    v_mfma_f32_16x16x32_bf16 a[100:103], v[80:83], v[100:103], 0
    v_exp_f32 v53, v53
    v_mfma_f32_16x16x32_bf16 a[100:103], v[84:87], v[116:119], a[100:103]
    ds_read_b128 v[64:67], v8
    v_cvt_pk_bf16_f32 v150, v52, v53
    v_mfma_f32_16x16x32_bf16 a[104:107], v[80:83], v[104:107], 0
    v_exp_f32 v54, v54
    v_mfma_f32_16x16x32_bf16 a[104:107], v[84:87], v[120:123], a[104:107]
    ds_read_b128 v[68:71], v9
    v_add_u32 v18, s65, v18
    v_mfma_f32_16x16x32_bf16 a[108:111], v[80:83], v[108:111], 0
    v_exp_f32 v55, v55
    v_mfma_f32_16x16x32_bf16 a[108:111], v[84:87], v[124:127], a[108:111]
    ds_read_b128 v[72:75], v10
    v_cvt_pk_bf16_f32 v151, v54, v55
    v_mfma_f32_16x16x32_bf16 a[112:115], v[88:91], v[96:99], 0
    v_exp_f32 v56, v56
    v_mfma_f32_16x16x32_bf16 a[112:115], v[92:95], v[112:115], a[112:115]
    ds_read_b128 v[76:79], v11
    v_add_u32 v19, s65, v19
    v_mfma_f32_16x16x32_bf16 a[116:119], v[88:91], v[100:103], 0
    v_exp_f32 v57, v57
    v_mfma_f32_16x16x32_bf16 a[116:119], v[92:95], v[116:119], a[116:119]
    v_cvt_pk_bf16_f32 v154, v56, v57
    v_mfma_f32_16x16x32_bf16 a[120:123], v[88:91], v[104:107], 0
    v_exp_f32 v58, v58
    v_mfma_f32_16x16x32_bf16 a[120:123], v[92:95], v[120:123], a[120:123]
    ds_read_b64_tr_b16 v[80:81], v12
    v_mfma_f32_16x16x32_bf16 a[124:127], v[88:91], v[108:111], 0
    v_exp_f32 v59, v59
    v_mfma_f32_16x16x32_bf16 a[124:127], v[92:95], v[124:127], a[124:127]
    ds_read_b64_tr_b16 v[82:83], v12 offset:4096
    v_cvt_pk_bf16_f32 v155, v58, v59
    v_mfma_f32_16x16x32_bf16 v[240:243], v[224:227], v[108:111], 0
    s_waitcnt lgkmcnt(2)
    v_exp_f32 v60, v60
    v_mfma_f32_16x16x32_bf16 v[240:243], v[224:227], v[124:127], v[240:243]
    ds_read_b64_tr_b16 v[84:85], v12 offset:8192
    s_cmp_lg_u32 s70, 0
    s_cselect_b32 s69, 1, 6

    s_branch L_loop
.p2align 12
L_hop6:
    s_cbranch_execz L_hop10
L_loop:
    v_mfma_f32_16x16x32_bf16 v[48:51], v[64:67], v[160:163], v[32:35]
    s_getreg_b32 s94, hwreg(HW_REG_IB_STS)
    v_exp_f32 v61, v61
    v_mfma_f32_16x16x32_bf16 v[48:51], v[68:71], v[164:167], v[48:51]
    s_and_b32 s94, s94, 0xc0000f
    ds_read_b64_tr_b16 v[86:87], v12 offset:12288
    v_cvt_pk_bf16_f32 v158, v60, v61
    v_mfma_f32_16x16x32_bf16 v[48:51], v[72:75], v[168:171], v[48:51]
    s_sub_u32 s76, s94, s95
    v_exp_f32 v62, v62
    v_mfma_f32_16x16x32_bf16 v[48:51], v[76:79], v[172:175], v[48:51]
    ds_read_b64_tr_b16 v[88:89], v13
    v_mfma_f32_16x16x32_bf16 v[52:55], v[64:67], v[176:179], v[36:39]
    s_cmp_gt_u32 s76, s74
    v_exp_f32 v63, v63
    v_mfma_f32_16x16x32_bf16 v[52:55], v[68:71], v[180:183], v[52:55]
    ds_read_b64_tr_b16 v[90:91], v13 offset:4096
    v_cvt_pk_bf16_f32 v159, v62, v63
    v_mfma_f32_16x16x32_bf16 v[52:55], v[72:75], v[184:187], v[52:55]
    s_cbranch_scc1 L_dec_bevenK
L_go_bevenK:
    v_mfma_f32_16x16x32_bf16 v[52:55], v[76:79], v[188:191], v[52:55]
    s_add_u32 s35, s35, 16384
    ds_read_b64_tr_b16 v[92:93], v13 offset:8192
    v_mfma_f32_16x16x32_bf16 v[56:59], v[64:67], v[192:195], v[40:43]
    s_cmp_eq_u32 s35, 81920
    v_exp_f32 v48, v48
    v_mfma_f32_16x16x32_bf16 v[56:59], v[68:71], v[196:199], v[56:59]
    s_cselect_b32 s65, 0xffff0000, s73
    ds_read_b64_tr_b16 v[94:95], v13 offset:12288
    v_mfma_f32_16x16x32_bf16 v[56:59], v[72:75], v[200:203], v[56:59]
    s_mov_b32 m0, s32
    v_exp_f32 v49, v49
    v_mfma_f32_16x16x32_bf16 v[56:59], v[76:79], v[204:207], v[56:59]
    buffer_load_dwordx4 v20, s[16:19], s30 offen nt lds
    v_cvt_pk_bf16_f32 v96, v48, v49
    v_mfma_f32_16x16x32_bf16 v[60:63], v[64:67], v[208:211], v[44:47]
    s_cselect_b32 s35, 0, s35
    v_exp_f32 v50, v50
    v_mfma_f32_16x16x32_bf16 v[60:63], v[68:71], v[212:215], v[60:63]
    s_add_u32 s23, s23, 2
    buffer_load_dwordx4 v21, s[16:19], s30 offen offset:1024 nt lds
    v_mfma_f32_16x16x32_bf16 v[60:63], v[72:75], v[216:219], v[60:63]
    s_waitcnt lgkmcnt(0)
    v_exp_f32 v51, v51
    v_mfma_f32_16x16x32_bf16 v[60:63], v[76:79], v[220:223], v[60:63]
    buffer_load_dwordx4 v22, s[16:19], s30 offen offset:2048 nt lds
    v_cvt_pk_bf16_f32 v97, v50, v51
    v_mfma_f32_16x16x32_bf16 a[0:3], v[80:83], v[128:131], a[0:3]
    s_lshl_b32 s92, s92, 8
    v_exp_f32 v52, v52
    v_mfma_f32_16x16x32_bf16 a[0:3], v[84:87], v[144:147], a[0:3]
    s_or_b32 s92, s92, s23
    buffer_load_dwordx4 v23, s[16:19], s30 offen offset:3072 nt lds
    v_mfma_f32_16x16x32_bf16 a[4:7], v[80:83], v[132:135], a[4:7]
    s_add_u32 s30, s30, s79
    v_exp_f32 v53, v53
    v_mfma_f32_16x16x32_bf16 a[4:7], v[84:87], v[148:151], a[4:7]
    ds_read_b128 v[64:67], v8 offset:4096
    v_cvt_pk_bf16_f32 v100, v52, v53
    v_mfma_f32_16x16x32_bf16 a[8:11], v[80:83], v[136:139], a[8:11]
    s_add_u32 s32, s32, 16384
    v_exp_f32 v54, v54
    v_mfma_f32_16x16x32_bf16 a[8:11], v[84:87], v[152:155], a[8:11]
    ds_read_b128 v[68:71], v9 offset:4096
    v_add_u32 v12, s65, v12
    v_mfma_f32_16x16x32_bf16 a[12:15], v[80:83], v[140:143], a[12:15]
    s_cmp_ge_u32 s32, 81920
    v_exp_f32 v55, v55
    v_mfma_f32_16x16x32_bf16 a[12:15], v[84:87], v[156:159], a[12:15]
    ds_read_b128 v[72:75], v10 offset:4096
    v_cvt_pk_bf16_f32 v101, v54, v55
    v_mfma_f32_16x16x32_bf16 a[16:19], v[88:91], v[128:131], a[16:19]
    s_cselect_b32 s66, 81920, 0
    v_exp_f32 v56, v56
    v_mfma_f32_16x16x32_bf16 a[16:19], v[92:95], v[144:147], a[16:19]
    ds_read_b128 v[76:79], v11 offset:4096
    v_add_u32 v13, s65, v13
    v_mfma_f32_16x16x32_bf16 a[20:23], v[88:91], v[132:135], a[20:23]
    s_sub_u32 s32, s32, s66
    v_exp_f32 v57, v57
L_end_bevenK:
    v_mfma_f32_16x16x32_bf16 a[20:23], v[92:95], v[148:151], a[20:23]
    v_cvt_pk_bf16_f32 v104, v56, v57
    v_mfma_f32_16x16x32_bf16 a[24:27], v[88:91], v[136:139], a[24:27]
    v_exp_f32 v58, v58
    v_mfma_f32_16x16x32_bf16 a[24:27], v[92:95], v[152:155], a[24:27]
    ds_read_b64_tr_b16 v[80:81], v14
    v_mfma_f32_16x16x32_bf16 a[28:31], v[88:91], v[140:143], a[28:31]
    v_exp_f32 v59, v59
    v_mfma_f32_16x16x32_bf16 a[28:31], v[92:95], v[156:159], a[28:31]
    ds_read_b64_tr_b16 v[82:83], v14 offset:4096
    v_cvt_pk_bf16_f32 v105, v58, v59
    v_mfma_f32_16x16x32_bf16 v[228:231], v[224:227], v[128:131], v[228:231]
    s_waitcnt lgkmcnt(2)
    v_exp_f32 v60, v60
    v_mfma_f32_16x16x32_bf16 v[228:231], v[224:227], v[144:147], v[228:231]
    ds_read_b64_tr_b16 v[84:85], v14 offset:8192
    v_mfma_f32_16x16x32_bf16 v[48:51], v[64:67], v[160:163], v[32:35]
    v_exp_f32 v61, v61
    v_mfma_f32_16x16x32_bf16 v[48:51], v[68:71], v[164:167], v[48:51]
    ds_read_b64_tr_b16 v[86:87], v14 offset:12288
    v_cvt_pk_bf16_f32 v108, v60, v61
    v_mfma_f32_16x16x32_bf16 v[48:51], v[72:75], v[168:171], v[48:51]
    s_add_u32 s34, s34, 16384
    v_exp_f32 v62, v62
    v_mfma_f32_16x16x32_bf16 v[48:51], v[76:79], v[172:175], v[48:51]
    ds_read_b64_tr_b16 v[88:89], v15
    v_mfma_f32_16x16x32_bf16 v[52:55], v[64:67], v[176:179], v[36:39]
    s_cmp_eq_u32 s34, 81920
    v_exp_f32 v63, v63
    v_mfma_f32_16x16x32_bf16 v[52:55], v[68:71], v[180:183], v[52:55]
    ds_read_b64_tr_b16 v[90:91], v15 offset:4096
    v_cvt_pk_bf16_f32 v109, v62, v63
    v_mfma_f32_16x16x32_bf16 v[52:55], v[72:75], v[184:187], v[52:55]
    s_cselect_b32 s64, 0xffff0000, s73
    v_mfma_f32_16x16x32_bf16 v[52:55], v[76:79], v[188:191], v[52:55]
    ds_read_b64_tr_b16 v[92:93], v15 offset:8192
    v_mfma_f32_16x16x32_bf16 v[56:59], v[64:67], v[192:195], v[40:43]
    s_cselect_b32 s34, 0, s34
    v_exp_f32 v48, v48
    v_mfma_f32_16x16x32_bf16 v[56:59], v[68:71], v[196:199], v[56:59]
    ds_read_b64_tr_b16 v[94:95], v15 offset:12288
    v_mfma_f32_16x16x32_bf16 v[56:59], v[72:75], v[200:203], v[56:59]
    v_exp_f32 v49, v49
    v_mfma_f32_16x16x32_bf16 v[56:59], v[76:79], v[204:207], v[56:59]
    v_cvt_pk_bf16_f32 v98, v48, v49
    v_mfma_f32_16x16x32_bf16 v[60:63], v[64:67], v[208:211], v[44:47]
    v_exp_f32 v50, v50
    v_mfma_f32_16x16x32_bf16 v[60:63], v[68:71], v[212:215], v[60:63]
    v_mfma_f32_16x16x32_bf16 v[60:63], v[72:75], v[216:219], v[60:63]
    s_waitcnt lgkmcnt(0)
    v_exp_f32 v51, v51
    v_mfma_f32_16x16x32_bf16 v[60:63], v[76:79], v[220:223], v[60:63]
    v_cvt_pk_bf16_f32 v99, v50, v51
    v_mfma_f32_16x16x32_bf16 a[32:35], v[80:83], v[128:131], a[32:35]
    v_exp_f32 v52, v52
    v_mfma_f32_16x16x32_bf16 a[32:35], v[84:87], v[144:147], a[32:35]
    v_mfma_f32_16x16x32_bf16 a[36:39], v[80:83], v[132:135], a[36:39]
    v_exp_f32 v53, v53
    v_mfma_f32_16x16x32_bf16 a[36:39], v[84:87], v[148:151], a[36:39]
    ds_read_b128 v[64:67], v8 offset:8192
    v_cvt_pk_bf16_f32 v102, v52, v53
    v_mfma_f32_16x16x32_bf16 a[40:43], v[80:83], v[136:139], a[40:43]
    v_exp_f32 v54, v54
    v_mfma_f32_16x16x32_bf16 a[40:43], v[84:87], v[152:155], a[40:43]
    ds_read_b128 v[68:71], v9 offset:8192
    v_add_u32 v14, s65, v14
    v_mfma_f32_16x16x32_bf16 a[44:47], v[80:83], v[140:143], a[44:47]
    v_exp_f32 v55, v55
    v_mfma_f32_16x16x32_bf16 a[44:47], v[84:87], v[156:159], a[44:47]
    ds_read_b128 v[72:75], v10 offset:8192
    v_cvt_pk_bf16_f32 v103, v54, v55
    v_mfma_f32_16x16x32_bf16 a[48:51], v[88:91], v[128:131], a[48:51]
    v_exp_f32 v56, v56
    v_mfma_f32_16x16x32_bf16 a[48:51], v[92:95], v[144:147], a[48:51]
    ds_read_b128 v[76:79], v11 offset:8192
    v_add_u32 v15, s65, v15
    v_mfma_f32_16x16x32_bf16 a[52:55], v[88:91], v[132:135], a[52:55]
    v_exp_f32 v57, v57
    v_mfma_f32_16x16x32_bf16 a[52:55], v[92:95], v[148:151], a[52:55]
    v_cvt_pk_bf16_f32 v106, v56, v57
    v_mfma_f32_16x16x32_bf16 a[56:59], v[88:91], v[136:139], a[56:59]
    v_exp_f32 v58, v58
    v_mfma_f32_16x16x32_bf16 a[56:59], v[92:95], v[152:155], a[56:59]
    ds_read_b64_tr_b16 v[80:81], v16
    v_mfma_f32_16x16x32_bf16 a[60:63], v[88:91], v[140:143], a[60:63]
    v_exp_f32 v59, v59
    v_mfma_f32_16x16x32_bf16 a[60:63], v[92:95], v[156:159], a[60:63]
    ds_read_b64_tr_b16 v[82:83], v16 offset:4096
    v_cvt_pk_bf16_f32 v107, v58, v59
    v_mfma_f32_16x16x32_bf16 v[232:235], v[224:227], v[132:135], v[232:235]
    s_waitcnt lgkmcnt(2)
    v_exp_f32 v60, v60
    v_mfma_f32_16x16x32_bf16 v[232:235], v[224:227], v[148:151], v[232:235]
    ds_read_b64_tr_b16 v[84:85], v16 offset:8192
    v_mfma_f32_16x16x32_bf16 v[48:51], v[64:67], v[160:163], v[32:35]
    s_getreg_b32 s94, hwreg(HW_REG_IB_STS)
    v_exp_f32 v61, v61
    v_mfma_f32_16x16x32_bf16 v[48:51], v[68:71], v[164:167], v[48:51]
    s_and_b32 s94, s94, 0xc0000f
    ds_read_b64_tr_b16 v[86:87], v16 offset:12288
    v_cvt_pk_bf16_f32 v110, v60, v61
    v_mfma_f32_16x16x32_bf16 v[48:51], v[72:75], v[168:171], v[48:51]
    s_sub_u32 s76, s94, s49
    v_exp_f32 v62, v62
    v_mfma_f32_16x16x32_bf16 v[48:51], v[76:79], v[172:175], v[48:51]
    ds_read_b64_tr_b16 v[88:89], v17
    v_mfma_f32_16x16x32_bf16 v[52:55], v[64:67], v[176:179], v[36:39]
    s_cmp_gt_u32 s76, s78
    v_exp_f32 v63, v63
    v_mfma_f32_16x16x32_bf16 v[52:55], v[68:71], v[180:183], v[52:55]
    ds_read_b64_tr_b16 v[90:91], v17 offset:4096
    v_cvt_pk_bf16_f32 v111, v62, v63
    v_mfma_f32_16x16x32_bf16 v[52:55], v[72:75], v[184:187], v[52:55]
    s_cbranch_scc1 L_dec_bevenV
L_go_bevenV:
    v_mfma_f32_16x16x32_bf16 v[52:55], v[76:79], v[188:191], v[52:55]
    ds_read_b64_tr_b16 v[92:93], v17 offset:8192
    v_mfma_f32_16x16x32_bf16 v[56:59], v[64:67], v[192:195], v[40:43]
    v_exp_f32 v48, v48
    v_mfma_f32_16x16x32_bf16 v[56:59], v[68:71], v[196:199], v[56:59]
    ds_read_b64_tr_b16 v[94:95], v17 offset:12288
    v_mfma_f32_16x16x32_bf16 v[56:59], v[72:75], v[200:203], v[56:59]
    s_mov_b32 m0, s33
    v_exp_f32 v49, v49
    v_mfma_f32_16x16x32_bf16 v[56:59], v[76:79], v[204:207], v[56:59]
    buffer_load_dwordx4 v24, s[12:15], s31 offen nt lds
    v_cvt_pk_bf16_f32 v112, v48, v49
    v_mfma_f32_16x16x32_bf16 v[60:63], v[64:67], v[208:211], v[44:47]
    v_exp_f32 v50, v50
    v_mfma_f32_16x16x32_bf16 v[60:63], v[68:71], v[212:215], v[60:63]
    s_add_u32 s23, s23, 2
    buffer_load_dwordx4 v25, s[12:15], s31 offen offset:1024 nt lds
    v_mfma_f32_16x16x32_bf16 v[60:63], v[72:75], v[216:219], v[60:63]
    s_waitcnt lgkmcnt(0)
    v_exp_f32 v51, v51
    v_mfma_f32_16x16x32_bf16 v[60:63], v[76:79], v[220:223], v[60:63]
    buffer_load_dwordx4 v24, s[12:15], s31 offen offset:2048 nt lds
    v_cvt_pk_bf16_f32 v113, v50, v51
    v_mfma_f32_16x16x32_bf16 a[64:67], v[80:83], v[128:131], a[64:67]
    s_lshl_b32 s93, s93, 8
    v_exp_f32 v52, v52
    v_mfma_f32_16x16x32_bf16 a[64:67], v[84:87], v[144:147], a[64:67]
    s_or_b32 s93, s93, s23
    buffer_load_dwordx4 v25, s[12:15], s31 offen offset:3072 nt lds
    v_mfma_f32_16x16x32_bf16 a[68:71], v[80:83], v[132:135], a[68:71]
    s_add_u32 s31, s31, 16384
    v_exp_f32 v53, v53
    v_mfma_f32_16x16x32_bf16 a[68:71], v[84:87], v[148:151], a[68:71]
    ds_read_b128 v[64:67], v8 offset:12288
    v_cvt_pk_bf16_f32 v116, v52, v53
    v_mfma_f32_16x16x32_bf16 a[72:75], v[80:83], v[136:139], a[72:75]
    s_add_u32 s33, s33, 16384
    v_exp_f32 v54, v54
    v_mfma_f32_16x16x32_bf16 a[72:75], v[84:87], v[152:155], a[72:75]
    ds_read_b128 v[68:71], v9 offset:12288
    v_add_u32 v16, s65, v16
    v_mfma_f32_16x16x32_bf16 a[76:79], v[80:83], v[140:143], a[76:79]
    s_cmp_ge_u32 s33, 163840
    v_exp_f32 v55, v55
    v_mfma_f32_16x16x32_bf16 a[76:79], v[84:87], v[156:159], a[76:79]
    ds_read_b128 v[72:75], v10 offset:12288
    v_cvt_pk_bf16_f32 v117, v54, v55
    v_mfma_f32_16x16x32_bf16 a[80:83], v[88:91], v[128:131], a[80:83]
    s_cselect_b32 s66, 81920, 0
    v_exp_f32 v56, v56
    v_mfma_f32_16x16x32_bf16 a[80:83], v[92:95], v[144:147], a[80:83]
    ds_read_b128 v[76:79], v11 offset:12288
    v_add_u32 v17, s65, v17
    v_mfma_f32_16x16x32_bf16 a[84:87], v[88:91], v[132:135], a[84:87]
    s_sub_u32 s33, s33, s66
    v_exp_f32 v57, v57
L_end_bevenV:
    v_mfma_f32_16x16x32_bf16 a[84:87], v[92:95], v[148:151], a[84:87]
    v_cvt_pk_bf16_f32 v120, v56, v57
    v_mfma_f32_16x16x32_bf16 a[88:91], v[88:91], v[136:139], a[88:91]
    s_bfe_u32 s76, s92, s20
    v_exp_f32 v58, v58
    v_mfma_f32_16x16x32_bf16 a[88:91], v[92:95], v[152:155], a[88:91]
    ds_read_b64_tr_b16 v[80:81], v18
    v_mfma_f32_16x16x32_bf16 a[92:95], v[88:91], v[140:143], a[92:95]
    s_bfe_u32 s94, s93, s21
    v_exp_f32 v59, v59
    v_mfma_f32_16x16x32_bf16 a[92:95], v[92:95], v[156:159], a[92:95]
    ds_read_b64_tr_b16 v[82:83], v18 offset:4096
    v_cvt_pk_bf16_f32 v121, v58, v59
    v_mfma_f32_16x16x32_bf16 v[236:239], v[224:227], v[136:139], v[236:239]
    s_waitcnt lgkmcnt(2)
    v_exp_f32 v60, v60
    v_mfma_f32_16x16x32_bf16 v[236:239], v[224:227], v[152:155], v[236:239]
    ds_read_b64_tr_b16 v[84:85], v18 offset:8192
    v_mfma_f32_16x16x32_bf16 v[48:51], v[64:67], v[160:163], v[32:35]
    s_max_u32 s76, s76, s94
    v_exp_f32 v61, v61
    v_mfma_f32_16x16x32_bf16 v[48:51], v[68:71], v[164:167], v[48:51]
    ds_read_b64_tr_b16 v[86:87], v18 offset:12288
    v_cvt_pk_bf16_f32 v124, v60, v61
    v_mfma_f32_16x16x32_bf16 v[48:51], v[72:75], v[168:171], v[48:51]
    s_sub_u32 s76, s23, s76
    v_exp_f32 v62, v62
    v_mfma_f32_16x16x32_bf16 v[48:51], v[76:79], v[172:175], v[48:51]
    ds_read_b64_tr_b16 v[88:89], v19
    v_add_u32 v8, s64, v8
    v_mfma_f32_16x16x32_bf16 v[52:55], v[64:67], v[176:179], v[36:39]
    s_lshl_b32 s76, s76, 1
    v_exp_f32 v63, v63
    v_mfma_f32_16x16x32_bf16 v[52:55], v[68:71], v[180:183], v[52:55]
    ds_read_b64_tr_b16 v[90:91], v19 offset:4096
    v_cvt_pk_bf16_f32 v125, v62, v63
    v_mfma_f32_16x16x32_bf16 v[52:55], v[72:75], v[184:187], v[52:55]
    v_mfma_f32_16x16x32_bf16 v[52:55], v[76:79], v[188:191], v[52:55]
    ds_read_b64_tr_b16 v[92:93], v19 offset:8192
    v_add_u32 v9, s64, v9
    v_mfma_f32_16x16x32_bf16 v[56:59], v[64:67], v[192:195], v[40:43]
    v_exp_f32 v48, v48
    v_mfma_f32_16x16x32_bf16 v[56:59], v[68:71], v[196:199], v[56:59]
    ds_read_b64_tr_b16 v[94:95], v19 offset:12288
    v_add_u32 v10, s64, v10
    v_mfma_f32_16x16x32_bf16 v[56:59], v[72:75], v[200:203], v[56:59]
    v_exp_f32 v49, v49
    v_mfma_f32_16x16x32_bf16 v[56:59], v[76:79], v[204:207], v[56:59]
    v_cvt_pk_bf16_f32 v114, v48, v49
    v_mfma_f32_16x16x32_bf16 v[60:63], v[64:67], v[208:211], v[44:47]
    s_getreg_b32 s66, hwreg(HW_REG_IB_STS, 22, 2)
    v_exp_f32 v50, v50
    v_mfma_f32_16x16x32_bf16 v[60:63], v[68:71], v[212:215], v[60:63]
    s_getreg_b32 s94, hwreg(HW_REG_IB_STS, 0, 4)
    s_lshl4_add_u32 s94, s66, s94
    v_add_u32 v11, s64, v11
    v_mfma_f32_16x16x32_bf16 v[60:63], v[72:75], v[216:219], v[60:63]
    s_waitcnt lgkmcnt(0)
    v_exp_f32 v51, v51
    v_mfma_f32_16x16x32_bf16 v[60:63], v[76:79], v[220:223], v[60:63]
    v_cvt_pk_bf16_f32 v115, v50, v51
    v_mfma_f32_16x16x32_bf16 a[96:99], v[80:83], v[128:131], a[96:99]
    s_cmp_gt_i32 s94, s76
    v_exp_f32 v52, v52
    v_mfma_f32_16x16x32_bf16 a[96:99], v[84:87], v[144:147], a[96:99]
    s_cbranch_scc1 L_lw_beven
L_bb_beven:
    s_waitcnt vmcnt(24)
    s_barrier
    v_mfma_f32_16x16x32_bf16 a[100:103], v[80:83], v[132:135], a[100:103]
    v_exp_f32 v53, v53
    v_mfma_f32_16x16x32_bf16 a[100:103], v[84:87], v[148:151], a[100:103]
    ds_read_b128 v[64:67], v8
    v_cvt_pk_bf16_f32 v118, v52, v53
    v_mfma_f32_16x16x32_bf16 a[104:107], v[80:83], v[136:139], a[104:107]
    v_exp_f32 v54, v54
    v_mfma_f32_16x16x32_bf16 a[104:107], v[84:87], v[152:155], a[104:107]
    ds_read_b128 v[68:71], v9
    v_add_u32 v18, s65, v18
    v_mfma_f32_16x16x32_bf16 a[108:111], v[80:83], v[140:143], a[108:111]
    v_exp_f32 v55, v55
    v_mfma_f32_16x16x32_bf16 a[108:111], v[84:87], v[156:159], a[108:111]
    ds_read_b128 v[72:75], v10
    v_cvt_pk_bf16_f32 v119, v54, v55
    v_mfma_f32_16x16x32_bf16 a[112:115], v[88:91], v[128:131], a[112:115]
    v_exp_f32 v56, v56
    v_mfma_f32_16x16x32_bf16 a[112:115], v[92:95], v[144:147], a[112:115]
    ds_read_b128 v[76:79], v11
    v_add_u32 v19, s65, v19
    v_mfma_f32_16x16x32_bf16 a[116:119], v[88:91], v[132:135], a[116:119]
    v_exp_f32 v57, v57
    v_mfma_f32_16x16x32_bf16 a[116:119], v[92:95], v[148:151], a[116:119]
    v_cvt_pk_bf16_f32 v122, v56, v57
    v_mfma_f32_16x16x32_bf16 a[120:123], v[88:91], v[136:139], a[120:123]
    v_exp_f32 v58, v58
    v_mfma_f32_16x16x32_bf16 a[120:123], v[92:95], v[152:155], a[120:123]
    ds_read_b64_tr_b16 v[80:81], v12
    v_mfma_f32_16x16x32_bf16 a[124:127], v[88:91], v[140:143], a[124:127]
    v_exp_f32 v59, v59
    v_mfma_f32_16x16x32_bf16 a[124:127], v[92:95], v[156:159], a[124:127]
    ds_read_b64_tr_b16 v[82:83], v12 offset:4096
    v_cvt_pk_bf16_f32 v123, v58, v59
    v_mfma_f32_16x16x32_bf16 v[240:243], v[224:227], v[140:143], v[240:243]
    s_waitcnt lgkmcnt(2)
    v_exp_f32 v60, v60
    v_mfma_f32_16x16x32_bf16 v[240:243], v[224:227], v[156:159], v[240:243]
    ds_read_b64_tr_b16 v[84:85], v12 offset:8192
    v_mfma_f32_16x16x32_bf16 v[48:51], v[64:67], v[160:163], v[32:35]
    s_getreg_b32 s94, hwreg(HW_REG_IB_STS)
    v_exp_f32 v61, v61
    v_mfma_f32_16x16x32_bf16 v[48:51], v[68:71], v[164:167], v[48:51]
    s_and_b32 s94, s94, 0xc0000f
    ds_read_b64_tr_b16 v[86:87], v12 offset:12288
    v_cvt_pk_bf16_f32 v126, v60, v61
    v_mfma_f32_16x16x32_bf16 v[48:51], v[72:75], v[168:171], v[48:51]
    s_sub_u32 s76, s94, s95
    v_exp_f32 v62, v62
    v_mfma_f32_16x16x32_bf16 v[48:51], v[76:79], v[172:175], v[48:51]
    ds_read_b64_tr_b16 v[88:89], v13
    v_mfma_f32_16x16x32_bf16 v[52:55], v[64:67], v[176:179], v[36:39]
    s_cmp_gt_u32 s76, s74
    v_exp_f32 v63, v63
    v_mfma_f32_16x16x32_bf16 v[52:55], v[68:71], v[180:183], v[52:55]
    ds_read_b64_tr_b16 v[90:91], v13 offset:4096
    v_cvt_pk_bf16_f32 v127, v62, v63
    v_mfma_f32_16x16x32_bf16 v[52:55], v[72:75], v[184:187], v[52:55]
    s_cbranch_scc1 L_dec_boddK
L_go_boddK:
    v_mfma_f32_16x16x32_bf16 v[52:55], v[76:79], v[188:191], v[52:55]
    s_add_u32 s35, s35, 16384
    ds_read_b64_tr_b16 v[92:93], v13 offset:8192
    v_mfma_f32_16x16x32_bf16 v[56:59], v[64:67], v[192:195], v[40:43]
    s_cmp_eq_u32 s35, 81920
    v_exp_f32 v48, v48
    v_mfma_f32_16x16x32_bf16 v[56:59], v[68:71], v[196:199], v[56:59]
    s_cselect_b32 s65, 0xffff0000, s73
    ds_read_b64_tr_b16 v[94:95], v13 offset:12288
    v_mfma_f32_16x16x32_bf16 v[56:59], v[72:75], v[200:203], v[56:59]
    s_mov_b32 m0, s32
    v_exp_f32 v49, v49
    v_mfma_f32_16x16x32_bf16 v[56:59], v[76:79], v[204:207], v[56:59]
    buffer_load_dwordx4 v20, s[16:19], s30 offen nt lds
    v_cvt_pk_bf16_f32 v128, v48, v49
    v_mfma_f32_16x16x32_bf16 v[60:63], v[64:67], v[208:211], v[44:47]
    s_cselect_b32 s35, 0, s35
    v_exp_f32 v50, v50
    v_mfma_f32_16x16x32_bf16 v[60:63], v[68:71], v[212:215], v[60:63]
    s_add_u32 s23, s23, 2
    buffer_load_dwordx4 v21, s[16:19], s30 offen offset:1024 nt lds
    v_mfma_f32_16x16x32_bf16 v[60:63], v[72:75], v[216:219], v[60:63]
    s_waitcnt lgkmcnt(0)
    v_exp_f32 v51, v51
    v_mfma_f32_16x16x32_bf16 v[60:63], v[76:79], v[220:223], v[60:63]
    buffer_load_dwordx4 v22, s[16:19], s30 offen offset:2048 nt lds
    v_cvt_pk_bf16_f32 v129, v50, v51
    v_mfma_f32_16x16x32_bf16 a[0:3], v[80:83], v[96:99], a[0:3]
    s_lshl_b32 s92, s92, 8
    v_exp_f32 v52, v52
    v_mfma_f32_16x16x32_bf16 a[0:3], v[84:87], v[112:115], a[0:3]
    s_or_b32 s92, s92, s23
    buffer_load_dwordx4 v23, s[16:19], s30 offen offset:3072 nt lds
    v_mfma_f32_16x16x32_bf16 a[4:7], v[80:83], v[100:103], a[4:7]
    s_add_u32 s30, s30, s79
    v_exp_f32 v53, v53
    v_mfma_f32_16x16x32_bf16 a[4:7], v[84:87], v[116:119], a[4:7]
    ds_read_b128 v[64:67], v8 offset:4096
    v_cvt_pk_bf16_f32 v132, v52, v53
    v_mfma_f32_16x16x32_bf16 a[8:11], v[80:83], v[104:107], a[8:11]
    s_add_u32 s32, s32, 16384
    v_exp_f32 v54, v54
    v_mfma_f32_16x16x32_bf16 a[8:11], v[84:87], v[120:123], a[8:11]
    ds_read_b128 v[68:71], v9 offset:4096
    v_add_u32 v12, s65, v12
    v_mfma_f32_16x16x32_bf16 a[12:15], v[80:83], v[108:111], a[12:15]
    s_cmp_ge_u32 s32, 81920
    v_exp_f32 v55, v55
    v_mfma_f32_16x16x32_bf16 a[12:15], v[84:87], v[124:127], a[12:15]
    ds_read_b128 v[72:75], v10 offset:4096
    v_cvt_pk_bf16_f32 v133, v54, v55
    v_mfma_f32_16x16x32_bf16 a[16:19], v[88:91], v[96:99], a[16:19]
    s_cselect_b32 s66, 81920, 0
    v_exp_f32 v56, v56
    v_mfma_f32_16x16x32_bf16 a[16:19], v[92:95], v[112:115], a[16:19]
    ds_read_b128 v[76:79], v11 offset:4096
    v_add_u32 v13, s65, v13
    v_mfma_f32_16x16x32_bf16 a[20:23], v[88:91], v[100:103], a[20:23]
    s_sub_u32 s32, s32, s66
    v_exp_f32 v57, v57
L_end_boddK:
    v_mfma_f32_16x16x32_bf16 a[20:23], v[92:95], v[116:119], a[20:23]
    v_cvt_pk_bf16_f32 v136, v56, v57
    v_mfma_f32_16x16x32_bf16 a[24:27], v[88:91], v[104:107], a[24:27]
    v_exp_f32 v58, v58
    v_mfma_f32_16x16x32_bf16 a[24:27], v[92:95], v[120:123], a[24:27]
    ds_read_b64_tr_b16 v[80:81], v14
    v_mfma_f32_16x16x32_bf16 a[28:31], v[88:91], v[108:111], a[28:31]
    v_exp_f32 v59, v59
    v_mfma_f32_16x16x32_bf16 a[28:31], v[92:95], v[124:127], a[28:31]
    ds_read_b64_tr_b16 v[82:83], v14 offset:4096
    v_cvt_pk_bf16_f32 v137, v58, v59
    v_mfma_f32_16x16x32_bf16 v[228:231], v[224:227], v[96:99], v[228:231]
    s_waitcnt lgkmcnt(2)
    v_exp_f32 v60, v60
    v_mfma_f32_16x16x32_bf16 v[228:231], v[224:227], v[112:115], v[228:231]
    ds_read_b64_tr_b16 v[84:85], v14 offset:8192
    v_mfma_f32_16x16x32_bf16 v[48:51], v[64:67], v[160:163], v[32:35]
    v_exp_f32 v61, v61
    v_mfma_f32_16x16x32_bf16 v[48:51], v[68:71], v[164:167], v[48:51]
    ds_read_b64_tr_b16 v[86:87], v14 offset:12288
    v_cvt_pk_bf16_f32 v140, v60, v61
    v_mfma_f32_16x16x32_bf16 v[48:51], v[72:75], v[168:171], v[48:51]
    s_add_u32 s34, s34, 16384
    v_exp_f32 v62, v62
    v_mfma_f32_16x16x32_bf16 v[48:51], v[76:79], v[172:175], v[48:51]
    ds_read_b64_tr_b16 v[88:89], v15
    v_mfma_f32_16x16x32_bf16 v[52:55], v[64:67], v[176:179], v[36:39]
    s_cmp_eq_u32 s34, 81920
    v_exp_f32 v63, v63
    v_mfma_f32_16x16x32_bf16 v[52:55], v[68:71], v[180:183], v[52:55]
    ds_read_b64_tr_b16 v[90:91], v15 offset:4096
    v_cvt_pk_bf16_f32 v141, v62, v63
    v_mfma_f32_16x16x32_bf16 v[52:55], v[72:75], v[184:187], v[52:55]
    s_cselect_b32 s64, 0xffff0000, s73
    v_mfma_f32_16x16x32_bf16 v[52:55], v[76:79], v[188:191], v[52:55]
    ds_read_b64_tr_b16 v[92:93], v15 offset:8192
    v_mfma_f32_16x16x32_bf16 v[56:59], v[64:67], v[192:195], v[40:43]
    s_cselect_b32 s34, 0, s34
    v_exp_f32 v48, v48
    v_mfma_f32_16x16x32_bf16 v[56:59], v[68:71], v[196:199], v[56:59]
    ds_read_b64_tr_b16 v[94:95], v15 offset:12288
    v_mfma_f32_16x16x32_bf16 v[56:59], v[72:75], v[200:203], v[56:59]
    v_exp_f32 v49, v49
    v_mfma_f32_16x16x32_bf16 v[56:59], v[76:79], v[204:207], v[56:59]
    v_cvt_pk_bf16_f32 v130, v48, v49
    v_mfma_f32_16x16x32_bf16 v[60:63], v[64:67], v[208:211], v[44:47]
    v_exp_f32 v50, v50
    v_mfma_f32_16x16x32_bf16 v[60:63], v[68:71], v[212:215], v[60:63]
    v_mfma_f32_16x16x32_bf16 v[60:63], v[72:75], v[216:219], v[60:63]
    s_waitcnt lgkmcnt(0)
    v_exp_f32 v51, v51
    v_mfma_f32_16x16x32_bf16 v[60:63], v[76:79], v[220:223], v[60:63]
    v_cvt_pk_bf16_f32 v131, v50, v51
    v_mfma_f32_16x16x32_bf16 a[32:35], v[80:83], v[96:99], a[32:35]
    v_exp_f32 v52, v52
    v_mfma_f32_16x16x32_bf16 a[32:35], v[84:87], v[112:115], a[32:35]
    v_mfma_f32_16x16x32_bf16 a[36:39], v[80:83], v[100:103], a[36:39]
    v_exp_f32 v53, v53
    v_mfma_f32_16x16x32_bf16 a[36:39], v[84:87], v[116:119], a[36:39]
    ds_read_b128 v[64:67], v8 offset:8192
    v_cvt_pk_bf16_f32 v134, v52, v53
    v_mfma_f32_16x16x32_bf16 a[40:43], v[80:83], v[104:107], a[40:43]
    v_exp_f32 v54, v54
    v_mfma_f32_16x16x32_bf16 a[40:43], v[84:87], v[120:123], a[40:43]
    ds_read_b128 v[68:71], v9 offset:8192
    v_add_u32 v14, s65, v14
    v_mfma_f32_16x16x32_bf16 a[44:47], v[80:83], v[108:111], a[44:47]
    v_exp_f32 v55, v55
    v_mfma_f32_16x16x32_bf16 a[44:47], v[84:87], v[124:127], a[44:47]
    ds_read_b128 v[72:75], v10 offset:8192
    v_cvt_pk_bf16_f32 v135, v54, v55
    v_mfma_f32_16x16x32_bf16 a[48:51], v[88:91], v[96:99], a[48:51]
    v_exp_f32 v56, v56
    v_mfma_f32_16x16x32_bf16 a[48:51], v[92:95], v[112:115], a[48:51]
    ds_read_b128 v[76:79], v11 offset:8192
    v_add_u32 v15, s65, v15
    v_mfma_f32_16x16x32_bf16 a[52:55], v[88:91], v[100:103], a[52:55]
    v_exp_f32 v57, v57
    v_mfma_f32_16x16x32_bf16 a[52:55], v[92:95], v[116:119], a[52:55]
    v_cvt_pk_bf16_f32 v138, v56, v57
    v_mfma_f32_16x16x32_bf16 a[56:59], v[88:91], v[104:107], a[56:59]
    v_exp_f32 v58, v58
    v_mfma_f32_16x16x32_bf16 a[56:59], v[92:95], v[120:123], a[56:59]
    ds_read_b64_tr_b16 v[80:81], v16
    v_mfma_f32_16x16x32_bf16 a[60:63], v[88:91], v[108:111], a[60:63]
    v_exp_f32 v59, v59
    v_mfma_f32_16x16x32_bf16 a[60:63], v[92:95], v[124:127], a[60:63]
    ds_read_b64_tr_b16 v[82:83], v16 offset:4096
    v_cvt_pk_bf16_f32 v139, v58, v59
    v_mfma_f32_16x16x32_bf16 v[232:235], v[224:227], v[100:103], v[232:235]
    s_waitcnt lgkmcnt(2)
    v_exp_f32 v60, v60
    v_mfma_f32_16x16x32_bf16 v[232:235], v[224:227], v[116:119], v[232:235]
    ds_read_b64_tr_b16 v[84:85], v16 offset:8192
    v_mfma_f32_16x16x32_bf16 v[48:51], v[64:67], v[160:163], v[32:35]
    s_getreg_b32 s94, hwreg(HW_REG_IB_STS)
    v_exp_f32 v61, v61
    v_mfma_f32_16x16x32_bf16 v[48:51], v[68:71], v[164:167], v[48:51]
    s_and_b32 s94, s94, 0xc0000f
    ds_read_b64_tr_b16 v[86:87], v16 offset:12288
    v_cvt_pk_bf16_f32 v142, v60, v61
    v_mfma_f32_16x16x32_bf16 v[48:51], v[72:75], v[168:171], v[48:51]
    s_sub_u32 s76, s94, s49
    v_exp_f32 v62, v62
    v_mfma_f32_16x16x32_bf16 v[48:51], v[76:79], v[172:175], v[48:51]
    ds_read_b64_tr_b16 v[88:89], v17
    v_mfma_f32_16x16x32_bf16 v[52:55], v[64:67], v[176:179], v[36:39]
    s_cmp_gt_u32 s76, s78
    v_exp_f32 v63, v63
    v_mfma_f32_16x16x32_bf16 v[52:55], v[68:71], v[180:183], v[52:55]
    ds_read_b64_tr_b16 v[90:91], v17 offset:4096
    v_cvt_pk_bf16_f32 v143, v62, v63
    v_mfma_f32_16x16x32_bf16 v[52:55], v[72:75], v[184:187], v[52:55]
    s_cbranch_scc1 L_dec_boddV
L_go_boddV:
    v_mfma_f32_16x16x32_bf16 v[52:55], v[76:79], v[188:191], v[52:55]
    ds_read_b64_tr_b16 v[92:93], v17 offset:8192
    v_mfma_f32_16x16x32_bf16 v[56:59], v[64:67], v[192:195], v[40:43]
    v_exp_f32 v48, v48
    v_mfma_f32_16x16x32_bf16 v[56:59], v[68:71], v[196:199], v[56:59]
    ds_read_b64_tr_b16 v[94:95], v17 offset:12288
    v_mfma_f32_16x16x32_bf16 v[56:59], v[72:75], v[200:203], v[56:59]
    s_mov_b32 m0, s33
    v_exp_f32 v49, v49
    v_mfma_f32_16x16x32_bf16 v[56:59], v[76:79], v[204:207], v[56:59]
    buffer_load_dwordx4 v24, s[12:15], s31 offen nt lds
    v_cvt_pk_bf16_f32 v144, v48, v49
    v_mfma_f32_16x16x32_bf16 v[60:63], v[64:67], v[208:211], v[44:47]
    v_exp_f32 v50, v50
    v_mfma_f32_16x16x32_bf16 v[60:63], v[68:71], v[212:215], v[60:63]
    s_add_u32 s23, s23, 2
    buffer_load_dwordx4 v25, s[12:15], s31 offen offset:1024 nt lds
    v_mfma_f32_16x16x32_bf16 v[60:63], v[72:75], v[216:219], v[60:63]
    s_waitcnt lgkmcnt(0)
    v_exp_f32 v51, v51
    v_mfma_f32_16x16x32_bf16 v[60:63], v[76:79], v[220:223], v[60:63]
    buffer_load_dwordx4 v24, s[12:15], s31 offen offset:2048 nt lds
    v_cvt_pk_bf16_f32 v145, v50, v51
    v_mfma_f32_16x16x32_bf16 a[64:67], v[80:83], v[96:99], a[64:67]
    s_lshl_b32 s93, s93, 8
    v_exp_f32 v52, v52
    v_mfma_f32_16x16x32_bf16 a[64:67], v[84:87], v[112:115], a[64:67]
    s_or_b32 s93, s93, s23
    buffer_load_dwordx4 v25, s[12:15], s31 offen offset:3072 nt lds
    v_mfma_f32_16x16x32_bf16 a[68:71], v[80:83], v[100:103], a[68:71]
    s_add_u32 s31, s31, 16384
    v_exp_f32 v53, v53
    v_mfma_f32_16x16x32_bf16 a[68:71], v[84:87], v[116:119], a[68:71]
    ds_read_b128 v[64:67], v8 offset:12288
    v_cvt_pk_bf16_f32 v148, v52, v53
    v_mfma_f32_16x16x32_bf16 a[72:75], v[80:83], v[104:107], a[72:75]
    s_add_u32 s33, s33, 16384
    v_exp_f32 v54, v54
    v_mfma_f32_16x16x32_bf16 a[72:75], v[84:87], v[120:123], a[72:75]
    ds_read_b128 v[68:71], v9 offset:12288
    v_add_u32 v16, s65, v16
    v_mfma_f32_16x16x32_bf16 a[76:79], v[80:83], v[108:111], a[76:79]
    s_cmp_ge_u32 s33, 163840
    v_exp_f32 v55, v55
    v_mfma_f32_16x16x32_bf16 a[76:79], v[84:87], v[124:127], a[76:79]
    ds_read_b128 v[72:75], v10 offset:12288
    v_cvt_pk_bf16_f32 v149, v54, v55
    v_mfma_f32_16x16x32_bf16 a[80:83], v[88:91], v[96:99], a[80:83]
    s_cselect_b32 s66, 81920, 0
    v_exp_f32 v56, v56
    v_mfma_f32_16x16x32_bf16 a[80:83], v[92:95], v[112:115], a[80:83]
    ds_read_b128 v[76:79], v11 offset:12288
    v_add_u32 v17, s65, v17
    v_mfma_f32_16x16x32_bf16 a[84:87], v[88:91], v[100:103], a[84:87]
    s_sub_u32 s33, s33, s66
    v_exp_f32 v57, v57
L_end_boddV:
    v_mfma_f32_16x16x32_bf16 a[84:87], v[92:95], v[116:119], a[84:87]
    v_cvt_pk_bf16_f32 v152, v56, v57
    v_mfma_f32_16x16x32_bf16 a[88:91], v[88:91], v[104:107], a[88:91]
L_hop7:
    s_cbranch_execz L_hop11
    s_bfe_u32 s76, s92, s20
    v_exp_f32 v58, v58
    v_mfma_f32_16x16x32_bf16 a[88:91], v[92:95], v[120:123], a[88:91]
    ds_read_b64_tr_b16 v[80:81], v18
    v_mfma_f32_16x16x32_bf16 a[92:95], v[88:91], v[108:111], a[92:95]
    s_bfe_u32 s94, s93, s21
    v_exp_f32 v59, v59
    v_mfma_f32_16x16x32_bf16 a[92:95], v[92:95], v[124:127], a[92:95]
    ds_read_b64_tr_b16 v[82:83], v18 offset:4096
    v_cvt_pk_bf16_f32 v153, v58, v59
    v_mfma_f32_16x16x32_bf16 v[236:239], v[224:227], v[104:107], v[236:239]
    s_waitcnt lgkmcnt(2)
    v_exp_f32 v60, v60
    v_mfma_f32_16x16x32_bf16 v[236:239], v[224:227], v[120:123], v[236:239]
    ds_read_b64_tr_b16 v[84:85], v18 offset:8192
    v_mfma_f32_16x16x32_bf16 v[48:51], v[64:67], v[160:163], v[32:35]
    s_max_u32 s76, s76, s94
    v_exp_f32 v61, v61
    v_mfma_f32_16x16x32_bf16 v[48:51], v[68:71], v[164:167], v[48:51]
    ds_read_b64_tr_b16 v[86:87], v18 offset:12288
    v_cvt_pk_bf16_f32 v156, v60, v61
    v_mfma_f32_16x16x32_bf16 v[48:51], v[72:75], v[168:171], v[48:51]
    s_sub_u32 s76, s23, s76
    v_exp_f32 v62, v62
    v_mfma_f32_16x16x32_bf16 v[48:51], v[76:79], v[172:175], v[48:51]
    ds_read_b64_tr_b16 v[88:89], v19
    v_add_u32 v8, s64, v8
    v_mfma_f32_16x16x32_bf16 v[52:55], v[64:67], v[176:179], v[36:39]
    s_lshl_b32 s76, s76, 1
    v_exp_f32 v63, v63
    v_mfma_f32_16x16x32_bf16 v[52:55], v[68:71], v[180:183], v[52:55]
    ds_read_b64_tr_b16 v[90:91], v19 offset:4096
    v_cvt_pk_bf16_f32 v157, v62, v63
    v_mfma_f32_16x16x32_bf16 v[52:55], v[72:75], v[184:187], v[52:55]
    v_mfma_f32_16x16x32_bf16 v[52:55], v[76:79], v[188:191], v[52:55]
    ds_read_b64_tr_b16 v[92:93], v19 offset:8192
    v_add_u32 v9, s64, v9
    v_mfma_f32_16x16x32_bf16 v[56:59], v[64:67], v[192:195], v[40:43]
    v_exp_f32 v48, v48
    v_mfma_f32_16x16x32_bf16 v[56:59], v[68:71], v[196:199], v[56:59]
    ds_read_b64_tr_b16 v[94:95], v19 offset:12288
    v_add_u32 v10, s64, v10
    v_mfma_f32_16x16x32_bf16 v[56:59], v[72:75], v[200:203], v[56:59]
    v_exp_f32 v49, v49
    v_mfma_f32_16x16x32_bf16 v[56:59], v[76:79], v[204:207], v[56:59]
    v_cvt_pk_bf16_f32 v146, v48, v49
    v_mfma_f32_16x16x32_bf16 v[60:63], v[64:67], v[208:211], v[44:47]
    s_getreg_b32 s66, hwreg(HW_REG_IB_STS, 22, 2)
    v_exp_f32 v50, v50
    v_mfma_f32_16x16x32_bf16 v[60:63], v[68:71], v[212:215], v[60:63]
    s_getreg_b32 s94, hwreg(HW_REG_IB_STS, 0, 4)
    s_lshl4_add_u32 s94, s66, s94
    v_add_u32 v11, s64, v11
    v_mfma_f32_16x16x32_bf16 v[60:63], v[72:75], v[216:219], v[60:63]
    s_waitcnt lgkmcnt(0)
    v_exp_f32 v51, v51
    v_mfma_f32_16x16x32_bf16 v[60:63], v[76:79], v[220:223], v[60:63]
    v_cvt_pk_bf16_f32 v147, v50, v51
    v_mfma_f32_16x16x32_bf16 a[96:99], v[80:83], v[96:99], a[96:99]
    s_cmp_gt_i32 s94, s76
    v_exp_f32_e64 v52, v52
    v_mfma_f32_16x16x32_bf16 a[96:99], v[84:87], v[112:115], a[96:99]
    s_cbranch_scc1 L_lw_bodd
L_bb_bodd:
    s_waitcnt vmcnt(24)
    s_barrier
    v_mfma_f32_16x16x32_bf16 a[100:103], v[80:83], v[100:103], a[100:103]
    v_exp_f32 v53, v53
    v_mfma_f32_16x16x32_bf16 a[100:103], v[84:87], v[116:119], a[100:103]
    ds_read_b128 v[64:67], v8
    v_cvt_pk_bf16_f32 v150, v52, v53
    v_mfma_f32_16x16x32_bf16 a[104:107], v[80:83], v[104:107], a[104:107]
    v_exp_f32 v54, v54
    v_mfma_f32_16x16x32_bf16 a[104:107], v[84:87], v[120:123], a[104:107]
    ds_read_b128 v[68:71], v9
    v_add_u32 v18, s65, v18
    v_mfma_f32_16x16x32_bf16 a[108:111], v[80:83], v[108:111], a[108:111]
    v_exp_f32 v55, v55
    v_mfma_f32_16x16x32_bf16 a[108:111], v[84:87], v[124:127], a[108:111]
    ds_read_b128 v[72:75], v10
    v_cvt_pk_bf16_f32 v151, v54, v55
    v_mfma_f32_16x16x32_bf16 a[112:115], v[88:91], v[96:99], a[112:115]
    v_exp_f32 v56, v56
    v_mfma_f32_16x16x32_bf16 a[112:115], v[92:95], v[112:115], a[112:115]
    ds_read_b128 v[76:79], v11
    v_add_u32 v19, s65, v19
    v_mfma_f32_16x16x32_bf16 a[116:119], v[88:91], v[100:103], a[116:119]
    v_exp_f32 v57, v57
    v_mfma_f32_16x16x32_bf16 a[116:119], v[92:95], v[116:119], a[116:119]
    v_cvt_pk_bf16_f32 v154, v56, v57
    v_mfma_f32_16x16x32_bf16 a[120:123], v[88:91], v[104:107], a[120:123]
    v_exp_f32 v58, v58
    v_mfma_f32_16x16x32_bf16 a[120:123], v[92:95], v[120:123], a[120:123]
    ds_read_b64_tr_b16 v[80:81], v12
    v_mfma_f32_16x16x32_bf16 a[124:127], v[88:91], v[108:111], a[124:127]
    v_exp_f32 v59, v59
    v_mfma_f32_16x16x32_bf16 a[124:127], v[92:95], v[124:127], a[124:127]
    ds_read_b64_tr_b16 v[82:83], v12 offset:4096
    v_cvt_pk_bf16_f32 v155, v58, v59
    v_mfma_f32_16x16x32_bf16 v[240:243], v[224:227], v[108:111], v[240:243]
    s_waitcnt lgkmcnt(2)
    v_exp_f32 v60, v60
    v_mfma_f32_16x16x32_bf16 v[240:243], v[224:227], v[124:127], v[240:243]
    ds_read_b64_tr_b16 v[84:85], v12 offset:8192
    s_sub_u32 s69, s69, 1
    s_cbranch_scc0 L_loop
    s_cmp_lg_u32 s70, 0
    s_cbranch_scc1 L_mid

    v_mfma_f32_16x16x32_bf16 v[228:231], v[224:227], v[128:131], v[228:231]
    ds_read_b64_tr_b16 v[86:87], v12 offset:12288
    v_exp_f32 v61, v61
    v_mfma_f32_16x16x32_bf16 v[228:231], v[224:227], v[144:147], v[228:231]
    ds_read_b64_tr_b16 v[88:89], v13
    v_cvt_pk_bf16_f32 v158, v60, v61
    v_mfma_f32_16x16x32_bf16 v[232:235], v[224:227], v[132:135], v[232:235]
    ds_read_b64_tr_b16 v[90:91], v13 offset:4096
    v_exp_f32 v62, v62
    v_mfma_f32_16x16x32_bf16 v[232:235], v[224:227], v[148:151], v[232:235]
    ds_read_b64_tr_b16 v[92:93], v13 offset:8192
    v_mfma_f32_16x16x32_bf16 v[236:239], v[224:227], v[136:139], v[236:239]
    ds_read_b64_tr_b16 v[94:95], v13 offset:12288
    v_exp_f32 v63, v63
    v_mfma_f32_16x16x32_bf16 v[236:239], v[224:227], v[152:155], v[236:239]
    v_cvt_pk_bf16_f32 v159, v62, v63
    v_mfma_f32_16x16x32_bf16 v[240:243], v[224:227], v[140:143], v[240:243]
    s_nop 0
    v_mfma_f32_16x16x32_bf16 v[240:243], v[224:227], v[156:159], v[240:243]
    s_waitcnt lgkmcnt(4)
    v_mfma_f32_16x16x32_bf16 a[0:3], v[80:83], v[128:131], a[0:3]
    v_mfma_f32_16x16x32_bf16 a[0:3], v[84:87], v[144:147], a[0:3]
    v_add_f32 v245, v228, v232
    v_mfma_f32_16x16x32_bf16 a[4:7], v[80:83], v[132:135], a[4:7]
    v_rcp_f32 v244, v228
    v_mfma_f32_16x16x32_bf16 a[4:7], v[84:87], v[148:151], a[4:7]
    v_rcp_f32 v246, v232
    v_mfma_f32_16x16x32_bf16 a[8:11], v[80:83], v[136:139], a[8:11]
    v_add_f32 v247, v236, v240
    v_add_f32 v245, v245, v247
    v_min3_f32 v249, v228, v232, v236
    v_min_f32 v249, v249, v240
    v_rcp_f32 v248, v236
    v_mfma_f32_16x16x32_bf16 a[8:11], v[84:87], v[152:155], a[8:11]
    v_cmp_nge_f32 vcc, s72, v245
    v_cmp_nle_f32 s[56:57], 0.5, v249
    v_rcp_f32 v250, v240
    v_mfma_f32_16x16x32_bf16 a[12:15], v[80:83], v[140:143], a[12:15]
    s_or_b64 vcc, vcc, s[56:57]
    s_cmp_lg_u64 vcc, 0
    s_cbranch_scc1 L_slow
    v_mfma_f32_16x16x32_bf16 a[12:15], v[84:87], v[156:159], a[12:15]
    s_waitcnt lgkmcnt(0)
    s_add_u32 s23, s23, 4
    v_accvgpr_read_b32 v160, a128
    v_accvgpr_read_b32 v161, a129
    v_accvgpr_read_b32 v162, a130
    v_accvgpr_read_b32 v163, a131
    v_accvgpr_read_b32 v164, a136
    v_accvgpr_read_b32 v165, a137
    v_mfma_f32_16x16x32_bf16 a[16:19], v[88:91], v[128:131], a[16:19]
    s_add_u32 s23, s23, 2
    ds_read_b64_tr_b16 v[80:81], v14
    v_accvgpr_read_b32 v166, a138
    v_accvgpr_read_b32 v167, a139
    v_accvgpr_read_b32 v168, a144
    v_accvgpr_read_b32 v169, a145
    v_accvgpr_read_b32 v170, a146
    v_accvgpr_read_b32 v171, a147
    v_mfma_f32_16x16x32_bf16 a[16:19], v[92:95], v[144:147], a[16:19]
    s_lshl_b32 s92, s92, 8
    ds_read_b64_tr_b16 v[82:83], v14 offset:4096
    v_accvgpr_read_b32 v172, a152
    v_accvgpr_read_b32 v173, a153
    v_accvgpr_read_b32 v174, a154
    v_accvgpr_read_b32 v175, a155
    v_accvgpr_read_b32 v176, a160
    v_accvgpr_read_b32 v177, a161
    v_mfma_f32_16x16x32_bf16 a[20:23], v[88:91], v[132:135], a[20:23]
    s_or_b32 s92, s92, s23
    ds_read_b64_tr_b16 v[84:85], v14 offset:8192
    v_accvgpr_read_b32 v178, a162
    v_accvgpr_read_b32 v179, a163
    v_accvgpr_read_b32 v180, a168
    v_accvgpr_read_b32 v181, a169
    v_accvgpr_read_b32 v182, a170
    v_accvgpr_read_b32 v183, a171
    v_mfma_f32_16x16x32_bf16 a[20:23], v[92:95], v[148:151], a[20:23]
    ds_read_b64_tr_b16 v[86:87], v14 offset:12288
    v_accvgpr_read_b32 v184, a176
    v_accvgpr_read_b32 v185, a177
    v_accvgpr_read_b32 v186, a178
    v_accvgpr_read_b32 v187, a179
    v_accvgpr_read_b32 v188, a184
    v_accvgpr_read_b32 v189, a185
    v_mfma_f32_16x16x32_bf16 a[24:27], v[88:91], v[136:139], a[24:27]
    s_mov_b32 m0, s32
    v_accvgpr_read_b32 v190, a186
    v_accvgpr_read_b32 v191, a187
    v_accvgpr_read_b32 v192, a192
    v_accvgpr_read_b32 v193, a193
    v_accvgpr_read_b32 v194, a194
    v_accvgpr_read_b32 v195, a195
    v_mfma_f32_16x16x32_bf16 a[24:27], v[92:95], v[152:155], a[24:27]
    buffer_load_dwordx4 v20, s[16:19], s30 offen nt lds
    v_accvgpr_read_b32 v196, a200
    v_accvgpr_read_b32 v197, a201
    v_accvgpr_read_b32 v198, a202
    v_accvgpr_read_b32 v199, a203
    v_accvgpr_read_b32 v200, a208
    v_accvgpr_read_b32 v201, a209
    v_mfma_f32_16x16x32_bf16 a[28:31], v[88:91], v[140:143], a[28:31]
    v_accvgpr_read_b32 v202, a210
    v_accvgpr_read_b32 v203, a211
    v_accvgpr_read_b32 v204, a216
    v_accvgpr_read_b32 v205, a217
    v_accvgpr_read_b32 v206, a218
    v_accvgpr_read_b32 v207, a219
    v_mfma_f32_16x16x32_bf16 a[28:31], v[92:95], v[156:159], a[28:31]
    s_waitcnt lgkmcnt(0)
    v_accvgpr_read_b32 v208, a224
    v_accvgpr_read_b32 v209, a225
    v_accvgpr_read_b32 v210, a226
    v_accvgpr_read_b32 v211, a227
    v_accvgpr_read_b32 v212, a232
    v_accvgpr_read_b32 v213, a233
    v_mfma_f32_16x16x32_bf16 a[32:35], v[80:83], v[128:131], a[32:35]
    ds_read_b64_tr_b16 v[88:89], v15
    v_accvgpr_read_b32 v214, a234
    v_accvgpr_read_b32 v215, a235
    v_accvgpr_read_b32 v216, a240
    v_accvgpr_read_b32 v217, a241
    v_accvgpr_read_b32 v218, a242
    v_accvgpr_read_b32 v219, a243
    v_mfma_f32_16x16x32_bf16 a[32:35], v[84:87], v[144:147], a[32:35]
    ds_read_b64_tr_b16 v[90:91], v15 offset:4096
    v_accvgpr_read_b32 v220, a248
    v_accvgpr_read_b32 v221, a249
    v_accvgpr_read_b32 v222, a250
    v_accvgpr_read_b32 v223, a251
    v_accvgpr_read_b32 v96, a0
    v_accvgpr_read_b32 v97, a1
    v_mfma_f32_16x16x32_bf16 a[36:39], v[80:83], v[132:135], a[36:39]
    ds_read_b64_tr_b16 v[92:93], v15 offset:8192
    v_accvgpr_read_b32 v98, a2
    v_accvgpr_read_b32 v99, a3
    v_accvgpr_read_b32 v100, a16
    v_accvgpr_read_b32 v101, a17
    v_accvgpr_read_b32 v102, a18
    v_accvgpr_read_b32 v103, a19
    v_mfma_f32_16x16x32_bf16 a[36:39], v[84:87], v[148:151], a[36:39]
    ds_read_b64_tr_b16 v[94:95], v15 offset:12288
    v_mul_f32 v96, v96, v244
    v_mul_f32 v97, v97, v244
    v_mul_f32 v98, v98, v244
    v_mul_f32 v99, v99, v244
    v_mul_f32 v100, v100, v244
    v_mul_f32 v101, v101, v244
    v_mfma_f32_16x16x32_bf16 a[40:43], v[80:83], v[136:139], a[40:43]
    v_mul_f32 v102, v102, v244
    v_mul_f32 v103, v103, v244
    v_cvt_pk_bf16_f32 v96, v96, v97
    v_cvt_pk_bf16_f32 v97, v98, v99
    v_cvt_pk_bf16_f32 v98, v100, v101
    v_cvt_pk_bf16_f32 v99, v102, v103
    v_mfma_f32_16x16x32_bf16 a[40:43], v[84:87], v[152:155], a[40:43]
    buffer_load_dwordx4 v21, s[16:19], s30 offen offset:1024 nt lds
    buffer_store_dwordx4 v[96:99], v26, s[24:27], s84 offen sc1
    v_accvgpr_read_b32 v104, a4
    v_accvgpr_read_b32 v105, a5
    v_accvgpr_read_b32 v106, a6
    v_accvgpr_read_b32 v107, a7
    v_accvgpr_read_b32 v108, a20
    v_mfma_f32_16x16x32_bf16 a[44:47], v[80:83], v[140:143], a[44:47]
    v_accvgpr_read_b32 v109, a21
    v_accvgpr_read_b32 v110, a22
    v_accvgpr_read_b32 v111, a23
    v_mul_f32 v104, v104, v246
    v_mul_f32 v105, v105, v246
    v_mul_f32 v106, v106, v246
    v_mfma_f32_16x16x32_bf16 a[44:47], v[84:87], v[156:159], a[44:47]
    s_waitcnt lgkmcnt(0)
    v_mul_f32 v107, v107, v246
    v_mul_f32 v108, v108, v246
    v_mul_f32 v109, v109, v246
    v_mul_f32 v110, v110, v246
    v_mul_f32 v111, v111, v246
    v_cvt_pk_bf16_f32 v104, v104, v105
    v_mfma_f32_16x16x32_bf16 a[48:51], v[88:91], v[128:131], a[48:51]
    ds_read_b64_tr_b16 v[80:81], v16
    v_cvt_pk_bf16_f32 v105, v106, v107
    v_cvt_pk_bf16_f32 v106, v108, v109
    v_cvt_pk_bf16_f32 v107, v110, v111
    buffer_store_dwordx4 v[104:107], v26, s[24:27], s85 offen sc1
    v_accvgpr_read_b32 v112, a8
    v_accvgpr_read_b32 v113, a9
    v_mfma_f32_16x16x32_bf16 a[48:51], v[92:95], v[144:147], a[48:51]
    ds_read_b64_tr_b16 v[82:83], v16 offset:4096
    v_accvgpr_read_b32 v114, a10
    v_accvgpr_read_b32 v115, a11
    v_accvgpr_read_b32 v116, a24
    v_accvgpr_read_b32 v117, a25
    v_accvgpr_read_b32 v118, a26
    v_accvgpr_read_b32 v119, a27
    v_mfma_f32_16x16x32_bf16 a[52:55], v[88:91], v[132:135], a[52:55]
    ds_read_b64_tr_b16 v[84:85], v16 offset:8192
    v_mul_f32 v112, v112, v248
    v_mul_f32 v113, v113, v248
    v_mul_f32 v114, v114, v248
    v_mul_f32 v115, v115, v248
    v_mul_f32 v116, v116, v248
    v_mul_f32 v117, v117, v248
    v_mfma_f32_16x16x32_bf16 a[52:55], v[92:95], v[148:151], a[52:55]
    ds_read_b64_tr_b16 v[86:87], v16 offset:12288
    v_mul_f32 v118, v118, v248
    v_mul_f32 v119, v119, v248
    v_cvt_pk_bf16_f32 v112, v112, v113
    v_cvt_pk_bf16_f32 v113, v114, v115
    v_cvt_pk_bf16_f32 v114, v116, v117
    v_cvt_pk_bf16_f32 v115, v118, v119
    v_mfma_f32_16x16x32_bf16 a[56:59], v[88:91], v[136:139], a[56:59]
    buffer_store_dwordx4 v[112:115], v26, s[24:27], s86 offen sc1
    v_accvgpr_read_b32 v120, a12
    v_accvgpr_read_b32 v121, a13
    v_accvgpr_read_b32 v122, a14
    v_accvgpr_read_b32 v123, a15
    v_accvgpr_read_b32 v124, a28
    v_mfma_f32_16x16x32_bf16 a[56:59], v[92:95], v[152:155], a[56:59]
    buffer_load_dwordx4 v22, s[16:19], s30 offen offset:2048 nt lds
    v_accvgpr_read_b32 v125, a29
    v_accvgpr_read_b32 v126, a30
    v_accvgpr_read_b32 v127, a31
    v_mul_f32 v120, v120, v250
    v_mul_f32 v121, v121, v250
    v_mul_f32 v122, v122, v250
    v_mfma_f32_16x16x32_bf16 a[60:63], v[88:91], v[140:143], a[60:63]
    v_mul_f32 v123, v123, v250
    v_mul_f32 v124, v124, v250
    v_mul_f32 v125, v125, v250
    v_mul_f32 v126, v126, v250
    v_mul_f32 v127, v127, v250
    v_cvt_pk_bf16_f32 v120, v120, v121
    v_mfma_f32_16x16x32_bf16 a[60:63], v[92:95], v[156:159], a[60:63]
    s_waitcnt lgkmcnt(0)
    v_cvt_pk_bf16_f32 v121, v122, v123
    v_cvt_pk_bf16_f32 v122, v124, v125
    v_cvt_pk_bf16_f32 v123, v126, v127
    buffer_store_dwordx4 v[120:123], v26, s[24:27], s87 offen sc1
    v_accvgpr_read_b32 v96, a32
    v_accvgpr_read_b32 v97, a33
    v_mfma_f32_16x16x32_bf16 a[64:67], v[80:83], v[128:131], a[64:67]
    ds_read_b64_tr_b16 v[88:89], v17
    v_accvgpr_read_b32 v98, a34
    v_accvgpr_read_b32 v99, a35
    v_accvgpr_read_b32 v100, a48
    v_accvgpr_read_b32 v101, a49
    v_accvgpr_read_b32 v102, a50
    v_accvgpr_read_b32 v103, a51
    v_mfma_f32_16x16x32_bf16 a[64:67], v[84:87], v[144:147], a[64:67]
    ds_read_b64_tr_b16 v[90:91], v17 offset:4096
    v_mul_f32 v96, v96, v244
    v_mul_f32 v97, v97, v244
    v_mul_f32 v98, v98, v244
    v_mul_f32 v99, v99, v244
    v_mul_f32 v100, v100, v244
    v_mul_f32 v101, v101, v244
    v_mfma_f32_16x16x32_bf16 a[68:71], v[80:83], v[132:135], a[68:71]
    ds_read_b64_tr_b16 v[92:93], v17 offset:8192
    v_mul_f32 v102, v102, v244
    v_mul_f32 v103, v103, v244
    v_cvt_pk_bf16_f32 v96, v96, v97
    v_cvt_pk_bf16_f32 v97, v98, v99
    v_cvt_pk_bf16_f32 v98, v100, v101
    v_cvt_pk_bf16_f32 v99, v102, v103
    v_mfma_f32_16x16x32_bf16 a[68:71], v[84:87], v[148:151], a[68:71]
    ds_read_b64_tr_b16 v[94:95], v17 offset:12288
    buffer_store_dwordx4 v[96:99], v26, s[24:27], s84 offen offset:1024 sc1
    v_accvgpr_read_b32 v104, a36
    v_accvgpr_read_b32 v105, a37
    v_accvgpr_read_b32 v106, a38
    v_accvgpr_read_b32 v107, a39
    v_accvgpr_read_b32 v108, a52
    v_mfma_f32_16x16x32_bf16 a[72:75], v[80:83], v[136:139], a[72:75]
    v_accvgpr_read_b32 v109, a53
    v_accvgpr_read_b32 v110, a54
    v_accvgpr_read_b32 v111, a55
    v_mul_f32 v104, v104, v246
    v_mul_f32 v105, v105, v246
    v_mul_f32 v106, v106, v246
    v_mfma_f32_16x16x32_bf16 a[72:75], v[84:87], v[152:155], a[72:75]
    buffer_load_dwordx4 v23, s[16:19], s30 offen offset:3072 nt lds
    v_mul_f32 v107, v107, v246
    v_mul_f32 v108, v108, v246
    v_mul_f32 v109, v109, v246
    v_mul_f32 v110, v110, v246
    v_mul_f32 v111, v111, v246
    v_cvt_pk_bf16_f32 v104, v104, v105
    v_mfma_f32_16x16x32_bf16 a[76:79], v[80:83], v[140:143], a[76:79]
    v_cvt_pk_bf16_f32 v105, v106, v107
    v_cvt_pk_bf16_f32 v106, v108, v109
    v_cvt_pk_bf16_f32 v107, v110, v111
    v_accvgpr_write_b32 a212, v104
    v_accvgpr_write_b32 a213, v105
    v_accvgpr_write_b32 a214, v106
    v_mfma_f32_16x16x32_bf16 a[76:79], v[84:87], v[156:159], a[76:79]
    s_waitcnt lgkmcnt(0)
    v_accvgpr_write_b32 a215, v107
    v_accvgpr_read_b32 v112, a40
    v_accvgpr_read_b32 v113, a41
    v_accvgpr_read_b32 v114, a42
    v_accvgpr_read_b32 v115, a43
    v_accvgpr_read_b32 v116, a56
    v_mfma_f32_16x16x32_bf16 a[80:83], v[88:91], v[128:131], a[80:83]
    ds_read_b64_tr_b16 v[80:81], v18
    v_accvgpr_read_b32 v117, a57
    v_accvgpr_read_b32 v118, a58
    v_accvgpr_read_b32 v119, a59
    v_mul_f32 v112, v112, v248
    v_mul_f32 v113, v113, v248
    v_mul_f32 v114, v114, v248
    v_mfma_f32_16x16x32_bf16 a[80:83], v[92:95], v[144:147], a[80:83]
    ds_read_b64_tr_b16 v[82:83], v18 offset:4096
    v_mul_f32 v115, v115, v248
    v_mul_f32 v116, v116, v248
    v_mul_f32 v117, v117, v248
    v_mul_f32 v118, v118, v248
    v_mul_f32 v119, v119, v248
    v_cvt_pk_bf16_f32 v112, v112, v113
    v_mfma_f32_16x16x32_bf16 a[84:87], v[88:91], v[132:135], a[84:87]
    ds_read_b64_tr_b16 v[84:85], v18 offset:8192
    v_cvt_pk_bf16_f32 v113, v114, v115
    v_cvt_pk_bf16_f32 v114, v116, v117
    v_cvt_pk_bf16_f32 v115, v118, v119
    v_accvgpr_write_b32 a228, v112
    v_accvgpr_write_b32 a229, v113
    v_accvgpr_write_b32 a230, v114
    v_mfma_f32_16x16x32_bf16 a[84:87], v[92:95], v[148:151], a[84:87]
    ds_read_b64_tr_b16 v[86:87], v18 offset:12288
    v_accvgpr_write_b32 a231, v115
    v_accvgpr_read_b32 v120, a44
    v_accvgpr_read_b32 v121, a45
    v_accvgpr_read_b32 v122, a46
    v_accvgpr_read_b32 v123, a47
    v_accvgpr_read_b32 v124, a60
    v_mfma_f32_16x16x32_bf16 a[88:91], v[88:91], v[136:139], a[88:91]
    v_accvgpr_read_b32 v125, a61
    v_accvgpr_read_b32 v126, a62
    v_accvgpr_read_b32 v127, a63
    v_mul_f32 v120, v120, v250
    v_mul_f32 v121, v121, v250
    v_mul_f32 v122, v122, v250
    v_mfma_f32_16x16x32_bf16 a[88:91], v[92:95], v[152:155], a[88:91]
    s_add_u32 s30, s30, s79
    v_mul_f32 v123, v123, v250
    v_mul_f32 v124, v124, v250
    v_mul_f32 v125, v125, v250
    v_mul_f32 v126, v126, v250
    v_mul_f32 v127, v127, v250
    v_cvt_pk_bf16_f32 v120, v120, v121
    v_mfma_f32_16x16x32_bf16 a[92:95], v[88:91], v[140:143], a[92:95]
    s_add_u32 s32, s32, 16384
    v_cvt_pk_bf16_f32 v121, v122, v123
    v_cvt_pk_bf16_f32 v122, v124, v125
    v_cvt_pk_bf16_f32 v123, v126, v127
    v_accvgpr_write_b32 a244, v120
    v_accvgpr_write_b32 a245, v121
    v_accvgpr_write_b32 a246, v122
    v_mfma_f32_16x16x32_bf16 a[92:95], v[92:95], v[156:159], a[92:95]
    s_waitcnt lgkmcnt(0)
    s_cmp_ge_u32 s32, 81920
    v_accvgpr_write_b32 a247, v123
    v_accvgpr_read_b32 v96, a64
    v_accvgpr_read_b32 v97, a65
    v_accvgpr_read_b32 v98, a66
    v_accvgpr_read_b32 v99, a67
    v_accvgpr_read_b32 v100, a80
    v_mfma_f32_16x16x32_bf16 a[96:99], v[80:83], v[128:131], a[96:99]
    s_cselect_b32 s66, 81920, 0
    ds_read_b64_tr_b16 v[88:89], v19
    v_accvgpr_read_b32 v101, a81
    v_accvgpr_read_b32 v102, a82
    v_accvgpr_read_b32 v103, a83
    v_mul_f32 v96, v96, v244
    v_mul_f32 v97, v97, v244
    v_mul_f32 v98, v98, v244
    v_mfma_f32_16x16x32_bf16 a[96:99], v[84:87], v[144:147], a[96:99]
    s_sub_u32 s32, s32, s66
    ds_read_b64_tr_b16 v[90:91], v19 offset:4096
    v_mul_f32 v99, v99, v244
    v_mul_f32 v100, v100, v244
    v_mul_f32 v101, v101, v244
    v_mul_f32 v102, v102, v244
    v_mul_f32 v103, v103, v244
    v_cvt_pk_bf16_f32 v96, v96, v97
    v_mfma_f32_16x16x32_bf16 a[100:103], v[80:83], v[132:135], a[100:103]
    ds_read_b64_tr_b16 v[92:93], v19 offset:8192
    v_cvt_pk_bf16_f32 v97, v98, v99
    v_cvt_pk_bf16_f32 v98, v100, v101
    v_cvt_pk_bf16_f32 v99, v102, v103
    v_accvgpr_write_b32 a200, v96
    v_accvgpr_write_b32 a201, v97
    v_accvgpr_write_b32 a202, v98
    v_mfma_f32_16x16x32_bf16 a[100:103], v[84:87], v[148:151], a[100:103]
    ds_read_b64_tr_b16 v[94:95], v19 offset:12288
    v_accvgpr_write_b32 a203, v99
    v_accvgpr_read_b32 v104, a68
    v_accvgpr_read_b32 v105, a69
    v_accvgpr_read_b32 v106, a70
    v_accvgpr_read_b32 v107, a71
    v_accvgpr_read_b32 v108, a84
    v_mfma_f32_16x16x32_bf16 a[104:107], v[80:83], v[136:139], a[104:107]
    v_accvgpr_read_b32 v109, a85
    v_accvgpr_read_b32 v110, a86
    v_accvgpr_read_b32 v111, a87
    v_mul_f32 v104, v104, v246
    v_mul_f32 v105, v105, v246
    v_mul_f32 v106, v106, v246
    v_mfma_f32_16x16x32_bf16 a[104:107], v[84:87], v[152:155], a[104:107]
    v_mul_f32 v107, v107, v246
    v_mul_f32 v108, v108, v246
    v_mul_f32 v109, v109, v246
    v_mul_f32 v110, v110, v246
    v_mul_f32 v111, v111, v246
    v_cvt_pk_bf16_f32 v104, v104, v105
    v_mfma_f32_16x16x32_bf16 a[108:111], v[80:83], v[140:143], a[108:111]
    v_cvt_pk_bf16_f32 v105, v106, v107
    v_cvt_pk_bf16_f32 v106, v108, v109
    v_cvt_pk_bf16_f32 v107, v110, v111
    v_accvgpr_write_b32 a216, v104
    v_accvgpr_write_b32 a217, v105
    v_accvgpr_write_b32 a218, v106
    v_mfma_f32_16x16x32_bf16 a[108:111], v[84:87], v[156:159], a[108:111]
    s_waitcnt lgkmcnt(0)
    v_accvgpr_write_b32 a219, v107
    v_accvgpr_read_b32 v112, a72
    v_accvgpr_read_b32 v113, a73
    v_accvgpr_read_b32 v114, a74
    v_accvgpr_read_b32 v115, a75
    v_accvgpr_read_b32 v116, a88
    v_mfma_f32_16x16x32_bf16 a[112:115], v[88:91], v[128:131], a[112:115]
    v_accvgpr_read_b32 v117, a89
    v_accvgpr_read_b32 v118, a90
    v_accvgpr_read_b32 v119, a91
    v_mul_f32 v112, v112, v248
    v_mul_f32 v113, v113, v248
    v_mul_f32 v114, v114, v248
    v_mfma_f32_16x16x32_bf16 a[112:115], v[92:95], v[144:147], a[112:115]
    v_mul_f32 v115, v115, v248
    v_mul_f32 v116, v116, v248
    v_mul_f32 v117, v117, v248
    v_mul_f32 v118, v118, v248
    v_mul_f32 v119, v119, v248
    v_cvt_pk_bf16_f32 v112, v112, v113
    v_mfma_f32_16x16x32_bf16 a[116:119], v[88:91], v[132:135], a[116:119]
    v_cvt_pk_bf16_f32 v113, v114, v115
    v_cvt_pk_bf16_f32 v114, v116, v117
    v_cvt_pk_bf16_f32 v115, v118, v119
    v_accvgpr_write_b32 a232, v112
    v_accvgpr_write_b32 a233, v113
    v_accvgpr_write_b32 a234, v114
    v_mfma_f32_16x16x32_bf16 a[116:119], v[92:95], v[148:151], a[116:119]
    v_accvgpr_write_b32 a235, v115
    v_accvgpr_read_b32 v120, a76
    v_accvgpr_read_b32 v121, a77
    v_accvgpr_read_b32 v122, a78
    v_accvgpr_read_b32 v123, a79
    v_accvgpr_read_b32 v124, a92
    v_mfma_f32_16x16x32_bf16 a[120:123], v[88:91], v[136:139], a[120:123]
    v_accvgpr_read_b32 v125, a93
    v_accvgpr_read_b32 v126, a94
    v_accvgpr_read_b32 v127, a95
    v_mul_f32 v120, v120, v250
    v_mul_f32 v121, v121, v250
    v_mul_f32 v122, v122, v250
    v_mfma_f32_16x16x32_bf16 a[120:123], v[92:95], v[152:155], a[120:123]
    v_mul_f32 v123, v123, v250
    v_mul_f32 v124, v124, v250
    v_mul_f32 v125, v125, v250
    v_mul_f32 v126, v126, v250
    v_mul_f32 v127, v127, v250
    v_cvt_pk_bf16_f32 v120, v120, v121
    v_mfma_f32_16x16x32_bf16 a[124:127], v[88:91], v[140:143], a[124:127]
    v_cvt_pk_bf16_f32 v121, v122, v123
    v_cvt_pk_bf16_f32 v122, v124, v125
    v_cvt_pk_bf16_f32 v123, v126, v127
    v_accvgpr_write_b32 a248, v120
    v_accvgpr_write_b32 a249, v121
    v_accvgpr_write_b32 a250, v122
    v_mfma_f32_16x16x32_bf16 a[124:127], v[92:95], v[156:159], a[124:127]
    v_accvgpr_write_b32 a251, v123
L_c1:

    s_waitcnt lgkmcnt(8)
    v_mfma_f32_16x16x32_bf16 v[48:51], v[64:67], v[160:163], 0
    v_accvgpr_read_b32 v96, a96
    v_accvgpr_read_b32 v97, a97
    v_accvgpr_read_b32 v98, a98
    v_accvgpr_read_b32 v99, a99
    v_accvgpr_read_b32 v100, a112
    v_mfma_f32_16x16x32_bf16 v[48:51], v[68:71], v[164:167], v[48:51]
    v_accvgpr_read_b32 v101, a113
    v_accvgpr_read_b32 v102, a114
    v_accvgpr_read_b32 v103, a115
    v_mul_f32 v96, v96, v244
    v_mul_f32 v97, v97, v244
    v_mfma_f32_16x16x32_bf16 v[48:51], v[72:75], v[168:171], v[48:51]
L_hop8:
    s_cbranch_execz L_hop12
    v_mul_f32 v98, v98, v244
    v_mul_f32 v99, v99, v244
    v_mul_f32 v100, v100, v244
    v_mul_f32 v101, v101, v244
    v_mul_f32 v102, v102, v244
    v_mfma_f32_16x16x32_bf16 v[48:51], v[76:79], v[172:175], v[48:51]
    v_mul_f32 v103, v103, v244
    v_cvt_pk_bf16_f32 v96, v96, v97
    v_cvt_pk_bf16_f32 v97, v98, v99
    v_cvt_pk_bf16_f32 v98, v100, v101
    v_cvt_pk_bf16_f32 v99, v102, v103
    v_mfma_f32_16x16x32_bf16 v[52:55], v[64:67], v[176:179], 0
    buffer_store_dwordx4 v[96:99], v26, s[24:27], s84 offen offset:3072 sc1
    v_accvgpr_read_b32 v104, a100
    v_accvgpr_read_b32 v105, a101
    v_accvgpr_read_b32 v106, a102
    v_accvgpr_read_b32 v107, a103
    v_mfma_f32_16x16x32_bf16 v[52:55], v[68:71], v[180:183], v[52:55]
    v_accvgpr_read_b32 v108, a116
    v_accvgpr_read_b32 v109, a117
    v_accvgpr_read_b32 v110, a118
    v_accvgpr_read_b32 v111, a119
    v_mul_f32 v104, v104, v246
    v_mfma_f32_16x16x32_bf16 v[52:55], v[72:75], v[184:187], v[52:55]
    v_mul_f32 v105, v105, v246
    v_mul_f32 v106, v106, v246
    v_mul_f32 v107, v107, v246
    v_mul_f32 v108, v108, v246
    v_mul_f32 v109, v109, v246
    v_mfma_f32_16x16x32_bf16 v[52:55], v[76:79], v[188:191], v[52:55]
    v_mul_f32 v110, v110, v246
    v_mul_f32 v111, v111, v246
    v_cvt_pk_bf16_f32 v104, v104, v105
    v_cvt_pk_bf16_f32 v105, v106, v107
    v_cvt_pk_bf16_f32 v106, v108, v109
    v_mfma_f32_16x16x32_bf16 v[56:59], v[64:67], v[192:195], 0
    v_cvt_pk_bf16_f32 v107, v110, v111
    buffer_store_dwordx4 v[104:107], v26, s[24:27], s85 offen offset:3072 sc1
    v_accvgpr_read_b32 v112, a104
    v_accvgpr_read_b32 v113, a105
    v_accvgpr_read_b32 v114, a106
    v_mfma_f32_16x16x32_bf16 v[56:59], v[68:71], v[196:199], v[56:59]
    v_accvgpr_read_b32 v115, a107
    v_accvgpr_read_b32 v116, a120
    v_accvgpr_read_b32 v117, a121
    v_accvgpr_read_b32 v118, a122
    v_accvgpr_read_b32 v119, a123
    v_mfma_f32_16x16x32_bf16 v[56:59], v[72:75], v[200:203], v[56:59]
    v_mul_f32 v112, v112, v248
    v_mul_f32 v113, v113, v248
    v_mul_f32 v114, v114, v248
    v_mul_f32 v115, v115, v248
    v_mul_f32 v116, v116, v248
    v_mfma_f32_16x16x32_bf16 v[56:59], v[76:79], v[204:207], v[56:59]
    v_mul_f32 v117, v117, v248
    v_mul_f32 v118, v118, v248
    v_mul_f32 v119, v119, v248
    v_cvt_pk_bf16_f32 v112, v112, v113
    v_cvt_pk_bf16_f32 v113, v114, v115
    v_mfma_f32_16x16x32_bf16 v[60:63], v[64:67], v[208:211], 0
    v_cvt_pk_bf16_f32 v114, v116, v117
    v_cvt_pk_bf16_f32 v115, v118, v119
    buffer_store_dwordx4 v[112:115], v26, s[24:27], s86 offen offset:3072 sc1
    v_accvgpr_read_b32 v120, a108
    v_accvgpr_read_b32 v121, a109
    v_mfma_f32_16x16x32_bf16 v[60:63], v[68:71], v[212:215], v[60:63]
    v_accvgpr_read_b32 v122, a110
    v_accvgpr_read_b32 v123, a111
    v_accvgpr_read_b32 v124, a124
    v_accvgpr_read_b32 v125, a125
    v_accvgpr_read_b32 v126, a126
    v_mfma_f32_16x16x32_bf16 v[60:63], v[72:75], v[216:219], v[60:63]
    v_accvgpr_read_b32 v127, a127
    v_mul_f32 v120, v120, v250
    v_mul_f32 v121, v121, v250
    v_mul_f32 v122, v122, v250
    v_mul_f32 v123, v123, v250
    v_mfma_f32_16x16x32_bf16 v[60:63], v[76:79], v[220:223], v[60:63]
    v_mul_f32 v124, v124, v250
    v_mul_f32 v125, v125, v250
    v_mul_f32 v126, v126, v250
    v_mul_f32 v127, v127, v250
    v_cvt_pk_bf16_f32 v120, v120, v121
    v_cvt_pk_bf16_f32 v121, v122, v123
    v_cvt_pk_bf16_f32 v122, v124, v125
    v_cvt_pk_bf16_f32 v123, v126, v127
    buffer_store_dwordx4 v[120:123], v26, s[24:27], s87 offen offset:3072 sc1
    s_mov_b32 s70, 1
    s_mov_b32 s90, s26
    s_add_u32 s24, s24, 4096
    s_addc_u32 s25, s25, 0
    s_sub_u32 s26, s26, 4096
    s_cmp_eq_u32 s20, 0x80018
    s_cselect_b32 s95, 0, 6
    s_cmp_eq_u32 s20, s48
    s_cselect_b32 s74, 0x7fffffff, s22
    s_sub_u32 s74, s74, s95
    s_cmp_eq_u32 s21, 0x80018
    s_cselect_b32 s49, 0, 6
    s_cmp_eq_u32 s21, 0x80000
    s_cselect_b32 s78, 0x7fffffff, s22
    s_sub_u32 s78, s78, s49
    v_max3_f32 v128, v48, v49, v50
    v_max3_f32 v129, v52, v53, v54
    v_max3_f32 v130, v56, v57, v58
    v_max3_f32 v131, v60, v61, v62
    v_max_f32 v128, v128, v51
    v_max_f32 v129, v129, v55
    v_max_f32 v130, v130, v59
    v_max_f32 v131, v131, v63
    v_mov_b32 v132, v128
    v_mov_b32 v133, v129
    v_mov_b32 v134, v130
    v_mov_b32 v135, v131
    v_permlane16_swap_b32 v128, v132
    v_permlane16_swap_b32 v129, v133
    v_permlane16_swap_b32 v130, v134
    v_permlane16_swap_b32 v131, v135
    v_max_f32 v128, v128, v132
    v_max_f32 v129, v129, v133
    v_max_f32 v130, v130, v134
    v_max_f32 v131, v131, v135
    v_mov_b32 v132, v128
    v_mov_b32 v133, v129
    v_mov_b32 v134, v130
    v_mov_b32 v135, v131
    v_permlane32_swap_b32 v128, v132
    v_permlane32_swap_b32 v129, v133
    v_permlane32_swap_b32 v130, v134
    v_permlane32_swap_b32 v131, v135
    v_max_f32 v128, v128, v132
    v_max_f32 v129, v129, v133
    v_max_f32 v130, v130, v134
    v_max_f32 v131, v131, v135
    v_sub_f32 v32, 0, v128
    v_sub_f32 v33, 0, v128
    v_sub_f32 v34, 0, v128
    v_sub_f32 v35, 0, v128
    v_sub_f32 v36, 0, v129
    v_sub_f32 v37, 0, v129
    v_sub_f32 v38, 0, v129
    v_sub_f32 v39, 0, v129
    v_sub_f32 v40, 0, v130
    v_sub_f32 v41, 0, v130
    v_sub_f32 v42, 0, v130
    v_sub_f32 v43, 0, v130
    v_sub_f32 v44, 0, v131
    v_sub_f32 v45, 0, v131
    v_sub_f32 v46, 0, v131
    v_sub_f32 v47, 0, v131
    s_branch L_iter0
L_slow:
    s_waitcnt lgkmcnt(0)
    s_waitcnt vmcnt(0)
L_dl_sk:
    s_cmp_eq_u32 s20, 0x80018
    s_cbranch_scc1 L_dx_sk
    s_mov_b32 m0, s32
    s_nop 0
    buffer_load_dwordx4 v20, s[16:19], s30 offen nt lds
    buffer_load_dwordx4 v21, s[16:19], s30 offen offset:1024 nt lds
    buffer_load_dwordx4 v22, s[16:19], s30 offen offset:2048 nt lds
    buffer_load_dwordx4 v23, s[16:19], s30 offen offset:3072 nt lds
    s_add_u32 s30, s30, s79
    s_add_u32 s32, s32, 16384
    s_cmp_ge_u32 s32, 81920
    s_cselect_b32 s66, 81920, 0
    s_sub_u32 s32, s32, s66
    s_add_u32 s23, s23, 2
    s_lshl_b32 s92, s92, 8
    s_or_b32 s92, s92, s23
    s_add_u32 s20, s20, 8
    s_branch L_dl_sk
L_dx_sk:
L_dl_sv:
    s_cmp_eq_u32 s21, 0x80018
    s_cbranch_scc1 L_dx_sv
    s_mov_b32 m0, s33
    s_nop 0
    buffer_load_dwordx4 v24, s[12:15], s31 offen nt lds
    buffer_load_dwordx4 v25, s[12:15], s31 offen offset:1024 nt lds
    buffer_load_dwordx4 v24, s[12:15], s31 offen offset:2048 nt lds
    buffer_load_dwordx4 v25, s[12:15], s31 offen offset:3072 nt lds
    s_add_u32 s31, s31, 16384
    s_add_u32 s33, s33, 16384
    s_cmp_ge_u32 s33, 163840
    s_cselect_b32 s66, 81920, 0
    s_sub_u32 s33, s33, s66
    s_add_u32 s23, s23, 2
    s_lshl_b32 s93, s93, 8
    s_or_b32 s93, s93, s23
    s_add_u32 s21, s21, 8
    s_branch L_dl_sv
L_dx_sv:
    s_add_u32 s23, s23, 4
    s_add_u32 s23, s23, 2
    s_lshl_b32 s92, s92, 8
    s_or_b32 s92, s92, s23
    s_cmp_lg_u32 s70, 0
    s_cbranch_scc1 L_slow_nod
    s_mov_b32 m0, s32
    s_nop 0
    buffer_load_dwordx4 v20, s[16:19], s30 offen nt lds
    buffer_load_dwordx4 v21, s[16:19], s30 offen offset:1024 nt lds
    buffer_load_dwordx4 v22, s[16:19], s30 offen offset:2048 nt lds
    buffer_load_dwordx4 v23, s[16:19], s30 offen offset:3072 nt lds
    s_add_u32 s30, s30, s79
    s_add_u32 s32, s32, 16384
    s_cmp_ge_u32 s32, 81920
    s_cselect_b32 s66, 81920, 0
    s_sub_u32 s32, s32, s66
L_slow_nod:
    v_and_b32 v1, 63, v0
    v_and_b32 v3, 15, v0
    v_lshrrev_b32 v4, 4, v1
    v_lshlrev_b32 v252, 8, v3
    v_lshl_add_u32 v252, v4, 4, v252
    v_lshlrev_b32 v253, 10, v4
    v_lshl_add_u32 v253, v3, 1, v253
    v_mov_b32 v32, 0xff800000
    v_mov_b32 v36, 0
    v_mov_b32 v33, 0xff800000
    v_mov_b32 v37, 0
    v_mov_b32 v34, 0xff800000
    v_mov_b32 v38, 0
    v_mov_b32 v35, 0xff800000
    v_mov_b32 v39, 0
    v_accvgpr_write_b32 a0, 0
    v_accvgpr_write_b32 a1, 0
    v_accvgpr_write_b32 a2, 0
    v_accvgpr_write_b32 a3, 0
    v_accvgpr_write_b32 a4, 0
    v_accvgpr_write_b32 a5, 0
    v_accvgpr_write_b32 a6, 0
    v_accvgpr_write_b32 a7, 0
    v_accvgpr_write_b32 a8, 0
    v_accvgpr_write_b32 a9, 0
    v_accvgpr_write_b32 a10, 0
    v_accvgpr_write_b32 a11, 0
    v_accvgpr_write_b32 a12, 0
    v_accvgpr_write_b32 a13, 0
    v_accvgpr_write_b32 a14, 0
    v_accvgpr_write_b32 a15, 0
    v_accvgpr_write_b32 a16, 0
    v_accvgpr_write_b32 a17, 0
    v_accvgpr_write_b32 a18, 0
    v_accvgpr_write_b32 a19, 0
    v_accvgpr_write_b32 a20, 0
    v_accvgpr_write_b32 a21, 0
    v_accvgpr_write_b32 a22, 0
    v_accvgpr_write_b32 a23, 0
    v_accvgpr_write_b32 a24, 0
    v_accvgpr_write_b32 a25, 0
    v_accvgpr_write_b32 a26, 0
    v_accvgpr_write_b32 a27, 0
    v_accvgpr_write_b32 a28, 0
    v_accvgpr_write_b32 a29, 0
    v_accvgpr_write_b32 a30, 0
    v_accvgpr_write_b32 a31, 0
    v_accvgpr_write_b32 a32, 0
    v_accvgpr_write_b32 a33, 0
    v_accvgpr_write_b32 a34, 0
    v_accvgpr_write_b32 a35, 0
    v_accvgpr_write_b32 a36, 0
    v_accvgpr_write_b32 a37, 0
    v_accvgpr_write_b32 a38, 0
    v_accvgpr_write_b32 a39, 0
    v_accvgpr_write_b32 a40, 0
    v_accvgpr_write_b32 a41, 0
    v_accvgpr_write_b32 a42, 0
    v_accvgpr_write_b32 a43, 0
    v_accvgpr_write_b32 a44, 0
    v_accvgpr_write_b32 a45, 0
    v_accvgpr_write_b32 a46, 0
    v_accvgpr_write_b32 a47, 0
    v_accvgpr_write_b32 a48, 0
    v_accvgpr_write_b32 a49, 0
    v_accvgpr_write_b32 a50, 0
    v_accvgpr_write_b32 a51, 0
    v_accvgpr_write_b32 a52, 0
    v_accvgpr_write_b32 a53, 0
    v_accvgpr_write_b32 a54, 0
    v_accvgpr_write_b32 a55, 0
    v_accvgpr_write_b32 a56, 0
    v_accvgpr_write_b32 a57, 0
    v_accvgpr_write_b32 a58, 0
    v_accvgpr_write_b32 a59, 0
    v_accvgpr_write_b32 a60, 0
    v_accvgpr_write_b32 a61, 0
    v_accvgpr_write_b32 a62, 0
    v_accvgpr_write_b32 a63, 0
    v_accvgpr_write_b32 a64, 0
    v_accvgpr_write_b32 a65, 0
    v_accvgpr_write_b32 a66, 0
    v_accvgpr_write_b32 a67, 0
    v_accvgpr_write_b32 a68, 0
    v_accvgpr_write_b32 a69, 0
    v_accvgpr_write_b32 a70, 0
    v_accvgpr_write_b32 a71, 0
    v_accvgpr_write_b32 a72, 0
    v_accvgpr_write_b32 a73, 0
    v_accvgpr_write_b32 a74, 0
    v_accvgpr_write_b32 a75, 0
    v_accvgpr_write_b32 a76, 0
    v_accvgpr_write_b32 a77, 0
    v_accvgpr_write_b32 a78, 0
    v_accvgpr_write_b32 a79, 0
    v_accvgpr_write_b32 a80, 0
    v_accvgpr_write_b32 a81, 0
    v_accvgpr_write_b32 a82, 0
    v_accvgpr_write_b32 a83, 0
    v_accvgpr_write_b32 a84, 0
    v_accvgpr_write_b32 a85, 0
    v_accvgpr_write_b32 a86, 0
    v_accvgpr_write_b32 a87, 0
    v_accvgpr_write_b32 a88, 0
    v_accvgpr_write_b32 a89, 0
    v_accvgpr_write_b32 a90, 0
    v_accvgpr_write_b32 a91, 0
    v_accvgpr_write_b32 a92, 0
    v_accvgpr_write_b32 a93, 0
    v_accvgpr_write_b32 a94, 0
    v_accvgpr_write_b32 a95, 0
    v_accvgpr_write_b32 a96, 0
    v_accvgpr_write_b32 a97, 0
    v_accvgpr_write_b32 a98, 0
    v_accvgpr_write_b32 a99, 0
    v_accvgpr_write_b32 a100, 0
    v_accvgpr_write_b32 a101, 0
    v_accvgpr_write_b32 a102, 0
    v_accvgpr_write_b32 a103, 0
    v_accvgpr_write_b32 a104, 0
    v_accvgpr_write_b32 a105, 0
    v_accvgpr_write_b32 a106, 0
    v_accvgpr_write_b32 a107, 0
    v_accvgpr_write_b32 a108, 0
    v_accvgpr_write_b32 a109, 0
    v_accvgpr_write_b32 a110, 0
    v_accvgpr_write_b32 a111, 0
    v_accvgpr_write_b32 a112, 0
    v_accvgpr_write_b32 a113, 0
    v_accvgpr_write_b32 a114, 0
    v_accvgpr_write_b32 a115, 0
    v_accvgpr_write_b32 a116, 0
    v_accvgpr_write_b32 a117, 0
    v_accvgpr_write_b32 a118, 0
    v_accvgpr_write_b32 a119, 0
    v_accvgpr_write_b32 a120, 0
    v_accvgpr_write_b32 a121, 0
    v_accvgpr_write_b32 a122, 0
    v_accvgpr_write_b32 a123, 0
    v_accvgpr_write_b32 a124, 0
    v_accvgpr_write_b32 a125, 0
    v_accvgpr_write_b32 a126, 0
    v_accvgpr_write_b32 a127, 0
    s_lshl_b32 s66, s70, 18
    s_add_u32 s67, s66, 4096
    s_mov_b32 s69, 31
L_slow_loop:
    buffer_load_dwordx4 v[96:99], v252, s[8:11], s66 offen
    buffer_load_dwordx4 v[100:103], v252, s[8:11], s66 offen offset:64
    buffer_load_dwordx4 v[104:107], v252, s[8:11], s66 offen offset:128
    buffer_load_dwordx4 v[108:111], v252, s[8:11], s66 offen offset:192
    buffer_load_dwordx4 v[112:115], v252, s[8:11], s67 offen
    buffer_load_dwordx4 v[116:119], v252, s[8:11], s67 offen offset:64
    buffer_load_dwordx4 v[120:123], v252, s[8:11], s67 offen offset:128
    buffer_load_dwordx4 v[124:127], v252, s[8:11], s67 offen offset:192
    s_waitcnt vmcnt(0)
    v_mfma_f32_16x16x32_bf16 v[128:131], v[96:99], v[160:163], 0
    v_mfma_f32_16x16x32_bf16 v[128:131], v[100:103], v[164:167], v[128:131]
    v_mfma_f32_16x16x32_bf16 v[128:131], v[104:107], v[168:171], v[128:131]
    v_mfma_f32_16x16x32_bf16 v[128:131], v[108:111], v[172:175], v[128:131]
    v_mfma_f32_16x16x32_bf16 v[136:139], v[96:99], v[176:179], 0
    v_mfma_f32_16x16x32_bf16 v[136:139], v[100:103], v[180:183], v[136:139]
    v_mfma_f32_16x16x32_bf16 v[136:139], v[104:107], v[184:187], v[136:139]
    v_mfma_f32_16x16x32_bf16 v[136:139], v[108:111], v[188:191], v[136:139]
    v_mfma_f32_16x16x32_bf16 v[144:147], v[96:99], v[192:195], 0
    v_mfma_f32_16x16x32_bf16 v[144:147], v[100:103], v[196:199], v[144:147]
    v_mfma_f32_16x16x32_bf16 v[144:147], v[104:107], v[200:203], v[144:147]
    v_mfma_f32_16x16x32_bf16 v[144:147], v[108:111], v[204:207], v[144:147]
    v_mfma_f32_16x16x32_bf16 v[152:155], v[96:99], v[208:211], 0
    v_mfma_f32_16x16x32_bf16 v[152:155], v[100:103], v[212:215], v[152:155]
    v_mfma_f32_16x16x32_bf16 v[152:155], v[104:107], v[216:219], v[152:155]
    v_mfma_f32_16x16x32_bf16 v[152:155], v[108:111], v[220:223], v[152:155]
    v_mfma_f32_16x16x32_bf16 v[132:135], v[112:115], v[160:163], 0
    v_mfma_f32_16x16x32_bf16 v[132:135], v[116:119], v[164:167], v[132:135]
    v_mfma_f32_16x16x32_bf16 v[132:135], v[120:123], v[168:171], v[132:135]
    v_mfma_f32_16x16x32_bf16 v[132:135], v[124:127], v[172:175], v[132:135]
    v_mfma_f32_16x16x32_bf16 v[140:143], v[112:115], v[176:179], 0
    v_mfma_f32_16x16x32_bf16 v[140:143], v[116:119], v[180:183], v[140:143]
    v_mfma_f32_16x16x32_bf16 v[140:143], v[120:123], v[184:187], v[140:143]
    v_mfma_f32_16x16x32_bf16 v[140:143], v[124:127], v[188:191], v[140:143]
    v_mfma_f32_16x16x32_bf16 v[148:151], v[112:115], v[192:195], 0
    v_mfma_f32_16x16x32_bf16 v[148:151], v[116:119], v[196:199], v[148:151]
    v_mfma_f32_16x16x32_bf16 v[148:151], v[120:123], v[200:203], v[148:151]
    v_mfma_f32_16x16x32_bf16 v[148:151], v[124:127], v[204:207], v[148:151]
    v_mfma_f32_16x16x32_bf16 v[156:159], v[112:115], v[208:211], 0
    v_mfma_f32_16x16x32_bf16 v[156:159], v[116:119], v[212:215], v[156:159]
    v_mfma_f32_16x16x32_bf16 v[156:159], v[120:123], v[216:219], v[156:159]
    v_mfma_f32_16x16x32_bf16 v[156:159], v[124:127], v[220:223], v[156:159]
    v_max3_f32 v44, v128, v129, v130
    v_max3_f32 v44, v44, v131, v132
    v_max3_f32 v44, v44, v133, v134
    v_max3_f32 v44, v44, v135, v32
    v_mov_b32 v45, v44
    s_nop 1
    v_permlane16_swap_b32 v44, v45
    v_max_f32 v44, v44, v45
    v_mov_b32 v45, v44
    s_nop 1
    v_permlane32_swap_b32 v44, v45
    v_max_f32 v44, v44, v45
    v_sub_f32 v40, v32, v44
    v_exp_f32 v40, v40
    v_mov_b32 v32, v44
    v_mul_f32 v36, v36, v40
    v_sub_f32 v128, v128, v44
    v_exp_f32 v128, v128
    v_sub_f32 v129, v129, v44
    v_exp_f32 v129, v129
    v_sub_f32 v130, v130, v44
    v_exp_f32 v130, v130
    v_sub_f32 v131, v131, v44
    v_exp_f32 v131, v131
    v_sub_f32 v132, v132, v44
    v_exp_f32 v132, v132
    v_sub_f32 v133, v133, v44
    v_exp_f32 v133, v133
    v_sub_f32 v134, v134, v44
    v_exp_f32 v134, v134
    v_sub_f32 v135, v135, v44
    v_exp_f32 v135, v135
    v_add_f32 v36, v36, v128
    v_add_f32 v36, v36, v129
    v_add_f32 v36, v36, v130
    v_add_f32 v36, v36, v131
    v_add_f32 v36, v36, v132
    v_add_f32 v36, v36, v133
    v_add_f32 v36, v36, v134
    v_add_f32 v36, v36, v135
    v_cvt_pk_bf16_f32 v48, v128, v129
    v_cvt_pk_bf16_f32 v49, v130, v131
    v_cvt_pk_bf16_f32 v50, v132, v133
    v_cvt_pk_bf16_f32 v51, v134, v135
    v_max3_f32 v44, v136, v137, v138
    v_max3_f32 v44, v44, v139, v140
    v_max3_f32 v44, v44, v141, v142
    v_max3_f32 v44, v44, v143, v33
    v_mov_b32 v45, v44
    s_nop 1
    v_permlane16_swap_b32 v44, v45
    v_max_f32 v44, v44, v45
    v_mov_b32 v45, v44
    s_nop 1
    v_permlane32_swap_b32 v44, v45
    v_max_f32 v44, v44, v45
    v_sub_f32 v41, v33, v44
    v_exp_f32 v41, v41
    v_mov_b32 v33, v44
    v_mul_f32 v37, v37, v41
    v_sub_f32 v136, v136, v44
    v_exp_f32 v136, v136
    v_sub_f32 v137, v137, v44
    v_exp_f32 v137, v137
    v_sub_f32 v138, v138, v44
    v_exp_f32 v138, v138
    v_sub_f32 v139, v139, v44
    v_exp_f32 v139, v139
    v_sub_f32 v140, v140, v44
    v_exp_f32 v140, v140
    v_sub_f32 v141, v141, v44
    v_exp_f32 v141, v141
    v_sub_f32 v142, v142, v44
    v_exp_f32 v142, v142
    v_sub_f32 v143, v143, v44
    v_exp_f32 v143, v143
    v_add_f32 v37, v37, v136
    v_add_f32 v37, v37, v137
    v_add_f32 v37, v37, v138
    v_add_f32 v37, v37, v139
    v_add_f32 v37, v37, v140
    v_add_f32 v37, v37, v141
    v_add_f32 v37, v37, v142
    v_add_f32 v37, v37, v143
    v_cvt_pk_bf16_f32 v52, v136, v137
    v_cvt_pk_bf16_f32 v53, v138, v139
    v_cvt_pk_bf16_f32 v54, v140, v141
    v_cvt_pk_bf16_f32 v55, v142, v143
    v_max3_f32 v44, v144, v145, v146
    v_max3_f32 v44, v44, v147, v148
    v_max3_f32 v44, v44, v149, v150
    v_max3_f32 v44, v44, v151, v34
    v_mov_b32 v45, v44
    s_nop 1
    v_permlane16_swap_b32 v44, v45
    v_max_f32 v44, v44, v45
    v_mov_b32 v45, v44
    s_nop 1
    v_permlane32_swap_b32 v44, v45
    v_max_f32 v44, v44, v45
    v_sub_f32 v42, v34, v44
    v_exp_f32 v42, v42
    v_mov_b32 v34, v44
    v_mul_f32 v38, v38, v42
    v_sub_f32 v144, v144, v44
    v_exp_f32 v144, v144
    v_sub_f32 v145, v145, v44
    v_exp_f32 v145, v145
    v_sub_f32 v146, v146, v44
    v_exp_f32 v146, v146
    v_sub_f32 v147, v147, v44
    v_exp_f32 v147, v147
    v_sub_f32 v148, v148, v44
    v_exp_f32 v148, v148
    v_sub_f32 v149, v149, v44
    v_exp_f32 v149, v149
    v_sub_f32 v150, v150, v44
    v_exp_f32 v150, v150
    v_sub_f32 v151, v151, v44
    v_exp_f32 v151, v151
    v_add_f32 v38, v38, v144
    v_add_f32 v38, v38, v145
    v_add_f32 v38, v38, v146
    v_add_f32 v38, v38, v147
    v_add_f32 v38, v38, v148
    v_add_f32 v38, v38, v149
    v_add_f32 v38, v38, v150
    v_add_f32 v38, v38, v151
    v_cvt_pk_bf16_f32 v56, v144, v145
    v_cvt_pk_bf16_f32 v57, v146, v147
    v_cvt_pk_bf16_f32 v58, v148, v149
    v_cvt_pk_bf16_f32 v59, v150, v151
    v_max3_f32 v44, v152, v153, v154
    v_max3_f32 v44, v44, v155, v156
    v_max3_f32 v44, v44, v157, v158
    v_max3_f32 v44, v44, v159, v35
    v_mov_b32 v45, v44
    s_nop 1
    v_permlane16_swap_b32 v44, v45
    v_max_f32 v44, v44, v45
    v_mov_b32 v45, v44
    s_nop 1
    v_permlane32_swap_b32 v44, v45
    v_max_f32 v44, v44, v45
    v_sub_f32 v43, v35, v44
    v_exp_f32 v43, v43
    v_mov_b32 v35, v44
    v_mul_f32 v39, v39, v43
    v_sub_f32 v152, v152, v44
    v_exp_f32 v152, v152
    v_sub_f32 v153, v153, v44
    v_exp_f32 v153, v153
    v_sub_f32 v154, v154, v44
    v_exp_f32 v154, v154
    v_sub_f32 v155, v155, v44
    v_exp_f32 v155, v155
    v_sub_f32 v156, v156, v44
    v_exp_f32 v156, v156
    v_sub_f32 v157, v157, v44
    v_exp_f32 v157, v157
    v_sub_f32 v158, v158, v44
    v_exp_f32 v158, v158
    v_sub_f32 v159, v159, v44
    v_exp_f32 v159, v159
    v_add_f32 v39, v39, v152
    v_add_f32 v39, v39, v153
    v_add_f32 v39, v39, v154
    v_add_f32 v39, v39, v155
    v_add_f32 v39, v39, v156
    v_add_f32 v39, v39, v157
    v_add_f32 v39, v39, v158
    v_add_f32 v39, v39, v159
    v_cvt_pk_bf16_f32 v60, v152, v153
    v_cvt_pk_bf16_f32 v61, v154, v155
    v_cvt_pk_bf16_f32 v62, v156, v157
    v_cvt_pk_bf16_f32 v63, v158, v159
    buffer_load_ushort v96, v253, s[12:15], s66 offen
    buffer_load_ushort v97, v253, s[12:15], s66 offen offset:256
    buffer_load_ushort v98, v253, s[12:15], s66 offen offset:512
    buffer_load_ushort v99, v253, s[12:15], s66 offen offset:768
    buffer_load_ushort v100, v253, s[12:15], s67 offen
    buffer_load_ushort v101, v253, s[12:15], s67 offen offset:256
    buffer_load_ushort v102, v253, s[12:15], s67 offen offset:512
    buffer_load_ushort v103, v253, s[12:15], s67 offen offset:768
    buffer_load_ushort v104, v253, s[12:15], s66 offen offset:32
    buffer_load_ushort v105, v253, s[12:15], s66 offen offset:288
    buffer_load_ushort v106, v253, s[12:15], s66 offen offset:544
    buffer_load_ushort v107, v253, s[12:15], s66 offen offset:800
    buffer_load_ushort v108, v253, s[12:15], s67 offen offset:32
    buffer_load_ushort v109, v253, s[12:15], s67 offen offset:288
    buffer_load_ushort v110, v253, s[12:15], s67 offen offset:544
    buffer_load_ushort v111, v253, s[12:15], s67 offen offset:800
    buffer_load_ushort v112, v253, s[12:15], s66 offen offset:64
    buffer_load_ushort v113, v253, s[12:15], s66 offen offset:320
    buffer_load_ushort v114, v253, s[12:15], s66 offen offset:576
    buffer_load_ushort v115, v253, s[12:15], s66 offen offset:832
    buffer_load_ushort v116, v253, s[12:15], s67 offen offset:64
    buffer_load_ushort v117, v253, s[12:15], s67 offen offset:320
    buffer_load_ushort v118, v253, s[12:15], s67 offen offset:576
    buffer_load_ushort v119, v253, s[12:15], s67 offen offset:832
    buffer_load_ushort v120, v253, s[12:15], s66 offen offset:96
    buffer_load_ushort v121, v253, s[12:15], s66 offen offset:352
    buffer_load_ushort v122, v253, s[12:15], s66 offen offset:608
    buffer_load_ushort v123, v253, s[12:15], s66 offen offset:864
    buffer_load_ushort v124, v253, s[12:15], s67 offen offset:96
    buffer_load_ushort v125, v253, s[12:15], s67 offen offset:352
    buffer_load_ushort v126, v253, s[12:15], s67 offen offset:608
    buffer_load_ushort v127, v253, s[12:15], s67 offen offset:864
    v_accvgpr_read_b32 v44, a0
    v_accvgpr_read_b32 v45, a1
    v_accvgpr_read_b32 v46, a2
    v_accvgpr_read_b32 v47, a3
    v_mul_f32 v44, v44, v40
    v_mul_f32 v45, v45, v40
    v_mul_f32 v46, v46, v40
    v_mul_f32 v47, v47, v40
    v_accvgpr_write_b32 a0, v44
    v_accvgpr_write_b32 a1, v45
    v_accvgpr_write_b32 a2, v46
    v_accvgpr_write_b32 a3, v47
    v_accvgpr_read_b32 v44, a4
    v_accvgpr_read_b32 v45, a5
    v_accvgpr_read_b32 v46, a6
    v_accvgpr_read_b32 v47, a7
    v_mul_f32 v44, v44, v41
    v_mul_f32 v45, v45, v41
    v_mul_f32 v46, v46, v41
    v_mul_f32 v47, v47, v41
    v_accvgpr_write_b32 a4, v44
    v_accvgpr_write_b32 a5, v45
    v_accvgpr_write_b32 a6, v46
    v_accvgpr_write_b32 a7, v47
    v_accvgpr_read_b32 v44, a8
    v_accvgpr_read_b32 v45, a9
    v_accvgpr_read_b32 v46, a10
    v_accvgpr_read_b32 v47, a11
    v_mul_f32 v44, v44, v42
    v_mul_f32 v45, v45, v42
    v_mul_f32 v46, v46, v42
    v_mul_f32 v47, v47, v42
    v_accvgpr_write_b32 a8, v44
    v_accvgpr_write_b32 a9, v45
    v_accvgpr_write_b32 a10, v46
    v_accvgpr_write_b32 a11, v47
    v_accvgpr_read_b32 v44, a12
    v_accvgpr_read_b32 v45, a13
    v_accvgpr_read_b32 v46, a14
    v_accvgpr_read_b32 v47, a15
    v_mul_f32 v44, v44, v43
    v_mul_f32 v45, v45, v43
    v_mul_f32 v46, v46, v43
    v_mul_f32 v47, v47, v43
    v_accvgpr_write_b32 a12, v44
    v_accvgpr_write_b32 a13, v45
    v_accvgpr_write_b32 a14, v46
    v_accvgpr_write_b32 a15, v47
    v_accvgpr_read_b32 v44, a16
    v_accvgpr_read_b32 v45, a17
    v_accvgpr_read_b32 v46, a18
    v_accvgpr_read_b32 v47, a19
    v_mul_f32 v44, v44, v40
    v_mul_f32 v45, v45, v40
    v_mul_f32 v46, v46, v40
    v_mul_f32 v47, v47, v40
    v_accvgpr_write_b32 a16, v44
    v_accvgpr_write_b32 a17, v45
    v_accvgpr_write_b32 a18, v46
    v_accvgpr_write_b32 a19, v47
    v_accvgpr_read_b32 v44, a20
    v_accvgpr_read_b32 v45, a21
    v_accvgpr_read_b32 v46, a22
    v_accvgpr_read_b32 v47, a23
    v_mul_f32 v44, v44, v41
    v_mul_f32 v45, v45, v41
    v_mul_f32 v46, v46, v41
    v_mul_f32 v47, v47, v41
    v_accvgpr_write_b32 a20, v44
    v_accvgpr_write_b32 a21, v45
    v_accvgpr_write_b32 a22, v46
    v_accvgpr_write_b32 a23, v47
    v_accvgpr_read_b32 v44, a24
    v_accvgpr_read_b32 v45, a25
    v_accvgpr_read_b32 v46, a26
    v_accvgpr_read_b32 v47, a27
    v_mul_f32 v44, v44, v42
    v_mul_f32 v45, v45, v42
    v_mul_f32 v46, v46, v42
    v_mul_f32 v47, v47, v42
    v_accvgpr_write_b32 a24, v44
    v_accvgpr_write_b32 a25, v45
    v_accvgpr_write_b32 a26, v46
    v_accvgpr_write_b32 a27, v47
    v_accvgpr_read_b32 v44, a28
    v_accvgpr_read_b32 v45, a29
    v_accvgpr_read_b32 v46, a30
    v_accvgpr_read_b32 v47, a31
    v_mul_f32 v44, v44, v43
    v_mul_f32 v45, v45, v43
    v_mul_f32 v46, v46, v43
    v_mul_f32 v47, v47, v43
    v_accvgpr_write_b32 a28, v44
    v_accvgpr_write_b32 a29, v45
    v_accvgpr_write_b32 a30, v46
    v_accvgpr_write_b32 a31, v47
    v_accvgpr_read_b32 v44, a32
    v_accvgpr_read_b32 v45, a33
    v_accvgpr_read_b32 v46, a34
    v_accvgpr_read_b32 v47, a35
    v_mul_f32 v44, v44, v40
    v_mul_f32 v45, v45, v40
    v_mul_f32 v46, v46, v40
    v_mul_f32 v47, v47, v40
    v_accvgpr_write_b32 a32, v44
    v_accvgpr_write_b32 a33, v45
    v_accvgpr_write_b32 a34, v46
    v_accvgpr_write_b32 a35, v47
    v_accvgpr_read_b32 v44, a36
    v_accvgpr_read_b32 v45, a37
    v_accvgpr_read_b32 v46, a38
    v_accvgpr_read_b32 v47, a39
    v_mul_f32 v44, v44, v41
    v_mul_f32 v45, v45, v41
    v_mul_f32 v46, v46, v41
    v_mul_f32 v47, v47, v41
    v_accvgpr_write_b32 a36, v44
    v_accvgpr_write_b32 a37, v45
    v_accvgpr_write_b32 a38, v46
    v_accvgpr_write_b32 a39, v47
    v_accvgpr_read_b32 v44, a40
    v_accvgpr_read_b32 v45, a41
    v_accvgpr_read_b32 v46, a42
    v_accvgpr_read_b32 v47, a43
    v_mul_f32 v44, v44, v42
    v_mul_f32 v45, v45, v42
    v_mul_f32 v46, v46, v42
    v_mul_f32 v47, v47, v42
    v_accvgpr_write_b32 a40, v44
    v_accvgpr_write_b32 a41, v45
    v_accvgpr_write_b32 a42, v46
    v_accvgpr_write_b32 a43, v47
    v_accvgpr_read_b32 v44, a44
    v_accvgpr_read_b32 v45, a45
    v_accvgpr_read_b32 v46, a46
    v_accvgpr_read_b32 v47, a47
    v_mul_f32 v44, v44, v43
    v_mul_f32 v45, v45, v43
    v_mul_f32 v46, v46, v43
    v_mul_f32 v47, v47, v43
    v_accvgpr_write_b32 a44, v44
    v_accvgpr_write_b32 a45, v45
    v_accvgpr_write_b32 a46, v46
    v_accvgpr_write_b32 a47, v47
    v_accvgpr_read_b32 v44, a48
    v_accvgpr_read_b32 v45, a49
    v_accvgpr_read_b32 v46, a50
    v_accvgpr_read_b32 v47, a51
    v_mul_f32 v44, v44, v40
    v_mul_f32 v45, v45, v40
    v_mul_f32 v46, v46, v40
    v_mul_f32 v47, v47, v40
    v_accvgpr_write_b32 a48, v44
    v_accvgpr_write_b32 a49, v45
    v_accvgpr_write_b32 a50, v46
    v_accvgpr_write_b32 a51, v47
    v_accvgpr_read_b32 v44, a52
    v_accvgpr_read_b32 v45, a53
    v_accvgpr_read_b32 v46, a54
    v_accvgpr_read_b32 v47, a55
    v_mul_f32 v44, v44, v41
    v_mul_f32 v45, v45, v41
    v_mul_f32 v46, v46, v41
    v_mul_f32 v47, v47, v41
    v_accvgpr_write_b32 a52, v44
    v_accvgpr_write_b32 a53, v45
    v_accvgpr_write_b32 a54, v46
    v_accvgpr_write_b32 a55, v47
    v_accvgpr_read_b32 v44, a56
    v_accvgpr_read_b32 v45, a57
    v_accvgpr_read_b32 v46, a58
    v_accvgpr_read_b32 v47, a59
    v_mul_f32 v44, v44, v42
    v_mul_f32 v45, v45, v42
    v_mul_f32 v46, v46, v42
    v_mul_f32 v47, v47, v42
    v_accvgpr_write_b32 a56, v44
    v_accvgpr_write_b32 a57, v45
    v_accvgpr_write_b32 a58, v46
    v_accvgpr_write_b32 a59, v47
    v_accvgpr_read_b32 v44, a60
    v_accvgpr_read_b32 v45, a61
    v_accvgpr_read_b32 v46, a62
    v_accvgpr_read_b32 v47, a63
    v_mul_f32 v44, v44, v43
    v_mul_f32 v45, v45, v43
    v_mul_f32 v46, v46, v43
    v_mul_f32 v47, v47, v43
    v_accvgpr_write_b32 a60, v44
    v_accvgpr_write_b32 a61, v45
    v_accvgpr_write_b32 a62, v46
    v_accvgpr_write_b32 a63, v47
    v_accvgpr_read_b32 v44, a64
    v_accvgpr_read_b32 v45, a65
    v_accvgpr_read_b32 v46, a66
    v_accvgpr_read_b32 v47, a67
    v_mul_f32 v44, v44, v40
    v_mul_f32 v45, v45, v40
    v_mul_f32 v46, v46, v40
    v_mul_f32 v47, v47, v40
    v_accvgpr_write_b32 a64, v44
    v_accvgpr_write_b32 a65, v45
    v_accvgpr_write_b32 a66, v46
    v_accvgpr_write_b32 a67, v47
    v_accvgpr_read_b32 v44, a68
    v_accvgpr_read_b32 v45, a69
    v_accvgpr_read_b32 v46, a70
    v_accvgpr_read_b32 v47, a71
    v_mul_f32 v44, v44, v41
    v_mul_f32 v45, v45, v41
    v_mul_f32 v46, v46, v41
    v_mul_f32 v47, v47, v41
    v_accvgpr_write_b32 a68, v44
    v_accvgpr_write_b32 a69, v45
    v_accvgpr_write_b32 a70, v46
    v_accvgpr_write_b32 a71, v47
    v_accvgpr_read_b32 v44, a72
    v_accvgpr_read_b32 v45, a73
    v_accvgpr_read_b32 v46, a74
    v_accvgpr_read_b32 v47, a75
    v_mul_f32 v44, v44, v42
    v_mul_f32 v45, v45, v42
    v_mul_f32 v46, v46, v42
    v_mul_f32 v47, v47, v42
    v_accvgpr_write_b32 a72, v44
    v_accvgpr_write_b32 a73, v45
    v_accvgpr_write_b32 a74, v46
    v_accvgpr_write_b32 a75, v47
    v_accvgpr_read_b32 v44, a76
    v_accvgpr_read_b32 v45, a77
    v_accvgpr_read_b32 v46, a78
    v_accvgpr_read_b32 v47, a79
    v_mul_f32 v44, v44, v43
    v_mul_f32 v45, v45, v43
    v_mul_f32 v46, v46, v43
    v_mul_f32 v47, v47, v43
    v_accvgpr_write_b32 a76, v44
    v_accvgpr_write_b32 a77, v45
    v_accvgpr_write_b32 a78, v46
    v_accvgpr_write_b32 a79, v47
    v_accvgpr_read_b32 v44, a80
    v_accvgpr_read_b32 v45, a81
    v_accvgpr_read_b32 v46, a82
    v_accvgpr_read_b32 v47, a83
    v_mul_f32 v44, v44, v40
    v_mul_f32 v45, v45, v40
    v_mul_f32 v46, v46, v40
    v_mul_f32 v47, v47, v40
    v_accvgpr_write_b32 a80, v44
    v_accvgpr_write_b32 a81, v45
    v_accvgpr_write_b32 a82, v46
    v_accvgpr_write_b32 a83, v47
    v_accvgpr_read_b32 v44, a84
    v_accvgpr_read_b32 v45, a85
    v_accvgpr_read_b32 v46, a86
    v_accvgpr_read_b32 v47, a87
    v_mul_f32 v44, v44, v41
    v_mul_f32 v45, v45, v41
    v_mul_f32 v46, v46, v41
    v_mul_f32 v47, v47, v41
    v_accvgpr_write_b32 a84, v44
    v_accvgpr_write_b32 a85, v45
    v_accvgpr_write_b32 a86, v46
    v_accvgpr_write_b32 a87, v47
    v_accvgpr_read_b32 v44, a88
    v_accvgpr_read_b32 v45, a89
    v_accvgpr_read_b32 v46, a90
    v_accvgpr_read_b32 v47, a91
    v_mul_f32 v44, v44, v42
    v_mul_f32 v45, v45, v42
    v_mul_f32 v46, v46, v42
    v_mul_f32 v47, v47, v42
    v_accvgpr_write_b32 a88, v44
    v_accvgpr_write_b32 a89, v45
    v_accvgpr_write_b32 a90, v46
    v_accvgpr_write_b32 a91, v47
    v_accvgpr_read_b32 v44, a92
    v_accvgpr_read_b32 v45, a93
    v_accvgpr_read_b32 v46, a94
    v_accvgpr_read_b32 v47, a95
    v_mul_f32 v44, v44, v43
    v_mul_f32 v45, v45, v43
    v_mul_f32 v46, v46, v43
    v_mul_f32 v47, v47, v43
    v_accvgpr_write_b32 a92, v44
    v_accvgpr_write_b32 a93, v45
    v_accvgpr_write_b32 a94, v46
    v_accvgpr_write_b32 a95, v47
    v_accvgpr_read_b32 v44, a96
    v_accvgpr_read_b32 v45, a97
    v_accvgpr_read_b32 v46, a98
    v_accvgpr_read_b32 v47, a99
    v_mul_f32 v44, v44, v40
    v_mul_f32 v45, v45, v40
    v_mul_f32 v46, v46, v40
    v_mul_f32 v47, v47, v40
    v_accvgpr_write_b32 a96, v44
    v_accvgpr_write_b32 a97, v45
    v_accvgpr_write_b32 a98, v46
    v_accvgpr_write_b32 a99, v47
    v_accvgpr_read_b32 v44, a100
    v_accvgpr_read_b32 v45, a101
    v_accvgpr_read_b32 v46, a102
    v_accvgpr_read_b32 v47, a103
    v_mul_f32 v44, v44, v41
    v_mul_f32 v45, v45, v41
    v_mul_f32 v46, v46, v41
    v_mul_f32 v47, v47, v41
    v_accvgpr_write_b32 a100, v44
    v_accvgpr_write_b32 a101, v45
    v_accvgpr_write_b32 a102, v46
    v_accvgpr_write_b32 a103, v47
    v_accvgpr_read_b32 v44, a104
    v_accvgpr_read_b32 v45, a105
    v_accvgpr_read_b32 v46, a106
    v_accvgpr_read_b32 v47, a107
    v_mul_f32 v44, v44, v42
    v_mul_f32 v45, v45, v42
    v_mul_f32 v46, v46, v42
    v_mul_f32 v47, v47, v42
    v_accvgpr_write_b32 a104, v44
    v_accvgpr_write_b32 a105, v45
    v_accvgpr_write_b32 a106, v46
    v_accvgpr_write_b32 a107, v47
    v_accvgpr_read_b32 v44, a108
    v_accvgpr_read_b32 v45, a109
    v_accvgpr_read_b32 v46, a110
    v_accvgpr_read_b32 v47, a111
    v_mul_f32 v44, v44, v43
    v_mul_f32 v45, v45, v43
    v_mul_f32 v46, v46, v43
    v_mul_f32 v47, v47, v43
    v_accvgpr_write_b32 a108, v44
    v_accvgpr_write_b32 a109, v45
    v_accvgpr_write_b32 a110, v46
    v_accvgpr_write_b32 a111, v47
    v_accvgpr_read_b32 v44, a112
    v_accvgpr_read_b32 v45, a113
    v_accvgpr_read_b32 v46, a114
    v_accvgpr_read_b32 v47, a115
    v_mul_f32 v44, v44, v40
    v_mul_f32 v45, v45, v40
    v_mul_f32 v46, v46, v40
    v_mul_f32 v47, v47, v40
    v_accvgpr_write_b32 a112, v44
    v_accvgpr_write_b32 a113, v45
    v_accvgpr_write_b32 a114, v46
    v_accvgpr_write_b32 a115, v47
    v_accvgpr_read_b32 v44, a116
    v_accvgpr_read_b32 v45, a117
    v_accvgpr_read_b32 v46, a118
    v_accvgpr_read_b32 v47, a119
    v_mul_f32 v44, v44, v41
    v_mul_f32 v45, v45, v41
    v_mul_f32 v46, v46, v41
    v_mul_f32 v47, v47, v41
    v_accvgpr_write_b32 a116, v44
    v_accvgpr_write_b32 a117, v45
    v_accvgpr_write_b32 a118, v46
    v_accvgpr_write_b32 a119, v47
    v_accvgpr_read_b32 v44, a120
    v_accvgpr_read_b32 v45, a121
    v_accvgpr_read_b32 v46, a122
    v_accvgpr_read_b32 v47, a123
    v_mul_f32 v44, v44, v42
    v_mul_f32 v45, v45, v42
    v_mul_f32 v46, v46, v42
    v_mul_f32 v47, v47, v42
    v_accvgpr_write_b32 a120, v44
    v_accvgpr_write_b32 a121, v45
    v_accvgpr_write_b32 a122, v46
    v_accvgpr_write_b32 a123, v47
    v_accvgpr_read_b32 v44, a124
    v_accvgpr_read_b32 v45, a125
    v_accvgpr_read_b32 v46, a126
    v_accvgpr_read_b32 v47, a127
    v_mul_f32 v44, v44, v43
    v_mul_f32 v45, v45, v43
    v_mul_f32 v46, v46, v43
    v_mul_f32 v47, v47, v43
    v_accvgpr_write_b32 a124, v44
    v_accvgpr_write_b32 a125, v45
    v_accvgpr_write_b32 a126, v46
    v_accvgpr_write_b32 a127, v47
    s_waitcnt vmcnt(0)
    v_lshl_or_b32 v80, v97, 16, v96
    v_lshl_or_b32 v81, v99, 16, v98
    v_lshl_or_b32 v82, v101, 16, v100
    v_lshl_or_b32 v83, v103, 16, v102
    v_lshl_or_b32 v84, v105, 16, v104
    v_lshl_or_b32 v85, v107, 16, v106
    v_lshl_or_b32 v86, v109, 16, v108
    v_lshl_or_b32 v87, v111, 16, v110
    v_lshl_or_b32 v88, v113, 16, v112
    v_lshl_or_b32 v89, v115, 16, v114
    v_lshl_or_b32 v90, v117, 16, v116
    v_lshl_or_b32 v91, v119, 16, v118
    v_lshl_or_b32 v92, v121, 16, v120
    v_lshl_or_b32 v93, v123, 16, v122
    v_lshl_or_b32 v94, v125, 16, v124
    v_lshl_or_b32 v95, v127, 16, v126
    v_mfma_f32_16x16x32_bf16 a[0:3], v[80:83], v[48:51], a[0:3]
    v_mfma_f32_16x16x32_bf16 a[4:7], v[80:83], v[52:55], a[4:7]
    v_mfma_f32_16x16x32_bf16 a[8:11], v[80:83], v[56:59], a[8:11]
    v_mfma_f32_16x16x32_bf16 a[12:15], v[80:83], v[60:63], a[12:15]
    v_mfma_f32_16x16x32_bf16 a[16:19], v[84:87], v[48:51], a[16:19]
    v_mfma_f32_16x16x32_bf16 a[20:23], v[84:87], v[52:55], a[20:23]
    v_mfma_f32_16x16x32_bf16 a[24:27], v[84:87], v[56:59], a[24:27]
    v_mfma_f32_16x16x32_bf16 a[28:31], v[84:87], v[60:63], a[28:31]
    v_mfma_f32_16x16x32_bf16 a[32:35], v[88:91], v[48:51], a[32:35]
    v_mfma_f32_16x16x32_bf16 a[36:39], v[88:91], v[52:55], a[36:39]
    v_mfma_f32_16x16x32_bf16 a[40:43], v[88:91], v[56:59], a[40:43]
    v_mfma_f32_16x16x32_bf16 a[44:47], v[88:91], v[60:63], a[44:47]
    v_mfma_f32_16x16x32_bf16 a[48:51], v[92:95], v[48:51], a[48:51]
    v_mfma_f32_16x16x32_bf16 a[52:55], v[92:95], v[52:55], a[52:55]
    v_mfma_f32_16x16x32_bf16 a[56:59], v[92:95], v[56:59], a[56:59]
    v_mfma_f32_16x16x32_bf16 a[60:63], v[92:95], v[60:63], a[60:63]
    buffer_load_ushort v96, v253, s[12:15], s66 offen offset:128
    buffer_load_ushort v97, v253, s[12:15], s66 offen offset:384
    buffer_load_ushort v98, v253, s[12:15], s66 offen offset:640
    buffer_load_ushort v99, v253, s[12:15], s66 offen offset:896
    buffer_load_ushort v100, v253, s[12:15], s67 offen offset:128
    buffer_load_ushort v101, v253, s[12:15], s67 offen offset:384
    buffer_load_ushort v102, v253, s[12:15], s67 offen offset:640
    buffer_load_ushort v103, v253, s[12:15], s67 offen offset:896
    buffer_load_ushort v104, v253, s[12:15], s66 offen offset:160
    buffer_load_ushort v105, v253, s[12:15], s66 offen offset:416
    buffer_load_ushort v106, v253, s[12:15], s66 offen offset:672
    buffer_load_ushort v107, v253, s[12:15], s66 offen offset:928
    buffer_load_ushort v108, v253, s[12:15], s67 offen offset:160
    buffer_load_ushort v109, v253, s[12:15], s67 offen offset:416
    buffer_load_ushort v110, v253, s[12:15], s67 offen offset:672
    buffer_load_ushort v111, v253, s[12:15], s67 offen offset:928
    buffer_load_ushort v112, v253, s[12:15], s66 offen offset:192
    buffer_load_ushort v113, v253, s[12:15], s66 offen offset:448
    buffer_load_ushort v114, v253, s[12:15], s66 offen offset:704
    buffer_load_ushort v115, v253, s[12:15], s66 offen offset:960
    buffer_load_ushort v116, v253, s[12:15], s67 offen offset:192
    buffer_load_ushort v117, v253, s[12:15], s67 offen offset:448
    buffer_load_ushort v118, v253, s[12:15], s67 offen offset:704
    buffer_load_ushort v119, v253, s[12:15], s67 offen offset:960
    buffer_load_ushort v120, v253, s[12:15], s66 offen offset:224
    buffer_load_ushort v121, v253, s[12:15], s66 offen offset:480
    buffer_load_ushort v122, v253, s[12:15], s66 offen offset:736
    buffer_load_ushort v123, v253, s[12:15], s66 offen offset:992
    buffer_load_ushort v124, v253, s[12:15], s67 offen offset:224
    buffer_load_ushort v125, v253, s[12:15], s67 offen offset:480
    buffer_load_ushort v126, v253, s[12:15], s67 offen offset:736
    buffer_load_ushort v127, v253, s[12:15], s67 offen offset:992
    s_waitcnt vmcnt(0)
    v_lshl_or_b32 v80, v97, 16, v96
    v_lshl_or_b32 v81, v99, 16, v98
    v_lshl_or_b32 v82, v101, 16, v100
    v_lshl_or_b32 v83, v103, 16, v102
    v_lshl_or_b32 v84, v105, 16, v104
    v_lshl_or_b32 v85, v107, 16, v106
    v_lshl_or_b32 v86, v109, 16, v108
    v_lshl_or_b32 v87, v111, 16, v110
    v_lshl_or_b32 v88, v113, 16, v112
    v_lshl_or_b32 v89, v115, 16, v114
    v_lshl_or_b32 v90, v117, 16, v116
    v_lshl_or_b32 v91, v119, 16, v118
    v_lshl_or_b32 v92, v121, 16, v120
    v_lshl_or_b32 v93, v123, 16, v122
    v_lshl_or_b32 v94, v125, 16, v124
    v_lshl_or_b32 v95, v127, 16, v126
    v_mfma_f32_16x16x32_bf16 a[64:67], v[80:83], v[48:51], a[64:67]
    v_mfma_f32_16x16x32_bf16 a[68:71], v[80:83], v[52:55], a[68:71]
    v_mfma_f32_16x16x32_bf16 a[72:75], v[80:83], v[56:59], a[72:75]
    v_mfma_f32_16x16x32_bf16 a[76:79], v[80:83], v[60:63], a[76:79]
    v_mfma_f32_16x16x32_bf16 a[80:83], v[84:87], v[48:51], a[80:83]
    v_mfma_f32_16x16x32_bf16 a[84:87], v[84:87], v[52:55], a[84:87]
    v_mfma_f32_16x16x32_bf16 a[88:91], v[84:87], v[56:59], a[88:91]
    v_mfma_f32_16x16x32_bf16 a[92:95], v[84:87], v[60:63], a[92:95]
    v_mfma_f32_16x16x32_bf16 a[96:99], v[88:91], v[48:51], a[96:99]
    v_mfma_f32_16x16x32_bf16 a[100:103], v[88:91], v[52:55], a[100:103]
    v_mfma_f32_16x16x32_bf16 a[104:107], v[88:91], v[56:59], a[104:107]
    v_mfma_f32_16x16x32_bf16 a[108:111], v[88:91], v[60:63], a[108:111]
    v_mfma_f32_16x16x32_bf16 a[112:115], v[92:95], v[48:51], a[112:115]
    v_mfma_f32_16x16x32_bf16 a[116:119], v[92:95], v[52:55], a[116:119]
    v_mfma_f32_16x16x32_bf16 a[120:123], v[92:95], v[56:59], a[120:123]
    v_mfma_f32_16x16x32_bf16 a[124:127], v[92:95], v[60:63], a[124:127]
    s_add_u32 s66, s66, 8192
    s_add_u32 s67, s67, 8192
    s_sub_u32 s69, s69, 1
    s_cbranch_scc0 L_slow_loop
    v_mov_b32 v44, v36
    s_nop 1
    v_permlane16_swap_b32 v36, v44
    v_add_f32 v36, v36, v44
    v_mov_b32 v44, v36
    s_nop 1
    v_permlane32_swap_b32 v36, v44
    v_add_f32 v36, v36, v44
    v_mov_b32 v228, v36
    v_mov_b32 v44, v37
    s_nop 1
    v_permlane16_swap_b32 v37, v44
    v_add_f32 v37, v37, v44
    v_mov_b32 v44, v37
    s_nop 1
    v_permlane32_swap_b32 v37, v44
    v_add_f32 v37, v37, v44
    v_mov_b32 v232, v37
    v_mov_b32 v44, v38
    s_nop 1
    v_permlane16_swap_b32 v38, v44
    v_add_f32 v38, v38, v44
    v_mov_b32 v44, v38
    s_nop 1
    v_permlane32_swap_b32 v38, v44
    v_add_f32 v38, v38, v44
    v_mov_b32 v236, v38
    v_mov_b32 v44, v39
    s_nop 1
    v_permlane16_swap_b32 v39, v44
    v_add_f32 v39, v39, v44
    v_mov_b32 v44, v39
    s_nop 1
    v_permlane32_swap_b32 v39, v44
    v_add_f32 v39, v39, v44
    v_mov_b32 v240, v39
    v_rcp_f32 v244, v228
    v_rcp_f32 v246, v232
    v_rcp_f32 v248, v236
    v_rcp_f32 v250, v240
    v_accvgpr_read_b32 v160, a128
    v_accvgpr_read_b32 v161, a129
    v_accvgpr_read_b32 v162, a130
    v_accvgpr_read_b32 v163, a131
    v_accvgpr_read_b32 v164, a136
    v_accvgpr_read_b32 v165, a137
    v_accvgpr_read_b32 v166, a138
    v_accvgpr_read_b32 v167, a139
    v_accvgpr_read_b32 v168, a144
    v_accvgpr_read_b32 v169, a145
    v_accvgpr_read_b32 v170, a146
    v_accvgpr_read_b32 v171, a147
    v_accvgpr_read_b32 v172, a152
    v_accvgpr_read_b32 v173, a153
    v_accvgpr_read_b32 v174, a154
    v_accvgpr_read_b32 v175, a155
    v_accvgpr_read_b32 v176, a160
    v_accvgpr_read_b32 v177, a161
    v_accvgpr_read_b32 v178, a162
    v_accvgpr_read_b32 v179, a163
    v_accvgpr_read_b32 v180, a168
    v_accvgpr_read_b32 v181, a169
    v_accvgpr_read_b32 v182, a170
    v_accvgpr_read_b32 v183, a171
    v_accvgpr_read_b32 v184, a176
    v_accvgpr_read_b32 v185, a177
    v_accvgpr_read_b32 v186, a178
    v_accvgpr_read_b32 v187, a179
    v_accvgpr_read_b32 v188, a184
    v_accvgpr_read_b32 v189, a185
    v_accvgpr_read_b32 v190, a186
    v_accvgpr_read_b32 v191, a187
    v_accvgpr_read_b32 v192, a192
    v_accvgpr_read_b32 v193, a193
    v_accvgpr_read_b32 v194, a194
    v_accvgpr_read_b32 v195, a195
    v_accvgpr_read_b32 v196, a200
    v_accvgpr_read_b32 v197, a201
    v_accvgpr_read_b32 v198, a202
    v_accvgpr_read_b32 v199, a203
    v_accvgpr_read_b32 v200, a208
    v_accvgpr_read_b32 v201, a209
    v_accvgpr_read_b32 v202, a210
    v_accvgpr_read_b32 v203, a211
    v_accvgpr_read_b32 v204, a216
    v_accvgpr_read_b32 v205, a217
    v_accvgpr_read_b32 v206, a218
    v_accvgpr_read_b32 v207, a219
    v_accvgpr_read_b32 v208, a224
    v_accvgpr_read_b32 v209, a225
    v_accvgpr_read_b32 v210, a226
    v_accvgpr_read_b32 v211, a227
    v_accvgpr_read_b32 v212, a232
    v_accvgpr_read_b32 v213, a233
    v_accvgpr_read_b32 v214, a234
    v_accvgpr_read_b32 v215, a235
    v_accvgpr_read_b32 v216, a240
    v_accvgpr_read_b32 v217, a241
    v_accvgpr_read_b32 v218, a242
    v_accvgpr_read_b32 v219, a243
    v_accvgpr_read_b32 v220, a248
    v_accvgpr_read_b32 v221, a249
    v_accvgpr_read_b32 v222, a250
    v_accvgpr_read_b32 v223, a251
    v_accvgpr_read_b32 v96, a0
    v_accvgpr_read_b32 v97, a1
    v_accvgpr_read_b32 v98, a2
    v_accvgpr_read_b32 v99, a3
    v_accvgpr_read_b32 v100, a16
    v_accvgpr_read_b32 v101, a17
    v_accvgpr_read_b32 v102, a18
    v_accvgpr_read_b32 v103, a19
    v_pk_mul_f32 v[96:97], v[96:97], v[244:245] op_sel_hi:[1,0]
    v_pk_mul_f32 v[98:99], v[98:99], v[244:245] op_sel_hi:[1,0]
    v_pk_mul_f32 v[100:101], v[100:101], v[244:245] op_sel_hi:[1,0]
    v_pk_mul_f32 v[102:103], v[102:103], v[244:245] op_sel_hi:[1,0]
    v_cvt_pk_bf16_f32 v96, v96, v97
    v_cvt_pk_bf16_f32 v97, v98, v99
    v_cvt_pk_bf16_f32 v98, v100, v101
    v_cvt_pk_bf16_f32 v99, v102, v103
    v_accvgpr_write_b32 a192, v96
    v_accvgpr_write_b32 a193, v97
    v_accvgpr_write_b32 a194, v98
    v_accvgpr_write_b32 a195, v99
    v_accvgpr_read_b32 v104, a4
    v_accvgpr_read_b32 v105, a5
    v_accvgpr_read_b32 v106, a6
    v_accvgpr_read_b32 v107, a7
    v_accvgpr_read_b32 v108, a20
    v_accvgpr_read_b32 v109, a21
    v_accvgpr_read_b32 v110, a22
    v_accvgpr_read_b32 v111, a23
    v_pk_mul_f32 v[104:105], v[104:105], v[246:247] op_sel_hi:[1,0]
    v_pk_mul_f32 v[106:107], v[106:107], v[246:247] op_sel_hi:[1,0]
    v_pk_mul_f32 v[108:109], v[108:109], v[246:247] op_sel_hi:[1,0]
    v_pk_mul_f32 v[110:111], v[110:111], v[246:247] op_sel_hi:[1,0]
    v_cvt_pk_bf16_f32 v104, v104, v105
    v_cvt_pk_bf16_f32 v105, v106, v107
    v_cvt_pk_bf16_f32 v106, v108, v109
    v_cvt_pk_bf16_f32 v107, v110, v111
    v_accvgpr_write_b32 a208, v104
    v_accvgpr_write_b32 a209, v105
    v_accvgpr_write_b32 a210, v106
    v_accvgpr_write_b32 a211, v107
    v_accvgpr_read_b32 v112, a8
    v_accvgpr_read_b32 v113, a9
    v_accvgpr_read_b32 v114, a10
    v_accvgpr_read_b32 v115, a11
    v_accvgpr_read_b32 v116, a24
    v_accvgpr_read_b32 v117, a25
    v_accvgpr_read_b32 v118, a26
    v_accvgpr_read_b32 v119, a27
    v_pk_mul_f32 v[112:113], v[112:113], v[248:249] op_sel_hi:[1,0]
    v_pk_mul_f32 v[114:115], v[114:115], v[248:249] op_sel_hi:[1,0]
    v_pk_mul_f32 v[116:117], v[116:117], v[248:249] op_sel_hi:[1,0]
    v_pk_mul_f32 v[118:119], v[118:119], v[248:249] op_sel_hi:[1,0]
    v_cvt_pk_bf16_f32 v112, v112, v113
    v_cvt_pk_bf16_f32 v113, v114, v115
    v_cvt_pk_bf16_f32 v114, v116, v117
    v_cvt_pk_bf16_f32 v115, v118, v119
    v_accvgpr_write_b32 a224, v112
    v_accvgpr_write_b32 a225, v113
    v_accvgpr_write_b32 a226, v114
    v_accvgpr_write_b32 a227, v115
    v_accvgpr_read_b32 v120, a12
    v_accvgpr_read_b32 v121, a13
    v_accvgpr_read_b32 v122, a14
    v_accvgpr_read_b32 v123, a15
    v_accvgpr_read_b32 v124, a28
    v_accvgpr_read_b32 v125, a29
    v_accvgpr_read_b32 v126, a30
    v_accvgpr_read_b32 v127, a31
    v_pk_mul_f32 v[120:121], v[120:121], v[250:251] op_sel_hi:[1,0]
    v_pk_mul_f32 v[122:123], v[122:123], v[250:251] op_sel_hi:[1,0]
    v_pk_mul_f32 v[124:125], v[124:125], v[250:251] op_sel_hi:[1,0]
    v_pk_mul_f32 v[126:127], v[126:127], v[250:251] op_sel_hi:[1,0]
    v_cvt_pk_bf16_f32 v120, v120, v121
    v_cvt_pk_bf16_f32 v121, v122, v123
    v_cvt_pk_bf16_f32 v122, v124, v125
    v_cvt_pk_bf16_f32 v123, v126, v127
    v_accvgpr_write_b32 a240, v120
    v_accvgpr_write_b32 a241, v121
    v_accvgpr_write_b32 a242, v122
    v_accvgpr_write_b32 a243, v123
    v_accvgpr_read_b32 v96, a32
    v_accvgpr_read_b32 v97, a33
    v_accvgpr_read_b32 v98, a34
    v_accvgpr_read_b32 v99, a35
    v_accvgpr_read_b32 v100, a48
    v_accvgpr_read_b32 v101, a49
    v_accvgpr_read_b32 v102, a50
    v_accvgpr_read_b32 v103, a51
    v_pk_mul_f32 v[96:97], v[96:97], v[244:245] op_sel_hi:[1,0]
    v_pk_mul_f32 v[98:99], v[98:99], v[244:245] op_sel_hi:[1,0]
    v_pk_mul_f32 v[100:101], v[100:101], v[244:245] op_sel_hi:[1,0]
    v_pk_mul_f32 v[102:103], v[102:103], v[244:245] op_sel_hi:[1,0]
    v_cvt_pk_bf16_f32 v96, v96, v97
    v_cvt_pk_bf16_f32 v97, v98, v99
    v_cvt_pk_bf16_f32 v98, v100, v101
    v_cvt_pk_bf16_f32 v99, v102, v103
    v_accvgpr_write_b32 a196, v96
    v_accvgpr_write_b32 a197, v97
    v_accvgpr_write_b32 a198, v98
    v_accvgpr_write_b32 a199, v99
    v_accvgpr_read_b32 v104, a36
    v_accvgpr_read_b32 v105, a37
    v_accvgpr_read_b32 v106, a38
    v_accvgpr_read_b32 v107, a39
    v_accvgpr_read_b32 v108, a52
    v_accvgpr_read_b32 v109, a53
    v_accvgpr_read_b32 v110, a54
    v_accvgpr_read_b32 v111, a55
    v_pk_mul_f32 v[104:105], v[104:105], v[246:247] op_sel_hi:[1,0]
    v_pk_mul_f32 v[106:107], v[106:107], v[246:247] op_sel_hi:[1,0]
    v_pk_mul_f32 v[108:109], v[108:109], v[246:247] op_sel_hi:[1,0]
    v_pk_mul_f32 v[110:111], v[110:111], v[246:247] op_sel_hi:[1,0]
    v_cvt_pk_bf16_f32 v104, v104, v105
    v_cvt_pk_bf16_f32 v105, v106, v107
    v_cvt_pk_bf16_f32 v106, v108, v109
    v_cvt_pk_bf16_f32 v107, v110, v111
    v_accvgpr_write_b32 a212, v104
    v_accvgpr_write_b32 a213, v105
    v_accvgpr_write_b32 a214, v106
    v_accvgpr_write_b32 a215, v107
    v_accvgpr_read_b32 v112, a40
    v_accvgpr_read_b32 v113, a41
    v_accvgpr_read_b32 v114, a42
    v_accvgpr_read_b32 v115, a43
    v_accvgpr_read_b32 v116, a56
    v_accvgpr_read_b32 v117, a57
    v_accvgpr_read_b32 v118, a58
    v_accvgpr_read_b32 v119, a59
    v_pk_mul_f32 v[112:113], v[112:113], v[248:249] op_sel_hi:[1,0]
    v_pk_mul_f32 v[114:115], v[114:115], v[248:249] op_sel_hi:[1,0]
    v_pk_mul_f32 v[116:117], v[116:117], v[248:249] op_sel_hi:[1,0]
    v_pk_mul_f32 v[118:119], v[118:119], v[248:249] op_sel_hi:[1,0]
    v_cvt_pk_bf16_f32 v112, v112, v113
    v_cvt_pk_bf16_f32 v113, v114, v115
    v_cvt_pk_bf16_f32 v114, v116, v117
    v_cvt_pk_bf16_f32 v115, v118, v119
    v_accvgpr_write_b32 a228, v112
    v_accvgpr_write_b32 a229, v113
    v_accvgpr_write_b32 a230, v114
    v_accvgpr_write_b32 a231, v115
    v_accvgpr_read_b32 v120, a44
    v_accvgpr_read_b32 v121, a45
    v_accvgpr_read_b32 v122, a46
    v_accvgpr_read_b32 v123, a47
    v_accvgpr_read_b32 v124, a60
    v_accvgpr_read_b32 v125, a61
    v_accvgpr_read_b32 v126, a62
    v_accvgpr_read_b32 v127, a63
    v_pk_mul_f32 v[120:121], v[120:121], v[250:251] op_sel_hi:[1,0]
    v_pk_mul_f32 v[122:123], v[122:123], v[250:251] op_sel_hi:[1,0]
    v_pk_mul_f32 v[124:125], v[124:125], v[250:251] op_sel_hi:[1,0]
    v_pk_mul_f32 v[126:127], v[126:127], v[250:251] op_sel_hi:[1,0]
    v_cvt_pk_bf16_f32 v120, v120, v121
    v_cvt_pk_bf16_f32 v121, v122, v123
    v_cvt_pk_bf16_f32 v122, v124, v125
    v_cvt_pk_bf16_f32 v123, v126, v127
    v_accvgpr_write_b32 a244, v120
    v_accvgpr_write_b32 a245, v121
    v_accvgpr_write_b32 a246, v122
    v_accvgpr_write_b32 a247, v123
    v_accvgpr_read_b32 v96, a64
    v_accvgpr_read_b32 v97, a65
    v_accvgpr_read_b32 v98, a66
    v_accvgpr_read_b32 v99, a67
    v_accvgpr_read_b32 v100, a80
    v_accvgpr_read_b32 v101, a81
    v_accvgpr_read_b32 v102, a82
    v_accvgpr_read_b32 v103, a83
    v_pk_mul_f32 v[96:97], v[96:97], v[244:245] op_sel_hi:[1,0]
    v_pk_mul_f32 v[98:99], v[98:99], v[244:245] op_sel_hi:[1,0]
    v_pk_mul_f32 v[100:101], v[100:101], v[244:245] op_sel_hi:[1,0]
    v_pk_mul_f32 v[102:103], v[102:103], v[244:245] op_sel_hi:[1,0]
    v_cvt_pk_bf16_f32 v96, v96, v97
    v_cvt_pk_bf16_f32 v97, v98, v99
    v_cvt_pk_bf16_f32 v98, v100, v101
    v_cvt_pk_bf16_f32 v99, v102, v103
    v_accvgpr_write_b32 a200, v96
    v_accvgpr_write_b32 a201, v97
    v_accvgpr_write_b32 a202, v98
    v_accvgpr_write_b32 a203, v99
    v_accvgpr_read_b32 v104, a68
    v_accvgpr_read_b32 v105, a69
    v_accvgpr_read_b32 v106, a70
    v_accvgpr_read_b32 v107, a71
    v_accvgpr_read_b32 v108, a84
    v_accvgpr_read_b32 v109, a85
    v_accvgpr_read_b32 v110, a86
    v_accvgpr_read_b32 v111, a87
    v_pk_mul_f32 v[104:105], v[104:105], v[246:247] op_sel_hi:[1,0]
    v_pk_mul_f32 v[106:107], v[106:107], v[246:247] op_sel_hi:[1,0]
    v_pk_mul_f32 v[108:109], v[108:109], v[246:247] op_sel_hi:[1,0]
    v_pk_mul_f32 v[110:111], v[110:111], v[246:247] op_sel_hi:[1,0]
    v_cvt_pk_bf16_f32 v104, v104, v105
    v_cvt_pk_bf16_f32 v105, v106, v107
    v_cvt_pk_bf16_f32 v106, v108, v109
    v_cvt_pk_bf16_f32 v107, v110, v111
    v_accvgpr_write_b32 a216, v104
    v_accvgpr_write_b32 a217, v105
    v_accvgpr_write_b32 a218, v106
    v_accvgpr_write_b32 a219, v107
    v_accvgpr_read_b32 v112, a72
    v_accvgpr_read_b32 v113, a73
    v_accvgpr_read_b32 v114, a74
    v_accvgpr_read_b32 v115, a75
    v_accvgpr_read_b32 v116, a88
    v_accvgpr_read_b32 v117, a89
    v_accvgpr_read_b32 v118, a90
    v_accvgpr_read_b32 v119, a91
    v_pk_mul_f32 v[112:113], v[112:113], v[248:249] op_sel_hi:[1,0]
    v_pk_mul_f32 v[114:115], v[114:115], v[248:249] op_sel_hi:[1,0]
    v_pk_mul_f32 v[116:117], v[116:117], v[248:249] op_sel_hi:[1,0]
    v_pk_mul_f32 v[118:119], v[118:119], v[248:249] op_sel_hi:[1,0]
    v_cvt_pk_bf16_f32 v112, v112, v113
    v_cvt_pk_bf16_f32 v113, v114, v115
    v_cvt_pk_bf16_f32 v114, v116, v117
    v_cvt_pk_bf16_f32 v115, v118, v119
    v_accvgpr_write_b32 a232, v112
    v_accvgpr_write_b32 a233, v113
    v_accvgpr_write_b32 a234, v114
    v_accvgpr_write_b32 a235, v115
    v_accvgpr_read_b32 v120, a76
    v_accvgpr_read_b32 v121, a77
    v_accvgpr_read_b32 v122, a78
    v_accvgpr_read_b32 v123, a79
    v_accvgpr_read_b32 v124, a92
    v_accvgpr_read_b32 v125, a93
    v_accvgpr_read_b32 v126, a94
    v_accvgpr_read_b32 v127, a95
    v_pk_mul_f32 v[120:121], v[120:121], v[250:251] op_sel_hi:[1,0]
    v_pk_mul_f32 v[122:123], v[122:123], v[250:251] op_sel_hi:[1,0]
    v_pk_mul_f32 v[124:125], v[124:125], v[250:251] op_sel_hi:[1,0]
    v_pk_mul_f32 v[126:127], v[126:127], v[250:251] op_sel_hi:[1,0]
    v_cvt_pk_bf16_f32 v120, v120, v121
    v_cvt_pk_bf16_f32 v121, v122, v123
    v_cvt_pk_bf16_f32 v122, v124, v125
    v_cvt_pk_bf16_f32 v123, v126, v127
    v_accvgpr_write_b32 a248, v120
    v_accvgpr_write_b32 a249, v121
    v_accvgpr_write_b32 a250, v122
    v_accvgpr_write_b32 a251, v123
    s_cmp_lg_u32 s70, 0
    s_cbranch_scc1 L_slow_x2
    buffer_store_dwordx4 a[192:195], v26, s[24:27], s84 offen sc1
    buffer_store_dwordx4 a[208:211], v26, s[24:27], s85 offen sc1
    buffer_store_dwordx4 a[224:227], v26, s[24:27], s86 offen sc1
    buffer_store_dwordx4 a[240:243], v26, s[24:27], s87 offen sc1
    buffer_store_dwordx4 a[196:199], v26, s[24:27], s84 offen offset:1024 sc1
    s_branch L_c1
L_slow_x2:
    s_waitcnt vmcnt(63)
    v_and_b32 v1, 63, v0
    v_lshrrev_b32 v2, 6, v0
    v_and_b32 v3, 15, v0
    v_lshrrev_b32 v4, 4, v1
    s_add_u32 m0, s29, 16384
    s_mov_b32 s66, 851968
    buffer_load_dwordx4 v20, s[36:39], s66 offen lds
    buffer_load_dwordx4 v21, s[36:39], s66 offen offset:1024 lds
    buffer_load_dwordx4 v22, s[36:39], s66 offen offset:2048 lds
    buffer_load_dwordx4 v23, s[36:39], s66 offen offset:3072 lds
    s_add_u32 m0, s29, 114688
    s_mov_b32 s66, 1048576
    buffer_load_dwordx4 v20, s[36:39], s66 offen lds
    buffer_load_dwordx4 v21, s[36:39], s66 offen offset:1024 lds
    buffer_load_dwordx4 v22, s[36:39], s66 offen offset:2048 lds
    buffer_load_dwordx4 v23, s[36:39], s66 offen offset:3072 lds
    buffer_store_dwordx4 a[192:195], v26, s[24:27], s84 offen sc1
    buffer_store_dwordx4 a[208:211], v26, s[24:27], s85 offen sc1
    buffer_store_dwordx4 a[224:227], v26, s[24:27], s86 offen sc1
    buffer_store_dwordx4 a[240:243], v26, s[24:27], s87 offen sc1
    buffer_store_dwordx4 a[196:199], v26, s[24:27], s84 offen offset:1024 sc1
    buffer_store_dwordx4 a[212:215], v26, s[24:27], s85 offen offset:1024 sc1
    buffer_store_dwordx4 a[228:231], v26, s[24:27], s86 offen offset:1024 sc1
    buffer_store_dwordx4 a[244:247], v26, s[24:27], s87 offen offset:1024 sc1
    buffer_store_dwordx4 a[200:203], v26, s[24:27], s84 offen offset:2048 sc1
    buffer_store_dwordx4 a[216:219], v26, s[24:27], s85 offen offset:2048 sc1
    buffer_store_dwordx4 a[232:235], v26, s[24:27], s86 offen offset:2048 sc1
    buffer_store_dwordx4 a[248:251], v26, s[24:27], s87 offen offset:2048 sc1
    s_waitcnt vmcnt(0)
    s_mov_b32 s48, 0
    s_mov_b32 s49, 131072
    buffer_load_dwordx4 a[192:195], v27, s[40:43], s48 offen offset:2048 sc1
    buffer_load_dwordx4 a[196:199], v27, s[40:43], s48 offen offset:3072 sc1
    buffer_load_dwordx4 a[200:203], v27, s[40:43], s49 offen offset:2048 sc1
    buffer_load_dwordx4 a[204:207], v27, s[40:43], s49 offen offset:3072 sc1
    s_mov_b32 s48, 8192
    s_mov_b32 s49, 139264
    buffer_load_dwordx4 a[208:211], v27, s[40:43], s48 offen offset:2048 sc1
    buffer_load_dwordx4 a[212:215], v27, s[40:43], s48 offen offset:3072 sc1
    buffer_load_dwordx4 a[216:219], v27, s[40:43], s49 offen offset:2048 sc1
    buffer_load_dwordx4 a[220:223], v27, s[40:43], s49 offen offset:3072 sc1
    s_mov_b32 s48, 16384
    s_mov_b32 s49, 147456
    buffer_load_dwordx4 a[224:227], v27, s[40:43], s48 offen offset:2048 sc1
    buffer_load_dwordx4 a[228:231], v27, s[40:43], s48 offen offset:3072 sc1
    buffer_load_dwordx4 a[232:235], v27, s[40:43], s49 offen offset:2048 sc1
    buffer_load_dwordx4 a[236:239], v27, s[40:43], s49 offen offset:3072 sc1
    s_mov_b32 s48, 24576
    s_mov_b32 s49, 155648
    buffer_load_dwordx4 a[240:243], v27, s[40:43], s48 offen offset:2048 sc1
    buffer_load_dwordx4 a[244:247], v27, s[40:43], s48 offen offset:3072 sc1
    buffer_load_dwordx4 a[248:251], v27, s[40:43], s49 offen offset:2048 sc1
    buffer_load_dwordx4 a[252:255], v27, s[40:43], s49 offen offset:3072 sc1
    s_waitcnt vmcnt(0)
    s_branch L_epi2
L_ool:
L_dec_b1fK:
    s_cmp_lt_u32 s94, s95
L_hop9:
    s_cbranch_execz L_hop13
    s_cbranch_scc1 L_de2_b1fK
    s_sub_u32 s20, s20, 8
    s_cmp_eq_u32 s20, 0x80018
    s_cselect_b32 s95, 0, 6
    s_cmp_eq_u32 s20, s48
    s_cselect_b32 s74, 0x7fffffff, s22
    s_sub_u32 s74, s74, s95
    v_mfma_f32_16x16x32_bf16 v[52:55], v[76:79], v[188:191], v[52:55]
    s_add_u32 s35, s35, 16384
    ds_read_b64_tr_b16 v[92:93], v13 offset:8192
    v_mfma_f32_16x16x32_bf16 v[56:59], v[64:67], v[192:195], v[40:43]
    s_cmp_eq_u32 s35, 81920
    v_exp_f32 v48, v48
    v_mfma_f32_16x16x32_bf16 v[56:59], v[68:71], v[196:199], v[56:59]
    s_cselect_b32 s65, 0xffff0000, s73
    ds_read_b64_tr_b16 v[94:95], v13 offset:12288
    v_mfma_f32_16x16x32_bf16 v[56:59], v[72:75], v[200:203], v[56:59]
    v_exp_f32 v49, v49
    v_mfma_f32_16x16x32_bf16 v[56:59], v[76:79], v[204:207], v[56:59]
    v_cvt_pk_bf16_f32 v128, v48, v49
    v_mfma_f32_16x16x32_bf16 v[60:63], v[64:67], v[208:211], v[44:47]
    s_cselect_b32 s35, 0, s35
    v_exp_f32 v50, v50
    v_mfma_f32_16x16x32_bf16 v[60:63], v[68:71], v[212:215], v[60:63]
    v_mfma_f32_16x16x32_bf16 v[60:63], v[72:75], v[216:219], v[60:63]
    s_waitcnt lgkmcnt(0)
    v_exp_f32 v51, v51
    v_mfma_f32_16x16x32_bf16 v[60:63], v[76:79], v[220:223], v[60:63]
    v_cvt_pk_bf16_f32 v129, v50, v51
    v_mfma_f32_16x16x32_bf16 a[0:3], v[80:83], v[96:99], 0
    v_exp_f32 v52, v52
    v_mfma_f32_16x16x32_bf16 a[0:3], v[84:87], v[112:115], a[0:3]
    v_mfma_f32_16x16x32_bf16 a[4:7], v[80:83], v[100:103], 0
    v_exp_f32 v53, v53
    v_mfma_f32_16x16x32_bf16 a[4:7], v[84:87], v[116:119], a[4:7]
    ds_read_b128 v[64:67], v8 offset:4096
    v_cvt_pk_bf16_f32 v132, v52, v53
    v_mfma_f32_16x16x32_bf16 a[8:11], v[80:83], v[104:107], 0
    v_exp_f32 v54, v54
    v_mfma_f32_16x16x32_bf16 a[8:11], v[84:87], v[120:123], a[8:11]
    ds_read_b128 v[68:71], v9 offset:4096
    v_add_u32 v12, s65, v12
    v_mfma_f32_16x16x32_bf16 a[12:15], v[80:83], v[108:111], 0
    v_exp_f32 v55, v55
    v_mfma_f32_16x16x32_bf16 a[12:15], v[84:87], v[124:127], a[12:15]
    ds_read_b128 v[72:75], v10 offset:4096
    v_cvt_pk_bf16_f32 v133, v54, v55
    v_mfma_f32_16x16x32_bf16 a[16:19], v[88:91], v[96:99], 0
    v_exp_f32 v56, v56
    v_mfma_f32_16x16x32_bf16 a[16:19], v[92:95], v[112:115], a[16:19]
    ds_read_b128 v[76:79], v11 offset:4096
    v_add_u32 v13, s65, v13
    v_mfma_f32_16x16x32_bf16 a[20:23], v[88:91], v[100:103], 0
    v_exp_f32 v57, v57
    s_branch L_end_b1fK
L_de2_b1fK:
    s_mov_b32 m0, s32
    s_nop 0
    buffer_load_dwordx4 v20, s[16:19], s30 offen nt lds
    buffer_load_dwordx4 v21, s[16:19], s30 offen offset:1024 nt lds
    buffer_load_dwordx4 v22, s[16:19], s30 offen offset:2048 nt lds
    buffer_load_dwordx4 v23, s[16:19], s30 offen offset:3072 nt lds
    s_add_u32 s30, s30, s79
    s_add_u32 s32, s32, 16384
    s_cmp_ge_u32 s32, 81920
    s_cselect_b32 s66, 81920, 0
    s_sub_u32 s32, s32, s66
    s_add_u32 s23, s23, 2
    s_lshl_b32 s92, s92, 8
    s_or_b32 s92, s92, s23
    s_add_u32 s20, s20, 8
    s_cmp_eq_u32 s20, 0x80018
    s_cselect_b32 s95, 0, 6
    s_cmp_eq_u32 s20, s48
    s_cselect_b32 s74, 0x7fffffff, s22
    s_sub_u32 s74, s74, s95
    s_branch L_go_b1fK
L_dec_b1fV:
    s_cmp_lt_u32 s94, s49
    s_cbranch_scc1 L_de2_b1fV
    s_sub_u32 s21, s21, 8
    s_cmp_eq_u32 s21, 0x80018
    s_cselect_b32 s49, 0, 6
    s_cmp_eq_u32 s21, 0x80000
    s_cselect_b32 s78, 0x7fffffff, s22
    s_sub_u32 s78, s78, s49
    v_mfma_f32_16x16x32_bf16 v[52:55], v[76:79], v[188:191], v[52:55]
    ds_read_b64_tr_b16 v[92:93], v17 offset:8192
    v_mfma_f32_16x16x32_bf16 v[56:59], v[64:67], v[192:195], v[40:43]
    v_exp_f32 v48, v48
    v_mfma_f32_16x16x32_bf16 v[56:59], v[68:71], v[196:199], v[56:59]
    ds_read_b64_tr_b16 v[94:95], v17 offset:12288
    v_mfma_f32_16x16x32_bf16 v[56:59], v[72:75], v[200:203], v[56:59]
    v_exp_f32 v49, v49
    v_mfma_f32_16x16x32_bf16 v[56:59], v[76:79], v[204:207], v[56:59]
    v_cvt_pk_bf16_f32 v144, v48, v49
    v_mfma_f32_16x16x32_bf16 v[60:63], v[64:67], v[208:211], v[44:47]
    v_exp_f32 v50, v50
    v_mfma_f32_16x16x32_bf16 v[60:63], v[68:71], v[212:215], v[60:63]
    v_mfma_f32_16x16x32_bf16 v[60:63], v[72:75], v[216:219], v[60:63]
    s_waitcnt lgkmcnt(0)
    v_exp_f32 v51, v51
    v_mfma_f32_16x16x32_bf16 v[60:63], v[76:79], v[220:223], v[60:63]
    v_cvt_pk_bf16_f32 v145, v50, v51
    v_mfma_f32_16x16x32_bf16 a[64:67], v[80:83], v[96:99], 0
    v_exp_f32 v52, v52
    v_mfma_f32_16x16x32_bf16 a[64:67], v[84:87], v[112:115], a[64:67]
    v_mfma_f32_16x16x32_bf16 a[68:71], v[80:83], v[100:103], 0
    v_exp_f32 v53, v53
    v_mfma_f32_16x16x32_bf16 a[68:71], v[84:87], v[116:119], a[68:71]
    ds_read_b128 v[64:67], v8 offset:12288
    v_cvt_pk_bf16_f32 v148, v52, v53
    v_mfma_f32_16x16x32_bf16 a[72:75], v[80:83], v[104:107], 0
    v_exp_f32 v54, v54
    v_mfma_f32_16x16x32_bf16 a[72:75], v[84:87], v[120:123], a[72:75]
    ds_read_b128 v[68:71], v9 offset:12288
    v_add_u32 v16, s65, v16
    v_mfma_f32_16x16x32_bf16 a[76:79], v[80:83], v[108:111], 0
    v_exp_f32 v55, v55
    v_mfma_f32_16x16x32_bf16 a[76:79], v[84:87], v[124:127], a[76:79]
    ds_read_b128 v[72:75], v10 offset:12288
    v_cvt_pk_bf16_f32 v149, v54, v55
    v_mfma_f32_16x16x32_bf16 a[80:83], v[88:91], v[96:99], 0
    v_exp_f32 v56, v56
    v_mfma_f32_16x16x32_bf16 a[80:83], v[92:95], v[112:115], a[80:83]
    ds_read_b128 v[76:79], v11 offset:12288
    v_add_u32 v17, s65, v17
    v_mfma_f32_16x16x32_bf16 a[84:87], v[88:91], v[100:103], 0
    v_exp_f32 v57, v57
    s_branch L_end_b1fV
L_de2_b1fV:
    s_mov_b32 m0, s33
    s_nop 0
    buffer_load_dwordx4 v24, s[12:15], s31 offen nt lds
    buffer_load_dwordx4 v25, s[12:15], s31 offen offset:1024 nt lds
    buffer_load_dwordx4 v24, s[12:15], s31 offen offset:2048 nt lds
    buffer_load_dwordx4 v25, s[12:15], s31 offen offset:3072 nt lds
    s_add_u32 s31, s31, 16384
    s_add_u32 s33, s33, 16384
    s_cmp_ge_u32 s33, 163840
    s_cselect_b32 s66, 81920, 0
    s_sub_u32 s33, s33, s66
    s_add_u32 s23, s23, 2
    s_lshl_b32 s93, s93, 8
    s_or_b32 s93, s93, s23
    s_add_u32 s21, s21, 8
    s_cmp_eq_u32 s21, 0x80018
    s_cselect_b32 s49, 0, 6
    s_cmp_eq_u32 s21, 0x80000
    s_cselect_b32 s78, 0x7fffffff, s22
    s_sub_u32 s78, s78, s49
    s_branch L_go_b1fV
L_dec_bevenK:
    s_cmp_lt_u32 s94, s95
    s_cbranch_scc1 L_de2_bevenK
    s_sub_u32 s20, s20, 8
    s_cmp_eq_u32 s20, 0x80018
    s_cselect_b32 s95, 0, 6
    s_cmp_eq_u32 s20, s48
    s_cselect_b32 s74, 0x7fffffff, s22
    s_sub_u32 s74, s74, s95
    v_mfma_f32_16x16x32_bf16 v[52:55], v[76:79], v[188:191], v[52:55]
    s_add_u32 s35, s35, 16384
    ds_read_b64_tr_b16 v[92:93], v13 offset:8192
    v_mfma_f32_16x16x32_bf16 v[56:59], v[64:67], v[192:195], v[40:43]
    s_cmp_eq_u32 s35, 81920
    v_exp_f32 v48, v48
    v_mfma_f32_16x16x32_bf16 v[56:59], v[68:71], v[196:199], v[56:59]
    s_cselect_b32 s65, 0xffff0000, s73
    ds_read_b64_tr_b16 v[94:95], v13 offset:12288
    v_mfma_f32_16x16x32_bf16 v[56:59], v[72:75], v[200:203], v[56:59]
    v_exp_f32 v49, v49
    v_mfma_f32_16x16x32_bf16 v[56:59], v[76:79], v[204:207], v[56:59]
    v_cvt_pk_bf16_f32 v96, v48, v49
    v_mfma_f32_16x16x32_bf16 v[60:63], v[64:67], v[208:211], v[44:47]
    s_cselect_b32 s35, 0, s35
    v_exp_f32 v50, v50
    v_mfma_f32_16x16x32_bf16 v[60:63], v[68:71], v[212:215], v[60:63]
    v_mfma_f32_16x16x32_bf16 v[60:63], v[72:75], v[216:219], v[60:63]
    s_waitcnt lgkmcnt(0)
    v_exp_f32 v51, v51
    v_mfma_f32_16x16x32_bf16 v[60:63], v[76:79], v[220:223], v[60:63]
    v_cvt_pk_bf16_f32 v97, v50, v51
    v_mfma_f32_16x16x32_bf16 a[0:3], v[80:83], v[128:131], a[0:3]
    v_exp_f32 v52, v52
    v_mfma_f32_16x16x32_bf16 a[0:3], v[84:87], v[144:147], a[0:3]
    v_mfma_f32_16x16x32_bf16 a[4:7], v[80:83], v[132:135], a[4:7]
    v_exp_f32 v53, v53
    v_mfma_f32_16x16x32_bf16 a[4:7], v[84:87], v[148:151], a[4:7]
    ds_read_b128 v[64:67], v8 offset:4096
    v_cvt_pk_bf16_f32 v100, v52, v53
    v_mfma_f32_16x16x32_bf16 a[8:11], v[80:83], v[136:139], a[8:11]
    v_exp_f32 v54, v54
    v_mfma_f32_16x16x32_bf16 a[8:11], v[84:87], v[152:155], a[8:11]
    ds_read_b128 v[68:71], v9 offset:4096
    v_add_u32 v12, s65, v12
    v_mfma_f32_16x16x32_bf16 a[12:15], v[80:83], v[140:143], a[12:15]
    v_exp_f32 v55, v55
    v_mfma_f32_16x16x32_bf16 a[12:15], v[84:87], v[156:159], a[12:15]
    ds_read_b128 v[72:75], v10 offset:4096
    v_cvt_pk_bf16_f32 v101, v54, v55
    v_mfma_f32_16x16x32_bf16 a[16:19], v[88:91], v[128:131], a[16:19]
    v_exp_f32 v56, v56
    v_mfma_f32_16x16x32_bf16 a[16:19], v[92:95], v[144:147], a[16:19]
    ds_read_b128 v[76:79], v11 offset:4096
    v_add_u32 v13, s65, v13
    v_mfma_f32_16x16x32_bf16 a[20:23], v[88:91], v[132:135], a[20:23]
    v_exp_f32 v57, v57
    s_branch L_end_bevenK
L_de2_bevenK:
    s_mov_b32 m0, s32
    s_nop 0
    buffer_load_dwordx4 v20, s[16:19], s30 offen nt lds
    buffer_load_dwordx4 v21, s[16:19], s30 offen offset:1024 nt lds
    buffer_load_dwordx4 v22, s[16:19], s30 offen offset:2048 nt lds
    buffer_load_dwordx4 v23, s[16:19], s30 offen offset:3072 nt lds
    s_add_u32 s30, s30, s79
    s_add_u32 s32, s32, 16384
    s_cmp_ge_u32 s32, 81920
    s_cselect_b32 s66, 81920, 0
    s_sub_u32 s32, s32, s66
    s_add_u32 s23, s23, 2
    s_lshl_b32 s92, s92, 8
    s_or_b32 s92, s92, s23
    s_add_u32 s20, s20, 8
    s_cmp_eq_u32 s20, 0x80018
    s_cselect_b32 s95, 0, 6
    s_cmp_eq_u32 s20, s48
    s_cselect_b32 s74, 0x7fffffff, s22
    s_sub_u32 s74, s74, s95
    s_branch L_go_bevenK
L_dec_bevenV:
    s_cmp_lt_u32 s94, s49
    s_cbranch_scc1 L_de2_bevenV
    s_sub_u32 s21, s21, 8
    s_cmp_eq_u32 s21, 0x80018
    s_cselect_b32 s49, 0, 6
    s_cmp_eq_u32 s21, 0x80000
    s_cselect_b32 s78, 0x7fffffff, s22
    s_sub_u32 s78, s78, s49
    v_mfma_f32_16x16x32_bf16 v[52:55], v[76:79], v[188:191], v[52:55]
    ds_read_b64_tr_b16 v[92:93], v17 offset:8192
    v_mfma_f32_16x16x32_bf16 v[56:59], v[64:67], v[192:195], v[40:43]
    v_exp_f32 v48, v48
    v_mfma_f32_16x16x32_bf16 v[56:59], v[68:71], v[196:199], v[56:59]
    ds_read_b64_tr_b16 v[94:95], v17 offset:12288
    v_mfma_f32_16x16x32_bf16 v[56:59], v[72:75], v[200:203], v[56:59]
    v_exp_f32 v49, v49
    v_mfma_f32_16x16x32_bf16 v[56:59], v[76:79], v[204:207], v[56:59]
    v_cvt_pk_bf16_f32 v112, v48, v49
    v_mfma_f32_16x16x32_bf16 v[60:63], v[64:67], v[208:211], v[44:47]
    v_exp_f32 v50, v50
    v_mfma_f32_16x16x32_bf16 v[60:63], v[68:71], v[212:215], v[60:63]
    v_mfma_f32_16x16x32_bf16 v[60:63], v[72:75], v[216:219], v[60:63]
    s_waitcnt lgkmcnt(0)
    v_exp_f32 v51, v51
    v_mfma_f32_16x16x32_bf16 v[60:63], v[76:79], v[220:223], v[60:63]
    v_cvt_pk_bf16_f32 v113, v50, v51
    v_mfma_f32_16x16x32_bf16 a[64:67], v[80:83], v[128:131], a[64:67]
    v_exp_f32 v52, v52
    v_mfma_f32_16x16x32_bf16 a[64:67], v[84:87], v[144:147], a[64:67]
    v_mfma_f32_16x16x32_bf16 a[68:71], v[80:83], v[132:135], a[68:71]
    v_exp_f32 v53, v53
    v_mfma_f32_16x16x32_bf16 a[68:71], v[84:87], v[148:151], a[68:71]
    ds_read_b128 v[64:67], v8 offset:12288
    v_cvt_pk_bf16_f32 v116, v52, v53
    v_mfma_f32_16x16x32_bf16 a[72:75], v[80:83], v[136:139], a[72:75]
    v_exp_f32 v54, v54
    v_mfma_f32_16x16x32_bf16 a[72:75], v[84:87], v[152:155], a[72:75]
    ds_read_b128 v[68:71], v9 offset:12288
    v_add_u32 v16, s65, v16
    v_mfma_f32_16x16x32_bf16 a[76:79], v[80:83], v[140:143], a[76:79]
    v_exp_f32 v55, v55
    v_mfma_f32_16x16x32_bf16 a[76:79], v[84:87], v[156:159], a[76:79]
    ds_read_b128 v[72:75], v10 offset:12288
    v_cvt_pk_bf16_f32 v117, v54, v55
    v_mfma_f32_16x16x32_bf16 a[80:83], v[88:91], v[128:131], a[80:83]
    v_exp_f32 v56, v56
    v_mfma_f32_16x16x32_bf16 a[80:83], v[92:95], v[144:147], a[80:83]
    ds_read_b128 v[76:79], v11 offset:12288
    v_add_u32 v17, s65, v17
    v_mfma_f32_16x16x32_bf16 a[84:87], v[88:91], v[132:135], a[84:87]
    v_exp_f32 v57, v57
    s_branch L_end_bevenV
L_de2_bevenV:
    s_mov_b32 m0, s33
    s_nop 0
    buffer_load_dwordx4 v24, s[12:15], s31 offen nt lds
    buffer_load_dwordx4 v25, s[12:15], s31 offen offset:1024 nt lds
    buffer_load_dwordx4 v24, s[12:15], s31 offen offset:2048 nt lds
    buffer_load_dwordx4 v25, s[12:15], s31 offen offset:3072 nt lds
    s_add_u32 s31, s31, 16384
    s_add_u32 s33, s33, 16384
    s_cmp_ge_u32 s33, 163840
    s_cselect_b32 s66, 81920, 0
    s_sub_u32 s33, s33, s66
    s_add_u32 s23, s23, 2
    s_lshl_b32 s93, s93, 8
    s_or_b32 s93, s93, s23
    s_add_u32 s21, s21, 8
    s_cmp_eq_u32 s21, 0x80018
    s_cselect_b32 s49, 0, 6
    s_cmp_eq_u32 s21, 0x80000
    s_cselect_b32 s78, 0x7fffffff, s22
    s_sub_u32 s78, s78, s49
    s_branch L_go_bevenV
L_dec_boddK:
    s_cmp_lt_u32 s94, s95
    s_cbranch_scc1 L_de2_boddK
    s_sub_u32 s20, s20, 8
    s_cmp_eq_u32 s20, 0x80018
    s_cselect_b32 s95, 0, 6
    s_cmp_eq_u32 s20, s48
    s_cselect_b32 s74, 0x7fffffff, s22
    s_sub_u32 s74, s74, s95
    v_mfma_f32_16x16x32_bf16 v[52:55], v[76:79], v[188:191], v[52:55]
    s_add_u32 s35, s35, 16384
    ds_read_b64_tr_b16 v[92:93], v13 offset:8192
    v_mfma_f32_16x16x32_bf16 v[56:59], v[64:67], v[192:195], v[40:43]
    s_cmp_eq_u32 s35, 81920
    v_exp_f32 v48, v48
    v_mfma_f32_16x16x32_bf16 v[56:59], v[68:71], v[196:199], v[56:59]
    s_cselect_b32 s65, 0xffff0000, s73
    ds_read_b64_tr_b16 v[94:95], v13 offset:12288
    v_mfma_f32_16x16x32_bf16 v[56:59], v[72:75], v[200:203], v[56:59]
    v_exp_f32 v49, v49
    v_mfma_f32_16x16x32_bf16 v[56:59], v[76:79], v[204:207], v[56:59]
    v_cvt_pk_bf16_f32 v128, v48, v49
    v_mfma_f32_16x16x32_bf16 v[60:63], v[64:67], v[208:211], v[44:47]
    s_cselect_b32 s35, 0, s35
    v_exp_f32 v50, v50
    v_mfma_f32_16x16x32_bf16 v[60:63], v[68:71], v[212:215], v[60:63]
    v_mfma_f32_16x16x32_bf16 v[60:63], v[72:75], v[216:219], v[60:63]
    s_waitcnt lgkmcnt(0)
    v_exp_f32 v51, v51
    v_mfma_f32_16x16x32_bf16 v[60:63], v[76:79], v[220:223], v[60:63]
    v_cvt_pk_bf16_f32 v129, v50, v51
    v_mfma_f32_16x16x32_bf16 a[0:3], v[80:83], v[96:99], a[0:3]
    v_exp_f32 v52, v52
    v_mfma_f32_16x16x32_bf16 a[0:3], v[84:87], v[112:115], a[0:3]
L_hop10:
    s_cbranch_execz L_hop14
    v_mfma_f32_16x16x32_bf16 a[4:7], v[80:83], v[100:103], a[4:7]
    v_exp_f32 v53, v53
    v_mfma_f32_16x16x32_bf16 a[4:7], v[84:87], v[116:119], a[4:7]
    ds_read_b128 v[64:67], v8 offset:4096
    v_cvt_pk_bf16_f32 v132, v52, v53
    v_mfma_f32_16x16x32_bf16 a[8:11], v[80:83], v[104:107], a[8:11]
    v_exp_f32 v54, v54
    v_mfma_f32_16x16x32_bf16 a[8:11], v[84:87], v[120:123], a[8:11]
    ds_read_b128 v[68:71], v9 offset:4096
    v_add_u32 v12, s65, v12
    v_mfma_f32_16x16x32_bf16 a[12:15], v[80:83], v[108:111], a[12:15]
    v_exp_f32 v55, v55
    v_mfma_f32_16x16x32_bf16 a[12:15], v[84:87], v[124:127], a[12:15]
    ds_read_b128 v[72:75], v10 offset:4096
    v_cvt_pk_bf16_f32 v133, v54, v55
    v_mfma_f32_16x16x32_bf16 a[16:19], v[88:91], v[96:99], a[16:19]
    v_exp_f32 v56, v56
    v_mfma_f32_16x16x32_bf16 a[16:19], v[92:95], v[112:115], a[16:19]
    ds_read_b128 v[76:79], v11 offset:4096
    v_add_u32 v13, s65, v13
    v_mfma_f32_16x16x32_bf16 a[20:23], v[88:91], v[100:103], a[20:23]
    v_exp_f32 v57, v57
    s_branch L_end_boddK
L_de2_boddK:
    s_mov_b32 m0, s32
    s_nop 0
    buffer_load_dwordx4 v20, s[16:19], s30 offen nt lds
    buffer_load_dwordx4 v21, s[16:19], s30 offen offset:1024 nt lds
    buffer_load_dwordx4 v22, s[16:19], s30 offen offset:2048 nt lds
    buffer_load_dwordx4 v23, s[16:19], s30 offen offset:3072 nt lds
    s_add_u32 s30, s30, s79
    s_add_u32 s32, s32, 16384
    s_cmp_ge_u32 s32, 81920
    s_cselect_b32 s66, 81920, 0
    s_sub_u32 s32, s32, s66
    s_add_u32 s23, s23, 2
    s_lshl_b32 s92, s92, 8
    s_or_b32 s92, s92, s23
    s_add_u32 s20, s20, 8
    s_cmp_eq_u32 s20, 0x80018
    s_cselect_b32 s95, 0, 6
    s_cmp_eq_u32 s20, s48
    s_cselect_b32 s74, 0x7fffffff, s22
    s_sub_u32 s74, s74, s95
    s_branch L_go_boddK
L_dec_boddV:
    s_cmp_lt_u32 s94, s49
    s_cbranch_scc1 L_de2_boddV
    s_sub_u32 s21, s21, 8
    s_cmp_eq_u32 s21, 0x80018
    s_cselect_b32 s49, 0, 6
    s_cmp_eq_u32 s21, 0x80000
    s_cselect_b32 s78, 0x7fffffff, s22
    s_sub_u32 s78, s78, s49
    v_mfma_f32_16x16x32_bf16 v[52:55], v[76:79], v[188:191], v[52:55]
    ds_read_b64_tr_b16 v[92:93], v17 offset:8192
    v_mfma_f32_16x16x32_bf16 v[56:59], v[64:67], v[192:195], v[40:43]
    v_exp_f32 v48, v48
    v_mfma_f32_16x16x32_bf16 v[56:59], v[68:71], v[196:199], v[56:59]
    ds_read_b64_tr_b16 v[94:95], v17 offset:12288
    v_mfma_f32_16x16x32_bf16 v[56:59], v[72:75], v[200:203], v[56:59]
    v_exp_f32 v49, v49
    v_mfma_f32_16x16x32_bf16 v[56:59], v[76:79], v[204:207], v[56:59]
    v_cvt_pk_bf16_f32 v144, v48, v49
    v_mfma_f32_16x16x32_bf16 v[60:63], v[64:67], v[208:211], v[44:47]
    v_exp_f32 v50, v50
    v_mfma_f32_16x16x32_bf16 v[60:63], v[68:71], v[212:215], v[60:63]
    v_mfma_f32_16x16x32_bf16 v[60:63], v[72:75], v[216:219], v[60:63]
    s_waitcnt lgkmcnt(0)
    v_exp_f32 v51, v51
    v_mfma_f32_16x16x32_bf16 v[60:63], v[76:79], v[220:223], v[60:63]
    v_cvt_pk_bf16_f32 v145, v50, v51
    v_mfma_f32_16x16x32_bf16 a[64:67], v[80:83], v[96:99], a[64:67]
    v_exp_f32 v52, v52
    v_mfma_f32_16x16x32_bf16 a[64:67], v[84:87], v[112:115], a[64:67]
    v_mfma_f32_16x16x32_bf16 a[68:71], v[80:83], v[100:103], a[68:71]
    v_exp_f32 v53, v53
    v_mfma_f32_16x16x32_bf16 a[68:71], v[84:87], v[116:119], a[68:71]
    ds_read_b128 v[64:67], v8 offset:12288
    v_cvt_pk_bf16_f32 v148, v52, v53
    v_mfma_f32_16x16x32_bf16 a[72:75], v[80:83], v[104:107], a[72:75]
    v_exp_f32 v54, v54
    v_mfma_f32_16x16x32_bf16 a[72:75], v[84:87], v[120:123], a[72:75]
    ds_read_b128 v[68:71], v9 offset:12288
    v_add_u32 v16, s65, v16
    v_mfma_f32_16x16x32_bf16 a[76:79], v[80:83], v[108:111], a[76:79]
    v_exp_f32 v55, v55
    v_mfma_f32_16x16x32_bf16 a[76:79], v[84:87], v[124:127], a[76:79]
    ds_read_b128 v[72:75], v10 offset:12288
    v_cvt_pk_bf16_f32 v149, v54, v55
    v_mfma_f32_16x16x32_bf16 a[80:83], v[88:91], v[96:99], a[80:83]
    v_exp_f32 v56, v56
    v_mfma_f32_16x16x32_bf16 a[80:83], v[92:95], v[112:115], a[80:83]
    ds_read_b128 v[76:79], v11 offset:12288
    v_add_u32 v17, s65, v17
    v_mfma_f32_16x16x32_bf16 a[84:87], v[88:91], v[100:103], a[84:87]
    v_exp_f32 v57, v57
    s_branch L_end_boddV
L_de2_boddV:
    s_mov_b32 m0, s33
    s_nop 0
    buffer_load_dwordx4 v24, s[12:15], s31 offen nt lds
    buffer_load_dwordx4 v25, s[12:15], s31 offen offset:1024 nt lds
    buffer_load_dwordx4 v24, s[12:15], s31 offen offset:2048 nt lds
    buffer_load_dwordx4 v25, s[12:15], s31 offen offset:3072 nt lds
    s_add_u32 s31, s31, 16384
    s_add_u32 s33, s33, 16384
    s_cmp_ge_u32 s33, 163840
    s_cselect_b32 s66, 81920, 0
    s_sub_u32 s33, s33, s66
    s_add_u32 s23, s23, 2
    s_lshl_b32 s93, s93, 8
    s_or_b32 s93, s93, s23
    s_add_u32 s21, s21, 8
    s_cmp_eq_u32 s21, 0x80018
    s_cselect_b32 s49, 0, 6
    s_cmp_eq_u32 s21, 0x80000
    s_cselect_b32 s78, 0x7fffffff, s22
    s_sub_u32 s78, s78, s49
    s_branch L_go_boddV
L_lw_it0:
    s_getreg_b32 s66, hwreg(HW_REG_IB_STS, 22, 2)
    s_getreg_b32 s94, hwreg(HW_REG_IB_STS, 0, 4)
    s_lshl4_add_u32 s94, s66, s94
    s_cmp_gt_u32 s94, s76
    s_cbranch_scc1 L_lw_it0
    s_branch L_bb_it0
L_lw_b1f:
    s_getreg_b32 s66, hwreg(HW_REG_IB_STS, 22, 2)
    s_getreg_b32 s94, hwreg(HW_REG_IB_STS, 0, 4)
    s_lshl4_add_u32 s94, s66, s94
    s_cmp_gt_u32 s94, s76
    s_cbranch_scc1 L_lw_b1f
    s_branch L_bb_b1f
L_lw_beven:
    s_getreg_b32 s66, hwreg(HW_REG_IB_STS, 22, 2)
    s_getreg_b32 s94, hwreg(HW_REG_IB_STS, 0, 4)
    s_lshl4_add_u32 s94, s66, s94
    s_cmp_gt_u32 s94, s76
    s_cbranch_scc1 L_lw_beven
    s_branch L_bb_beven
L_lw_bodd:
    s_getreg_b32 s66, hwreg(HW_REG_IB_STS, 22, 2)
    s_getreg_b32 s94, hwreg(HW_REG_IB_STS, 0, 4)
    s_lshl4_add_u32 s94, s66, s94
    s_cmp_gt_u32 s94, s76
    s_cbranch_scc1 L_lw_bodd
    s_branch L_bb_bodd
L_lw_pl0:
    s_getreg_b32 s66, hwreg(HW_REG_IB_STS, 22, 2)
    s_getreg_b32 s94, hwreg(HW_REG_IB_STS, 0, 4)
    s_lshl4_add_u32 s94, s66, s94
    s_cmp_gt_u32 s94, s76
    s_cbranch_scc1 L_lw_pl0
    s_branch L_bb_pl0
L_lw_pl1:
    s_getreg_b32 s66, hwreg(HW_REG_IB_STS, 22, 2)
    s_getreg_b32 s94, hwreg(HW_REG_IB_STS, 0, 4)
    s_lshl4_add_u32 s94, s66, s94
    s_cmp_gt_u32 s94, s76
    s_cbranch_scc1 L_lw_pl1
    s_branch L_bb_pl1
L_lw_pl2:
    s_getreg_b32 s66, hwreg(HW_REG_IB_STS, 22, 2)
    s_getreg_b32 s94, hwreg(HW_REG_IB_STS, 0, 4)
    s_lshl4_add_u32 s94, s66, s94
    s_cmp_gt_u32 s94, s76
    s_cbranch_scc1 L_lw_pl2
    s_branch L_bb_pl2
L_lw_pl3:
    s_getreg_b32 s66, hwreg(HW_REG_IB_STS, 22, 2)
    s_getreg_b32 s94, hwreg(HW_REG_IB_STS, 0, 4)
    s_lshl4_add_u32 s94, s66, s94
    s_cmp_gt_u32 s94, s76
    s_cbranch_scc1 L_lw_pl3
    s_branch L_bb_pl3
L_spin1:
    s_mov_b32 s57, 0x40000
L_spin1_l:
    s_sleep 8
    global_load_dword v6, v30, s[58:59] offset:128 sc1
    s_waitcnt vmcnt(0)
    v_readfirstlane_b32 s56, v6
    s_nop 3
    s_cmp_ge_u32 s56, 16
    s_cbranch_scc1 L_back1
    s_sub_u32 s57, s57, 1
    s_cbranch_scc0 L_spin1_l
    s_branch L_back1
L_spin2:
    s_mov_b32 s57, 0x40000
L_spin2_l:
    s_sleep 8
    global_load_dword v6, v28, s[60:61] sc1
    s_waitcnt vmcnt(0)
    v_readfirstlane_b32 s56, v6
    s_nop 3
    s_cmp_ge_u32 s56, 16
    s_cbranch_scc1 L_back2
    s_sub_u32 s57, s57, 1
    s_cbranch_scc0 L_spin2_l
    s_branch L_back2
L_spin3:
    s_mov_b32 s57, 0x40000
L_spin3_l:
    s_sleep 8
    global_load_dword v6, v31, s[60:61] sc1
    s_waitcnt vmcnt(0)
    v_readfirstlane_b32 s56, v6
    s_nop 3
    s_cmp_ge_u32 s56, 1
    s_cbranch_scc1 L_back3
    s_sub_u32 s57, s57, 1
    s_cbranch_scc0 L_spin3_l
    s_branch L_back3
L_mid:
    s_cmp_eq_u32 s70, 2
    s_cbranch_scc1 L_peel
L_hop11:
    s_cbranch_execz L_hop15
    s_mov_b32 s70, 2
    s_mov_b32 s69, 2
    s_cmp_eq_u32 s28, 0
    s_cbranch_scc0 L_loop
    s_mov_b64 exec, 1
    global_atomic_add v30, v7, s[58:59] offset:128 sc1
    s_mov_b64 exec, -1
L_nosig1:
    s_branch L_loop
L_peel:
L_dl_pk:
    s_cmp_eq_u32 s20, 0x80018
    s_cbranch_scc1 L_dx_pk
    s_mov_b32 m0, s32
    s_nop 0
    buffer_load_dwordx4 v20, s[16:19], s30 offen nt lds
    buffer_load_dwordx4 v21, s[16:19], s30 offen offset:1024 nt lds
    buffer_load_dwordx4 v22, s[16:19], s30 offen offset:2048 nt lds
    buffer_load_dwordx4 v23, s[16:19], s30 offen offset:3072 nt lds
    s_add_u32 s30, s30, s79
    s_add_u32 s32, s32, 16384
    s_cmp_ge_u32 s32, 81920
    s_cselect_b32 s66, 81920, 0
    s_sub_u32 s32, s32, s66
    s_add_u32 s23, s23, 2
    s_lshl_b32 s92, s92, 8
    s_or_b32 s92, s92, s23
    s_add_u32 s20, s20, 8
    s_branch L_dl_pk
L_dx_pk:
L_dl_pv:
    s_cmp_eq_u32 s21, 0x80018
    s_cbranch_scc1 L_dx_pv
    s_mov_b32 m0, s33
    s_nop 0
    buffer_load_dwordx4 v24, s[12:15], s31 offen nt lds
    buffer_load_dwordx4 v25, s[12:15], s31 offen offset:1024 nt lds
    buffer_load_dwordx4 v24, s[12:15], s31 offen offset:2048 nt lds
    buffer_load_dwordx4 v25, s[12:15], s31 offen offset:3072 nt lds
    s_add_u32 s31, s31, 16384
    s_add_u32 s33, s33, 16384
    s_cmp_ge_u32 s33, 163840
    s_cselect_b32 s66, 81920, 0
    s_sub_u32 s33, s33, s66
    s_add_u32 s23, s23, 2
    s_lshl_b32 s93, s93, 8
    s_or_b32 s93, s93, s23
    s_add_u32 s21, s21, 8
    s_branch L_dl_pv
L_dx_pv:
    v_and_b32 v252, 63, v0
    v_lshlrev_b32 v252, 7, v252
    s_lshl_b32 s71, s28, 13
    buffer_load_dword v4, v252, s[80:83], s71 offen
    v_and_b32 v5, 0xffffff00, v24
    v_and_b32 v20, 255, v24
    v_lshl_add_u32 v20, v5, 2, v20
    v_and_b32 v5, 0xffffff00, v25
    v_and_b32 v21, 255, v25
    v_lshl_add_u32 v21, v5, 2, v21
    v_add_u32 v21, 3072, v21
    v_add_u32 v22, 6144, v20
    v_add_u32 v23, 6144, v21
    v_mov_b32 v6, 0
    s_mov_b32 s70, 1
    v_and_b32 v1, 63, v0
    v_lshrrev_b32 v2, 6, v0
    v_lshlrev_b32 v5, 18, v2
    v_lshl_add_u32 v27, v1, 4, v5
    v_mfma_f32_16x16x32_bf16 v[48:51], v[64:67], v[160:163], v[32:35]
    v_exp_f32 v61, v61
    v_mfma_f32_16x16x32_bf16 v[48:51], v[68:71], v[164:167], v[48:51]
    ds_read_b64_tr_b16 v[86:87], v12 offset:12288
    v_cvt_pk_bf16_f32 v158, v60, v61
    v_mfma_f32_16x16x32_bf16 v[48:51], v[72:75], v[168:171], v[48:51]
    s_mov_b32 s66, 0
    v_exp_f32 v62, v62
    v_mfma_f32_16x16x32_bf16 v[48:51], v[76:79], v[172:175], v[48:51]
    ds_read_b64_tr_b16 v[88:89], v13
    v_mfma_f32_16x16x32_bf16 v[52:55], v[64:67], v[176:179], v[36:39]
    s_add_u32 m0, s29, 32768
    v_exp_f32 v63, v63
    v_mfma_f32_16x16x32_bf16 v[52:55], v[68:71], v[180:183], v[52:55]
    ds_read_b64_tr_b16 v[90:91], v13 offset:4096
    v_cvt_pk_bf16_f32 v159, v62, v63
    v_mfma_f32_16x16x32_bf16 v[52:55], v[72:75], v[184:187], v[52:55]
    v_mfma_f32_16x16x32_bf16 v[52:55], v[76:79], v[188:191], v[52:55]
    s_add_u32 s35, s35, 16384
    ds_read_b64_tr_b16 v[92:93], v13 offset:8192
    v_mfma_f32_16x16x32_bf16 v[56:59], v[64:67], v[192:195], v[40:43]
    s_cmp_eq_u32 s35, 81920
    v_exp_f32 v48, v48
    v_mfma_f32_16x16x32_bf16 v[56:59], v[68:71], v[196:199], v[56:59]
    s_cselect_b32 s65, 0xffff0000, s73
    ds_read_b64_tr_b16 v[94:95], v13 offset:12288
    v_mfma_f32_16x16x32_bf16 v[56:59], v[72:75], v[200:203], v[56:59]
    v_exp_f32 v49, v49
    v_mfma_f32_16x16x32_bf16 v[56:59], v[76:79], v[204:207], v[56:59]
    buffer_load_dwordx4 v20, s[36:39], s66 offen lds
    v_cvt_pk_bf16_f32 v96, v48, v49
    v_mfma_f32_16x16x32_bf16 v[60:63], v[64:67], v[208:211], v[44:47]
    s_cselect_b32 s35, 0, s35
    v_exp_f32 v50, v50
    v_mfma_f32_16x16x32_bf16 v[60:63], v[68:71], v[212:215], v[60:63]
    s_add_u32 s23, s23, 2
    buffer_load_dwordx4 v21, s[36:39], s66 offen offset:1024 lds
    v_mfma_f32_16x16x32_bf16 v[60:63], v[72:75], v[216:219], v[60:63]
    s_waitcnt lgkmcnt(0)
    v_exp_f32 v51, v51
    v_mfma_f32_16x16x32_bf16 v[60:63], v[76:79], v[220:223], v[60:63]
    buffer_load_dwordx4 v22, s[36:39], s66 offen offset:2048 lds
    v_cvt_pk_bf16_f32 v97, v50, v51
    v_mfma_f32_16x16x32_bf16 a[0:3], v[80:83], v[128:131], a[0:3]
    s_lshl_b32 s92, s92, 8
    v_exp_f32 v52, v52
    v_mfma_f32_16x16x32_bf16 a[0:3], v[84:87], v[144:147], a[0:3]
    s_or_b32 s92, s92, s23
    buffer_load_dwordx4 v23, s[36:39], s66 offen offset:3072 lds
    v_mfma_f32_16x16x32_bf16 a[4:7], v[80:83], v[132:135], a[4:7]
    v_exp_f32 v53, v53
    v_mfma_f32_16x16x32_bf16 a[4:7], v[84:87], v[148:151], a[4:7]
    ds_read_b128 v[64:67], v8 offset:4096
    v_cvt_pk_bf16_f32 v100, v52, v53
    v_mfma_f32_16x16x32_bf16 a[8:11], v[80:83], v[136:139], a[8:11]
    v_exp_f32 v54, v54
    v_mfma_f32_16x16x32_bf16 a[8:11], v[84:87], v[152:155], a[8:11]
    ds_read_b128 v[68:71], v9 offset:4096
    v_add_u32 v12, s65, v12
    v_mfma_f32_16x16x32_bf16 a[12:15], v[80:83], v[140:143], a[12:15]
    v_exp_f32 v55, v55
    v_mfma_f32_16x16x32_bf16 a[12:15], v[84:87], v[156:159], a[12:15]
    ds_read_b128 v[72:75], v10 offset:4096
    v_cvt_pk_bf16_f32 v101, v54, v55
    v_mfma_f32_16x16x32_bf16 a[16:19], v[88:91], v[128:131], a[16:19]
    v_exp_f32 v56, v56
    v_mfma_f32_16x16x32_bf16 a[16:19], v[92:95], v[144:147], a[16:19]
    ds_read_b128 v[76:79], v11 offset:4096
    v_add_u32 v13, s65, v13
    v_mfma_f32_16x16x32_bf16 a[20:23], v[88:91], v[132:135], a[20:23]
    v_exp_f32 v57, v57
    v_mfma_f32_16x16x32_bf16 a[20:23], v[92:95], v[148:151], a[20:23]
    v_cvt_pk_bf16_f32 v104, v56, v57
    v_mfma_f32_16x16x32_bf16 a[24:27], v[88:91], v[136:139], a[24:27]
    v_exp_f32 v58, v58
    v_mfma_f32_16x16x32_bf16 a[24:27], v[92:95], v[152:155], a[24:27]
    ds_read_b64_tr_b16 v[80:81], v14
    v_mfma_f32_16x16x32_bf16 a[28:31], v[88:91], v[140:143], a[28:31]
    v_exp_f32 v59, v59
    v_mfma_f32_16x16x32_bf16 a[28:31], v[92:95], v[156:159], a[28:31]
    ds_read_b64_tr_b16 v[82:83], v14 offset:4096
    v_cvt_pk_bf16_f32 v105, v58, v59
    v_mfma_f32_16x16x32_bf16 v[228:231], v[224:227], v[128:131], v[228:231]
    s_waitcnt lgkmcnt(2)
    v_exp_f32 v60, v60
    v_mfma_f32_16x16x32_bf16 v[228:231], v[224:227], v[144:147], v[228:231]
    ds_read_b64_tr_b16 v[84:85], v14 offset:8192
    v_mfma_f32_16x16x32_bf16 v[48:51], v[64:67], v[160:163], v[32:35]
    v_exp_f32 v61, v61
    v_mfma_f32_16x16x32_bf16 v[48:51], v[68:71], v[164:167], v[48:51]
    ds_read_b64_tr_b16 v[86:87], v14 offset:12288
    v_cvt_pk_bf16_f32 v108, v60, v61
    v_mfma_f32_16x16x32_bf16 v[48:51], v[72:75], v[168:171], v[48:51]
    s_add_u32 s34, s34, 16384
    v_exp_f32 v62, v62
    v_mfma_f32_16x16x32_bf16 v[48:51], v[76:79], v[172:175], v[48:51]
    ds_read_b64_tr_b16 v[88:89], v15
    v_mfma_f32_16x16x32_bf16 v[52:55], v[64:67], v[176:179], v[36:39]
    s_cmp_eq_u32 s34, 81920
    v_exp_f32 v63, v63
    v_mfma_f32_16x16x32_bf16 v[52:55], v[68:71], v[180:183], v[52:55]
    ds_read_b64_tr_b16 v[90:91], v15 offset:4096
    v_cvt_pk_bf16_f32 v109, v62, v63
    v_mfma_f32_16x16x32_bf16 v[52:55], v[72:75], v[184:187], v[52:55]
    s_cselect_b32 s64, 0xffff0000, s73
    v_mfma_f32_16x16x32_bf16 v[52:55], v[76:79], v[188:191], v[52:55]
    ds_read_b64_tr_b16 v[92:93], v15 offset:8192
    v_mfma_f32_16x16x32_bf16 v[56:59], v[64:67], v[192:195], v[40:43]
    s_cselect_b32 s34, 0, s34
    v_exp_f32 v48, v48
    v_mfma_f32_16x16x32_bf16 v[56:59], v[68:71], v[196:199], v[56:59]
    ds_read_b64_tr_b16 v[94:95], v15 offset:12288
    v_mfma_f32_16x16x32_bf16 v[56:59], v[72:75], v[200:203], v[56:59]
    s_cmp_eq_u32 s28, 0
    v_exp_f32 v49, v49
    v_mfma_f32_16x16x32_bf16 v[56:59], v[76:79], v[204:207], v[56:59]
    v_cvt_pk_bf16_f32 v98, v48, v49
    v_mfma_f32_16x16x32_bf16 v[60:63], v[64:67], v[208:211], v[44:47]
    v_exp_f32 v50, v50
    v_mfma_f32_16x16x32_bf16 v[60:63], v[68:71], v[212:215], v[60:63]
    s_cbranch_scc0 L_nopoll1
    global_load_dword v6, v30, s[58:59] offset:128 sc1
L_nopoll1:
    v_mfma_f32_16x16x32_bf16 v[60:63], v[72:75], v[216:219], v[60:63]
    s_waitcnt lgkmcnt(0)
    v_exp_f32 v51, v51
    v_mfma_f32_16x16x32_bf16 v[60:63], v[76:79], v[220:223], v[60:63]
    v_cvt_pk_bf16_f32 v99, v50, v51
    v_mfma_f32_16x16x32_bf16 a[32:35], v[80:83], v[128:131], a[32:35]
    v_exp_f32 v52, v52
    v_mfma_f32_16x16x32_bf16 a[32:35], v[84:87], v[144:147], a[32:35]
    v_mfma_f32_16x16x32_bf16 a[36:39], v[80:83], v[132:135], a[36:39]
    v_exp_f32 v53, v53
    v_mfma_f32_16x16x32_bf16 a[36:39], v[84:87], v[148:151], a[36:39]
    ds_read_b128 v[64:67], v8 offset:8192
    v_cvt_pk_bf16_f32 v102, v52, v53
    v_mfma_f32_16x16x32_bf16 a[40:43], v[80:83], v[136:139], a[40:43]
    v_exp_f32 v54, v54
    v_mfma_f32_16x16x32_bf16 a[40:43], v[84:87], v[152:155], a[40:43]
    ds_read_b128 v[68:71], v9 offset:8192
    v_add_u32 v14, s65, v14
    v_mfma_f32_16x16x32_bf16 a[44:47], v[80:83], v[140:143], a[44:47]
    v_exp_f32 v55, v55
    v_mfma_f32_16x16x32_bf16 a[44:47], v[84:87], v[156:159], a[44:47]
    ds_read_b128 v[72:75], v10 offset:8192
    v_cvt_pk_bf16_f32 v103, v54, v55
    v_mfma_f32_16x16x32_bf16 a[48:51], v[88:91], v[128:131], a[48:51]
    v_exp_f32 v56, v56
    v_mfma_f32_16x16x32_bf16 a[48:51], v[92:95], v[144:147], a[48:51]
    ds_read_b128 v[76:79], v11 offset:8192
    v_add_u32 v15, s65, v15
    v_mfma_f32_16x16x32_bf16 a[52:55], v[88:91], v[132:135], a[52:55]
    v_exp_f32 v57, v57
    v_mfma_f32_16x16x32_bf16 a[52:55], v[92:95], v[148:151], a[52:55]
    v_cvt_pk_bf16_f32 v106, v56, v57
    v_mfma_f32_16x16x32_bf16 a[56:59], v[88:91], v[136:139], a[56:59]
    v_exp_f32 v58, v58
    v_mfma_f32_16x16x32_bf16 a[56:59], v[92:95], v[152:155], a[56:59]
    ds_read_b64_tr_b16 v[80:81], v16
    v_mfma_f32_16x16x32_bf16 a[60:63], v[88:91], v[140:143], a[60:63]
    v_exp_f32 v59, v59
    v_mfma_f32_16x16x32_bf16 a[60:63], v[92:95], v[156:159], a[60:63]
    ds_read_b64_tr_b16 v[82:83], v16 offset:4096
    v_cvt_pk_bf16_f32 v107, v58, v59
    v_mfma_f32_16x16x32_bf16 v[232:235], v[224:227], v[132:135], v[232:235]
    s_waitcnt lgkmcnt(2)
    v_exp_f32 v60, v60
    v_mfma_f32_16x16x32_bf16 v[232:235], v[224:227], v[148:151], v[232:235]
    ds_read_b64_tr_b16 v[84:85], v16 offset:8192
    v_mfma_f32_16x16x32_bf16 v[48:51], v[64:67], v[160:163], v[32:35]
    v_exp_f32 v61, v61
    v_mfma_f32_16x16x32_bf16 v[48:51], v[68:71], v[164:167], v[48:51]
    ds_read_b64_tr_b16 v[86:87], v16 offset:12288
    v_cvt_pk_bf16_f32 v110, v60, v61
    v_mfma_f32_16x16x32_bf16 v[48:51], v[72:75], v[168:171], v[48:51]
    v_exp_f32 v62, v62
    v_mfma_f32_16x16x32_bf16 v[48:51], v[76:79], v[172:175], v[48:51]
    ds_read_b64_tr_b16 v[88:89], v17
    v_mfma_f32_16x16x32_bf16 v[52:55], v[64:67], v[176:179], v[36:39]
    v_exp_f32 v63, v63
    v_mfma_f32_16x16x32_bf16 v[52:55], v[68:71], v[180:183], v[52:55]
    ds_read_b64_tr_b16 v[90:91], v17 offset:4096
    v_cvt_pk_bf16_f32 v111, v62, v63
    v_mfma_f32_16x16x32_bf16 v[52:55], v[72:75], v[184:187], v[52:55]
    v_mfma_f32_16x16x32_bf16 v[52:55], v[76:79], v[188:191], v[52:55]
    ds_read_b64_tr_b16 v[92:93], v17 offset:8192
    v_mfma_f32_16x16x32_bf16 v[56:59], v[64:67], v[192:195], v[40:43]
    v_exp_f32 v48, v48
    v_mfma_f32_16x16x32_bf16 v[56:59], v[68:71], v[196:199], v[56:59]
    ds_read_b64_tr_b16 v[94:95], v17 offset:12288
    v_mfma_f32_16x16x32_bf16 v[56:59], v[72:75], v[200:203], v[56:59]
    s_mov_b32 m0, s33
    v_exp_f32 v49, v49
    v_mfma_f32_16x16x32_bf16 v[56:59], v[76:79], v[204:207], v[56:59]
    buffer_load_dwordx4 v24, s[12:15], s31 offen nt lds
    v_cvt_pk_bf16_f32 v112, v48, v49
    v_mfma_f32_16x16x32_bf16 v[60:63], v[64:67], v[208:211], v[44:47]
    v_exp_f32 v50, v50
    v_mfma_f32_16x16x32_bf16 v[60:63], v[68:71], v[212:215], v[60:63]
    s_add_u32 s23, s23, 2
    buffer_load_dwordx4 v25, s[12:15], s31 offen offset:1024 nt lds
    v_mfma_f32_16x16x32_bf16 v[60:63], v[72:75], v[216:219], v[60:63]
    s_waitcnt lgkmcnt(0)
    v_exp_f32 v51, v51
    v_mfma_f32_16x16x32_bf16 v[60:63], v[76:79], v[220:223], v[60:63]
    buffer_load_dwordx4 v24, s[12:15], s31 offen offset:2048 nt lds
    v_cvt_pk_bf16_f32 v113, v50, v51
    v_mfma_f32_16x16x32_bf16 a[64:67], v[80:83], v[128:131], a[64:67]
    s_lshl_b32 s93, s93, 8
    v_exp_f32 v52, v52
    v_mfma_f32_16x16x32_bf16 a[64:67], v[84:87], v[144:147], a[64:67]
    s_or_b32 s93, s93, s23
    buffer_load_dwordx4 v25, s[12:15], s31 offen offset:3072 nt lds
    v_mfma_f32_16x16x32_bf16 a[68:71], v[80:83], v[132:135], a[68:71]
    s_add_u32 s31, s31, 16384
    v_exp_f32 v53, v53
    v_mfma_f32_16x16x32_bf16 a[68:71], v[84:87], v[148:151], a[68:71]
    ds_read_b128 v[64:67], v8 offset:12288
    v_cvt_pk_bf16_f32 v116, v52, v53
    v_mfma_f32_16x16x32_bf16 a[72:75], v[80:83], v[136:139], a[72:75]
    s_add_u32 s33, s33, 16384
    v_exp_f32 v54, v54
    v_mfma_f32_16x16x32_bf16 a[72:75], v[84:87], v[152:155], a[72:75]
    ds_read_b128 v[68:71], v9 offset:12288
    v_add_u32 v16, s65, v16
    v_mfma_f32_16x16x32_bf16 a[76:79], v[80:83], v[140:143], a[76:79]
    s_cmp_ge_u32 s33, 163840
    v_exp_f32 v55, v55
    v_mfma_f32_16x16x32_bf16 a[76:79], v[84:87], v[156:159], a[76:79]
    ds_read_b128 v[72:75], v10 offset:12288
    v_cvt_pk_bf16_f32 v117, v54, v55
    v_mfma_f32_16x16x32_bf16 a[80:83], v[88:91], v[128:131], a[80:83]
    s_cselect_b32 s66, 81920, 0
    v_exp_f32 v56, v56
    v_mfma_f32_16x16x32_bf16 a[80:83], v[92:95], v[144:147], a[80:83]
    ds_read_b128 v[76:79], v11 offset:12288
    v_add_u32 v17, s65, v17
    v_mfma_f32_16x16x32_bf16 a[84:87], v[88:91], v[132:135], a[84:87]
    s_sub_u32 s33, s33, s66
    v_exp_f32 v57, v57
    v_mfma_f32_16x16x32_bf16 a[84:87], v[92:95], v[148:151], a[84:87]
    v_cvt_pk_bf16_f32 v120, v56, v57
    v_mfma_f32_16x16x32_bf16 a[88:91], v[88:91], v[136:139], a[88:91]
    s_bfe_u32 s76, s92, s20
    v_exp_f32 v58, v58
    v_mfma_f32_16x16x32_bf16 a[88:91], v[92:95], v[152:155], a[88:91]
    ds_read_b64_tr_b16 v[80:81], v18
    v_mfma_f32_16x16x32_bf16 a[92:95], v[88:91], v[140:143], a[92:95]
    s_bfe_u32 s94, s93, s21
    v_exp_f32 v59, v59
    v_mfma_f32_16x16x32_bf16 a[92:95], v[92:95], v[156:159], a[92:95]
    ds_read_b64_tr_b16 v[82:83], v18 offset:4096
    v_cvt_pk_bf16_f32 v121, v58, v59
    v_mfma_f32_16x16x32_bf16 v[236:239], v[224:227], v[136:139], v[236:239]
    s_waitcnt lgkmcnt(2)
    v_exp_f32 v60, v60
    v_mfma_f32_16x16x32_bf16 v[236:239], v[224:227], v[152:155], v[236:239]
    ds_read_b64_tr_b16 v[84:85], v18 offset:8192
    v_mfma_f32_16x16x32_bf16 v[48:51], v[64:67], v[160:163], v[32:35]
    s_max_u32 s76, s76, s94
    v_exp_f32 v61, v61
    v_mfma_f32_16x16x32_bf16 v[48:51], v[68:71], v[164:167], v[48:51]
    ds_read_b64_tr_b16 v[86:87], v18 offset:12288
    v_cvt_pk_bf16_f32 v124, v60, v61
    v_mfma_f32_16x16x32_bf16 v[48:51], v[72:75], v[168:171], v[48:51]
    s_sub_u32 s76, s23, s76
    v_exp_f32 v62, v62
    v_mfma_f32_16x16x32_bf16 v[48:51], v[76:79], v[172:175], v[48:51]
    ds_read_b64_tr_b16 v[88:89], v19
    v_add_u32 v8, s64, v8
    v_mfma_f32_16x16x32_bf16 v[52:55], v[64:67], v[176:179], v[36:39]
    s_lshl_b32 s76, s76, 1
    v_exp_f32 v63, v63
    v_mfma_f32_16x16x32_bf16 v[52:55], v[68:71], v[180:183], v[52:55]
    ds_read_b64_tr_b16 v[90:91], v19 offset:4096
    v_cvt_pk_bf16_f32 v125, v62, v63
    v_mfma_f32_16x16x32_bf16 v[52:55], v[72:75], v[184:187], v[52:55]
    v_mfma_f32_16x16x32_bf16 v[52:55], v[76:79], v[188:191], v[52:55]
    ds_read_b64_tr_b16 v[92:93], v19 offset:8192
    v_add_u32 v9, s64, v9
    v_mfma_f32_16x16x32_bf16 v[56:59], v[64:67], v[192:195], v[40:43]
    v_exp_f32 v48, v48
    v_mfma_f32_16x16x32_bf16 v[56:59], v[68:71], v[196:199], v[56:59]
    ds_read_b64_tr_b16 v[94:95], v19 offset:12288
    v_add_u32 v10, s64, v10
    v_mfma_f32_16x16x32_bf16 v[56:59], v[72:75], v[200:203], v[56:59]
    v_exp_f32 v49, v49
    v_mfma_f32_16x16x32_bf16 v[56:59], v[76:79], v[204:207], v[56:59]
    v_cvt_pk_bf16_f32 v114, v48, v49
    v_mfma_f32_16x16x32_bf16 v[60:63], v[64:67], v[208:211], v[44:47]
    s_getreg_b32 s66, hwreg(HW_REG_IB_STS, 22, 2)
    v_exp_f32 v50, v50
    v_mfma_f32_16x16x32_bf16 v[60:63], v[68:71], v[212:215], v[60:63]
    s_getreg_b32 s94, hwreg(HW_REG_IB_STS, 0, 4)
    s_lshl4_add_u32 s94, s66, s94
    v_add_u32 v11, s64, v11
    v_mfma_f32_16x16x32_bf16 v[60:63], v[72:75], v[216:219], v[60:63]
    s_waitcnt lgkmcnt(0)
    v_exp_f32 v51, v51
    v_mfma_f32_16x16x32_bf16 v[60:63], v[76:79], v[220:223], v[60:63]
    v_cvt_pk_bf16_f32 v115, v50, v51
    v_mfma_f32_16x16x32_bf16 a[96:99], v[80:83], v[128:131], a[96:99]
    s_cmp_gt_i32 s94, s76
    v_exp_f32 v52, v52
    v_mfma_f32_16x16x32_bf16 a[96:99], v[84:87], v[144:147], a[96:99]
    s_cbranch_scc1 L_lw_pl0
L_bb_pl0:
    s_cmp_eq_u32 s28, 0
    s_cbranch_scc0 L_back1
    s_waitcnt vmcnt(4)
    v_readfirstlane_b32 s56, v6
    s_nop 2
    s_cmp_ge_u32 s56, 16
    s_cbranch_scc0 L_spin1
L_back1:
    s_waitcnt vmcnt(24)
    s_barrier
    v_mfma_f32_16x16x32_bf16 a[100:103], v[80:83], v[132:135], a[100:103]
    v_exp_f32 v53, v53
    v_mfma_f32_16x16x32_bf16 a[100:103], v[84:87], v[148:151], a[100:103]
    ds_read_b128 v[64:67], v8
    v_cvt_pk_bf16_f32 v118, v52, v53
    v_mfma_f32_16x16x32_bf16 a[104:107], v[80:83], v[136:139], a[104:107]
    v_exp_f32 v54, v54
    v_mfma_f32_16x16x32_bf16 a[104:107], v[84:87], v[152:155], a[104:107]
    ds_read_b128 v[68:71], v9
    v_add_u32 v18, s65, v18
    v_mfma_f32_16x16x32_bf16 a[108:111], v[80:83], v[140:143], a[108:111]
    v_exp_f32 v55, v55
    v_mfma_f32_16x16x32_bf16 a[108:111], v[84:87], v[156:159], a[108:111]
    ds_read_b128 v[72:75], v10
    v_cvt_pk_bf16_f32 v119, v54, v55
    v_mfma_f32_16x16x32_bf16 a[112:115], v[88:91], v[128:131], a[112:115]
    v_exp_f32 v56, v56
    v_mfma_f32_16x16x32_bf16 a[112:115], v[92:95], v[144:147], a[112:115]
    ds_read_b128 v[76:79], v11
    v_add_u32 v19, s65, v19
    v_mfma_f32_16x16x32_bf16 a[116:119], v[88:91], v[132:135], a[116:119]
    v_exp_f32 v57, v57
    v_mfma_f32_16x16x32_bf16 a[116:119], v[92:95], v[148:151], a[116:119]
    v_cvt_pk_bf16_f32 v122, v56, v57
    v_mfma_f32_16x16x32_bf16 a[120:123], v[88:91], v[136:139], a[120:123]
    v_exp_f32 v58, v58
    v_mfma_f32_16x16x32_bf16 a[120:123], v[92:95], v[152:155], a[120:123]
    ds_read_b64_tr_b16 v[80:81], v12
    v_mfma_f32_16x16x32_bf16 a[124:127], v[88:91], v[140:143], a[124:127]
    v_exp_f32 v59, v59
    v_mfma_f32_16x16x32_bf16 a[124:127], v[92:95], v[156:159], a[124:127]
    ds_read_b64_tr_b16 v[82:83], v12 offset:4096
    v_cvt_pk_bf16_f32 v123, v58, v59
    v_mfma_f32_16x16x32_bf16 v[240:243], v[224:227], v[140:143], v[240:243]
    s_waitcnt lgkmcnt(2)
    v_exp_f32 v60, v60
    v_mfma_f32_16x16x32_bf16 v[240:243], v[224:227], v[156:159], v[240:243]
    ds_read_b64_tr_b16 v[84:85], v12 offset:8192
    v_mfma_f32_16x16x32_bf16 v[48:51], v[64:67], v[160:163], v[32:35]
    v_exp_f32 v61, v61
    v_mfma_f32_16x16x32_bf16 v[48:51], v[68:71], v[164:167], v[48:51]
    ds_read_b64_tr_b16 v[86:87], v12 offset:12288
    v_cvt_pk_bf16_f32 v126, v60, v61
    v_mfma_f32_16x16x32_bf16 v[48:51], v[72:75], v[168:171], v[48:51]
    s_mov_b32 s66, 262144
    v_exp_f32 v62, v62
    v_mfma_f32_16x16x32_bf16 v[48:51], v[76:79], v[172:175], v[48:51]
    s_add_u32 s23, s23, 6
    ds_read_b64_tr_b16 v[88:89], v13
    v_mfma_f32_16x16x32_bf16 v[52:55], v[64:67], v[176:179], v[36:39]
    s_add_u32 m0, s29, 49152
    v_exp_f32 v63, v63
    v_mfma_f32_16x16x32_bf16 v[52:55], v[68:71], v[180:183], v[52:55]
    s_mov_b32 s48, 0
    ds_read_b64_tr_b16 v[90:91], v13 offset:4096
    v_cvt_pk_bf16_f32 v127, v62, v63
    s_mov_b32 s49, 131072
    v_mfma_f32_16x16x32_bf16 v[52:55], v[72:75], v[184:187], v[52:55]
    buffer_load_dwordx4 a[128:131], v27, s[40:43], s48 offen sc1
    v_mfma_f32_16x16x32_bf16 v[52:55], v[76:79], v[188:191], v[52:55]
    s_add_u32 s35, s35, 16384
    ds_read_b64_tr_b16 v[92:93], v13 offset:8192
    v_mfma_f32_16x16x32_bf16 v[56:59], v[64:67], v[192:195], v[40:43]
    s_cmp_eq_u32 s35, 81920
    v_exp_f32 v48, v48
    v_mfma_f32_16x16x32_bf16 v[56:59], v[68:71], v[196:199], v[56:59]
    s_cselect_b32 s65, 0xffff0000, s73
    ds_read_b64_tr_b16 v[94:95], v13 offset:12288
    v_mfma_f32_16x16x32_bf16 v[56:59], v[72:75], v[200:203], v[56:59]
    v_exp_f32 v49, v49
    v_mfma_f32_16x16x32_bf16 v[56:59], v[76:79], v[204:207], v[56:59]
    buffer_load_dwordx4 v20, s[36:39], s66 offen lds
    v_cvt_pk_bf16_f32 v128, v48, v49
    v_mfma_f32_16x16x32_bf16 v[60:63], v[64:67], v[208:211], v[44:47]
    s_cselect_b32 s35, 0, s35
    v_exp_f32 v50, v50
    v_mfma_f32_16x16x32_bf16 v[60:63], v[68:71], v[212:215], v[60:63]
L_hop12:
    s_cbranch_execz L_hop16
    s_add_u32 s23, s23, 2
    buffer_load_dwordx4 v21, s[36:39], s66 offen offset:1024 lds
    v_mfma_f32_16x16x32_bf16 v[60:63], v[72:75], v[216:219], v[60:63]
    s_waitcnt lgkmcnt(0)
    v_exp_f32 v51, v51
    v_mfma_f32_16x16x32_bf16 v[60:63], v[76:79], v[220:223], v[60:63]
    buffer_load_dwordx4 v22, s[36:39], s66 offen offset:2048 lds
    v_cvt_pk_bf16_f32 v129, v50, v51
    v_mfma_f32_16x16x32_bf16 a[0:3], v[80:83], v[96:99], a[0:3]
    s_lshl_b32 s92, s92, 8
    v_exp_f32 v52, v52
    v_mfma_f32_16x16x32_bf16 a[0:3], v[84:87], v[112:115], a[0:3]
    s_or_b32 s92, s92, s23
    buffer_load_dwordx4 v23, s[36:39], s66 offen offset:3072 lds
    v_mfma_f32_16x16x32_bf16 a[4:7], v[80:83], v[100:103], a[4:7]
    v_exp_f32 v53, v53
    v_mfma_f32_16x16x32_bf16 a[4:7], v[84:87], v[116:119], a[4:7]
    ds_read_b128 v[64:67], v8 offset:4096
    v_cvt_pk_bf16_f32 v132, v52, v53
    v_mfma_f32_16x16x32_bf16 a[8:11], v[80:83], v[104:107], a[8:11]
    v_exp_f32 v54, v54
    v_mfma_f32_16x16x32_bf16 a[8:11], v[84:87], v[120:123], a[8:11]
    ds_read_b128 v[68:71], v9 offset:4096
    v_add_u32 v12, s65, v12
    v_mfma_f32_16x16x32_bf16 a[12:15], v[80:83], v[108:111], a[12:15]
    v_exp_f32 v55, v55
    v_mfma_f32_16x16x32_bf16 a[12:15], v[84:87], v[124:127], a[12:15]
    ds_read_b128 v[72:75], v10 offset:4096
    v_cvt_pk_bf16_f32 v133, v54, v55
    v_mfma_f32_16x16x32_bf16 a[16:19], v[88:91], v[96:99], a[16:19]
    v_exp_f32 v56, v56
    v_mfma_f32_16x16x32_bf16 a[16:19], v[92:95], v[112:115], a[16:19]
    ds_read_b128 v[76:79], v11 offset:4096
    v_add_u32 v13, s65, v13
    v_mfma_f32_16x16x32_bf16 a[20:23], v[88:91], v[100:103], a[20:23]
    v_exp_f32 v57, v57
    v_mfma_f32_16x16x32_bf16 a[20:23], v[92:95], v[116:119], a[20:23]
    buffer_load_dwordx4 a[132:135], v27, s[40:43], s48 offen offset:1024 sc1
    v_cvt_pk_bf16_f32 v136, v56, v57
    v_mfma_f32_16x16x32_bf16 a[24:27], v[88:91], v[104:107], a[24:27]
    v_exp_f32 v58, v58
    v_mfma_f32_16x16x32_bf16 a[24:27], v[92:95], v[120:123], a[24:27]
    ds_read_b64_tr_b16 v[80:81], v14
    v_mfma_f32_16x16x32_bf16 a[28:31], v[88:91], v[108:111], a[28:31]
    v_exp_f32 v59, v59
    v_mfma_f32_16x16x32_bf16 a[28:31], v[92:95], v[124:127], a[28:31]
    ds_read_b64_tr_b16 v[82:83], v14 offset:4096
    v_cvt_pk_bf16_f32 v137, v58, v59
    v_mfma_f32_16x16x32_bf16 v[228:231], v[224:227], v[96:99], v[228:231]
    s_waitcnt lgkmcnt(2)
    v_exp_f32 v60, v60
    v_mfma_f32_16x16x32_bf16 v[228:231], v[224:227], v[112:115], v[228:231]
    ds_read_b64_tr_b16 v[84:85], v14 offset:8192
    v_mfma_f32_16x16x32_bf16 v[48:51], v[64:67], v[160:163], v[32:35]
    v_exp_f32 v61, v61
    v_mfma_f32_16x16x32_bf16 v[48:51], v[68:71], v[164:167], v[48:51]
    ds_read_b64_tr_b16 v[86:87], v14 offset:12288
    v_cvt_pk_bf16_f32 v140, v60, v61
    v_mfma_f32_16x16x32_bf16 v[48:51], v[72:75], v[168:171], v[48:51]
    s_add_u32 s34, s34, 16384
    v_exp_f32 v62, v62
    v_mfma_f32_16x16x32_bf16 v[48:51], v[76:79], v[172:175], v[48:51]
    ds_read_b64_tr_b16 v[88:89], v15
    v_mfma_f32_16x16x32_bf16 v[52:55], v[64:67], v[176:179], v[36:39]
    s_cmp_eq_u32 s34, 81920
    v_exp_f32 v63, v63
    v_mfma_f32_16x16x32_bf16 v[52:55], v[68:71], v[180:183], v[52:55]
    ds_read_b64_tr_b16 v[90:91], v15 offset:4096
    v_cvt_pk_bf16_f32 v141, v62, v63
    v_mfma_f32_16x16x32_bf16 v[52:55], v[72:75], v[184:187], v[52:55]
    s_cselect_b32 s64, 0xffff0000, s73
    buffer_load_dwordx4 a[136:139], v27, s[40:43], s49 offen sc1
    v_mfma_f32_16x16x32_bf16 v[52:55], v[76:79], v[188:191], v[52:55]
    ds_read_b64_tr_b16 v[92:93], v15 offset:8192
    v_mfma_f32_16x16x32_bf16 v[56:59], v[64:67], v[192:195], v[40:43]
    s_cselect_b32 s34, 0, s34
    v_exp_f32 v48, v48
    v_mfma_f32_16x16x32_bf16 v[56:59], v[68:71], v[196:199], v[56:59]
    ds_read_b64_tr_b16 v[94:95], v15 offset:12288
    v_mfma_f32_16x16x32_bf16 v[56:59], v[72:75], v[200:203], v[56:59]
    v_exp_f32 v49, v49
    v_mfma_f32_16x16x32_bf16 v[56:59], v[76:79], v[204:207], v[56:59]
    buffer_load_dwordx4 a[140:143], v27, s[40:43], s49 offen offset:1024 sc1
    v_cvt_pk_bf16_f32 v130, v48, v49
    v_mfma_f32_16x16x32_bf16 v[60:63], v[64:67], v[208:211], v[44:47]
    s_mov_b32 s48, 8192
    v_exp_f32 v50, v50
    s_mov_b32 s49, 139264
    v_mfma_f32_16x16x32_bf16 v[60:63], v[68:71], v[212:215], v[60:63]
    buffer_load_dwordx4 a[144:147], v27, s[40:43], s48 offen sc1
    v_mfma_f32_16x16x32_bf16 v[60:63], v[72:75], v[216:219], v[60:63]
    s_waitcnt lgkmcnt(0)
    v_exp_f32 v51, v51
    v_mfma_f32_16x16x32_bf16 v[60:63], v[76:79], v[220:223], v[60:63]
    buffer_load_dwordx4 a[148:151], v27, s[40:43], s48 offen offset:1024 sc1
    v_cvt_pk_bf16_f32 v131, v50, v51
    v_mfma_f32_16x16x32_bf16 a[32:35], v[80:83], v[96:99], a[32:35]
    v_exp_f32 v52, v52
    v_mfma_f32_16x16x32_bf16 a[32:35], v[84:87], v[112:115], a[32:35]
    buffer_load_dwordx4 a[152:155], v27, s[40:43], s49 offen sc1
    v_mfma_f32_16x16x32_bf16 a[36:39], v[80:83], v[100:103], a[36:39]
    v_exp_f32 v53, v53
    v_mfma_f32_16x16x32_bf16 a[36:39], v[84:87], v[116:119], a[36:39]
    ds_read_b128 v[64:67], v8 offset:8192
    v_cvt_pk_bf16_f32 v134, v52, v53
    v_mfma_f32_16x16x32_bf16 a[40:43], v[80:83], v[104:107], a[40:43]
    v_exp_f32 v54, v54
    v_mfma_f32_16x16x32_bf16 a[40:43], v[84:87], v[120:123], a[40:43]
    ds_read_b128 v[68:71], v9 offset:8192
    v_add_u32 v14, s65, v14
    v_mfma_f32_16x16x32_bf16 a[44:47], v[80:83], v[108:111], a[44:47]
    v_exp_f32 v55, v55
    v_mfma_f32_16x16x32_bf16 a[44:47], v[84:87], v[124:127], a[44:47]
    ds_read_b128 v[72:75], v10 offset:8192
    v_cvt_pk_bf16_f32 v135, v54, v55
    v_mfma_f32_16x16x32_bf16 a[48:51], v[88:91], v[96:99], a[48:51]
    v_exp_f32 v56, v56
    v_mfma_f32_16x16x32_bf16 a[48:51], v[92:95], v[112:115], a[48:51]
    ds_read_b128 v[76:79], v11 offset:8192
    v_add_u32 v15, s65, v15
    v_mfma_f32_16x16x32_bf16 a[52:55], v[88:91], v[100:103], a[52:55]
    v_exp_f32 v57, v57
    v_mfma_f32_16x16x32_bf16 a[52:55], v[92:95], v[116:119], a[52:55]
    buffer_load_dwordx4 a[156:159], v27, s[40:43], s49 offen offset:1024 sc1
    v_cvt_pk_bf16_f32 v138, v56, v57
    v_mfma_f32_16x16x32_bf16 a[56:59], v[88:91], v[104:107], a[56:59]
    v_exp_f32 v58, v58
    v_mfma_f32_16x16x32_bf16 a[56:59], v[92:95], v[120:123], a[56:59]
    ds_read_b64_tr_b16 v[80:81], v16
    v_mfma_f32_16x16x32_bf16 a[60:63], v[88:91], v[108:111], a[60:63]
    v_exp_f32 v59, v59
    v_mfma_f32_16x16x32_bf16 a[60:63], v[92:95], v[124:127], a[60:63]
    ds_read_b64_tr_b16 v[82:83], v16 offset:4096
    v_cvt_pk_bf16_f32 v139, v58, v59
    v_mfma_f32_16x16x32_bf16 v[232:235], v[224:227], v[100:103], v[232:235]
    s_waitcnt lgkmcnt(2)
    v_exp_f32 v60, v60
    v_mfma_f32_16x16x32_bf16 v[232:235], v[224:227], v[116:119], v[232:235]
    ds_read_b64_tr_b16 v[84:85], v16 offset:8192
    v_mfma_f32_16x16x32_bf16 v[48:51], v[64:67], v[160:163], v[32:35]
    v_exp_f32 v61, v61
    v_mfma_f32_16x16x32_bf16 v[48:51], v[68:71], v[164:167], v[48:51]
    ds_read_b64_tr_b16 v[86:87], v16 offset:12288
    v_cvt_pk_bf16_f32 v142, v60, v61
    v_mfma_f32_16x16x32_bf16 v[48:51], v[72:75], v[168:171], v[48:51]
    s_mov_b32 s66, 65536
    v_exp_f32 v62, v62
    v_mfma_f32_16x16x32_bf16 v[48:51], v[76:79], v[172:175], v[48:51]
    ds_read_b64_tr_b16 v[88:89], v17
    v_mfma_f32_16x16x32_bf16 v[52:55], v[64:67], v[176:179], v[36:39]
    s_add_u32 m0, s29, 147456
    v_exp_f32 v63, v63
    v_mfma_f32_16x16x32_bf16 v[52:55], v[68:71], v[180:183], v[52:55]
    s_mov_b32 s48, 16384
    ds_read_b64_tr_b16 v[90:91], v17 offset:4096
    v_cvt_pk_bf16_f32 v143, v62, v63
    s_mov_b32 s49, 147456
    v_mfma_f32_16x16x32_bf16 v[52:55], v[72:75], v[184:187], v[52:55]
    buffer_load_dwordx4 a[160:163], v27, s[40:43], s48 offen sc1
    v_mfma_f32_16x16x32_bf16 v[52:55], v[76:79], v[188:191], v[52:55]
    ds_read_b64_tr_b16 v[92:93], v17 offset:8192
    v_mfma_f32_16x16x32_bf16 v[56:59], v[64:67], v[192:195], v[40:43]
    v_exp_f32 v48, v48
    v_mfma_f32_16x16x32_bf16 v[56:59], v[68:71], v[196:199], v[56:59]
    ds_read_b64_tr_b16 v[94:95], v17 offset:12288
    v_mfma_f32_16x16x32_bf16 v[56:59], v[72:75], v[200:203], v[56:59]
    v_exp_f32 v49, v49
    v_mfma_f32_16x16x32_bf16 v[56:59], v[76:79], v[204:207], v[56:59]
    buffer_load_dwordx4 v20, s[36:39], s66 offen lds
    v_cvt_pk_bf16_f32 v144, v48, v49
    v_mfma_f32_16x16x32_bf16 v[60:63], v[64:67], v[208:211], v[44:47]
    v_exp_f32 v50, v50
    v_mfma_f32_16x16x32_bf16 v[60:63], v[68:71], v[212:215], v[60:63]
    s_add_u32 s23, s23, 2
    buffer_load_dwordx4 v21, s[36:39], s66 offen offset:1024 lds
    v_mfma_f32_16x16x32_bf16 v[60:63], v[72:75], v[216:219], v[60:63]
    s_waitcnt lgkmcnt(0)
    v_exp_f32 v51, v51
    v_mfma_f32_16x16x32_bf16 v[60:63], v[76:79], v[220:223], v[60:63]
    buffer_load_dwordx4 v22, s[36:39], s66 offen offset:2048 lds
    v_cvt_pk_bf16_f32 v145, v50, v51
    v_mfma_f32_16x16x32_bf16 a[64:67], v[80:83], v[96:99], a[64:67]
    s_lshl_b32 s93, s93, 8
    v_exp_f32 v52, v52
    v_mfma_f32_16x16x32_bf16 a[64:67], v[84:87], v[112:115], a[64:67]
    s_or_b32 s93, s93, s23
    buffer_load_dwordx4 v23, s[36:39], s66 offen offset:3072 lds
    v_mfma_f32_16x16x32_bf16 a[68:71], v[80:83], v[100:103], a[68:71]
    v_exp_f32 v53, v53
    v_mfma_f32_16x16x32_bf16 a[68:71], v[84:87], v[116:119], a[68:71]
    ds_read_b128 v[64:67], v8 offset:12288
    v_cvt_pk_bf16_f32 v148, v52, v53
    v_mfma_f32_16x16x32_bf16 a[72:75], v[80:83], v[104:107], a[72:75]
    v_exp_f32 v54, v54
    v_mfma_f32_16x16x32_bf16 a[72:75], v[84:87], v[120:123], a[72:75]
    ds_read_b128 v[68:71], v9 offset:12288
    v_add_u32 v16, s65, v16
    v_mfma_f32_16x16x32_bf16 a[76:79], v[80:83], v[108:111], a[76:79]
    v_exp_f32 v55, v55
    v_mfma_f32_16x16x32_bf16 a[76:79], v[84:87], v[124:127], a[76:79]
    ds_read_b128 v[72:75], v10 offset:12288
    v_cvt_pk_bf16_f32 v149, v54, v55
    v_mfma_f32_16x16x32_bf16 a[80:83], v[88:91], v[96:99], a[80:83]
    v_exp_f32 v56, v56
    v_mfma_f32_16x16x32_bf16 a[80:83], v[92:95], v[112:115], a[80:83]
    ds_read_b128 v[76:79], v11 offset:12288
    v_add_u32 v17, s65, v17
    v_mfma_f32_16x16x32_bf16 a[84:87], v[88:91], v[100:103], a[84:87]
    v_exp_f32 v57, v57
    v_mfma_f32_16x16x32_bf16 a[84:87], v[92:95], v[116:119], a[84:87]
    buffer_load_dwordx4 a[164:167], v27, s[40:43], s48 offen offset:1024 sc1
    v_cvt_pk_bf16_f32 v152, v56, v57
    v_mfma_f32_16x16x32_bf16 a[88:91], v[88:91], v[104:107], a[88:91]
    s_bfe_u32 s76, s92, s20
    v_exp_f32 v58, v58
    v_mfma_f32_16x16x32_bf16 a[88:91], v[92:95], v[120:123], a[88:91]
    ds_read_b64_tr_b16 v[80:81], v18
    v_mfma_f32_16x16x32_bf16 a[92:95], v[88:91], v[108:111], a[92:95]
    s_bfe_u32 s94, s93, s21
    v_exp_f32 v59, v59
    v_mfma_f32_16x16x32_bf16 a[92:95], v[92:95], v[124:127], a[92:95]
    ds_read_b64_tr_b16 v[82:83], v18 offset:4096
    v_cvt_pk_bf16_f32 v153, v58, v59
    v_mfma_f32_16x16x32_bf16 v[236:239], v[224:227], v[104:107], v[236:239]
    s_waitcnt lgkmcnt(2)
    v_exp_f32 v60, v60
    v_mfma_f32_16x16x32_bf16 v[236:239], v[224:227], v[120:123], v[236:239]
    ds_read_b64_tr_b16 v[84:85], v18 offset:8192
    v_mfma_f32_16x16x32_bf16 v[48:51], v[64:67], v[160:163], v[32:35]
    s_max_u32 s76, s76, s94
    v_exp_f32 v61, v61
    v_mfma_f32_16x16x32_bf16 v[48:51], v[68:71], v[164:167], v[48:51]
    ds_read_b64_tr_b16 v[86:87], v18 offset:12288
    v_cvt_pk_bf16_f32 v156, v60, v61
    v_mfma_f32_16x16x32_bf16 v[48:51], v[72:75], v[168:171], v[48:51]
    s_sub_u32 s76, s23, s76
    v_exp_f32 v62, v62
    v_mfma_f32_16x16x32_bf16 v[48:51], v[76:79], v[172:175], v[48:51]
    ds_read_b64_tr_b16 v[88:89], v19
    v_add_u32 v8, s64, v8
    v_mfma_f32_16x16x32_bf16 v[52:55], v[64:67], v[176:179], v[36:39]
    s_lshl_b32 s76, s76, 1
    v_exp_f32 v63, v63
    v_mfma_f32_16x16x32_bf16 v[52:55], v[68:71], v[180:183], v[52:55]
    ds_read_b64_tr_b16 v[90:91], v19 offset:4096
    v_cvt_pk_bf16_f32 v157, v62, v63
    v_mfma_f32_16x16x32_bf16 v[52:55], v[72:75], v[184:187], v[52:55]
    buffer_load_dwordx4 a[168:171], v27, s[40:43], s49 offen sc1
    v_mfma_f32_16x16x32_bf16 v[52:55], v[76:79], v[188:191], v[52:55]
    ds_read_b64_tr_b16 v[92:93], v19 offset:8192
    v_add_u32 v9, s64, v9
    v_mfma_f32_16x16x32_bf16 v[56:59], v[64:67], v[192:195], v[40:43]
    v_exp_f32 v48, v48
    v_mfma_f32_16x16x32_bf16 v[56:59], v[68:71], v[196:199], v[56:59]
    ds_read_b64_tr_b16 v[94:95], v19 offset:12288
    v_add_u32 v10, s64, v10
    v_mfma_f32_16x16x32_bf16 v[56:59], v[72:75], v[200:203], v[56:59]
    v_exp_f32 v49, v49
    v_mfma_f32_16x16x32_bf16 v[56:59], v[76:79], v[204:207], v[56:59]
    buffer_load_dwordx4 a[172:175], v27, s[40:43], s49 offen offset:1024 sc1
    v_cvt_pk_bf16_f32 v146, v48, v49
    v_mfma_f32_16x16x32_bf16 v[60:63], v[64:67], v[208:211], v[44:47]
    s_getreg_b32 s66, hwreg(HW_REG_IB_STS, 22, 2)
    v_exp_f32 v50, v50
    v_mfma_f32_16x16x32_bf16 v[60:63], v[68:71], v[212:215], v[60:63]
    s_getreg_b32 s94, hwreg(HW_REG_IB_STS, 0, 4)
    s_lshl4_add_u32 s94, s66, s94
    v_add_u32 v11, s64, v11
    v_mfma_f32_16x16x32_bf16 v[60:63], v[72:75], v[216:219], v[60:63]
    s_waitcnt lgkmcnt(0)
    v_exp_f32 v51, v51
    v_mfma_f32_16x16x32_bf16 v[60:63], v[76:79], v[220:223], v[60:63]
    v_cvt_pk_bf16_f32 v147, v50, v51
    v_mfma_f32_16x16x32_bf16 a[96:99], v[80:83], v[96:99], a[96:99]
    s_cmp_gt_i32 s94, s76
    v_exp_f32 v52, v52
    v_mfma_f32_16x16x32_bf16 a[96:99], v[84:87], v[112:115], a[96:99]
    s_cbranch_scc1 L_lw_pl1
L_bb_pl1:
    s_waitcnt vmcnt(36)
    s_barrier
    v_mfma_f32_16x16x32_bf16 a[100:103], v[80:83], v[100:103], a[100:103]
    v_exp_f32 v53, v53
    v_mfma_f32_16x16x32_bf16 a[100:103], v[84:87], v[116:119], a[100:103]
    ds_read_b128 v[64:67], v8
    v_cvt_pk_bf16_f32 v150, v52, v53
    v_mfma_f32_16x16x32_bf16 a[104:107], v[80:83], v[104:107], a[104:107]
    v_exp_f32 v54, v54
    v_mfma_f32_16x16x32_bf16 a[104:107], v[84:87], v[120:123], a[104:107]
    ds_read_b128 v[68:71], v9
    v_add_u32 v18, s65, v18
    v_mfma_f32_16x16x32_bf16 a[108:111], v[80:83], v[108:111], a[108:111]
    v_exp_f32 v55, v55
    v_mfma_f32_16x16x32_bf16 a[108:111], v[84:87], v[124:127], a[108:111]
    ds_read_b128 v[72:75], v10
    v_cvt_pk_bf16_f32 v151, v54, v55
    v_mfma_f32_16x16x32_bf16 a[112:115], v[88:91], v[96:99], a[112:115]
    v_exp_f32 v56, v56
    v_mfma_f32_16x16x32_bf16 a[112:115], v[92:95], v[112:115], a[112:115]
    ds_read_b128 v[76:79], v11
    v_add_u32 v19, s65, v19
    v_mfma_f32_16x16x32_bf16 a[116:119], v[88:91], v[100:103], a[116:119]
    v_exp_f32 v57, v57
    v_mfma_f32_16x16x32_bf16 a[116:119], v[92:95], v[116:119], a[116:119]
    v_cvt_pk_bf16_f32 v154, v56, v57
    v_mfma_f32_16x16x32_bf16 a[120:123], v[88:91], v[104:107], a[120:123]
    v_exp_f32 v58, v58
    v_mfma_f32_16x16x32_bf16 a[120:123], v[92:95], v[120:123], a[120:123]
    ds_read_b64_tr_b16 v[80:81], v12
    v_mfma_f32_16x16x32_bf16 a[124:127], v[88:91], v[108:111], a[124:127]
    v_exp_f32 v59, v59
    v_mfma_f32_16x16x32_bf16 a[124:127], v[92:95], v[124:127], a[124:127]
    ds_read_b64_tr_b16 v[82:83], v12 offset:4096
    v_cvt_pk_bf16_f32 v155, v58, v59
    v_mfma_f32_16x16x32_bf16 v[240:243], v[224:227], v[108:111], v[240:243]
    s_waitcnt lgkmcnt(2)
    v_exp_f32 v60, v60
    v_mfma_f32_16x16x32_bf16 v[240:243], v[224:227], v[124:127], v[240:243]
    ds_read_b64_tr_b16 v[84:85], v12 offset:8192
    v_mfma_f32_16x16x32_bf16 v[48:51], v[64:67], v[160:163], v[32:35]
    v_exp_f32 v61, v61
    v_mfma_f32_16x16x32_bf16 v[48:51], v[68:71], v[164:167], v[48:51]
    ds_read_b64_tr_b16 v[86:87], v12 offset:12288
    v_cvt_pk_bf16_f32 v158, v60, v61
    v_mfma_f32_16x16x32_bf16 v[48:51], v[72:75], v[168:171], v[48:51]
    s_mov_b32 s66, 524288
    v_exp_f32 v62, v62
    v_mfma_f32_16x16x32_bf16 v[48:51], v[76:79], v[172:175], v[48:51]
    s_add_u32 s23, s23, 6
    ds_read_b64_tr_b16 v[88:89], v13
    v_mfma_f32_16x16x32_bf16 v[52:55], v[64:67], v[176:179], v[36:39]
    s_add_u32 m0, s29, 65536
    v_exp_f32 v63, v63
    v_mfma_f32_16x16x32_bf16 v[52:55], v[68:71], v[180:183], v[52:55]
    s_mov_b32 s48, 24576
    ds_read_b64_tr_b16 v[90:91], v13 offset:4096
    v_cvt_pk_bf16_f32 v159, v62, v63
    s_mov_b32 s49, 155648
    v_mfma_f32_16x16x32_bf16 v[52:55], v[72:75], v[184:187], v[52:55]
    buffer_load_dwordx4 a[176:179], v27, s[40:43], s48 offen sc1
    v_mfma_f32_16x16x32_bf16 v[52:55], v[76:79], v[188:191], v[52:55]
    s_add_u32 s35, s35, 16384
    ds_read_b64_tr_b16 v[92:93], v13 offset:8192
    v_mfma_f32_16x16x32_bf16 v[56:59], v[64:67], v[192:195], v[40:43]
    s_cmp_eq_u32 s35, 81920
    v_exp_f32 v48, v48
    v_mfma_f32_16x16x32_bf16 v[56:59], v[68:71], v[196:199], v[56:59]
    s_cselect_b32 s65, 0xffff0000, s73
    ds_read_b64_tr_b16 v[94:95], v13 offset:12288
    v_mfma_f32_16x16x32_bf16 v[56:59], v[72:75], v[200:203], v[56:59]
    v_exp_f32 v49, v49
    v_mfma_f32_16x16x32_bf16 v[56:59], v[76:79], v[204:207], v[56:59]
    buffer_load_dwordx4 v20, s[36:39], s66 offen lds
    v_cvt_pk_bf16_f32 v96, v48, v49
    v_mfma_f32_16x16x32_bf16 v[60:63], v[64:67], v[208:211], v[44:47]
    s_cselect_b32 s35, 0, s35
    v_exp_f32 v50, v50
    v_mfma_f32_16x16x32_bf16 v[60:63], v[68:71], v[212:215], v[60:63]
    s_add_u32 s23, s23, 2
    buffer_load_dwordx4 v21, s[36:39], s66 offen offset:1024 lds
    v_mfma_f32_16x16x32_bf16 v[60:63], v[72:75], v[216:219], v[60:63]
    s_waitcnt lgkmcnt(0)
    v_exp_f32 v51, v51
    v_mfma_f32_16x16x32_bf16 v[60:63], v[76:79], v[220:223], v[60:63]
    buffer_load_dwordx4 v22, s[36:39], s66 offen offset:2048 lds
    v_cvt_pk_bf16_f32 v97, v50, v51
    v_mfma_f32_16x16x32_bf16 a[0:3], v[80:83], v[128:131], a[0:3]
    s_lshl_b32 s92, s92, 8
    v_exp_f32 v52, v52
    v_mfma_f32_16x16x32_bf16 a[0:3], v[84:87], v[144:147], a[0:3]
    s_or_b32 s92, s92, s23
    buffer_load_dwordx4 v23, s[36:39], s66 offen offset:3072 lds
    v_mfma_f32_16x16x32_bf16 a[4:7], v[80:83], v[132:135], a[4:7]
    v_exp_f32 v53, v53
    v_mfma_f32_16x16x32_bf16 a[4:7], v[84:87], v[148:151], a[4:7]
    ds_read_b128 v[64:67], v8 offset:4096
    v_cvt_pk_bf16_f32 v100, v52, v53
    v_mfma_f32_16x16x32_bf16 a[8:11], v[80:83], v[136:139], a[8:11]
    v_exp_f32 v54, v54
    v_mfma_f32_16x16x32_bf16 a[8:11], v[84:87], v[152:155], a[8:11]
    ds_read_b128 v[68:71], v9 offset:4096
    v_add_u32 v12, s65, v12
    v_mfma_f32_16x16x32_bf16 a[12:15], v[80:83], v[140:143], a[12:15]
    v_exp_f32 v55, v55
    v_mfma_f32_16x16x32_bf16 a[12:15], v[84:87], v[156:159], a[12:15]
    ds_read_b128 v[72:75], v10 offset:4096
    v_cvt_pk_bf16_f32 v101, v54, v55
    v_mfma_f32_16x16x32_bf16 a[16:19], v[88:91], v[128:131], a[16:19]
    v_exp_f32 v56, v56
    v_mfma_f32_16x16x32_bf16 a[16:19], v[92:95], v[144:147], a[16:19]
    ds_read_b128 v[76:79], v11 offset:4096
    v_add_u32 v13, s65, v13
    v_mfma_f32_16x16x32_bf16 a[20:23], v[88:91], v[132:135], a[20:23]
    v_exp_f32 v57, v57
    v_mfma_f32_16x16x32_bf16 a[20:23], v[92:95], v[148:151], a[20:23]
    buffer_load_dwordx4 a[180:183], v27, s[40:43], s48 offen offset:1024 sc1
    v_cvt_pk_bf16_f32 v104, v56, v57
    v_mfma_f32_16x16x32_bf16 a[24:27], v[88:91], v[136:139], a[24:27]
    v_exp_f32 v58, v58
    v_mfma_f32_16x16x32_bf16 a[24:27], v[92:95], v[152:155], a[24:27]
    ds_read_b64_tr_b16 v[80:81], v14
    v_mfma_f32_16x16x32_bf16 a[28:31], v[88:91], v[140:143], a[28:31]
    v_exp_f32 v59, v59
    v_mfma_f32_16x16x32_bf16 a[28:31], v[92:95], v[156:159], a[28:31]
    ds_read_b64_tr_b16 v[82:83], v14 offset:4096
    v_cvt_pk_bf16_f32 v105, v58, v59
    v_mfma_f32_16x16x32_bf16 v[228:231], v[224:227], v[128:131], v[228:231]
    s_waitcnt lgkmcnt(2)
    v_exp_f32 v60, v60
    v_mfma_f32_16x16x32_bf16 v[228:231], v[224:227], v[144:147], v[228:231]
    ds_read_b64_tr_b16 v[84:85], v14 offset:8192
    v_mfma_f32_16x16x32_bf16 v[48:51], v[64:67], v[160:163], v[32:35]
    v_exp_f32 v61, v61
    v_mfma_f32_16x16x32_bf16 v[48:51], v[68:71], v[164:167], v[48:51]
    ds_read_b64_tr_b16 v[86:87], v14 offset:12288
    v_cvt_pk_bf16_f32 v108, v60, v61
    v_mfma_f32_16x16x32_bf16 v[48:51], v[72:75], v[168:171], v[48:51]
    s_add_u32 s34, s34, 16384
    v_exp_f32 v62, v62
    v_mfma_f32_16x16x32_bf16 v[48:51], v[76:79], v[172:175], v[48:51]
    ds_read_b64_tr_b16 v[88:89], v15
    v_mfma_f32_16x16x32_bf16 v[52:55], v[64:67], v[176:179], v[36:39]
    s_cmp_eq_u32 s34, 81920
    v_exp_f32 v63, v63
    v_mfma_f32_16x16x32_bf16 v[52:55], v[68:71], v[180:183], v[52:55]
    ds_read_b64_tr_b16 v[90:91], v15 offset:4096
    v_cvt_pk_bf16_f32 v109, v62, v63
    v_mfma_f32_16x16x32_bf16 v[52:55], v[72:75], v[184:187], v[52:55]
    s_cselect_b32 s64, 0xffff0000, s73
    buffer_load_dwordx4 a[184:187], v27, s[40:43], s49 offen sc1
    v_mfma_f32_16x16x32_bf16 v[52:55], v[76:79], v[188:191], v[52:55]
    ds_read_b64_tr_b16 v[92:93], v15 offset:8192
    v_mfma_f32_16x16x32_bf16 v[56:59], v[64:67], v[192:195], v[40:43]
    s_cselect_b32 s34, 0, s34
    v_exp_f32 v48, v48
    v_mfma_f32_16x16x32_bf16 v[56:59], v[68:71], v[196:199], v[56:59]
    ds_read_b64_tr_b16 v[94:95], v15 offset:12288
    v_mfma_f32_16x16x32_bf16 v[56:59], v[72:75], v[200:203], v[56:59]
    v_exp_f32 v49, v49
    v_mfma_f32_16x16x32_bf16 v[56:59], v[76:79], v[204:207], v[56:59]
    buffer_load_dwordx4 a[188:191], v27, s[40:43], s49 offen offset:1024 sc1
    v_cvt_pk_bf16_f32 v98, v48, v49
    v_mfma_f32_16x16x32_bf16 v[60:63], v[64:67], v[208:211], v[44:47]
    s_mov_b32 s48, 0
    v_exp_f32 v50, v50
    s_mov_b32 s49, 131072
    v_mfma_f32_16x16x32_bf16 v[60:63], v[68:71], v[212:215], v[60:63]
    buffer_load_dwordx4 a[192:195], v27, s[40:43], s48 offen offset:2048 sc1
    v_mfma_f32_16x16x32_bf16 v[60:63], v[72:75], v[216:219], v[60:63]
    s_waitcnt lgkmcnt(0)
    v_exp_f32 v51, v51
    v_mfma_f32_16x16x32_bf16 v[60:63], v[76:79], v[220:223], v[60:63]
    buffer_load_dwordx4 a[196:199], v27, s[40:43], s48 offen offset:3072 sc1
    v_cvt_pk_bf16_f32 v99, v50, v51
    v_mfma_f32_16x16x32_bf16 a[32:35], v[80:83], v[128:131], a[32:35]
    v_exp_f32 v52, v52
    v_mfma_f32_16x16x32_bf16 a[32:35], v[84:87], v[144:147], a[32:35]
    buffer_load_dwordx4 a[200:203], v27, s[40:43], s49 offen offset:2048 sc1
    v_mfma_f32_16x16x32_bf16 a[36:39], v[80:83], v[132:135], a[36:39]
    v_exp_f32 v53, v53
    v_mfma_f32_16x16x32_bf16 a[36:39], v[84:87], v[148:151], a[36:39]
    ds_read_b128 v[64:67], v8 offset:8192
    v_cvt_pk_bf16_f32 v102, v52, v53
    v_mfma_f32_16x16x32_bf16 a[40:43], v[80:83], v[136:139], a[40:43]
    v_exp_f32 v54, v54
    v_mfma_f32_16x16x32_bf16 a[40:43], v[84:87], v[152:155], a[40:43]
    ds_read_b128 v[68:71], v9 offset:8192
    v_add_u32 v14, s65, v14
    v_mfma_f32_16x16x32_bf16 a[44:47], v[80:83], v[140:143], a[44:47]
    v_exp_f32 v55, v55
    v_mfma_f32_16x16x32_bf16 a[44:47], v[84:87], v[156:159], a[44:47]
    ds_read_b128 v[72:75], v10 offset:8192
    v_cvt_pk_bf16_f32 v103, v54, v55
    v_mfma_f32_16x16x32_bf16 a[48:51], v[88:91], v[128:131], a[48:51]
    v_exp_f32 v56, v56
    v_mfma_f32_16x16x32_bf16 a[48:51], v[92:95], v[144:147], a[48:51]
    ds_read_b128 v[76:79], v11 offset:8192
    v_add_u32 v15, s65, v15
    v_mfma_f32_16x16x32_bf16 a[52:55], v[88:91], v[132:135], a[52:55]
    v_exp_f32 v57, v57
    v_mfma_f32_16x16x32_bf16 a[52:55], v[92:95], v[148:151], a[52:55]
    buffer_load_dwordx4 a[204:207], v27, s[40:43], s49 offen offset:3072 sc1
    v_cvt_pk_bf16_f32 v106, v56, v57
    v_mfma_f32_16x16x32_bf16 a[56:59], v[88:91], v[136:139], a[56:59]
    v_exp_f32 v58, v58
    v_mfma_f32_16x16x32_bf16 a[56:59], v[92:95], v[152:155], a[56:59]
    ds_read_b64_tr_b16 v[80:81], v16
    v_mfma_f32_16x16x32_bf16 a[60:63], v[88:91], v[140:143], a[60:63]
    v_exp_f32 v59, v59
    v_mfma_f32_16x16x32_bf16 a[60:63], v[92:95], v[156:159], a[60:63]
    ds_read_b64_tr_b16 v[82:83], v16 offset:4096
    v_cvt_pk_bf16_f32 v107, v58, v59
    v_mfma_f32_16x16x32_bf16 v[232:235], v[224:227], v[132:135], v[232:235]
    s_waitcnt lgkmcnt(2)
    v_exp_f32 v60, v60
    v_mfma_f32_16x16x32_bf16 v[232:235], v[224:227], v[148:151], v[232:235]
    ds_read_b64_tr_b16 v[84:85], v16 offset:8192
    v_mfma_f32_16x16x32_bf16 v[48:51], v[64:67], v[160:163], v[32:35]
    v_exp_f32 v61, v61
    v_mfma_f32_16x16x32_bf16 v[48:51], v[68:71], v[164:167], v[48:51]
    ds_read_b64_tr_b16 v[86:87], v16 offset:12288
    v_cvt_pk_bf16_f32 v110, v60, v61
    v_mfma_f32_16x16x32_bf16 v[48:51], v[72:75], v[168:171], v[48:51]
    s_mov_b32 s66, 327680
    v_exp_f32 v62, v62
    v_mfma_f32_16x16x32_bf16 v[48:51], v[76:79], v[172:175], v[48:51]
    ds_read_b64_tr_b16 v[88:89], v17
    v_mfma_f32_16x16x32_bf16 v[52:55], v[64:67], v[176:179], v[36:39]
    s_add_u32 m0, s29, 81920
    v_exp_f32 v63, v63
    v_mfma_f32_16x16x32_bf16 v[52:55], v[68:71], v[180:183], v[52:55]
    s_mov_b32 s48, 8192
    ds_read_b64_tr_b16 v[90:91], v17 offset:4096
    v_cvt_pk_bf16_f32 v111, v62, v63
    s_mov_b32 s49, 139264
    v_mfma_f32_16x16x32_bf16 v[52:55], v[72:75], v[184:187], v[52:55]
    buffer_load_dwordx4 a[208:211], v27, s[40:43], s48 offen offset:2048 sc1
    v_mfma_f32_16x16x32_bf16 v[52:55], v[76:79], v[188:191], v[52:55]
    ds_read_b64_tr_b16 v[92:93], v17 offset:8192
    v_mfma_f32_16x16x32_bf16 v[56:59], v[64:67], v[192:195], v[40:43]
    v_exp_f32 v48, v48
    v_mfma_f32_16x16x32_bf16 v[56:59], v[68:71], v[196:199], v[56:59]
    ds_read_b64_tr_b16 v[94:95], v17 offset:12288
    v_mfma_f32_16x16x32_bf16 v[56:59], v[72:75], v[200:203], v[56:59]
    v_exp_f32 v49, v49
    v_mfma_f32_16x16x32_bf16 v[56:59], v[76:79], v[204:207], v[56:59]
    buffer_load_dwordx4 v20, s[36:39], s66 offen lds
    v_cvt_pk_bf16_f32 v112, v48, v49
    v_mfma_f32_16x16x32_bf16 v[60:63], v[64:67], v[208:211], v[44:47]
    v_exp_f32 v50, v50
    v_mfma_f32_16x16x32_bf16 v[60:63], v[68:71], v[212:215], v[60:63]
    s_add_u32 s23, s23, 2
    buffer_load_dwordx4 v21, s[36:39], s66 offen offset:1024 lds
    v_mfma_f32_16x16x32_bf16 v[60:63], v[72:75], v[216:219], v[60:63]
    s_waitcnt lgkmcnt(0)
    v_exp_f32 v51, v51
    v_mfma_f32_16x16x32_bf16 v[60:63], v[76:79], v[220:223], v[60:63]
    buffer_load_dwordx4 v22, s[36:39], s66 offen offset:2048 lds
    v_cvt_pk_bf16_f32 v113, v50, v51
    v_mfma_f32_16x16x32_bf16 a[64:67], v[80:83], v[128:131], a[64:67]
    s_lshl_b32 s93, s93, 8
    v_exp_f32 v52, v52
    v_mfma_f32_16x16x32_bf16 a[64:67], v[84:87], v[144:147], a[64:67]
    s_or_b32 s93, s93, s23
    buffer_load_dwordx4 v23, s[36:39], s66 offen offset:3072 lds
    v_mfma_f32_16x16x32_bf16 a[68:71], v[80:83], v[132:135], a[68:71]
    v_exp_f32 v53, v53
    v_mfma_f32_16x16x32_bf16 a[68:71], v[84:87], v[148:151], a[68:71]
    ds_read_b128 v[64:67], v8 offset:12288
    v_cvt_pk_bf16_f32 v116, v52, v53
    v_mfma_f32_16x16x32_bf16 a[72:75], v[80:83], v[136:139], a[72:75]
    v_exp_f32 v54, v54
    v_mfma_f32_16x16x32_bf16 a[72:75], v[84:87], v[152:155], a[72:75]
    ds_read_b128 v[68:71], v9 offset:12288
    v_add_u32 v16, s65, v16
    v_mfma_f32_16x16x32_bf16 a[76:79], v[80:83], v[140:143], a[76:79]
    v_exp_f32 v55, v55
    v_mfma_f32_16x16x32_bf16 a[76:79], v[84:87], v[156:159], a[76:79]
    ds_read_b128 v[72:75], v10 offset:12288
    v_cvt_pk_bf16_f32 v117, v54, v55
    v_mfma_f32_16x16x32_bf16 a[80:83], v[88:91], v[128:131], a[80:83]
    v_exp_f32 v56, v56
    v_mfma_f32_16x16x32_bf16 a[80:83], v[92:95], v[144:147], a[80:83]
    ds_read_b128 v[76:79], v11 offset:12288
    v_add_u32 v17, s65, v17
    v_mfma_f32_16x16x32_bf16 a[84:87], v[88:91], v[132:135], a[84:87]
    v_exp_f32 v57, v57
    v_mfma_f32_16x16x32_bf16 a[84:87], v[92:95], v[148:151], a[84:87]
    buffer_load_dwordx4 a[212:215], v27, s[40:43], s48 offen offset:3072 sc1
    v_cvt_pk_bf16_f32 v120, v56, v57
    v_mfma_f32_16x16x32_bf16 a[88:91], v[88:91], v[136:139], a[88:91]
    s_bfe_u32 s76, s92, s20
    v_exp_f32 v58, v58
    v_mfma_f32_16x16x32_bf16 a[88:91], v[92:95], v[152:155], a[88:91]
    ds_read_b64_tr_b16 v[80:81], v18
    v_mfma_f32_16x16x32_bf16 a[92:95], v[88:91], v[140:143], a[92:95]
    s_bfe_u32 s94, s93, s21
    v_exp_f32 v59, v59
    v_mfma_f32_16x16x32_bf16 a[92:95], v[92:95], v[156:159], a[92:95]
    ds_read_b64_tr_b16 v[82:83], v18 offset:4096
    v_cvt_pk_bf16_f32 v121, v58, v59
    v_mfma_f32_16x16x32_bf16 v[236:239], v[224:227], v[136:139], v[236:239]
    s_waitcnt lgkmcnt(2)
    v_exp_f32 v60, v60
    v_mfma_f32_16x16x32_bf16 v[236:239], v[224:227], v[152:155], v[236:239]
    ds_read_b64_tr_b16 v[84:85], v18 offset:8192
    v_mfma_f32_16x16x32_bf16 v[48:51], v[64:67], v[160:163], v[32:35]
    s_max_u32 s76, s76, s94
    v_exp_f32 v61, v61
    v_mfma_f32_16x16x32_bf16 v[48:51], v[68:71], v[164:167], v[48:51]
    ds_read_b64_tr_b16 v[86:87], v18 offset:12288
    v_cvt_pk_bf16_f32 v124, v60, v61
    v_mfma_f32_16x16x32_bf16 v[48:51], v[72:75], v[168:171], v[48:51]
    s_sub_u32 s76, s23, s76
    v_exp_f32 v62, v62
    v_mfma_f32_16x16x32_bf16 v[48:51], v[76:79], v[172:175], v[48:51]
    ds_read_b64_tr_b16 v[88:89], v19
    v_add_u32 v8, s64, v8
    v_mfma_f32_16x16x32_bf16 v[52:55], v[64:67], v[176:179], v[36:39]
L_hop13:
    s_cbranch_execz L_hop17
    s_lshl_b32 s76, s76, 1
    v_exp_f32 v63, v63
    v_mfma_f32_16x16x32_bf16 v[52:55], v[68:71], v[180:183], v[52:55]
    ds_read_b64_tr_b16 v[90:91], v19 offset:4096
    v_cvt_pk_bf16_f32 v125, v62, v63
    v_mfma_f32_16x16x32_bf16 v[52:55], v[72:75], v[184:187], v[52:55]
    buffer_load_dwordx4 a[216:219], v27, s[40:43], s49 offen offset:2048 sc1
    v_mfma_f32_16x16x32_bf16 v[52:55], v[76:79], v[188:191], v[52:55]
    ds_read_b64_tr_b16 v[92:93], v19 offset:8192
    v_add_u32 v9, s64, v9
    v_mfma_f32_16x16x32_bf16 v[56:59], v[64:67], v[192:195], v[40:43]
    v_exp_f32 v48, v48
    v_mfma_f32_16x16x32_bf16 v[56:59], v[68:71], v[196:199], v[56:59]
    ds_read_b64_tr_b16 v[94:95], v19 offset:12288
    v_add_u32 v10, s64, v10
    v_mfma_f32_16x16x32_bf16 v[56:59], v[72:75], v[200:203], v[56:59]
    v_exp_f32 v49, v49
    v_mfma_f32_16x16x32_bf16 v[56:59], v[76:79], v[204:207], v[56:59]
    buffer_load_dwordx4 a[220:223], v27, s[40:43], s49 offen offset:3072 sc1
    v_cvt_pk_bf16_f32 v114, v48, v49
    v_mfma_f32_16x16x32_bf16 v[60:63], v[64:67], v[208:211], v[44:47]
    s_getreg_b32 s66, hwreg(HW_REG_IB_STS, 22, 2)
    v_exp_f32 v50, v50
    v_mfma_f32_16x16x32_bf16 v[60:63], v[68:71], v[212:215], v[60:63]
    s_getreg_b32 s94, hwreg(HW_REG_IB_STS, 0, 4)
    s_lshl4_add_u32 s94, s66, s94
    v_add_u32 v11, s64, v11
    v_mfma_f32_16x16x32_bf16 v[60:63], v[72:75], v[216:219], v[60:63]
    s_waitcnt lgkmcnt(0)
    v_exp_f32 v51, v51
    v_mfma_f32_16x16x32_bf16 v[60:63], v[76:79], v[220:223], v[60:63]
    v_cvt_pk_bf16_f32 v115, v50, v51
    v_mfma_f32_16x16x32_bf16 a[96:99], v[80:83], v[128:131], a[96:99]
    s_cmp_gt_i32 s94, s76
    v_exp_f32 v52, v52
    v_mfma_f32_16x16x32_bf16 a[96:99], v[84:87], v[144:147], a[96:99]
    s_cbranch_scc1 L_lw_pl2
L_bb_pl2:
    s_waitcnt vmcnt(44)
    s_barrier
    v_mfma_f32_16x16x32_bf16 a[100:103], v[80:83], v[132:135], a[100:103]
    v_exp_f32 v53, v53
    v_mfma_f32_16x16x32_bf16 a[100:103], v[84:87], v[148:151], a[100:103]
    ds_read_b128 v[64:67], v8
    v_cvt_pk_bf16_f32 v118, v52, v53
    v_mfma_f32_16x16x32_bf16 a[104:107], v[80:83], v[136:139], a[104:107]
    v_exp_f32 v54, v54
    v_mfma_f32_16x16x32_bf16 a[104:107], v[84:87], v[152:155], a[104:107]
    ds_read_b128 v[68:71], v9
    v_add_u32 v18, s65, v18
    v_mfma_f32_16x16x32_bf16 a[108:111], v[80:83], v[140:143], a[108:111]
    v_exp_f32 v55, v55
    v_mfma_f32_16x16x32_bf16 a[108:111], v[84:87], v[156:159], a[108:111]
    ds_read_b128 v[72:75], v10
    v_cvt_pk_bf16_f32 v119, v54, v55
    v_mfma_f32_16x16x32_bf16 a[112:115], v[88:91], v[128:131], a[112:115]
    v_exp_f32 v56, v56
    v_mfma_f32_16x16x32_bf16 a[112:115], v[92:95], v[144:147], a[112:115]
    ds_read_b128 v[76:79], v11
    v_add_u32 v19, s65, v19
    v_mfma_f32_16x16x32_bf16 a[116:119], v[88:91], v[132:135], a[116:119]
    v_exp_f32 v57, v57
    v_mfma_f32_16x16x32_bf16 a[116:119], v[92:95], v[148:151], a[116:119]
    v_cvt_pk_bf16_f32 v122, v56, v57
    v_mfma_f32_16x16x32_bf16 a[120:123], v[88:91], v[136:139], a[120:123]
    v_exp_f32 v58, v58
    v_mfma_f32_16x16x32_bf16 a[120:123], v[92:95], v[152:155], a[120:123]
    ds_read_b64_tr_b16 v[80:81], v12
    v_mfma_f32_16x16x32_bf16 a[124:127], v[88:91], v[140:143], a[124:127]
    v_exp_f32 v59, v59
    v_mfma_f32_16x16x32_bf16 a[124:127], v[92:95], v[156:159], a[124:127]
    ds_read_b64_tr_b16 v[82:83], v12 offset:4096
    v_cvt_pk_bf16_f32 v123, v58, v59
    v_mfma_f32_16x16x32_bf16 v[240:243], v[224:227], v[140:143], v[240:243]
    s_waitcnt lgkmcnt(2)
    v_exp_f32 v60, v60
    v_mfma_f32_16x16x32_bf16 v[240:243], v[224:227], v[156:159], v[240:243]
    ds_read_b64_tr_b16 v[84:85], v12 offset:8192
    v_mfma_f32_16x16x32_bf16 v[48:51], v[64:67], v[160:163], v[32:35]
    v_exp_f32 v61, v61
    v_mfma_f32_16x16x32_bf16 v[48:51], v[68:71], v[164:167], v[48:51]
    ds_read_b64_tr_b16 v[86:87], v12 offset:12288
    v_cvt_pk_bf16_f32 v126, v60, v61
    v_mfma_f32_16x16x32_bf16 v[48:51], v[72:75], v[168:171], v[48:51]
    s_mov_b32 s66, 786432
    v_exp_f32 v62, v62
    v_mfma_f32_16x16x32_bf16 v[48:51], v[76:79], v[172:175], v[48:51]
    s_add_u32 s23, s23, 4
    ds_read_b64_tr_b16 v[88:89], v13
    v_mfma_f32_16x16x32_bf16 v[52:55], v[64:67], v[176:179], v[36:39]
    s_add_u32 m0, s29, 0
    v_exp_f32 v63, v63
    v_mfma_f32_16x16x32_bf16 v[52:55], v[68:71], v[180:183], v[52:55]
    s_mov_b32 s48, 16384
    ds_read_b64_tr_b16 v[90:91], v13 offset:4096
    v_cvt_pk_bf16_f32 v127, v62, v63
    s_mov_b32 s49, 147456
    v_mfma_f32_16x16x32_bf16 v[52:55], v[72:75], v[184:187], v[52:55]
    buffer_load_dwordx4 a[224:227], v27, s[40:43], s48 offen offset:2048 sc1
    v_mfma_f32_16x16x32_bf16 v[52:55], v[76:79], v[188:191], v[52:55]
    s_add_u32 s35, s35, 16384
    ds_read_b64_tr_b16 v[92:93], v13 offset:8192
    v_mfma_f32_16x16x32_bf16 v[56:59], v[64:67], v[192:195], v[40:43]
    s_cmp_eq_u32 s35, 81920
    v_exp_f32 v48, v48
    v_mfma_f32_16x16x32_bf16 v[56:59], v[68:71], v[196:199], v[56:59]
    s_cselect_b32 s65, 0xffff0000, s73
    ds_read_b64_tr_b16 v[94:95], v13 offset:12288
    v_mfma_f32_16x16x32_bf16 v[56:59], v[72:75], v[200:203], v[56:59]
    v_exp_f32 v49, v49
    v_mfma_f32_16x16x32_bf16 v[56:59], v[76:79], v[204:207], v[56:59]
    buffer_load_dwordx4 v20, s[36:39], s66 offen lds
    v_cvt_pk_bf16_f32 v128, v48, v49
    v_mfma_f32_16x16x32_bf16 v[60:63], v[64:67], v[208:211], v[44:47]
    s_cselect_b32 s35, 0, s35
    v_exp_f32 v50, v50
    v_mfma_f32_16x16x32_bf16 v[60:63], v[68:71], v[212:215], v[60:63]
    s_add_u32 s23, s23, 2
    buffer_load_dwordx4 v21, s[36:39], s66 offen offset:1024 lds
    v_mfma_f32_16x16x32_bf16 v[60:63], v[72:75], v[216:219], v[60:63]
    s_waitcnt lgkmcnt(0)
    v_exp_f32 v51, v51
    v_mfma_f32_16x16x32_bf16 v[60:63], v[76:79], v[220:223], v[60:63]
    buffer_load_dwordx4 v22, s[36:39], s66 offen offset:2048 lds
    v_cvt_pk_bf16_f32 v129, v50, v51
    v_mfma_f32_16x16x32_bf16 a[0:3], v[80:83], v[96:99], a[0:3]
    s_lshl_b32 s92, s92, 8
    v_exp_f32 v52, v52
    v_mfma_f32_16x16x32_bf16 a[0:3], v[84:87], v[112:115], a[0:3]
    s_or_b32 s92, s92, s23
    buffer_load_dwordx4 v23, s[36:39], s66 offen offset:3072 lds
    v_mfma_f32_16x16x32_bf16 a[4:7], v[80:83], v[100:103], a[4:7]
    v_exp_f32 v53, v53
    v_mfma_f32_16x16x32_bf16 a[4:7], v[84:87], v[116:119], a[4:7]
    ds_read_b128 v[64:67], v8 offset:4096
    v_cvt_pk_bf16_f32 v132, v52, v53
    v_mfma_f32_16x16x32_bf16 a[8:11], v[80:83], v[104:107], a[8:11]
    v_exp_f32 v54, v54
    v_mfma_f32_16x16x32_bf16 a[8:11], v[84:87], v[120:123], a[8:11]
    ds_read_b128 v[68:71], v9 offset:4096
    v_add_u32 v12, s65, v12
    v_mfma_f32_16x16x32_bf16 a[12:15], v[80:83], v[108:111], a[12:15]
    v_exp_f32 v55, v55
    v_mfma_f32_16x16x32_bf16 a[12:15], v[84:87], v[124:127], a[12:15]
    ds_read_b128 v[72:75], v10 offset:4096
    v_cvt_pk_bf16_f32 v133, v54, v55
    v_mfma_f32_16x16x32_bf16 a[16:19], v[88:91], v[96:99], a[16:19]
    v_exp_f32 v56, v56
    v_mfma_f32_16x16x32_bf16 a[16:19], v[92:95], v[112:115], a[16:19]
    ds_read_b128 v[76:79], v11 offset:4096
    v_add_u32 v13, s65, v13
    v_mfma_f32_16x16x32_bf16 a[20:23], v[88:91], v[100:103], a[20:23]
    v_exp_f32 v57, v57
    v_mfma_f32_16x16x32_bf16 a[20:23], v[92:95], v[116:119], a[20:23]
    buffer_load_dwordx4 a[228:231], v27, s[40:43], s48 offen offset:3072 sc1
    v_cvt_pk_bf16_f32 v136, v56, v57
    v_mfma_f32_16x16x32_bf16 a[24:27], v[88:91], v[104:107], a[24:27]
    v_exp_f32 v58, v58
    v_mfma_f32_16x16x32_bf16 a[24:27], v[92:95], v[120:123], a[24:27]
    ds_read_b64_tr_b16 v[80:81], v14
    v_mfma_f32_16x16x32_bf16 a[28:31], v[88:91], v[108:111], a[28:31]
    v_exp_f32 v59, v59
    v_mfma_f32_16x16x32_bf16 a[28:31], v[92:95], v[124:127], a[28:31]
    ds_read_b64_tr_b16 v[82:83], v14 offset:4096
    v_cvt_pk_bf16_f32 v137, v58, v59
    v_mfma_f32_16x16x32_bf16 v[228:231], v[224:227], v[96:99], v[228:231]
    s_waitcnt lgkmcnt(2)
    v_exp_f32 v60, v60
    v_mfma_f32_16x16x32_bf16 v[228:231], v[224:227], v[112:115], v[228:231]
    ds_read_b64_tr_b16 v[84:85], v14 offset:8192
    v_mfma_f32_16x16x32_bf16 v[48:51], v[64:67], v[160:163], v[32:35]
    v_exp_f32 v61, v61
    v_mfma_f32_16x16x32_bf16 v[48:51], v[68:71], v[164:167], v[48:51]
    ds_read_b64_tr_b16 v[86:87], v14 offset:12288
    v_cvt_pk_bf16_f32 v140, v60, v61
    v_mfma_f32_16x16x32_bf16 v[48:51], v[72:75], v[168:171], v[48:51]
    s_add_u32 s34, s34, 16384
    v_exp_f32 v62, v62
    v_mfma_f32_16x16x32_bf16 v[48:51], v[76:79], v[172:175], v[48:51]
    ds_read_b64_tr_b16 v[88:89], v15
    v_mfma_f32_16x16x32_bf16 v[52:55], v[64:67], v[176:179], v[36:39]
    s_cmp_eq_u32 s34, 81920
    v_exp_f32 v63, v63
    v_mfma_f32_16x16x32_bf16 v[52:55], v[68:71], v[180:183], v[52:55]
    ds_read_b64_tr_b16 v[90:91], v15 offset:4096
    v_cvt_pk_bf16_f32 v141, v62, v63
    v_mfma_f32_16x16x32_bf16 v[52:55], v[72:75], v[184:187], v[52:55]
    s_cselect_b32 s64, 0xffff0000, s73
    buffer_load_dwordx4 a[232:235], v27, s[40:43], s49 offen offset:2048 sc1
    v_mfma_f32_16x16x32_bf16 v[52:55], v[76:79], v[188:191], v[52:55]
    ds_read_b64_tr_b16 v[92:93], v15 offset:8192
    v_mfma_f32_16x16x32_bf16 v[56:59], v[64:67], v[192:195], v[40:43]
    s_cselect_b32 s34, 0, s34
    v_exp_f32 v48, v48
    v_mfma_f32_16x16x32_bf16 v[56:59], v[68:71], v[196:199], v[56:59]
    ds_read_b64_tr_b16 v[94:95], v15 offset:12288
    v_mfma_f32_16x16x32_bf16 v[56:59], v[72:75], v[200:203], v[56:59]
    v_exp_f32 v49, v49
    v_mfma_f32_16x16x32_bf16 v[56:59], v[76:79], v[204:207], v[56:59]
    buffer_load_dwordx4 a[236:239], v27, s[40:43], s49 offen offset:3072 sc1
    v_cvt_pk_bf16_f32 v130, v48, v49
    v_mfma_f32_16x16x32_bf16 v[60:63], v[64:67], v[208:211], v[44:47]
    s_mov_b32 s48, 24576
    v_exp_f32 v50, v50
    s_mov_b32 s49, 155648
    v_mfma_f32_16x16x32_bf16 v[60:63], v[68:71], v[212:215], v[60:63]
    buffer_load_dwordx4 a[240:243], v27, s[40:43], s48 offen offset:2048 sc1
    v_mfma_f32_16x16x32_bf16 v[60:63], v[72:75], v[216:219], v[60:63]
    s_waitcnt lgkmcnt(0)
    v_exp_f32 v51, v51
    v_mfma_f32_16x16x32_bf16 v[60:63], v[76:79], v[220:223], v[60:63]
    buffer_load_dwordx4 a[244:247], v27, s[40:43], s48 offen offset:3072 sc1
    v_cvt_pk_bf16_f32 v131, v50, v51
    v_mfma_f32_16x16x32_bf16 a[32:35], v[80:83], v[96:99], a[32:35]
    v_exp_f32 v52, v52
    v_mfma_f32_16x16x32_bf16 a[32:35], v[84:87], v[112:115], a[32:35]
    buffer_load_dwordx4 a[248:251], v27, s[40:43], s49 offen offset:2048 sc1
    v_mfma_f32_16x16x32_bf16 a[36:39], v[80:83], v[100:103], a[36:39]
    v_exp_f32 v53, v53
    v_mfma_f32_16x16x32_bf16 a[36:39], v[84:87], v[116:119], a[36:39]
    ds_read_b128 v[64:67], v8 offset:8192
    v_cvt_pk_bf16_f32 v134, v52, v53
    v_mfma_f32_16x16x32_bf16 a[40:43], v[80:83], v[104:107], a[40:43]
    v_exp_f32 v54, v54
    v_mfma_f32_16x16x32_bf16 a[40:43], v[84:87], v[120:123], a[40:43]
    ds_read_b128 v[68:71], v9 offset:8192
    v_add_u32 v14, s65, v14
    v_mfma_f32_16x16x32_bf16 a[44:47], v[80:83], v[108:111], a[44:47]
    v_exp_f32 v55, v55
    v_mfma_f32_16x16x32_bf16 a[44:47], v[84:87], v[124:127], a[44:47]
    ds_read_b128 v[72:75], v10 offset:8192
    v_cvt_pk_bf16_f32 v135, v54, v55
    v_mfma_f32_16x16x32_bf16 a[48:51], v[88:91], v[96:99], a[48:51]
    v_exp_f32 v56, v56
    v_mfma_f32_16x16x32_bf16 a[48:51], v[92:95], v[112:115], a[48:51]
    ds_read_b128 v[76:79], v11 offset:8192
    v_add_u32 v15, s65, v15
    v_mfma_f32_16x16x32_bf16 a[52:55], v[88:91], v[100:103], a[52:55]
    v_exp_f32 v57, v57
    v_mfma_f32_16x16x32_bf16 a[52:55], v[92:95], v[116:119], a[52:55]
    buffer_load_dwordx4 a[252:255], v27, s[40:43], s49 offen offset:3072 sc1
    v_cvt_pk_bf16_f32 v138, v56, v57
    v_mfma_f32_16x16x32_bf16 a[56:59], v[88:91], v[104:107], a[56:59]
    v_exp_f32 v58, v58
    v_mfma_f32_16x16x32_bf16 a[56:59], v[92:95], v[120:123], a[56:59]
    ds_read_b64_tr_b16 v[80:81], v16
    v_mfma_f32_16x16x32_bf16 a[60:63], v[88:91], v[108:111], a[60:63]
    v_exp_f32 v59, v59
    v_mfma_f32_16x16x32_bf16 a[60:63], v[92:95], v[124:127], a[60:63]
    ds_read_b64_tr_b16 v[82:83], v16 offset:4096
    v_cvt_pk_bf16_f32 v139, v58, v59
    v_mfma_f32_16x16x32_bf16 v[232:235], v[224:227], v[100:103], v[232:235]
    s_waitcnt lgkmcnt(2)
    v_exp_f32 v60, v60
    v_mfma_f32_16x16x32_bf16 v[232:235], v[224:227], v[116:119], v[232:235]
    ds_read_b64_tr_b16 v[84:85], v16 offset:8192
    v_mfma_f32_16x16x32_bf16 v[48:51], v[64:67], v[160:163], v[32:35]
    v_exp_f32 v61, v61
    v_mfma_f32_16x16x32_bf16 v[48:51], v[68:71], v[164:167], v[48:51]
    ds_read_b64_tr_b16 v[86:87], v16 offset:12288
    v_cvt_pk_bf16_f32 v142, v60, v61
    v_mfma_f32_16x16x32_bf16 v[48:51], v[72:75], v[168:171], v[48:51]
    s_mov_b32 s66, 589824
    v_exp_f32 v62, v62
    v_mfma_f32_16x16x32_bf16 v[48:51], v[76:79], v[172:175], v[48:51]
    ds_read_b64_tr_b16 v[88:89], v17
    v_mfma_f32_16x16x32_bf16 v[52:55], v[64:67], v[176:179], v[36:39]
    s_add_u32 m0, s29, 98304
    v_exp_f32 v63, v63
    v_mfma_f32_16x16x32_bf16 v[52:55], v[68:71], v[180:183], v[52:55]
    ds_read_b64_tr_b16 v[90:91], v17 offset:4096
    v_cvt_pk_bf16_f32 v143, v62, v63
    v_mfma_f32_16x16x32_bf16 v[52:55], v[72:75], v[184:187], v[52:55]
    v_mfma_f32_16x16x32_bf16 v[52:55], v[76:79], v[188:191], v[52:55]
    ds_read_b64_tr_b16 v[92:93], v17 offset:8192
    v_mfma_f32_16x16x32_bf16 v[56:59], v[64:67], v[192:195], v[40:43]
    v_exp_f32 v48, v48
    v_mfma_f32_16x16x32_bf16 v[56:59], v[68:71], v[196:199], v[56:59]
    ds_read_b64_tr_b16 v[94:95], v17 offset:12288
    v_mfma_f32_16x16x32_bf16 v[56:59], v[72:75], v[200:203], v[56:59]
    v_exp_f32 v49, v49
    v_mfma_f32_16x16x32_bf16 v[56:59], v[76:79], v[204:207], v[56:59]
    buffer_load_dwordx4 v20, s[36:39], s66 offen lds
    v_cvt_pk_bf16_f32 v144, v48, v49
    v_mfma_f32_16x16x32_bf16 v[60:63], v[64:67], v[208:211], v[44:47]
    v_exp_f32 v50, v50
    v_mfma_f32_16x16x32_bf16 v[60:63], v[68:71], v[212:215], v[60:63]
    s_add_u32 s23, s23, 2
    buffer_load_dwordx4 v21, s[36:39], s66 offen offset:1024 lds
    v_mfma_f32_16x16x32_bf16 v[60:63], v[72:75], v[216:219], v[60:63]
    s_waitcnt lgkmcnt(0)
    v_exp_f32 v51, v51
    v_mfma_f32_16x16x32_bf16 v[60:63], v[76:79], v[220:223], v[60:63]
    buffer_load_dwordx4 v22, s[36:39], s66 offen offset:2048 lds
    v_cvt_pk_bf16_f32 v145, v50, v51
    v_mfma_f32_16x16x32_bf16 a[64:67], v[80:83], v[96:99], a[64:67]
    s_lshl_b32 s93, s93, 8
    v_exp_f32 v52, v52
    v_mfma_f32_16x16x32_bf16 a[64:67], v[84:87], v[112:115], a[64:67]
    s_or_b32 s93, s93, s23
    buffer_load_dwordx4 v23, s[36:39], s66 offen offset:3072 lds
    v_mfma_f32_16x16x32_bf16 a[68:71], v[80:83], v[100:103], a[68:71]
    v_exp_f32 v53, v53
    v_mfma_f32_16x16x32_bf16 a[68:71], v[84:87], v[116:119], a[68:71]
    ds_read_b128 v[64:67], v8 offset:12288
    v_cvt_pk_bf16_f32 v148, v52, v53
    v_mfma_f32_16x16x32_bf16 a[72:75], v[80:83], v[104:107], a[72:75]
    v_exp_f32 v54, v54
    v_mfma_f32_16x16x32_bf16 a[72:75], v[84:87], v[120:123], a[72:75]
    ds_read_b128 v[68:71], v9 offset:12288
    v_add_u32 v16, s65, v16
    v_mfma_f32_16x16x32_bf16 a[76:79], v[80:83], v[108:111], a[76:79]
    v_exp_f32 v55, v55
    v_mfma_f32_16x16x32_bf16 a[76:79], v[84:87], v[124:127], a[76:79]
    ds_read_b128 v[72:75], v10 offset:12288
    v_cvt_pk_bf16_f32 v149, v54, v55
    v_mfma_f32_16x16x32_bf16 a[80:83], v[88:91], v[96:99], a[80:83]
    v_exp_f32 v56, v56
    v_mfma_f32_16x16x32_bf16 a[80:83], v[92:95], v[112:115], a[80:83]
    ds_read_b128 v[76:79], v11 offset:12288
    v_add_u32 v17, s65, v17
    v_mfma_f32_16x16x32_bf16 a[84:87], v[88:91], v[100:103], a[84:87]
    v_exp_f32 v57, v57
    v_mfma_f32_16x16x32_bf16 a[84:87], v[92:95], v[116:119], a[84:87]
    v_cvt_pk_bf16_f32 v152, v56, v57
    v_mfma_f32_16x16x32_bf16 a[88:91], v[88:91], v[104:107], a[88:91]
    s_bfe_u32 s76, s92, s20
    v_exp_f32 v58, v58
    v_mfma_f32_16x16x32_bf16 a[88:91], v[92:95], v[120:123], a[88:91]
    ds_read_b64_tr_b16 v[80:81], v18
    v_mfma_f32_16x16x32_bf16 a[92:95], v[88:91], v[108:111], a[92:95]
    s_bfe_u32 s94, s93, s21
    v_exp_f32 v59, v59
    v_mfma_f32_16x16x32_bf16 a[92:95], v[92:95], v[124:127], a[92:95]
    ds_read_b64_tr_b16 v[82:83], v18 offset:4096
    v_cvt_pk_bf16_f32 v153, v58, v59
    v_mfma_f32_16x16x32_bf16 v[236:239], v[224:227], v[104:107], v[236:239]
    s_waitcnt lgkmcnt(2)
    v_exp_f32 v60, v60
    v_mfma_f32_16x16x32_bf16 v[236:239], v[224:227], v[120:123], v[236:239]
    ds_read_b64_tr_b16 v[84:85], v18 offset:8192
    v_mfma_f32_16x16x32_bf16 v[48:51], v[64:67], v[160:163], v[32:35]
    s_max_u32 s76, s76, s94
    v_exp_f32 v61, v61
    v_mfma_f32_16x16x32_bf16 v[48:51], v[68:71], v[164:167], v[48:51]
    ds_read_b64_tr_b16 v[86:87], v18 offset:12288
    v_cvt_pk_bf16_f32 v156, v60, v61
    v_mfma_f32_16x16x32_bf16 v[48:51], v[72:75], v[168:171], v[48:51]
    s_sub_u32 s76, s23, s76
    v_exp_f32 v62, v62
    v_mfma_f32_16x16x32_bf16 v[48:51], v[76:79], v[172:175], v[48:51]
    ds_read_b64_tr_b16 v[88:89], v19
    v_add_u32 v8, s64, v8
    v_mfma_f32_16x16x32_bf16 v[52:55], v[64:67], v[176:179], v[36:39]
    s_lshl_b32 s76, s76, 1
    v_exp_f32 v63, v63
    v_mfma_f32_16x16x32_bf16 v[52:55], v[68:71], v[180:183], v[52:55]
    ds_read_b64_tr_b16 v[90:91], v19 offset:4096
    v_cvt_pk_bf16_f32 v157, v62, v63
    v_mfma_f32_16x16x32_bf16 v[52:55], v[72:75], v[184:187], v[52:55]
    v_mfma_f32_16x16x32_bf16 v[52:55], v[76:79], v[188:191], v[52:55]
    ds_read_b64_tr_b16 v[92:93], v19 offset:8192
    v_add_u32 v9, s64, v9
    v_mfma_f32_16x16x32_bf16 v[56:59], v[64:67], v[192:195], v[40:43]
    v_exp_f32 v48, v48
    v_mfma_f32_16x16x32_bf16 v[56:59], v[68:71], v[196:199], v[56:59]
    ds_read_b64_tr_b16 v[94:95], v19 offset:12288
    v_add_u32 v10, s64, v10
    v_mfma_f32_16x16x32_bf16 v[56:59], v[72:75], v[200:203], v[56:59]
    v_exp_f32 v49, v49
    v_mfma_f32_16x16x32_bf16 v[56:59], v[76:79], v[204:207], v[56:59]
    v_cvt_pk_bf16_f32 v146, v48, v49
    v_mfma_f32_16x16x32_bf16 v[60:63], v[64:67], v[208:211], v[44:47]
    s_getreg_b32 s66, hwreg(HW_REG_IB_STS, 22, 2)
    v_exp_f32 v50, v50
    v_mfma_f32_16x16x32_bf16 v[60:63], v[68:71], v[212:215], v[60:63]
    s_getreg_b32 s94, hwreg(HW_REG_IB_STS, 0, 4)
    s_lshl4_add_u32 s94, s66, s94
    v_add_u32 v11, s64, v11
    v_mfma_f32_16x16x32_bf16 v[60:63], v[72:75], v[216:219], v[60:63]
    s_waitcnt lgkmcnt(0)
    v_exp_f32 v51, v51
    v_mfma_f32_16x16x32_bf16 v[60:63], v[76:79], v[220:223], v[60:63]
    v_cvt_pk_bf16_f32 v147, v50, v51
    v_mfma_f32_16x16x32_bf16 a[96:99], v[80:83], v[96:99], a[96:99]
    s_cmp_gt_i32 s94, s76
    v_exp_f32 v52, v52
    v_mfma_f32_16x16x32_bf16 a[96:99], v[84:87], v[112:115], a[96:99]
    s_cbranch_scc1 L_lw_pl3
L_bb_pl3:
    s_waitcnt vmcnt(56)
    s_barrier
    v_mfma_f32_16x16x32_bf16 a[100:103], v[80:83], v[100:103], a[100:103]
    v_exp_f32 v53, v53
    v_mfma_f32_16x16x32_bf16 a[100:103], v[84:87], v[116:119], a[100:103]
    ds_read_b128 v[64:67], v8
    v_cvt_pk_bf16_f32 v150, v52, v53
    v_mfma_f32_16x16x32_bf16 a[104:107], v[80:83], v[104:107], a[104:107]
    v_exp_f32 v54, v54
    v_mfma_f32_16x16x32_bf16 a[104:107], v[84:87], v[120:123], a[104:107]
    ds_read_b128 v[68:71], v9
    v_add_u32 v18, s65, v18
    v_mfma_f32_16x16x32_bf16 a[108:111], v[80:83], v[108:111], a[108:111]
    v_exp_f32 v55, v55
    v_mfma_f32_16x16x32_bf16 a[108:111], v[84:87], v[124:127], a[108:111]
    ds_read_b128 v[72:75], v10
    v_cvt_pk_bf16_f32 v151, v54, v55
    v_mfma_f32_16x16x32_bf16 a[112:115], v[88:91], v[96:99], a[112:115]
    v_exp_f32 v56, v56
    v_mfma_f32_16x16x32_bf16 a[112:115], v[92:95], v[112:115], a[112:115]
    ds_read_b128 v[76:79], v11
    v_add_u32 v19, s65, v19
    v_mfma_f32_16x16x32_bf16 a[116:119], v[88:91], v[100:103], a[116:119]
    v_exp_f32 v57, v57
    v_mfma_f32_16x16x32_bf16 a[116:119], v[92:95], v[116:119], a[116:119]
    v_cvt_pk_bf16_f32 v154, v56, v57
    v_mfma_f32_16x16x32_bf16 a[120:123], v[88:91], v[104:107], a[120:123]
    v_exp_f32 v58, v58
    v_mfma_f32_16x16x32_bf16 a[120:123], v[92:95], v[120:123], a[120:123]
    ds_read_b64_tr_b16 v[80:81], v12
    v_mfma_f32_16x16x32_bf16 a[124:127], v[88:91], v[108:111], a[124:127]
    v_exp_f32 v59, v59
    v_mfma_f32_16x16x32_bf16 a[124:127], v[92:95], v[124:127], a[124:127]
    ds_read_b64_tr_b16 v[82:83], v12 offset:4096
    v_cvt_pk_bf16_f32 v155, v58, v59
    v_mfma_f32_16x16x32_bf16 v[240:243], v[224:227], v[108:111], v[240:243]
    s_waitcnt lgkmcnt(2)
    v_exp_f32 v60, v60
    v_mfma_f32_16x16x32_bf16 v[240:243], v[224:227], v[124:127], v[240:243]
    ds_read_b64_tr_b16 v[84:85], v12 offset:8192

    v_mfma_f32_16x16x32_bf16 v[228:231], v[224:227], v[128:131], v[228:231]
    ds_read_b64_tr_b16 v[86:87], v12 offset:12288
    v_exp_f32 v61, v61
    v_mfma_f32_16x16x32_bf16 v[228:231], v[224:227], v[144:147], v[228:231]
    ds_read_b64_tr_b16 v[88:89], v13
    v_cvt_pk_bf16_f32 v158, v60, v61
    v_mfma_f32_16x16x32_bf16 v[232:235], v[224:227], v[132:135], v[232:235]
    ds_read_b64_tr_b16 v[90:91], v13 offset:4096
    v_exp_f32 v62, v62
    v_mfma_f32_16x16x32_bf16 v[232:235], v[224:227], v[148:151], v[232:235]
    ds_read_b64_tr_b16 v[92:93], v13 offset:8192
    v_mfma_f32_16x16x32_bf16 v[236:239], v[224:227], v[136:139], v[236:239]
    ds_read_b64_tr_b16 v[94:95], v13 offset:12288
    v_exp_f32 v63, v63
    v_mfma_f32_16x16x32_bf16 v[236:239], v[224:227], v[152:155], v[236:239]
    v_cvt_pk_bf16_f32 v159, v62, v63
    v_mfma_f32_16x16x32_bf16 v[240:243], v[224:227], v[140:143], v[240:243]
    s_nop 0
    v_mfma_f32_16x16x32_bf16 v[240:243], v[224:227], v[156:159], v[240:243]
    s_waitcnt lgkmcnt(4)
    v_mfma_f32_16x16x32_bf16 a[0:3], v[80:83], v[128:131], a[0:3]
    v_mfma_f32_16x16x32_bf16 a[0:3], v[84:87], v[144:147], a[0:3]
    v_add_f32 v245, v228, v232
    v_mfma_f32_16x16x32_bf16 a[4:7], v[80:83], v[132:135], a[4:7]
    v_rcp_f32 v244, v228
    v_mfma_f32_16x16x32_bf16 a[4:7], v[84:87], v[148:151], a[4:7]
    v_rcp_f32 v246, v232
    v_mfma_f32_16x16x32_bf16 a[8:11], v[80:83], v[136:139], a[8:11]
    v_add_f32 v247, v236, v240
    v_add_f32 v245, v245, v247
    v_min3_f32 v249, v228, v232, v236
    v_min_f32 v249, v249, v240
    v_rcp_f32 v248, v236
    v_mfma_f32_16x16x32_bf16 a[8:11], v[84:87], v[152:155], a[8:11]
    v_cmp_nge_f32 vcc, s72, v245
    v_cmp_nle_f32 s[56:57], 0.5, v249
    v_rcp_f32 v250, v240
    v_mfma_f32_16x16x32_bf16 a[12:15], v[80:83], v[140:143], a[12:15]
    s_or_b64 vcc, vcc, s[56:57]
    s_cmp_lg_u64 vcc, 0
    s_cbranch_scc1 L_slow
    v_mfma_f32_16x16x32_bf16 a[12:15], v[84:87], v[156:159], a[12:15]
    s_waitcnt lgkmcnt(0)
    s_waitcnt vmcnt(24)
    v_and_b32 v1, 63, v0
    v_lshrrev_b32 v2, 6, v0
    v_and_b32 v3, 15, v0
    v_lshrrev_b32 v4, 4, v1
    s_add_u32 m0, s29, 16384
    v_mfma_f32_16x16x32_bf16 a[16:19], v[88:91], v[128:131], a[16:19]
    ds_read_b64_tr_b16 v[80:81], v14
    s_mov_b32 s66, 851968
    buffer_load_dwordx4 v20, s[36:39], s66 offen lds
    v_mfma_f32_16x16x32_bf16 a[16:19], v[92:95], v[144:147], a[16:19]
    ds_read_b64_tr_b16 v[82:83], v14 offset:4096
    buffer_load_dwordx4 v21, s[36:39], s66 offen offset:1024 lds
    v_mfma_f32_16x16x32_bf16 a[20:23], v[88:91], v[132:135], a[20:23]
    ds_read_b64_tr_b16 v[84:85], v14 offset:8192
    buffer_load_dwordx4 v22, s[36:39], s66 offen offset:2048 lds
    v_mfma_f32_16x16x32_bf16 a[20:23], v[92:95], v[148:151], a[20:23]
    ds_read_b64_tr_b16 v[86:87], v14 offset:12288
    buffer_load_dwordx4 v23, s[36:39], s66 offen offset:3072 lds
    v_mfma_f32_16x16x32_bf16 a[24:27], v[88:91], v[136:139], a[24:27]
    s_add_u32 m0, s29, 114688
    s_mov_b32 s66, 1048576
    buffer_load_dwordx4 v20, s[36:39], s66 offen lds
    v_accvgpr_read_b32 v96, a0
    v_accvgpr_read_b32 v97, a1
    v_accvgpr_read_b32 v98, a2
    v_mfma_f32_16x16x32_bf16 a[24:27], v[92:95], v[152:155], a[24:27]
    buffer_load_dwordx4 v21, s[36:39], s66 offen offset:1024 lds
    v_accvgpr_read_b32 v99, a3
    v_accvgpr_read_b32 v100, a16
    v_accvgpr_read_b32 v101, a17
    v_accvgpr_read_b32 v102, a18
    v_accvgpr_read_b32 v103, a19
    v_mfma_f32_16x16x32_bf16 a[28:31], v[88:91], v[140:143], a[28:31]
    buffer_load_dwordx4 v22, s[36:39], s66 offen offset:2048 lds
    v_mul_f32 v96, v96, v244
    v_mul_f32 v97, v97, v244
    v_mul_f32 v98, v98, v244
    v_mul_f32 v99, v99, v244
    v_mul_f32 v100, v100, v244
    v_mfma_f32_16x16x32_bf16 a[28:31], v[92:95], v[156:159], a[28:31]
    s_waitcnt lgkmcnt(0)
    buffer_load_dwordx4 v23, s[36:39], s66 offen offset:3072 lds
    v_mul_f32 v101, v101, v244
    v_mul_f32 v102, v102, v244
    v_mul_f32 v103, v103, v244
    v_cvt_pk_bf16_f32 v96, v96, v97
    v_cvt_pk_bf16_f32 v97, v98, v99
    v_mfma_f32_16x16x32_bf16 a[32:35], v[80:83], v[128:131], a[32:35]
    ds_read_b64_tr_b16 v[88:89], v15
    v_cvt_pk_bf16_f32 v98, v100, v101
    v_cvt_pk_bf16_f32 v99, v102, v103
    buffer_store_dwordx4 v[96:99], v26, s[24:27], s84 offen sc1
    v_accvgpr_read_b32 v104, a4
    v_accvgpr_read_b32 v105, a5
    v_accvgpr_read_b32 v106, a6
    v_mfma_f32_16x16x32_bf16 a[32:35], v[84:87], v[144:147], a[32:35]
    ds_read_b64_tr_b16 v[90:91], v15 offset:4096
    v_accvgpr_read_b32 v107, a7
    v_accvgpr_read_b32 v108, a20
    v_accvgpr_read_b32 v109, a21
    v_accvgpr_read_b32 v110, a22
    v_accvgpr_read_b32 v111, a23
    v_mul_f32 v104, v104, v246
    v_mfma_f32_16x16x32_bf16 a[36:39], v[80:83], v[132:135], a[36:39]
    ds_read_b64_tr_b16 v[92:93], v15 offset:8192
    v_mul_f32 v105, v105, v246
    v_mul_f32 v106, v106, v246
    v_mul_f32 v107, v107, v246
    v_mul_f32 v108, v108, v246
    v_mul_f32 v109, v109, v246
    v_mul_f32 v110, v110, v246
    v_mfma_f32_16x16x32_bf16 a[36:39], v[84:87], v[148:151], a[36:39]
    ds_read_b64_tr_b16 v[94:95], v15 offset:12288
    v_mul_f32 v111, v111, v246
    v_cvt_pk_bf16_f32 v104, v104, v105
    v_cvt_pk_bf16_f32 v105, v106, v107
    v_cvt_pk_bf16_f32 v106, v108, v109
    v_cvt_pk_bf16_f32 v107, v110, v111
    buffer_store_dwordx4 v[104:107], v26, s[24:27], s85 offen sc1
    v_mfma_f32_16x16x32_bf16 a[40:43], v[80:83], v[136:139], a[40:43]
    v_accvgpr_read_b32 v112, a8
    v_accvgpr_read_b32 v113, a9
    v_accvgpr_read_b32 v114, a10
    v_accvgpr_read_b32 v115, a11
    v_accvgpr_read_b32 v116, a24
    v_accvgpr_read_b32 v117, a25
    v_mfma_f32_16x16x32_bf16 a[40:43], v[84:87], v[152:155], a[40:43]
    v_accvgpr_read_b32 v118, a26
    v_accvgpr_read_b32 v119, a27
    v_mul_f32 v112, v112, v248
    v_mul_f32 v113, v113, v248
    v_mul_f32 v114, v114, v248
    v_mul_f32 v115, v115, v248
    v_mfma_f32_16x16x32_bf16 a[44:47], v[80:83], v[140:143], a[44:47]
    v_mul_f32 v116, v116, v248
    v_mul_f32 v117, v117, v248
    v_mul_f32 v118, v118, v248
    v_mul_f32 v119, v119, v248
    v_cvt_pk_bf16_f32 v112, v112, v113
    v_cvt_pk_bf16_f32 v113, v114, v115
    v_mfma_f32_16x16x32_bf16 a[44:47], v[84:87], v[156:159], a[44:47]
    s_waitcnt lgkmcnt(0)
    v_cvt_pk_bf16_f32 v114, v116, v117
    v_cvt_pk_bf16_f32 v115, v118, v119
    buffer_store_dwordx4 v[112:115], v26, s[24:27], s86 offen sc1
    v_accvgpr_read_b32 v120, a12
    v_accvgpr_read_b32 v121, a13
    v_accvgpr_read_b32 v122, a14
    v_mfma_f32_16x16x32_bf16 a[48:51], v[88:91], v[128:131], a[48:51]
    ds_read_b64_tr_b16 v[80:81], v16
    v_accvgpr_read_b32 v123, a15
    v_accvgpr_read_b32 v124, a28
    v_accvgpr_read_b32 v125, a29
    v_accvgpr_read_b32 v126, a30
    v_accvgpr_read_b32 v127, a31
    v_mul_f32 v120, v120, v250
    v_mfma_f32_16x16x32_bf16 a[48:51], v[92:95], v[144:147], a[48:51]
    ds_read_b64_tr_b16 v[82:83], v16 offset:4096
    v_mul_f32 v121, v121, v250
    v_mul_f32 v122, v122, v250
    v_mul_f32 v123, v123, v250
    v_mul_f32 v124, v124, v250
    v_mul_f32 v125, v125, v250
    v_mul_f32 v126, v126, v250
    v_mfma_f32_16x16x32_bf16 a[52:55], v[88:91], v[132:135], a[52:55]
    ds_read_b64_tr_b16 v[84:85], v16 offset:8192
    v_mul_f32 v127, v127, v250
    v_cvt_pk_bf16_f32 v120, v120, v121
    v_cvt_pk_bf16_f32 v121, v122, v123
    v_cvt_pk_bf16_f32 v122, v124, v125
    v_cvt_pk_bf16_f32 v123, v126, v127
    buffer_store_dwordx4 v[120:123], v26, s[24:27], s87 offen sc1
    v_mfma_f32_16x16x32_bf16 a[52:55], v[92:95], v[148:151], a[52:55]
    ds_read_b64_tr_b16 v[86:87], v16 offset:12288
    v_mfma_f32_16x16x32_bf16 a[56:59], v[88:91], v[136:139], a[56:59]
L_hop14:
    s_cbranch_execz L_hop18
    v_accvgpr_read_b32 v96, a32
    v_accvgpr_read_b32 v97, a33
    v_accvgpr_read_b32 v98, a34
    v_accvgpr_read_b32 v99, a35
    v_accvgpr_read_b32 v100, a48
    v_accvgpr_read_b32 v101, a49
    v_mfma_f32_16x16x32_bf16 a[56:59], v[92:95], v[152:155], a[56:59]
    v_accvgpr_read_b32 v102, a50
    v_accvgpr_read_b32 v103, a51
    v_mul_f32 v96, v96, v244
    v_mul_f32 v97, v97, v244
    v_mul_f32 v98, v98, v244
    v_mul_f32 v99, v99, v244
    v_mfma_f32_16x16x32_bf16 a[60:63], v[88:91], v[140:143], a[60:63]
    v_mul_f32 v100, v100, v244
    v_mul_f32 v101, v101, v244
    v_mul_f32 v102, v102, v244
    v_mul_f32 v103, v103, v244
    v_cvt_pk_bf16_f32 v96, v96, v97
    v_cvt_pk_bf16_f32 v97, v98, v99
    v_mfma_f32_16x16x32_bf16 a[60:63], v[92:95], v[156:159], a[60:63]
    s_waitcnt lgkmcnt(0)
    v_cvt_pk_bf16_f32 v98, v100, v101
    v_cvt_pk_bf16_f32 v99, v102, v103
    buffer_store_dwordx4 v[96:99], v26, s[24:27], s84 offen offset:1024 sc1
    v_accvgpr_read_b32 v104, a36
    v_accvgpr_read_b32 v105, a37
    v_accvgpr_read_b32 v106, a38
    v_mfma_f32_16x16x32_bf16 a[64:67], v[80:83], v[128:131], a[64:67]
    ds_read_b64_tr_b16 v[88:89], v17
    v_accvgpr_read_b32 v107, a39
    v_accvgpr_read_b32 v108, a52
    v_accvgpr_read_b32 v109, a53
    v_accvgpr_read_b32 v110, a54
    v_accvgpr_read_b32 v111, a55
    v_mul_f32 v104, v104, v246
    v_mfma_f32_16x16x32_bf16 a[64:67], v[84:87], v[144:147], a[64:67]
    ds_read_b64_tr_b16 v[90:91], v17 offset:4096
    v_mul_f32 v105, v105, v246
    v_mul_f32 v106, v106, v246
    v_mul_f32 v107, v107, v246
    v_mul_f32 v108, v108, v246
    v_mul_f32 v109, v109, v246
    v_mul_f32 v110, v110, v246
    v_mfma_f32_16x16x32_bf16 a[68:71], v[80:83], v[132:135], a[68:71]
    ds_read_b64_tr_b16 v[92:93], v17 offset:8192
    v_mul_f32 v111, v111, v246
    v_cvt_pk_bf16_f32 v104, v104, v105
    v_cvt_pk_bf16_f32 v105, v106, v107
    v_cvt_pk_bf16_f32 v106, v108, v109
    v_cvt_pk_bf16_f32 v107, v110, v111
    buffer_store_dwordx4 v[104:107], v26, s[24:27], s85 offen offset:1024 sc1
    v_mfma_f32_16x16x32_bf16 a[68:71], v[84:87], v[148:151], a[68:71]
    ds_read_b64_tr_b16 v[94:95], v17 offset:12288
    v_accvgpr_read_b32 v112, a40
    v_accvgpr_read_b32 v113, a41
    v_accvgpr_read_b32 v114, a42
    v_accvgpr_read_b32 v115, a43
    v_accvgpr_read_b32 v116, a56
    v_accvgpr_read_b32 v117, a57
    v_mfma_f32_16x16x32_bf16 a[72:75], v[80:83], v[136:139], a[72:75]
    v_accvgpr_read_b32 v118, a58
    v_accvgpr_read_b32 v119, a59
    v_mul_f32 v112, v112, v248
    v_mul_f32 v113, v113, v248
    v_mul_f32 v114, v114, v248
    v_mul_f32 v115, v115, v248
    v_mfma_f32_16x16x32_bf16 a[72:75], v[84:87], v[152:155], a[72:75]
    v_mul_f32 v116, v116, v248
    v_mul_f32 v117, v117, v248
    v_mul_f32 v118, v118, v248
    v_mul_f32 v119, v119, v248
    v_cvt_pk_bf16_f32 v112, v112, v113
    v_cvt_pk_bf16_f32 v113, v114, v115
    v_mfma_f32_16x16x32_bf16 a[76:79], v[80:83], v[140:143], a[76:79]
    v_cvt_pk_bf16_f32 v114, v116, v117
    v_cvt_pk_bf16_f32 v115, v118, v119
    buffer_store_dwordx4 v[112:115], v26, s[24:27], s86 offen offset:1024 sc1
    v_accvgpr_read_b32 v120, a44
    v_accvgpr_read_b32 v121, a45
    v_accvgpr_read_b32 v122, a46
    v_mfma_f32_16x16x32_bf16 a[76:79], v[84:87], v[156:159], a[76:79]
    s_waitcnt lgkmcnt(0)
    v_accvgpr_read_b32 v123, a47
    v_accvgpr_read_b32 v124, a60
    v_accvgpr_read_b32 v125, a61
    v_accvgpr_read_b32 v126, a62
    v_accvgpr_read_b32 v127, a63
    v_mul_f32 v120, v120, v250
    v_mfma_f32_16x16x32_bf16 a[80:83], v[88:91], v[128:131], a[80:83]
    ds_read_b64_tr_b16 v[80:81], v18
    v_mul_f32 v121, v121, v250
    v_mul_f32 v122, v122, v250
    v_mul_f32 v123, v123, v250
    v_mul_f32 v124, v124, v250
    v_mul_f32 v125, v125, v250
    v_mul_f32 v126, v126, v250
    v_mfma_f32_16x16x32_bf16 a[80:83], v[92:95], v[144:147], a[80:83]
    ds_read_b64_tr_b16 v[82:83], v18 offset:4096
    v_mul_f32 v127, v127, v250
    v_cvt_pk_bf16_f32 v120, v120, v121
    v_cvt_pk_bf16_f32 v121, v122, v123
    v_cvt_pk_bf16_f32 v122, v124, v125
    v_cvt_pk_bf16_f32 v123, v126, v127
    buffer_store_dwordx4 v[120:123], v26, s[24:27], s87 offen offset:1024 sc1
    v_mfma_f32_16x16x32_bf16 a[84:87], v[88:91], v[132:135], a[84:87]
    ds_read_b64_tr_b16 v[84:85], v18 offset:8192
    v_mfma_f32_16x16x32_bf16 a[84:87], v[92:95], v[148:151], a[84:87]
    ds_read_b64_tr_b16 v[86:87], v18 offset:12288
    v_mfma_f32_16x16x32_bf16 a[88:91], v[88:91], v[136:139], a[88:91]
    v_accvgpr_read_b32 v96, a64
    v_accvgpr_read_b32 v97, a65
    v_accvgpr_read_b32 v98, a66
    v_accvgpr_read_b32 v99, a67
    v_accvgpr_read_b32 v100, a80
    v_accvgpr_read_b32 v101, a81
    v_mfma_f32_16x16x32_bf16 a[88:91], v[92:95], v[152:155], a[88:91]
    v_accvgpr_read_b32 v102, a82
    v_accvgpr_read_b32 v103, a83
    v_mul_f32 v96, v96, v244
    v_mul_f32 v97, v97, v244
    v_mul_f32 v98, v98, v244
    v_mul_f32 v99, v99, v244
    v_mfma_f32_16x16x32_bf16 a[92:95], v[88:91], v[140:143], a[92:95]
    v_mul_f32 v100, v100, v244
    v_mul_f32 v101, v101, v244
    v_mul_f32 v102, v102, v244
    v_mul_f32 v103, v103, v244
    v_cvt_pk_bf16_f32 v96, v96, v97
    v_cvt_pk_bf16_f32 v97, v98, v99
    v_mfma_f32_16x16x32_bf16 a[92:95], v[92:95], v[156:159], a[92:95]
    s_waitcnt lgkmcnt(0)
    v_cvt_pk_bf16_f32 v98, v100, v101
    v_cvt_pk_bf16_f32 v99, v102, v103
    buffer_store_dwordx4 v[96:99], v26, s[24:27], s84 offen offset:2048 sc1
    v_accvgpr_read_b32 v104, a68
    v_accvgpr_read_b32 v105, a69
    v_accvgpr_read_b32 v106, a70
    v_mfma_f32_16x16x32_bf16 a[96:99], v[80:83], v[128:131], a[96:99]
    ds_read_b64_tr_b16 v[88:89], v19
    v_accvgpr_read_b32 v107, a71
    v_accvgpr_read_b32 v108, a84
    v_accvgpr_read_b32 v109, a85
    v_accvgpr_read_b32 v110, a86
    v_accvgpr_read_b32 v111, a87
    v_mul_f32 v104, v104, v246
    v_mfma_f32_16x16x32_bf16 a[96:99], v[84:87], v[144:147], a[96:99]
    ds_read_b64_tr_b16 v[90:91], v19 offset:4096
    v_mul_f32 v105, v105, v246
    v_mul_f32 v106, v106, v246
    v_mul_f32 v107, v107, v246
    v_mul_f32 v108, v108, v246
    v_mul_f32 v109, v109, v246
    v_mul_f32 v110, v110, v246
    v_mfma_f32_16x16x32_bf16 a[100:103], v[80:83], v[132:135], a[100:103]
    ds_read_b64_tr_b16 v[92:93], v19 offset:8192
    v_mul_f32 v111, v111, v246
    v_cvt_pk_bf16_f32 v104, v104, v105
    v_cvt_pk_bf16_f32 v105, v106, v107
    v_cvt_pk_bf16_f32 v106, v108, v109
    v_cvt_pk_bf16_f32 v107, v110, v111
    buffer_store_dwordx4 v[104:107], v26, s[24:27], s85 offen offset:2048 sc1
    v_mfma_f32_16x16x32_bf16 a[100:103], v[84:87], v[148:151], a[100:103]
    ds_read_b64_tr_b16 v[94:95], v19 offset:12288
    v_accvgpr_read_b32 v112, a72
    v_accvgpr_read_b32 v113, a73
    v_accvgpr_read_b32 v114, a74
    v_accvgpr_read_b32 v115, a75
    v_accvgpr_read_b32 v116, a88
    v_accvgpr_read_b32 v117, a89
    v_mfma_f32_16x16x32_bf16 a[104:107], v[80:83], v[136:139], a[104:107]
    v_accvgpr_read_b32 v118, a90
    v_accvgpr_read_b32 v119, a91
    v_mul_f32 v112, v112, v248
    v_mul_f32 v113, v113, v248
    v_mul_f32 v114, v114, v248
    v_mul_f32 v115, v115, v248
    v_mfma_f32_16x16x32_bf16 a[104:107], v[84:87], v[152:155], a[104:107]
    v_mul_f32 v116, v116, v248
    v_mul_f32 v117, v117, v248
    v_mul_f32 v118, v118, v248
    v_mul_f32 v119, v119, v248
    v_cvt_pk_bf16_f32 v112, v112, v113
    v_cvt_pk_bf16_f32 v113, v114, v115
    v_mfma_f32_16x16x32_bf16 a[108:111], v[80:83], v[140:143], a[108:111]
    v_cvt_pk_bf16_f32 v114, v116, v117
    v_cvt_pk_bf16_f32 v115, v118, v119
    buffer_store_dwordx4 v[112:115], v26, s[24:27], s86 offen offset:2048 sc1
    v_accvgpr_read_b32 v120, a76
    v_accvgpr_read_b32 v121, a77
    v_accvgpr_read_b32 v122, a78
    v_mfma_f32_16x16x32_bf16 a[108:111], v[84:87], v[156:159], a[108:111]
    s_waitcnt lgkmcnt(0)
    v_accvgpr_read_b32 v123, a79
    v_accvgpr_read_b32 v124, a92
    v_accvgpr_read_b32 v125, a93
    v_accvgpr_read_b32 v126, a94
    v_accvgpr_read_b32 v127, a95
    v_mul_f32 v120, v120, v250
    v_mfma_f32_16x16x32_bf16 a[112:115], v[88:91], v[128:131], a[112:115]
    v_mul_f32 v121, v121, v250
    v_mul_f32 v122, v122, v250
    v_mul_f32 v123, v123, v250
    v_mul_f32 v124, v124, v250
    v_mul_f32 v125, v125, v250
    v_mul_f32 v126, v126, v250
    v_mfma_f32_16x16x32_bf16 a[112:115], v[92:95], v[144:147], a[112:115]
    v_mul_f32 v127, v127, v250
    v_cvt_pk_bf16_f32 v120, v120, v121
    v_cvt_pk_bf16_f32 v121, v122, v123
    v_cvt_pk_bf16_f32 v122, v124, v125
    v_cvt_pk_bf16_f32 v123, v126, v127
    buffer_store_dwordx4 v[120:123], v26, s[24:27], s87 offen offset:2048 sc1
    v_mfma_f32_16x16x32_bf16 a[116:119], v[88:91], v[132:135], a[116:119]
    v_mfma_f32_16x16x32_bf16 a[116:119], v[92:95], v[148:151], a[116:119]
    v_mfma_f32_16x16x32_bf16 a[120:123], v[88:91], v[136:139], a[120:123]
    v_mfma_f32_16x16x32_bf16 a[120:123], v[92:95], v[152:155], a[120:123]
    v_mfma_f32_16x16x32_bf16 a[124:127], v[88:91], v[140:143], a[124:127]
    v_mfma_f32_16x16x32_bf16 a[124:127], v[92:95], v[156:159], a[124:127]
L_epi2:

    v_accvgpr_read_b32 v96, a96
    v_accvgpr_read_b32 v97, a97
    v_accvgpr_read_b32 v98, a98
    v_accvgpr_read_b32 v99, a99
    v_accvgpr_read_b32 v100, a112
    v_accvgpr_read_b32 v101, a113
    v_accvgpr_read_b32 v102, a114
    v_accvgpr_read_b32 v103, a115
    v_pk_mul_f32 v[96:97], v[96:97], v[244:245] op_sel_hi:[1,0]
    v_pk_mul_f32 v[98:99], v[98:99], v[244:245] op_sel_hi:[1,0]
    v_pk_mul_f32 v[100:101], v[100:101], v[244:245] op_sel_hi:[1,0]
    v_pk_mul_f32 v[102:103], v[102:103], v[244:245] op_sel_hi:[1,0]
    v_cvt_pk_bf16_f32 v96, v96, v97
    v_cvt_pk_bf16_f32 v97, v98, v99
    v_cvt_pk_bf16_f32 v98, v100, v101
    v_cvt_pk_bf16_f32 v99, v102, v103
    buffer_store_dwordx4 v[96:99], v26, s[24:27], s84 offen offset:3072 sc1
    v_accvgpr_read_b32 v104, a100
    v_accvgpr_read_b32 v105, a101
    v_accvgpr_read_b32 v106, a102
    v_accvgpr_read_b32 v107, a103
    v_accvgpr_read_b32 v108, a116
    v_accvgpr_read_b32 v109, a117
    v_accvgpr_read_b32 v110, a118
    v_accvgpr_read_b32 v111, a119
    v_pk_mul_f32 v[104:105], v[104:105], v[246:247] op_sel_hi:[1,0]
    v_pk_mul_f32 v[106:107], v[106:107], v[246:247] op_sel_hi:[1,0]
    v_pk_mul_f32 v[108:109], v[108:109], v[246:247] op_sel_hi:[1,0]
    v_pk_mul_f32 v[110:111], v[110:111], v[246:247] op_sel_hi:[1,0]
    v_cvt_pk_bf16_f32 v104, v104, v105
    v_cvt_pk_bf16_f32 v105, v106, v107
    v_cvt_pk_bf16_f32 v106, v108, v109
    v_cvt_pk_bf16_f32 v107, v110, v111
    buffer_store_dwordx4 v[104:107], v26, s[24:27], s85 offen offset:3072 sc1
    v_accvgpr_read_b32 v112, a104
    v_accvgpr_read_b32 v113, a105
    v_accvgpr_read_b32 v114, a106
    v_accvgpr_read_b32 v115, a107
    v_accvgpr_read_b32 v116, a120
    v_accvgpr_read_b32 v117, a121
    v_accvgpr_read_b32 v118, a122
    v_accvgpr_read_b32 v119, a123
    v_pk_mul_f32 v[112:113], v[112:113], v[248:249] op_sel_hi:[1,0]
    v_pk_mul_f32 v[114:115], v[114:115], v[248:249] op_sel_hi:[1,0]
    v_pk_mul_f32 v[116:117], v[116:117], v[248:249] op_sel_hi:[1,0]
    v_pk_mul_f32 v[118:119], v[118:119], v[248:249] op_sel_hi:[1,0]
    v_cvt_pk_bf16_f32 v112, v112, v113
    v_cvt_pk_bf16_f32 v113, v114, v115
    v_cvt_pk_bf16_f32 v114, v116, v117
    v_cvt_pk_bf16_f32 v115, v118, v119
    buffer_store_dwordx4 v[112:115], v26, s[24:27], s86 offen offset:3072 sc1
    v_accvgpr_read_b32 v120, a108
    v_accvgpr_read_b32 v121, a109
    v_accvgpr_read_b32 v122, a110
    v_accvgpr_read_b32 v123, a111
    v_accvgpr_read_b32 v124, a124
    v_accvgpr_read_b32 v125, a125
    v_accvgpr_read_b32 v126, a126
    v_accvgpr_read_b32 v127, a127
    v_pk_mul_f32 v[120:121], v[120:121], v[250:251] op_sel_hi:[1,0]
    v_pk_mul_f32 v[122:123], v[122:123], v[250:251] op_sel_hi:[1,0]
    v_pk_mul_f32 v[124:125], v[124:125], v[250:251] op_sel_hi:[1,0]
    v_pk_mul_f32 v[126:127], v[126:127], v[250:251] op_sel_hi:[1,0]
    v_cvt_pk_bf16_f32 v120, v120, v121
    v_cvt_pk_bf16_f32 v121, v122, v123
    v_cvt_pk_bf16_f32 v122, v124, v125
    v_cvt_pk_bf16_f32 v123, v126, v127
    buffer_store_dwordx4 v[120:123], v26, s[24:27], s87 offen offset:3072 sc1
    v_xor_b32 v12, s3, v12
    v_xor_b32 v13, s3, v13
    v_xor_b32 v14, s3, v14
    v_xor_b32 v15, s3, v15
    v_xor_b32 v16, s3, v16
    v_xor_b32 v17, s3, v17
    v_xor_b32 v18, s3, v18
    v_xor_b32 v19, s3, v19
    v_lshlrev_b32 v5, 13, v2
    v_lshl_add_u32 v29, v1, 4, v5
    s_xor_b32 s68, s3, 128
    s_waitcnt vmcnt(55)
    s_barrier
    v_add_u32 v12, 0xfffe8000, v12
    ds_read_b64_tr_b16 v[32:33], v12
    ds_read_b64_tr_b16 v[34:35], v12 offset:4096
    ds_read_b64_tr_b16 v[36:37], v12 offset:8192
    ds_read_b64_tr_b16 v[38:39], v12 offset:12288
    v_add_u32 v13, 0xfffe8000, v13
    ds_read_b64_tr_b16 v[40:41], v13
    ds_read_b64_tr_b16 v[42:43], v13 offset:4096
    ds_read_b64_tr_b16 v[44:45], v13 offset:8192
    ds_read_b64_tr_b16 v[46:47], v13 offset:12288
    v_add_u32 v14, 0xfffe8000, v14
    ds_read_b64_tr_b16 v[48:49], v14
    ds_read_b64_tr_b16 v[50:51], v14 offset:4096
    ds_read_b64_tr_b16 v[52:53], v14 offset:8192
    ds_read_b64_tr_b16 v[54:55], v14 offset:12288
    s_waitcnt vmcnt(63)
    s_waitcnt lgkmcnt(8)

    v_mfma_f32_16x16x32_bf16 a[0:3], v[32:35], a[128:131], 0
    v_add_u32 v15, 0xfffe8000, v15
    ds_read_b64_tr_b16 v[56:57], v15
    ds_read_b64_tr_b16 v[58:59], v15 offset:4096
    v_mfma_f32_16x16x32_bf16 a[0:3], v[36:39], a[132:135], a[0:3]
    v_mfma_f32_16x16x32_bf16 a[4:7], v[32:35], a[136:139], 0
    ds_read_b64_tr_b16 v[60:61], v15 offset:8192
    v_mfma_f32_16x16x32_bf16 a[4:7], v[36:39], a[140:143], a[4:7]
    s_waitcnt lgkmcnt(7)
    ds_read_b64_tr_b16 v[62:63], v15 offset:12288
    v_add_u32 v16, 0xfffe8000, v16
    v_mfma_f32_16x16x32_bf16 a[8:11], v[40:43], a[128:131], 0
    ds_read_b64_tr_b16 v[32:33], v16
    ds_read_b64_tr_b16 v[34:35], v16 offset:4096
    v_mfma_f32_16x16x32_bf16 a[8:11], v[44:47], a[132:135], a[8:11]
    v_mfma_f32_16x16x32_bf16 a[12:15], v[40:43], a[136:139], 0
    ds_read_b64_tr_b16 v[36:37], v16 offset:8192
    v_mfma_f32_16x16x32_bf16 a[12:15], v[44:47], a[140:143], a[12:15]
    s_waitcnt lgkmcnt(7)
    ds_read_b64_tr_b16 v[38:39], v16 offset:12288
    v_add_u32 v17, 0xfffe8000, v17
    v_mfma_f32_16x16x32_bf16 a[16:19], v[48:51], a[128:131], 0
    ds_read_b64_tr_b16 v[40:41], v17
    ds_read_b64_tr_b16 v[42:43], v17 offset:4096
    v_mfma_f32_16x16x32_bf16 a[16:19], v[52:55], a[132:135], a[16:19]
    v_mfma_f32_16x16x32_bf16 a[20:23], v[48:51], a[136:139], 0
    ds_read_b64_tr_b16 v[44:45], v17 offset:8192
    v_mfma_f32_16x16x32_bf16 a[20:23], v[52:55], a[140:143], a[20:23]
    s_waitcnt lgkmcnt(7)
    ds_read_b64_tr_b16 v[46:47], v17 offset:12288
    v_add_u32 v18, 0xfffe8000, v18
    v_mfma_f32_16x16x32_bf16 a[24:27], v[56:59], a[128:131], 0
    ds_read_b64_tr_b16 v[48:49], v18
    ds_read_b64_tr_b16 v[50:51], v18 offset:4096
    v_mfma_f32_16x16x32_bf16 a[24:27], v[60:63], a[132:135], a[24:27]
    v_mfma_f32_16x16x32_bf16 a[28:31], v[56:59], a[136:139], 0
    ds_read_b64_tr_b16 v[52:53], v18 offset:8192
    v_mfma_f32_16x16x32_bf16 a[28:31], v[60:63], a[140:143], a[28:31]
    s_waitcnt lgkmcnt(7)
    ds_read_b64_tr_b16 v[54:55], v18 offset:12288
    v_add_u32 v19, 0xfffe8000, v19
    v_mfma_f32_16x16x32_bf16 a[32:35], v[32:35], a[128:131], 0
    ds_read_b64_tr_b16 v[56:57], v19
    ds_read_b64_tr_b16 v[58:59], v19 offset:4096
    v_mfma_f32_16x16x32_bf16 a[32:35], v[36:39], a[132:135], a[32:35]
    v_mfma_f32_16x16x32_bf16 a[36:39], v[32:35], a[136:139], 0
    ds_read_b64_tr_b16 v[60:61], v19 offset:8192
    v_mfma_f32_16x16x32_bf16 a[36:39], v[36:39], a[140:143], a[36:39]
    s_waitcnt lgkmcnt(7)
    ds_read_b64_tr_b16 v[62:63], v19 offset:12288
    v_mfma_f32_16x16x32_bf16 a[40:43], v[40:43], a[128:131], 0
    ds_read_b64_tr_b16 v[32:33], v12 offset:16384
    ds_read_b64_tr_b16 v[34:35], v12 offset:20480
    v_mfma_f32_16x16x32_bf16 a[40:43], v[44:47], a[132:135], a[40:43]
    v_mfma_f32_16x16x32_bf16 a[44:47], v[40:43], a[136:139], 0
    ds_read_b64_tr_b16 v[36:37], v12 offset:24576
    v_mfma_f32_16x16x32_bf16 a[44:47], v[44:47], a[140:143], a[44:47]
    s_waitcnt lgkmcnt(7)
    ds_read_b64_tr_b16 v[38:39], v12 offset:28672
    v_mfma_f32_16x16x32_bf16 a[48:51], v[48:51], a[128:131], 0
    ds_read_b64_tr_b16 v[40:41], v13 offset:16384
    ds_read_b64_tr_b16 v[42:43], v13 offset:20480
    v_mfma_f32_16x16x32_bf16 a[48:51], v[52:55], a[132:135], a[48:51]
    v_mfma_f32_16x16x32_bf16 a[52:55], v[48:51], a[136:139], 0
    ds_read_b64_tr_b16 v[44:45], v13 offset:24576
    v_mfma_f32_16x16x32_bf16 a[52:55], v[52:55], a[140:143], a[52:55]
    s_waitcnt lgkmcnt(7)
    ds_read_b64_tr_b16 v[46:47], v13 offset:28672
    v_mfma_f32_16x16x32_bf16 a[56:59], v[56:59], a[128:131], 0
    ds_read_b64_tr_b16 v[48:49], v14 offset:16384
    ds_read_b64_tr_b16 v[50:51], v14 offset:20480
    v_mfma_f32_16x16x32_bf16 a[56:59], v[60:63], a[132:135], a[56:59]
    v_mfma_f32_16x16x32_bf16 a[60:63], v[56:59], a[136:139], 0
    s_waitcnt vmcnt(0)
    s_barrier
    s_cmp_eq_u32 s28, 0
    s_cbranch_scc0 L_nosig2
    s_mov_b64 exec, 1
    global_atomic_add v28, v7, s[60:61] sc1
    s_mov_b64 exec, -1
L_nosig2:
    ds_read_b64_tr_b16 v[52:53], v14 offset:24576
    v_mfma_f32_16x16x32_bf16 a[60:63], v[60:63], a[140:143], a[60:63]
    s_waitcnt lgkmcnt(7)
    s_waitcnt vmcnt(63)
    ds_read_b64_tr_b16 v[54:55], v14 offset:28672
    v_mfma_f32_16x16x32_bf16 a[0:3], v[32:35], a[144:147], a[0:3]
    ds_read_b64_tr_b16 v[56:57], v15 offset:16384
    ds_read_b64_tr_b16 v[58:59], v15 offset:20480
    v_mfma_f32_16x16x32_bf16 a[0:3], v[36:39], a[148:151], a[0:3]
    v_mfma_f32_16x16x32_bf16 a[4:7], v[32:35], a[152:155], a[4:7]
    ds_read_b64_tr_b16 v[60:61], v15 offset:24576
    v_mfma_f32_16x16x32_bf16 a[4:7], v[36:39], a[156:159], a[4:7]
    s_waitcnt lgkmcnt(7)
    ds_read_b64_tr_b16 v[62:63], v15 offset:28672
    v_mfma_f32_16x16x32_bf16 a[8:11], v[40:43], a[144:147], a[8:11]
    ds_read_b64_tr_b16 v[32:33], v16 offset:16384
    ds_read_b64_tr_b16 v[34:35], v16 offset:20480
    v_mfma_f32_16x16x32_bf16 a[8:11], v[44:47], a[148:151], a[8:11]
    v_mfma_f32_16x16x32_bf16 a[12:15], v[40:43], a[152:155], a[12:15]
    ds_read_b64_tr_b16 v[36:37], v16 offset:24576
    v_mfma_f32_16x16x32_bf16 a[12:15], v[44:47], a[156:159], a[12:15]
    s_waitcnt lgkmcnt(7)
    ds_read_b64_tr_b16 v[38:39], v16 offset:28672
    v_mfma_f32_16x16x32_bf16 a[16:19], v[48:51], a[144:147], a[16:19]
    ds_read_b64_tr_b16 v[40:41], v17 offset:16384
    ds_read_b64_tr_b16 v[42:43], v17 offset:20480
    v_mfma_f32_16x16x32_bf16 a[16:19], v[52:55], a[148:151], a[16:19]
    v_mfma_f32_16x16x32_bf16 a[20:23], v[48:51], a[152:155], a[20:23]
    ds_read_b64_tr_b16 v[44:45], v17 offset:24576
    v_mfma_f32_16x16x32_bf16 a[20:23], v[52:55], a[156:159], a[20:23]
    s_waitcnt lgkmcnt(7)
    ds_read_b64_tr_b16 v[46:47], v17 offset:28672
    v_mfma_f32_16x16x32_bf16 a[24:27], v[56:59], a[144:147], a[24:27]
    ds_read_b64_tr_b16 v[48:49], v18 offset:16384
    ds_read_b64_tr_b16 v[50:51], v18 offset:20480
    v_mfma_f32_16x16x32_bf16 a[24:27], v[60:63], a[148:151], a[24:27]
    v_mfma_f32_16x16x32_bf16 a[28:31], v[56:59], a[152:155], a[28:31]
    ds_read_b64_tr_b16 v[52:53], v18 offset:24576
    v_mfma_f32_16x16x32_bf16 a[28:31], v[60:63], a[156:159], a[28:31]
    s_waitcnt lgkmcnt(7)
    ds_read_b64_tr_b16 v[54:55], v18 offset:28672
    v_mfma_f32_16x16x32_bf16 a[32:35], v[32:35], a[144:147], a[32:35]
    ds_read_b64_tr_b16 v[56:57], v19 offset:16384
    ds_read_b64_tr_b16 v[58:59], v19 offset:20480
    v_mfma_f32_16x16x32_bf16 a[32:35], v[36:39], a[148:151], a[32:35]
    v_mfma_f32_16x16x32_bf16 a[36:39], v[32:35], a[152:155], a[36:39]
    ds_read_b64_tr_b16 v[60:61], v19 offset:24576
    v_mfma_f32_16x16x32_bf16 a[36:39], v[36:39], a[156:159], a[36:39]
    s_waitcnt lgkmcnt(7)
    ds_read_b64_tr_b16 v[62:63], v19 offset:28672
    v_mfma_f32_16x16x32_bf16 a[40:43], v[40:43], a[144:147], a[40:43]
    ds_read_b64_tr_b16 v[32:33], v12 offset:32768
    ds_read_b64_tr_b16 v[34:35], v12 offset:36864
    v_mfma_f32_16x16x32_bf16 a[40:43], v[44:47], a[148:151], a[40:43]
    v_mfma_f32_16x16x32_bf16 a[44:47], v[40:43], a[152:155], a[44:47]
    ds_read_b64_tr_b16 v[36:37], v12 offset:40960
    v_mfma_f32_16x16x32_bf16 a[44:47], v[44:47], a[156:159], a[44:47]
    s_waitcnt lgkmcnt(7)
    ds_read_b64_tr_b16 v[38:39], v12 offset:45056
    v_mfma_f32_16x16x32_bf16 a[48:51], v[48:51], a[144:147], a[48:51]
    ds_read_b64_tr_b16 v[40:41], v13 offset:32768
    ds_read_b64_tr_b16 v[42:43], v13 offset:36864
    v_mfma_f32_16x16x32_bf16 a[48:51], v[52:55], a[148:151], a[48:51]
    v_mfma_f32_16x16x32_bf16 a[52:55], v[48:51], a[152:155], a[52:55]
    ds_read_b64_tr_b16 v[44:45], v13 offset:40960
    v_mfma_f32_16x16x32_bf16 a[52:55], v[52:55], a[156:159], a[52:55]
    s_waitcnt lgkmcnt(7)
    ds_read_b64_tr_b16 v[46:47], v13 offset:45056
    v_mfma_f32_16x16x32_bf16 a[56:59], v[56:59], a[144:147], a[56:59]
    ds_read_b64_tr_b16 v[48:49], v14 offset:32768
    ds_read_b64_tr_b16 v[50:51], v14 offset:36864
    v_mfma_f32_16x16x32_bf16 a[56:59], v[60:63], a[148:151], a[56:59]
    v_mfma_f32_16x16x32_bf16 a[60:63], v[56:59], a[152:155], a[60:63]
    ds_read_b64_tr_b16 v[52:53], v14 offset:40960
    v_mfma_f32_16x16x32_bf16 a[60:63], v[60:63], a[156:159], a[60:63]
    s_waitcnt lgkmcnt(7)
    s_waitcnt vmcnt(60)
    ds_read_b64_tr_b16 v[54:55], v14 offset:45056
    v_mfma_f32_16x16x32_bf16 a[0:3], v[32:35], a[160:163], a[0:3]
    ds_read_b64_tr_b16 v[56:57], v15 offset:32768
    ds_read_b64_tr_b16 v[58:59], v15 offset:36864
    v_mfma_f32_16x16x32_bf16 a[0:3], v[36:39], a[164:167], a[0:3]
    v_mfma_f32_16x16x32_bf16 a[4:7], v[32:35], a[168:171], a[4:7]
    ds_read_b64_tr_b16 v[60:61], v15 offset:40960
    v_mfma_f32_16x16x32_bf16 a[4:7], v[36:39], a[172:175], a[4:7]
    s_waitcnt lgkmcnt(7)
    ds_read_b64_tr_b16 v[62:63], v15 offset:45056
    v_mfma_f32_16x16x32_bf16 a[8:11], v[40:43], a[160:163], a[8:11]
    ds_read_b64_tr_b16 v[32:33], v16 offset:32768
    ds_read_b64_tr_b16 v[34:35], v16 offset:36864
    v_mfma_f32_16x16x32_bf16 a[8:11], v[44:47], a[164:167], a[8:11]
    v_mfma_f32_16x16x32_bf16 a[12:15], v[40:43], a[168:171], a[12:15]
    ds_read_b64_tr_b16 v[36:37], v16 offset:40960
    v_mfma_f32_16x16x32_bf16 a[12:15], v[44:47], a[172:175], a[12:15]
    s_waitcnt lgkmcnt(7)
    ds_read_b64_tr_b16 v[38:39], v16 offset:45056
    v_mfma_f32_16x16x32_bf16 a[16:19], v[48:51], a[160:163], a[16:19]
    ds_read_b64_tr_b16 v[40:41], v17 offset:32768
    ds_read_b64_tr_b16 v[42:43], v17 offset:36864
    v_mfma_f32_16x16x32_bf16 a[16:19], v[52:55], a[164:167], a[16:19]
    v_mfma_f32_16x16x32_bf16 a[20:23], v[48:51], a[168:171], a[20:23]
    ds_read_b64_tr_b16 v[44:45], v17 offset:40960
    v_mfma_f32_16x16x32_bf16 a[20:23], v[52:55], a[172:175], a[20:23]
    s_waitcnt lgkmcnt(7)
    ds_read_b64_tr_b16 v[46:47], v17 offset:45056
    v_mfma_f32_16x16x32_bf16 a[24:27], v[56:59], a[160:163], a[24:27]
    ds_read_b64_tr_b16 v[48:49], v18 offset:32768
    ds_read_b64_tr_b16 v[50:51], v18 offset:36864
    v_mfma_f32_16x16x32_bf16 a[24:27], v[60:63], a[164:167], a[24:27]
    v_mfma_f32_16x16x32_bf16 a[28:31], v[56:59], a[168:171], a[28:31]
    ds_read_b64_tr_b16 v[52:53], v18 offset:40960
    v_mfma_f32_16x16x32_bf16 a[28:31], v[60:63], a[172:175], a[28:31]
    s_waitcnt lgkmcnt(7)
    ds_read_b64_tr_b16 v[54:55], v18 offset:45056
    v_mfma_f32_16x16x32_bf16 a[32:35], v[32:35], a[160:163], a[32:35]
    ds_read_b64_tr_b16 v[56:57], v19 offset:32768
    ds_read_b64_tr_b16 v[58:59], v19 offset:36864
    v_mfma_f32_16x16x32_bf16 a[32:35], v[36:39], a[164:167], a[32:35]
    v_mfma_f32_16x16x32_bf16 a[36:39], v[32:35], a[168:171], a[36:39]
    ds_read_b64_tr_b16 v[60:61], v19 offset:40960
    v_mfma_f32_16x16x32_bf16 a[36:39], v[36:39], a[172:175], a[36:39]
    s_waitcnt lgkmcnt(7)
    ds_read_b64_tr_b16 v[62:63], v19 offset:45056
    v_add_u32 v12, 0xffff8000, v12
    v_mfma_f32_16x16x32_bf16 a[40:43], v[40:43], a[160:163], a[40:43]
    ds_read_b64_tr_b16 v[32:33], v12
    ds_read_b64_tr_b16 v[34:35], v12 offset:4096
    v_mfma_f32_16x16x32_bf16 a[40:43], v[44:47], a[164:167], a[40:43]
    v_mfma_f32_16x16x32_bf16 a[44:47], v[40:43], a[168:171], a[44:47]
    ds_read_b64_tr_b16 v[36:37], v12 offset:8192
    v_mfma_f32_16x16x32_bf16 a[44:47], v[44:47], a[172:175], a[44:47]
    s_waitcnt lgkmcnt(7)
    ds_read_b64_tr_b16 v[38:39], v12 offset:12288
    v_add_u32 v13, 0xffff8000, v13
    v_mfma_f32_16x16x32_bf16 a[48:51], v[48:51], a[160:163], a[48:51]
    ds_read_b64_tr_b16 v[40:41], v13
    ds_read_b64_tr_b16 v[42:43], v13 offset:4096
    v_mfma_f32_16x16x32_bf16 a[48:51], v[52:55], a[164:167], a[48:51]
    v_mfma_f32_16x16x32_bf16 a[52:55], v[48:51], a[168:171], a[52:55]
    ds_read_b64_tr_b16 v[44:45], v13 offset:8192
    v_mfma_f32_16x16x32_bf16 a[52:55], v[52:55], a[172:175], a[52:55]
    s_waitcnt lgkmcnt(7)
    ds_read_b64_tr_b16 v[46:47], v13 offset:12288
    v_add_u32 v14, 0xffff8000, v14
    v_mfma_f32_16x16x32_bf16 a[56:59], v[56:59], a[160:163], a[56:59]
    ds_read_b64_tr_b16 v[48:49], v14
    ds_read_b64_tr_b16 v[50:51], v14 offset:4096
    v_mfma_f32_16x16x32_bf16 a[56:59], v[60:63], a[164:167], a[56:59]
    v_mfma_f32_16x16x32_bf16 a[60:63], v[56:59], a[168:171], a[60:63]
    s_waitcnt vmcnt(43)
    s_barrier
    ds_read_b64_tr_b16 v[52:53], v14 offset:8192
    v_mfma_f32_16x16x32_bf16 a[60:63], v[60:63], a[172:175], a[60:63]
    s_waitcnt lgkmcnt(7)
    s_waitcnt vmcnt(52)
    ds_read_b64_tr_b16 v[54:55], v14 offset:12288
    v_add_u32 v15, 0xffff8000, v15
    v_mfma_f32_16x16x32_bf16 a[0:3], v[32:35], a[176:179], a[0:3]
    ds_read_b64_tr_b16 v[56:57], v15
    ds_read_b64_tr_b16 v[58:59], v15 offset:4096
    s_add_u32 m0, s29, 131072
    s_mov_b32 s66, 1114112
    v_mfma_f32_16x16x32_bf16 a[0:3], v[36:39], a[180:183], a[0:3]
    buffer_load_dwordx4 v20, s[36:39], s66 offen lds
    v_mfma_f32_16x16x32_bf16 a[4:7], v[32:35], a[184:187], a[4:7]
    ds_read_b64_tr_b16 v[60:61], v15 offset:8192
    v_mfma_f32_16x16x32_bf16 a[4:7], v[36:39], a[188:191], a[4:7]
    s_waitcnt lgkmcnt(7)
    ds_read_b64_tr_b16 v[62:63], v15 offset:12288
    v_add_u32 v16, 0xffff8000, v16
    v_mfma_f32_16x16x32_bf16 a[8:11], v[40:43], a[176:179], a[8:11]
    ds_read_b64_tr_b16 v[32:33], v16
    ds_read_b64_tr_b16 v[34:35], v16 offset:4096
    v_mfma_f32_16x16x32_bf16 a[8:11], v[44:47], a[180:183], a[8:11]
L_hop15:
    s_cbranch_execz L_hop19
    buffer_load_dwordx4 v21, s[36:39], s66 offen offset:1024 lds
    v_mfma_f32_16x16x32_bf16 a[12:15], v[40:43], a[184:187], a[12:15]
    ds_read_b64_tr_b16 v[36:37], v16 offset:8192
    v_mfma_f32_16x16x32_bf16 a[12:15], v[44:47], a[188:191], a[12:15]
    s_waitcnt lgkmcnt(7)
    ds_read_b64_tr_b16 v[38:39], v16 offset:12288
    v_add_u32 v17, 0xffff8000, v17
    v_mfma_f32_16x16x32_bf16 a[16:19], v[48:51], a[176:179], a[16:19]
    ds_read_b64_tr_b16 v[40:41], v17
    ds_read_b64_tr_b16 v[42:43], v17 offset:4096
    v_mfma_f32_16x16x32_bf16 a[16:19], v[52:55], a[180:183], a[16:19]
    buffer_load_dwordx4 v22, s[36:39], s66 offen offset:2048 lds
    v_mfma_f32_16x16x32_bf16 a[20:23], v[48:51], a[184:187], a[20:23]
    ds_read_b64_tr_b16 v[44:45], v17 offset:8192
    v_mfma_f32_16x16x32_bf16 a[20:23], v[52:55], a[188:191], a[20:23]
    s_waitcnt lgkmcnt(7)
    ds_read_b64_tr_b16 v[46:47], v17 offset:12288
    v_add_u32 v18, 0xffff8000, v18
    v_mfma_f32_16x16x32_bf16 a[24:27], v[56:59], a[176:179], a[24:27]
    ds_read_b64_tr_b16 v[48:49], v18
    ds_read_b64_tr_b16 v[50:51], v18 offset:4096
    v_mfma_f32_16x16x32_bf16 a[24:27], v[60:63], a[180:183], a[24:27]
    buffer_load_dwordx4 v23, s[36:39], s66 offen offset:3072 lds
    v_mfma_f32_16x16x32_bf16 a[28:31], v[56:59], a[184:187], a[28:31]
    ds_read_b64_tr_b16 v[52:53], v18 offset:8192
    v_mfma_f32_16x16x32_bf16 a[28:31], v[60:63], a[188:191], a[28:31]
    s_waitcnt lgkmcnt(7)
    ds_read_b64_tr_b16 v[54:55], v18 offset:12288
    v_add_u32 v19, 0xffff8000, v19
    v_mfma_f32_16x16x32_bf16 a[32:35], v[32:35], a[176:179], a[32:35]
    ds_read_b64_tr_b16 v[56:57], v19
    ds_read_b64_tr_b16 v[58:59], v19 offset:4096
    v_mfma_f32_16x16x32_bf16 a[32:35], v[36:39], a[180:183], a[32:35]
    v_mfma_f32_16x16x32_bf16 a[36:39], v[32:35], a[184:187], a[36:39]
    ds_read_b64_tr_b16 v[60:61], v19 offset:8192
    v_mfma_f32_16x16x32_bf16 a[36:39], v[36:39], a[188:191], a[36:39]
    s_waitcnt lgkmcnt(7)
    ds_read_b64_tr_b16 v[62:63], v19 offset:12288
    v_add_u32 v12, 0x24000, v12
    v_mfma_f32_16x16x32_bf16 a[40:43], v[40:43], a[176:179], a[40:43]
    ds_read_b64_tr_b16 v[32:33], v12
    ds_read_b64_tr_b16 v[34:35], v12 offset:4096
    v_mfma_f32_16x16x32_bf16 a[40:43], v[44:47], a[180:183], a[40:43]
    v_mfma_f32_16x16x32_bf16 a[44:47], v[40:43], a[184:187], a[44:47]
    ds_read_b64_tr_b16 v[36:37], v12 offset:8192
    v_mfma_f32_16x16x32_bf16 a[44:47], v[44:47], a[188:191], a[44:47]
    s_waitcnt lgkmcnt(7)
    ds_read_b64_tr_b16 v[38:39], v12 offset:12288
    v_add_u32 v13, 0x24000, v13
    v_mfma_f32_16x16x32_bf16 a[48:51], v[48:51], a[176:179], a[48:51]
    ds_read_b64_tr_b16 v[40:41], v13
    ds_read_b64_tr_b16 v[42:43], v13 offset:4096
    v_mfma_f32_16x16x32_bf16 a[48:51], v[52:55], a[180:183], a[48:51]
    v_mfma_f32_16x16x32_bf16 a[52:55], v[48:51], a[184:187], a[52:55]
    ds_read_b64_tr_b16 v[44:45], v13 offset:8192
    v_mfma_f32_16x16x32_bf16 a[52:55], v[52:55], a[188:191], a[52:55]
    s_waitcnt lgkmcnt(7)
    ds_read_b64_tr_b16 v[46:47], v13 offset:12288
    v_add_u32 v14, 0x24000, v14
    v_mfma_f32_16x16x32_bf16 a[56:59], v[56:59], a[176:179], a[56:59]
    ds_read_b64_tr_b16 v[48:49], v14
    ds_read_b64_tr_b16 v[50:51], v14 offset:4096
    v_mfma_f32_16x16x32_bf16 a[56:59], v[60:63], a[180:183], a[56:59]
    v_mfma_f32_16x16x32_bf16 a[60:63], v[56:59], a[184:187], a[60:63]
    ds_read_b64_tr_b16 v[52:53], v14 offset:8192
    v_mfma_f32_16x16x32_bf16 a[60:63], v[60:63], a[188:191], a[60:63]
    s_waitcnt lgkmcnt(7)
    s_waitcnt vmcnt(52)
    ds_read_b64_tr_b16 v[54:55], v14 offset:12288
    v_add_u32 v15, 0x24000, v15
    v_mfma_f32_16x16x32_bf16 a[0:3], v[32:35], a[192:195], a[0:3]
    ds_read_b64_tr_b16 v[56:57], v15
    ds_read_b64_tr_b16 v[58:59], v15 offset:4096
    s_add_u32 m0, s29, 32768
    s_mov_b32 s66, 1310720
    v_mfma_f32_16x16x32_bf16 a[0:3], v[36:39], a[196:199], a[0:3]
    buffer_load_dwordx4 v20, s[36:39], s66 offen lds
    v_mfma_f32_16x16x32_bf16 a[4:7], v[32:35], a[200:203], a[4:7]
    ds_read_b64_tr_b16 v[60:61], v15 offset:8192
    v_mfma_f32_16x16x32_bf16 a[4:7], v[36:39], a[204:207], a[4:7]
    s_waitcnt lgkmcnt(7)
    ds_read_b64_tr_b16 v[62:63], v15 offset:12288
    v_add_u32 v16, 0x24000, v16
    v_mfma_f32_16x16x32_bf16 a[8:11], v[40:43], a[192:195], a[8:11]
    ds_read_b64_tr_b16 v[32:33], v16
    ds_read_b64_tr_b16 v[34:35], v16 offset:4096
    v_mfma_f32_16x16x32_bf16 a[8:11], v[44:47], a[196:199], a[8:11]
    buffer_load_dwordx4 v21, s[36:39], s66 offen offset:1024 lds
    v_mfma_f32_16x16x32_bf16 a[12:15], v[40:43], a[200:203], a[12:15]
    ds_read_b64_tr_b16 v[36:37], v16 offset:8192
    v_mfma_f32_16x16x32_bf16 a[12:15], v[44:47], a[204:207], a[12:15]
    s_waitcnt lgkmcnt(7)
    ds_read_b64_tr_b16 v[38:39], v16 offset:12288
    v_add_u32 v17, 0x24000, v17
    v_mfma_f32_16x16x32_bf16 a[16:19], v[48:51], a[192:195], a[16:19]
    ds_read_b64_tr_b16 v[40:41], v17
    ds_read_b64_tr_b16 v[42:43], v17 offset:4096
    v_mfma_f32_16x16x32_bf16 a[16:19], v[52:55], a[196:199], a[16:19]
    buffer_load_dwordx4 v22, s[36:39], s66 offen offset:2048 lds
    v_mfma_f32_16x16x32_bf16 a[20:23], v[48:51], a[200:203], a[20:23]
    ds_read_b64_tr_b16 v[44:45], v17 offset:8192
    v_mfma_f32_16x16x32_bf16 a[20:23], v[52:55], a[204:207], a[20:23]
    s_waitcnt lgkmcnt(7)
    ds_read_b64_tr_b16 v[46:47], v17 offset:12288
    v_add_u32 v18, 0x24000, v18
    v_mfma_f32_16x16x32_bf16 a[24:27], v[56:59], a[192:195], a[24:27]
    ds_read_b64_tr_b16 v[48:49], v18
    ds_read_b64_tr_b16 v[50:51], v18 offset:4096
    v_mfma_f32_16x16x32_bf16 a[24:27], v[60:63], a[196:199], a[24:27]
    buffer_load_dwordx4 v23, s[36:39], s66 offen offset:3072 lds
    v_mfma_f32_16x16x32_bf16 a[28:31], v[56:59], a[200:203], a[28:31]
    ds_read_b64_tr_b16 v[52:53], v18 offset:8192
    v_mfma_f32_16x16x32_bf16 a[28:31], v[60:63], a[204:207], a[28:31]
    s_waitcnt lgkmcnt(7)
    ds_read_b64_tr_b16 v[54:55], v18 offset:12288
    v_add_u32 v19, 0x24000, v19
    v_mfma_f32_16x16x32_bf16 a[32:35], v[32:35], a[192:195], a[32:35]
    ds_read_b64_tr_b16 v[56:57], v19
    ds_read_b64_tr_b16 v[58:59], v19 offset:4096
    v_mfma_f32_16x16x32_bf16 a[32:35], v[36:39], a[196:199], a[32:35]
    v_mfma_f32_16x16x32_bf16 a[36:39], v[32:35], a[200:203], a[36:39]
    ds_read_b64_tr_b16 v[60:61], v19 offset:8192
    v_mfma_f32_16x16x32_bf16 a[36:39], v[36:39], a[204:207], a[36:39]
    s_waitcnt lgkmcnt(7)
    ds_read_b64_tr_b16 v[62:63], v19 offset:12288
    v_add_u32 v12, 0xffff0000, v12
    v_mfma_f32_16x16x32_bf16 a[40:43], v[40:43], a[192:195], a[40:43]
    ds_read_b64_tr_b16 v[32:33], v12
    ds_read_b64_tr_b16 v[34:35], v12 offset:4096
    v_mfma_f32_16x16x32_bf16 a[40:43], v[44:47], a[196:199], a[40:43]
    v_mfma_f32_16x16x32_bf16 a[44:47], v[40:43], a[200:203], a[44:47]
    ds_read_b64_tr_b16 v[36:37], v12 offset:8192
    v_mfma_f32_16x16x32_bf16 a[44:47], v[44:47], a[204:207], a[44:47]
    s_waitcnt lgkmcnt(7)
    ds_read_b64_tr_b16 v[38:39], v12 offset:12288
    v_add_u32 v13, 0xffff0000, v13
    v_mfma_f32_16x16x32_bf16 a[48:51], v[48:51], a[192:195], a[48:51]
    ds_read_b64_tr_b16 v[40:41], v13
    ds_read_b64_tr_b16 v[42:43], v13 offset:4096
    v_mfma_f32_16x16x32_bf16 a[48:51], v[52:55], a[196:199], a[48:51]
    v_mfma_f32_16x16x32_bf16 a[52:55], v[48:51], a[200:203], a[52:55]
    ds_read_b64_tr_b16 v[44:45], v13 offset:8192
    v_mfma_f32_16x16x32_bf16 a[52:55], v[52:55], a[204:207], a[52:55]
    s_waitcnt lgkmcnt(7)
    ds_read_b64_tr_b16 v[46:47], v13 offset:12288
    v_add_u32 v14, 0xffff0000, v14
    v_mfma_f32_16x16x32_bf16 a[56:59], v[56:59], a[192:195], a[56:59]
    ds_read_b64_tr_b16 v[48:49], v14
    ds_read_b64_tr_b16 v[50:51], v14 offset:4096
    v_mfma_f32_16x16x32_bf16 a[56:59], v[60:63], a[196:199], a[56:59]
    v_mfma_f32_16x16x32_bf16 a[60:63], v[56:59], a[200:203], a[60:63]
    s_waitcnt vmcnt(28)
    s_barrier
    ds_read_b64_tr_b16 v[52:53], v14 offset:8192
    v_mfma_f32_16x16x32_bf16 a[60:63], v[60:63], a[204:207], a[60:63]
    s_waitcnt lgkmcnt(7)
    s_waitcnt vmcnt(48)
    ds_read_b64_tr_b16 v[54:55], v14 offset:12288
    v_add_u32 v15, 0xffff0000, v15
    v_mfma_f32_16x16x32_bf16 a[0:3], v[32:35], a[208:211], a[0:3]
    ds_read_b64_tr_b16 v[56:57], v15
    ds_read_b64_tr_b16 v[58:59], v15 offset:4096
    s_add_u32 m0, s29, 49152
    s_mov_b32 s66, 1376256
    v_mfma_f32_16x16x32_bf16 a[0:3], v[36:39], a[212:215], a[0:3]
    buffer_load_dwordx4 v20, s[36:39], s66 offen lds
    v_mfma_f32_16x16x32_bf16 a[4:7], v[32:35], a[216:219], a[4:7]
    ds_read_b64_tr_b16 v[60:61], v15 offset:8192
    v_mfma_f32_16x16x32_bf16 a[4:7], v[36:39], a[220:223], a[4:7]
    s_waitcnt lgkmcnt(7)
    ds_read_b64_tr_b16 v[62:63], v15 offset:12288
    v_add_u32 v16, 0xffff0000, v16
    v_mfma_f32_16x16x32_bf16 a[8:11], v[40:43], a[208:211], a[8:11]
    ds_read_b64_tr_b16 v[32:33], v16
    ds_read_b64_tr_b16 v[34:35], v16 offset:4096
    v_mfma_f32_16x16x32_bf16 a[8:11], v[44:47], a[212:215], a[8:11]
    buffer_load_dwordx4 v21, s[36:39], s66 offen offset:1024 lds
    v_mfma_f32_16x16x32_bf16 a[12:15], v[40:43], a[216:219], a[12:15]
    ds_read_b64_tr_b16 v[36:37], v16 offset:8192
    v_mfma_f32_16x16x32_bf16 a[12:15], v[44:47], a[220:223], a[12:15]
    s_waitcnt lgkmcnt(7)
    ds_read_b64_tr_b16 v[38:39], v16 offset:12288
    v_add_u32 v17, 0xffff0000, v17
    v_mfma_f32_16x16x32_bf16 a[16:19], v[48:51], a[208:211], a[16:19]
    ds_read_b64_tr_b16 v[40:41], v17
    ds_read_b64_tr_b16 v[42:43], v17 offset:4096
    v_mfma_f32_16x16x32_bf16 a[16:19], v[52:55], a[212:215], a[16:19]
    buffer_load_dwordx4 v22, s[36:39], s66 offen offset:2048 lds
    v_mfma_f32_16x16x32_bf16 a[20:23], v[48:51], a[216:219], a[20:23]
    ds_read_b64_tr_b16 v[44:45], v17 offset:8192
    v_mfma_f32_16x16x32_bf16 a[20:23], v[52:55], a[220:223], a[20:23]
    s_waitcnt lgkmcnt(7)
    ds_read_b64_tr_b16 v[46:47], v17 offset:12288
    v_add_u32 v18, 0xffff0000, v18
    v_mfma_f32_16x16x32_bf16 a[24:27], v[56:59], a[208:211], a[24:27]
    ds_read_b64_tr_b16 v[48:49], v18
    ds_read_b64_tr_b16 v[50:51], v18 offset:4096
    v_mfma_f32_16x16x32_bf16 a[24:27], v[60:63], a[212:215], a[24:27]
    buffer_load_dwordx4 v23, s[36:39], s66 offen offset:3072 lds
    v_mfma_f32_16x16x32_bf16 a[28:31], v[56:59], a[216:219], a[28:31]
    ds_read_b64_tr_b16 v[52:53], v18 offset:8192
    v_mfma_f32_16x16x32_bf16 a[28:31], v[60:63], a[220:223], a[28:31]
    s_waitcnt lgkmcnt(7)
    ds_read_b64_tr_b16 v[54:55], v18 offset:12288
    v_add_u32 v19, 0xffff0000, v19
    v_mfma_f32_16x16x32_bf16 a[32:35], v[32:35], a[208:211], a[32:35]
    ds_read_b64_tr_b16 v[56:57], v19
    ds_read_b64_tr_b16 v[58:59], v19 offset:4096
    s_mov_b32 s48, 32768
    s_mov_b32 s49, 163840
    v_mfma_f32_16x16x32_bf16 a[32:35], v[36:39], a[212:215], a[32:35]
    buffer_load_dwordx4 v[96:99], v27, s[40:43], s48 offen sc1
    v_mfma_f32_16x16x32_bf16 a[36:39], v[32:35], a[216:219], a[36:39]
    ds_read_b64_tr_b16 v[60:61], v19 offset:8192
    v_mfma_f32_16x16x32_bf16 a[36:39], v[36:39], a[220:223], a[36:39]
    s_waitcnt lgkmcnt(7)
    ds_read_b64_tr_b16 v[62:63], v19 offset:12288
    v_mfma_f32_16x16x32_bf16 a[40:43], v[40:43], a[208:211], a[40:43]
    ds_read_b64_tr_b16 v[32:33], v12 offset:16384
    ds_read_b64_tr_b16 v[34:35], v12 offset:20480
    v_mfma_f32_16x16x32_bf16 a[40:43], v[44:47], a[212:215], a[40:43]
    buffer_load_dwordx4 v[100:103], v27, s[40:43], s48 offen offset:1024 sc1
    v_mfma_f32_16x16x32_bf16 a[44:47], v[40:43], a[216:219], a[44:47]
    ds_read_b64_tr_b16 v[36:37], v12 offset:24576
    v_mfma_f32_16x16x32_bf16 a[44:47], v[44:47], a[220:223], a[44:47]
    s_waitcnt lgkmcnt(7)
    ds_read_b64_tr_b16 v[38:39], v12 offset:28672
    v_mfma_f32_16x16x32_bf16 a[48:51], v[48:51], a[208:211], a[48:51]
    ds_read_b64_tr_b16 v[40:41], v13 offset:16384
    ds_read_b64_tr_b16 v[42:43], v13 offset:20480
    v_mfma_f32_16x16x32_bf16 a[48:51], v[52:55], a[212:215], a[48:51]
    buffer_load_dwordx4 v[104:107], v27, s[40:43], s49 offen sc1
    v_mfma_f32_16x16x32_bf16 a[52:55], v[48:51], a[216:219], a[52:55]
    ds_read_b64_tr_b16 v[44:45], v13 offset:24576
    v_mfma_f32_16x16x32_bf16 a[52:55], v[52:55], a[220:223], a[52:55]
    s_waitcnt lgkmcnt(7)
    ds_read_b64_tr_b16 v[46:47], v13 offset:28672
    v_mfma_f32_16x16x32_bf16 a[56:59], v[56:59], a[208:211], a[56:59]
    ds_read_b64_tr_b16 v[48:49], v14 offset:16384
    ds_read_b64_tr_b16 v[50:51], v14 offset:20480
    v_mfma_f32_16x16x32_bf16 a[56:59], v[60:63], a[212:215], a[56:59]
    buffer_load_dwordx4 v[108:111], v27, s[40:43], s49 offen offset:1024 sc1
    v_mfma_f32_16x16x32_bf16 a[60:63], v[56:59], a[216:219], a[60:63]
    ds_read_b64_tr_b16 v[52:53], v14 offset:24576
    v_mfma_f32_16x16x32_bf16 a[60:63], v[60:63], a[220:223], a[60:63]
    s_waitcnt lgkmcnt(7)
    s_waitcnt vmcnt(48)
    ds_read_b64_tr_b16 v[54:55], v14 offset:28672
    v_mfma_f32_16x16x32_bf16 a[0:3], v[32:35], a[224:227], a[0:3]
    ds_read_b64_tr_b16 v[56:57], v15 offset:16384
    ds_read_b64_tr_b16 v[58:59], v15 offset:20480
    s_add_u32 m0, s29, 65536
    s_mov_b32 s66, 1572864
    v_mfma_f32_16x16x32_bf16 a[0:3], v[36:39], a[228:231], a[0:3]
    buffer_load_dwordx4 v20, s[36:39], s66 offen lds
    v_mfma_f32_16x16x32_bf16 a[4:7], v[32:35], a[232:235], a[4:7]
    ds_read_b64_tr_b16 v[60:61], v15 offset:24576
    v_mfma_f32_16x16x32_bf16 a[4:7], v[36:39], a[236:239], a[4:7]
    s_waitcnt lgkmcnt(7)
    ds_read_b64_tr_b16 v[62:63], v15 offset:28672
    v_mfma_f32_16x16x32_bf16 a[8:11], v[40:43], a[224:227], a[8:11]
    ds_read_b64_tr_b16 v[32:33], v16 offset:16384
    ds_read_b64_tr_b16 v[34:35], v16 offset:20480
    v_mfma_f32_16x16x32_bf16 a[8:11], v[44:47], a[228:231], a[8:11]
    buffer_load_dwordx4 v21, s[36:39], s66 offen offset:1024 lds
    v_mfma_f32_16x16x32_bf16 a[12:15], v[40:43], a[232:235], a[12:15]
    ds_read_b64_tr_b16 v[36:37], v16 offset:24576
    v_mfma_f32_16x16x32_bf16 a[12:15], v[44:47], a[236:239], a[12:15]
    s_waitcnt lgkmcnt(7)
    ds_read_b64_tr_b16 v[38:39], v16 offset:28672
    v_mfma_f32_16x16x32_bf16 a[16:19], v[48:51], a[224:227], a[16:19]
    ds_read_b64_tr_b16 v[40:41], v17 offset:16384
    ds_read_b64_tr_b16 v[42:43], v17 offset:20480
    v_mfma_f32_16x16x32_bf16 a[16:19], v[52:55], a[228:231], a[16:19]
    buffer_load_dwordx4 v22, s[36:39], s66 offen offset:2048 lds
    v_mfma_f32_16x16x32_bf16 a[20:23], v[48:51], a[232:235], a[20:23]
    ds_read_b64_tr_b16 v[44:45], v17 offset:24576
    v_mfma_f32_16x16x32_bf16 a[20:23], v[52:55], a[236:239], a[20:23]
    s_waitcnt lgkmcnt(7)
    ds_read_b64_tr_b16 v[46:47], v17 offset:28672
    v_mfma_f32_16x16x32_bf16 a[24:27], v[56:59], a[224:227], a[24:27]
    ds_read_b64_tr_b16 v[48:49], v18 offset:16384
    ds_read_b64_tr_b16 v[50:51], v18 offset:20480
    v_mfma_f32_16x16x32_bf16 a[24:27], v[60:63], a[228:231], a[24:27]
    buffer_load_dwordx4 v23, s[36:39], s66 offen offset:3072 lds
    v_mfma_f32_16x16x32_bf16 a[28:31], v[56:59], a[232:235], a[28:31]
    ds_read_b64_tr_b16 v[52:53], v18 offset:24576
    v_mfma_f32_16x16x32_bf16 a[28:31], v[60:63], a[236:239], a[28:31]
    s_waitcnt lgkmcnt(7)
    ds_read_b64_tr_b16 v[54:55], v18 offset:28672
    v_mfma_f32_16x16x32_bf16 a[32:35], v[32:35], a[224:227], a[32:35]
    ds_read_b64_tr_b16 v[56:57], v19 offset:16384
    ds_read_b64_tr_b16 v[58:59], v19 offset:20480
    s_mov_b32 s48, 32768
    s_mov_b32 s49, 163840
    v_mfma_f32_16x16x32_bf16 a[32:35], v[36:39], a[228:231], a[32:35]
    buffer_load_dwordx4 v[112:115], v27, s[40:43], s48 offen offset:2048 sc1
    v_mfma_f32_16x16x32_bf16 a[36:39], v[32:35], a[232:235], a[36:39]
    ds_read_b64_tr_b16 v[60:61], v19 offset:24576
    v_mfma_f32_16x16x32_bf16 a[36:39], v[36:39], a[236:239], a[36:39]
    s_waitcnt lgkmcnt(7)
    ds_read_b64_tr_b16 v[62:63], v19 offset:28672
    v_add_u32 v12, 0xffff0000, v12
    v_mfma_f32_16x16x32_bf16 a[40:43], v[40:43], a[224:227], a[40:43]
    ds_read_b64_tr_b16 v[32:33], v12
    ds_read_b64_tr_b16 v[34:35], v12 offset:4096
    v_mfma_f32_16x16x32_bf16 a[40:43], v[44:47], a[228:231], a[40:43]
    buffer_load_dwordx4 v[116:119], v27, s[40:43], s48 offen offset:3072 sc1
    v_mfma_f32_16x16x32_bf16 a[44:47], v[40:43], a[232:235], a[44:47]
    ds_read_b64_tr_b16 v[36:37], v12 offset:8192
    v_mfma_f32_16x16x32_bf16 a[44:47], v[44:47], a[236:239], a[44:47]
    s_waitcnt lgkmcnt(7)
    ds_read_b64_tr_b16 v[38:39], v12 offset:12288
    v_add_u32 v13, 0xffff0000, v13
    v_mfma_f32_16x16x32_bf16 a[48:51], v[48:51], a[224:227], a[48:51]
    ds_read_b64_tr_b16 v[40:41], v13
    ds_read_b64_tr_b16 v[42:43], v13 offset:4096
    v_mfma_f32_16x16x32_bf16 a[48:51], v[52:55], a[228:231], a[48:51]
    buffer_load_dwordx4 v[120:123], v27, s[40:43], s49 offen offset:2048 sc1
    v_mfma_f32_16x16x32_bf16 a[52:55], v[48:51], a[232:235], a[52:55]
    ds_read_b64_tr_b16 v[44:45], v13 offset:8192
    v_mfma_f32_16x16x32_bf16 a[52:55], v[52:55], a[236:239], a[52:55]
    s_waitcnt lgkmcnt(7)
    ds_read_b64_tr_b16 v[46:47], v13 offset:12288
    v_add_u32 v14, 0xffff0000, v14
    v_mfma_f32_16x16x32_bf16 a[56:59], v[56:59], a[224:227], a[56:59]
    ds_read_b64_tr_b16 v[48:49], v14
    ds_read_b64_tr_b16 v[50:51], v14 offset:4096
    v_mfma_f32_16x16x32_bf16 a[56:59], v[60:63], a[228:231], a[56:59]
    buffer_load_dwordx4 v[124:127], v27, s[40:43], s49 offen offset:3072 sc1
    v_mfma_f32_16x16x32_bf16 a[60:63], v[56:59], a[232:235], a[60:63]
    s_waitcnt vmcnt(20)
    s_barrier
    ds_read_b64_tr_b16 v[52:53], v14 offset:8192
    v_mfma_f32_16x16x32_bf16 a[60:63], v[60:63], a[236:239], a[60:63]
    s_waitcnt lgkmcnt(7)
    s_waitcnt vmcnt(52)
    ds_read_b64_tr_b16 v[54:55], v14 offset:12288
    v_add_u32 v15, 0xffff0000, v15
    v_mfma_f32_16x16x32_bf16 a[0:3], v[32:35], a[240:243], a[0:3]
    ds_read_b64_tr_b16 v[56:57], v15
    ds_read_b64_tr_b16 v[58:59], v15 offset:4096
    s_add_u32 m0, s29, 0
    s_mov_b32 s66, 1638400
    v_mfma_f32_16x16x32_bf16 a[0:3], v[36:39], a[244:247], a[0:3]
    buffer_load_dwordx4 v20, s[36:39], s66 offen lds
    v_mfma_f32_16x16x32_bf16 a[4:7], v[32:35], a[248:251], a[4:7]
    ds_read_b64_tr_b16 v[60:61], v15 offset:8192
    v_mfma_f32_16x16x32_bf16 a[4:7], v[36:39], a[252:255], a[4:7]
    s_waitcnt lgkmcnt(7)
    ds_read_b64_tr_b16 v[62:63], v15 offset:12288
    v_add_u32 v16, 0xffff0000, v16
    v_mfma_f32_16x16x32_bf16 a[8:11], v[40:43], a[240:243], a[8:11]
    ds_read_b64_tr_b16 v[32:33], v16
    ds_read_b64_tr_b16 v[34:35], v16 offset:4096
    v_mfma_f32_16x16x32_bf16 a[8:11], v[44:47], a[244:247], a[8:11]
    buffer_load_dwordx4 v21, s[36:39], s66 offen offset:1024 lds
    v_mfma_f32_16x16x32_bf16 a[12:15], v[40:43], a[248:251], a[12:15]
    ds_read_b64_tr_b16 v[36:37], v16 offset:8192
    v_mfma_f32_16x16x32_bf16 a[12:15], v[44:47], a[252:255], a[12:15]
    s_waitcnt lgkmcnt(7)
    ds_read_b64_tr_b16 v[38:39], v16 offset:12288
    v_add_u32 v17, 0xffff0000, v17
    v_mfma_f32_16x16x32_bf16 a[16:19], v[48:51], a[240:243], a[16:19]
    ds_read_b64_tr_b16 v[40:41], v17
    ds_read_b64_tr_b16 v[42:43], v17 offset:4096
    v_mfma_f32_16x16x32_bf16 a[16:19], v[52:55], a[244:247], a[16:19]
    buffer_load_dwordx4 v22, s[36:39], s66 offen offset:2048 lds
    v_mfma_f32_16x16x32_bf16 a[20:23], v[48:51], a[248:251], a[20:23]
    ds_read_b64_tr_b16 v[44:45], v17 offset:8192
    v_mfma_f32_16x16x32_bf16 a[20:23], v[52:55], a[252:255], a[20:23]
    s_waitcnt lgkmcnt(7)
    ds_read_b64_tr_b16 v[46:47], v17 offset:12288
    v_add_u32 v18, 0xffff0000, v18
    v_mfma_f32_16x16x32_bf16 a[24:27], v[56:59], a[240:243], a[24:27]
    ds_read_b64_tr_b16 v[48:49], v18
    ds_read_b64_tr_b16 v[50:51], v18 offset:4096
    v_mfma_f32_16x16x32_bf16 a[24:27], v[60:63], a[244:247], a[24:27]
    buffer_load_dwordx4 v23, s[36:39], s66 offen offset:3072 lds
    v_mfma_f32_16x16x32_bf16 a[28:31], v[56:59], a[248:251], a[28:31]
    ds_read_b64_tr_b16 v[52:53], v18 offset:8192
    v_mfma_f32_16x16x32_bf16 a[28:31], v[60:63], a[252:255], a[28:31]
    s_waitcnt lgkmcnt(7)
    ds_read_b64_tr_b16 v[54:55], v18 offset:12288
    v_add_u32 v19, 0xffff0000, v19
    v_mfma_f32_16x16x32_bf16 a[32:35], v[32:35], a[240:243], a[32:35]
    ds_read_b64_tr_b16 v[56:57], v19
    ds_read_b64_tr_b16 v[58:59], v19 offset:4096
    s_mov_b32 s48, 40960
    s_mov_b32 s49, 172032
    v_mfma_f32_16x16x32_bf16 a[32:35], v[36:39], a[244:247], a[32:35]
    buffer_load_dwordx4 v[128:131], v27, s[40:43], s48 offen sc1
    v_mfma_f32_16x16x32_bf16 a[36:39], v[32:35], a[248:251], a[36:39]
    ds_read_b64_tr_b16 v[60:61], v19 offset:8192
    v_mfma_f32_16x16x32_bf16 a[36:39], v[36:39], a[252:255], a[36:39]
    s_waitcnt lgkmcnt(7)
    ds_read_b64_tr_b16 v[62:63], v19 offset:12288
    v_add_u32 v12, 0x18000, v12
    v_mfma_f32_16x16x32_bf16 a[40:43], v[40:43], a[240:243], a[40:43]
    ds_read_b64_tr_b16 v[32:33], v12
    ds_read_b64_tr_b16 v[34:35], v12 offset:4096
    v_mfma_f32_16x16x32_bf16 a[40:43], v[44:47], a[244:247], a[40:43]
    buffer_load_dwordx4 v[132:135], v27, s[40:43], s48 offen offset:1024 sc1
    v_mfma_f32_16x16x32_bf16 a[44:47], v[40:43], a[248:251], a[44:47]
    s_cmp_eq_u32 s28, 0
    ds_read_b64_tr_b16 v[36:37], v12 offset:8192
    v_mfma_f32_16x16x32_bf16 a[44:47], v[44:47], a[252:255], a[44:47]
    s_waitcnt lgkmcnt(7)
    s_cbranch_scc0 L_nopoll2
    global_load_dword v6, v28, s[60:61] sc1
L_nopoll2:
    ds_read_b64_tr_b16 v[38:39], v12 offset:12288
    v_add_u32 v13, 0x18000, v13
    v_mfma_f32_16x16x32_bf16 a[48:51], v[48:51], a[240:243], a[48:51]
    ds_read_b64_tr_b16 v[40:41], v13
    ds_read_b64_tr_b16 v[42:43], v13 offset:4096
    v_mfma_f32_16x16x32_bf16 a[48:51], v[52:55], a[244:247], a[48:51]
    buffer_load_dwordx4 v[136:139], v27, s[40:43], s49 offen sc1
    v_mfma_f32_16x16x32_bf16 a[52:55], v[48:51], a[248:251], a[52:55]
    ds_read_b64_tr_b16 v[44:45], v13 offset:8192
    v_mfma_f32_16x16x32_bf16 a[52:55], v[52:55], a[252:255], a[52:55]
    s_waitcnt lgkmcnt(7)
    ds_read_b64_tr_b16 v[46:47], v13 offset:12288
    v_add_u32 v14, 0x18000, v14
    v_mfma_f32_16x16x32_bf16 a[56:59], v[56:59], a[240:243], a[56:59]
    ds_read_b64_tr_b16 v[48:49], v14
    ds_read_b64_tr_b16 v[50:51], v14 offset:4096
    v_mfma_f32_16x16x32_bf16 a[56:59], v[60:63], a[244:247], a[56:59]
    buffer_load_dwordx4 v[140:143], v27, s[40:43], s49 offen offset:1024 sc1
    v_mfma_f32_16x16x32_bf16 a[60:63], v[56:59], a[248:251], a[60:63]
    ds_read_b64_tr_b16 v[52:53], v14 offset:8192
    v_mfma_f32_16x16x32_bf16 a[60:63], v[60:63], a[252:255], a[60:63]
    s_waitcnt lgkmcnt(7)
    s_waitcnt vmcnt(16)
    ds_read_b64_tr_b16 v[54:55], v14 offset:12288
    v_add_u32 v15, 0x18000, v15
    v_mfma_f32_16x16x32_bf16 a[0:3], v[32:35], v[96:99], a[0:3]
    ds_read_b64_tr_b16 v[56:57], v15
    ds_read_b64_tr_b16 v[58:59], v15 offset:4096
    s_add_u32 m0, s29, 147456
    s_mov_b32 s66, 1835008
    v_mfma_f32_16x16x32_bf16 a[0:3], v[36:39], v[100:103], a[0:3]
    buffer_load_dwordx4 v20, s[36:39], s66 offen lds
    v_mfma_f32_16x16x32_bf16 a[4:7], v[32:35], v[104:107], a[4:7]
    ds_read_b64_tr_b16 v[60:61], v15 offset:8192
    v_mfma_f32_16x16x32_bf16 a[4:7], v[36:39], v[108:111], a[4:7]
    s_waitcnt lgkmcnt(7)
    ds_read_b64_tr_b16 v[62:63], v15 offset:12288
    v_add_u32 v16, 0x18000, v16
    v_mfma_f32_16x16x32_bf16 a[8:11], v[40:43], v[96:99], a[8:11]
    ds_read_b64_tr_b16 v[32:33], v16
    ds_read_b64_tr_b16 v[34:35], v16 offset:4096
    v_mfma_f32_16x16x32_bf16 a[8:11], v[44:47], v[100:103], a[8:11]
    buffer_load_dwordx4 v21, s[36:39], s66 offen offset:1024 lds
    v_mfma_f32_16x16x32_bf16 a[12:15], v[40:43], v[104:107], a[12:15]
    ds_read_b64_tr_b16 v[36:37], v16 offset:8192
    v_mfma_f32_16x16x32_bf16 a[12:15], v[44:47], v[108:111], a[12:15]
    s_waitcnt lgkmcnt(7)
    ds_read_b64_tr_b16 v[38:39], v16 offset:12288
    v_add_u32 v17, 0x18000, v17
    v_mfma_f32_16x16x32_bf16 a[16:19], v[48:51], v[96:99], a[16:19]
    ds_read_b64_tr_b16 v[40:41], v17
    ds_read_b64_tr_b16 v[42:43], v17 offset:4096
    v_mfma_f32_16x16x32_bf16 a[16:19], v[52:55], v[100:103], a[16:19]
    buffer_load_dwordx4 v22, s[36:39], s66 offen offset:2048 lds
    v_mfma_f32_16x16x32_bf16 a[20:23], v[48:51], v[104:107], a[20:23]
    ds_read_b64_tr_b16 v[44:45], v17 offset:8192
    v_mfma_f32_16x16x32_bf16 a[20:23], v[52:55], v[108:111], a[20:23]
    s_waitcnt lgkmcnt(7)
    ds_read_b64_tr_b16 v[46:47], v17 offset:12288
    v_add_u32 v18, 0x18000, v18
    v_mfma_f32_16x16x32_bf16 a[24:27], v[56:59], v[96:99], a[24:27]
    ds_read_b64_tr_b16 v[48:49], v18
    ds_read_b64_tr_b16 v[50:51], v18 offset:4096
    v_mfma_f32_16x16x32_bf16 a[24:27], v[60:63], v[100:103], a[24:27]
    buffer_load_dwordx4 v23, s[36:39], s66 offen offset:3072 lds
    v_mfma_f32_16x16x32_bf16 a[28:31], v[56:59], v[104:107], a[28:31]
    ds_read_b64_tr_b16 v[52:53], v18 offset:8192
    v_mfma_f32_16x16x32_bf16 a[28:31], v[60:63], v[108:111], a[28:31]
    s_waitcnt lgkmcnt(7)
    ds_read_b64_tr_b16 v[54:55], v18 offset:12288
    v_add_u32 v19, 0x18000, v19
    v_mfma_f32_16x16x32_bf16 a[32:35], v[32:35], v[96:99], a[32:35]
    ds_read_b64_tr_b16 v[56:57], v19
    ds_read_b64_tr_b16 v[58:59], v19 offset:4096
    s_mov_b32 s48, 40960
    s_mov_b32 s49, 172032
    v_mfma_f32_16x16x32_bf16 a[32:35], v[36:39], v[100:103], a[32:35]
    buffer_load_dwordx4 v[144:147], v27, s[40:43], s48 offen offset:2048 sc1
    v_mfma_f32_16x16x32_bf16 a[36:39], v[32:35], v[104:107], a[36:39]
    ds_read_b64_tr_b16 v[60:61], v19 offset:8192
    v_mfma_f32_16x16x32_bf16 a[36:39], v[36:39], v[108:111], a[36:39]
    s_waitcnt lgkmcnt(7)
    ds_read_b64_tr_b16 v[62:63], v19 offset:12288
    v_mfma_f32_16x16x32_bf16 a[40:43], v[40:43], v[96:99], a[40:43]
    ds_read_b64_tr_b16 v[32:33], v12 offset:16384
    ds_read_b64_tr_b16 v[34:35], v12 offset:20480
    v_mfma_f32_16x16x32_bf16 a[40:43], v[44:47], v[100:103], a[40:43]
    buffer_load_dwordx4 v[148:151], v27, s[40:43], s48 offen offset:3072 sc1
    v_mfma_f32_16x16x32_bf16 a[44:47], v[40:43], v[104:107], a[44:47]
    ds_read_b64_tr_b16 v[36:37], v12 offset:24576
    v_mfma_f32_16x16x32_bf16 a[44:47], v[44:47], v[108:111], a[44:47]
    s_waitcnt lgkmcnt(7)
    ds_read_b64_tr_b16 v[38:39], v12 offset:28672
    v_mfma_f32_16x16x32_bf16 a[48:51], v[48:51], v[96:99], a[48:51]
    ds_read_b64_tr_b16 v[40:41], v13 offset:16384
    ds_read_b64_tr_b16 v[42:43], v13 offset:20480
    v_mfma_f32_16x16x32_bf16 a[48:51], v[52:55], v[100:103], a[48:51]
    buffer_load_dwordx4 v[152:155], v27, s[40:43], s49 offen offset:2048 sc1
    v_mfma_f32_16x16x32_bf16 a[52:55], v[48:51], v[104:107], a[52:55]
    ds_read_b64_tr_b16 v[44:45], v13 offset:24576
    v_mfma_f32_16x16x32_bf16 a[52:55], v[52:55], v[108:111], a[52:55]
    s_waitcnt lgkmcnt(7)
    ds_read_b64_tr_b16 v[46:47], v13 offset:28672
    v_mfma_f32_16x16x32_bf16 a[56:59], v[56:59], v[96:99], a[56:59]
    ds_read_b64_tr_b16 v[48:49], v14 offset:16384
    ds_read_b64_tr_b16 v[50:51], v14 offset:20480
    v_mfma_f32_16x16x32_bf16 a[56:59], v[60:63], v[100:103], a[56:59]
    buffer_load_dwordx4 v[156:159], v27, s[40:43], s49 offen offset:3072 sc1
    v_mfma_f32_16x16x32_bf16 a[60:63], v[56:59], v[104:107], a[60:63]
    s_cmp_eq_u32 s28, 0
    s_cbranch_scc0 L_back2
    s_waitcnt vmcnt(10)
    v_readfirstlane_b32 s56, v6
    s_nop 2
    s_cmp_ge_u32 s56, 16
    s_cbranch_scc0 L_spin2
L_back2:
    s_waitcnt vmcnt(28)
    s_barrier
    ds_read_b64_tr_b16 v[52:53], v14 offset:24576
    v_mfma_f32_16x16x32_bf16 a[60:63], v[60:63], v[108:111], a[60:63]
    s_waitcnt lgkmcnt(7)
    s_waitcnt vmcnt(16)
    ds_read_b64_tr_b16 v[54:55], v14 offset:28672
    v_mfma_f32_16x16x32_bf16 a[0:3], v[32:35], v[112:115], a[0:3]
    ds_read_b64_tr_b16 v[56:57], v15 offset:16384
    ds_read_b64_tr_b16 v[58:59], v15 offset:20480
    s_add_u32 m0, s29, 81920
    s_mov_b32 s66, 1900544
    v_mfma_f32_16x16x32_bf16 a[0:3], v[36:39], v[116:119], a[0:3]
    buffer_load_dwordx4 v20, s[36:39], s66 offen lds
    v_mfma_f32_16x16x32_bf16 a[4:7], v[32:35], v[120:123], a[4:7]
    ds_read_b64_tr_b16 v[60:61], v15 offset:24576
    v_mfma_f32_16x16x32_bf16 a[4:7], v[36:39], v[124:127], a[4:7]
    s_waitcnt lgkmcnt(7)
    ds_read_b64_tr_b16 v[62:63], v15 offset:28672
    v_mfma_f32_16x16x32_bf16 a[8:11], v[40:43], v[112:115], a[8:11]
L_hop16:
    s_cbranch_execz L_hopret
    ds_read_b64_tr_b16 v[32:33], v16 offset:16384
    ds_read_b64_tr_b16 v[34:35], v16 offset:20480
    v_mfma_f32_16x16x32_bf16 a[8:11], v[44:47], v[116:119], a[8:11]
    buffer_load_dwordx4 v21, s[36:39], s66 offen offset:1024 lds
    v_mfma_f32_16x16x32_bf16 a[12:15], v[40:43], v[120:123], a[12:15]
    ds_read_b64_tr_b16 v[36:37], v16 offset:24576
    v_mfma_f32_16x16x32_bf16 a[12:15], v[44:47], v[124:127], a[12:15]
    s_waitcnt lgkmcnt(7)
    ds_read_b64_tr_b16 v[38:39], v16 offset:28672
    v_mfma_f32_16x16x32_bf16 a[16:19], v[48:51], v[112:115], a[16:19]
    ds_read_b64_tr_b16 v[40:41], v17 offset:16384
    ds_read_b64_tr_b16 v[42:43], v17 offset:20480
    v_mfma_f32_16x16x32_bf16 a[16:19], v[52:55], v[116:119], a[16:19]
    buffer_load_dwordx4 v22, s[36:39], s66 offen offset:2048 lds
    v_mfma_f32_16x16x32_bf16 a[20:23], v[48:51], v[120:123], a[20:23]
    ds_read_b64_tr_b16 v[44:45], v17 offset:24576
    v_mfma_f32_16x16x32_bf16 a[20:23], v[52:55], v[124:127], a[20:23]
    s_waitcnt lgkmcnt(7)
    ds_read_b64_tr_b16 v[46:47], v17 offset:28672
    v_mfma_f32_16x16x32_bf16 a[24:27], v[56:59], v[112:115], a[24:27]
    ds_read_b64_tr_b16 v[48:49], v18 offset:16384
    ds_read_b64_tr_b16 v[50:51], v18 offset:20480
    v_mfma_f32_16x16x32_bf16 a[24:27], v[60:63], v[116:119], a[24:27]
    buffer_load_dwordx4 v23, s[36:39], s66 offen offset:3072 lds
    v_mfma_f32_16x16x32_bf16 a[28:31], v[56:59], v[120:123], a[28:31]
    ds_read_b64_tr_b16 v[52:53], v18 offset:24576
    v_mfma_f32_16x16x32_bf16 a[28:31], v[60:63], v[124:127], a[28:31]
    s_waitcnt lgkmcnt(7)
    ds_read_b64_tr_b16 v[54:55], v18 offset:28672
    v_mfma_f32_16x16x32_bf16 a[32:35], v[32:35], v[112:115], a[32:35]
    ds_read_b64_tr_b16 v[56:57], v19 offset:16384
    ds_read_b64_tr_b16 v[58:59], v19 offset:20480
    s_mov_b32 s48, 49152
    s_mov_b32 s49, 180224
    v_mfma_f32_16x16x32_bf16 a[32:35], v[36:39], v[116:119], a[32:35]
    buffer_load_dwordx4 v[160:163], v27, s[40:43], s48 offen sc1
    v_mfma_f32_16x16x32_bf16 a[36:39], v[32:35], v[120:123], a[36:39]
    ds_read_b64_tr_b16 v[60:61], v19 offset:24576
    v_mfma_f32_16x16x32_bf16 a[36:39], v[36:39], v[124:127], a[36:39]
    s_waitcnt lgkmcnt(7)
    ds_read_b64_tr_b16 v[62:63], v19 offset:28672
    v_add_u32 v12, 0xfffec000, v12
    v_mfma_f32_16x16x32_bf16 a[40:43], v[40:43], v[112:115], a[40:43]
    ds_read_b64_tr_b16 v[32:33], v12
    ds_read_b64_tr_b16 v[34:35], v12 offset:4096
    v_mfma_f32_16x16x32_bf16 a[40:43], v[44:47], v[116:119], a[40:43]
    buffer_load_dwordx4 v[164:167], v27, s[40:43], s48 offen offset:1024 sc1
    v_mfma_f32_16x16x32_bf16 a[44:47], v[40:43], v[120:123], a[44:47]
    ds_read_b64_tr_b16 v[36:37], v12 offset:8192
    v_mfma_f32_16x16x32_bf16 a[44:47], v[44:47], v[124:127], a[44:47]
    s_waitcnt lgkmcnt(7)
    ds_read_b64_tr_b16 v[38:39], v12 offset:12288
    v_add_u32 v13, 0xfffec000, v13
    v_mfma_f32_16x16x32_bf16 a[48:51], v[48:51], v[112:115], a[48:51]
    ds_read_b64_tr_b16 v[40:41], v13
    ds_read_b64_tr_b16 v[42:43], v13 offset:4096
    v_mfma_f32_16x16x32_bf16 a[48:51], v[52:55], v[116:119], a[48:51]
    buffer_load_dwordx4 v[168:171], v27, s[40:43], s49 offen sc1
    v_mfma_f32_16x16x32_bf16 a[52:55], v[48:51], v[120:123], a[52:55]
    ds_read_b64_tr_b16 v[44:45], v13 offset:8192
    v_mfma_f32_16x16x32_bf16 a[52:55], v[52:55], v[124:127], a[52:55]
    s_waitcnt lgkmcnt(7)
    ds_read_b64_tr_b16 v[46:47], v13 offset:12288
    v_add_u32 v14, 0xfffec000, v14
    v_mfma_f32_16x16x32_bf16 a[56:59], v[56:59], v[112:115], a[56:59]
    ds_read_b64_tr_b16 v[48:49], v14
    ds_read_b64_tr_b16 v[50:51], v14 offset:4096
    v_mfma_f32_16x16x32_bf16 a[56:59], v[60:63], v[116:119], a[56:59]
    buffer_load_dwordx4 v[172:175], v27, s[40:43], s49 offen offset:1024 sc1
    v_mfma_f32_16x16x32_bf16 a[60:63], v[56:59], v[120:123], a[60:63]
    ds_read_b64_tr_b16 v[52:53], v14 offset:8192
    v_mfma_f32_16x16x32_bf16 a[60:63], v[60:63], v[124:127], a[60:63]
    s_waitcnt lgkmcnt(7)
    s_waitcnt vmcnt(16)
    ds_read_b64_tr_b16 v[54:55], v14 offset:12288
    v_add_u32 v15, 0xfffec000, v15
    v_mfma_f32_16x16x32_bf16 a[0:3], v[32:35], v[128:131], a[0:3]
    ds_read_b64_tr_b16 v[56:57], v15
    ds_read_b64_tr_b16 v[58:59], v15 offset:4096
    s_mov_b32 s48, 4096
    s_mov_b32 s49, 135168
    v_mfma_f32_16x16x32_bf16 a[0:3], v[36:39], v[132:135], a[0:3]
    buffer_load_dwordx4 a[64:67], v27, s[40:43], s48 offen sc1
    v_mfma_f32_16x16x32_bf16 a[4:7], v[32:35], v[136:139], a[4:7]
    ds_read_b64_tr_b16 v[60:61], v15 offset:8192
    v_mfma_f32_16x16x32_bf16 a[4:7], v[36:39], v[140:143], a[4:7]
    s_waitcnt lgkmcnt(7)
    ds_read_b64_tr_b16 v[62:63], v15 offset:12288
    v_add_u32 v16, 0xfffec000, v16
    v_mfma_f32_16x16x32_bf16 a[8:11], v[40:43], v[128:131], a[8:11]
    ds_read_b64_tr_b16 v[32:33], v16
    ds_read_b64_tr_b16 v[34:35], v16 offset:4096
    v_mfma_f32_16x16x32_bf16 a[8:11], v[44:47], v[132:135], a[8:11]
    buffer_load_dwordx4 a[68:71], v27, s[40:43], s48 offen offset:1024 sc1
    v_mfma_f32_16x16x32_bf16 a[12:15], v[40:43], v[136:139], a[12:15]
    ds_read_b64_tr_b16 v[36:37], v16 offset:8192
    v_mfma_f32_16x16x32_bf16 a[12:15], v[44:47], v[140:143], a[12:15]
    s_waitcnt lgkmcnt(7)
    ds_read_b64_tr_b16 v[38:39], v16 offset:12288
    v_add_u32 v17, 0xfffec000, v17
    v_mfma_f32_16x16x32_bf16 a[16:19], v[48:51], v[128:131], a[16:19]
    ds_read_b64_tr_b16 v[40:41], v17
    ds_read_b64_tr_b16 v[42:43], v17 offset:4096
    v_mfma_f32_16x16x32_bf16 a[16:19], v[52:55], v[132:135], a[16:19]
    buffer_load_dwordx4 a[72:75], v27, s[40:43], s49 offen sc1
    v_mfma_f32_16x16x32_bf16 a[20:23], v[48:51], v[136:139], a[20:23]
    ds_read_b64_tr_b16 v[44:45], v17 offset:8192
    v_mfma_f32_16x16x32_bf16 a[20:23], v[52:55], v[140:143], a[20:23]
    s_waitcnt lgkmcnt(7)
    ds_read_b64_tr_b16 v[46:47], v17 offset:12288
    v_add_u32 v18, 0xfffec000, v18
    v_mfma_f32_16x16x32_bf16 a[24:27], v[56:59], v[128:131], a[24:27]
    ds_read_b64_tr_b16 v[48:49], v18
    ds_read_b64_tr_b16 v[50:51], v18 offset:4096
    v_mfma_f32_16x16x32_bf16 a[24:27], v[60:63], v[132:135], a[24:27]
    buffer_load_dwordx4 a[76:79], v27, s[40:43], s49 offen offset:1024 sc1
    v_mfma_f32_16x16x32_bf16 a[28:31], v[56:59], v[136:139], a[28:31]
    ds_read_b64_tr_b16 v[52:53], v18 offset:8192
    v_mfma_f32_16x16x32_bf16 a[28:31], v[60:63], v[140:143], a[28:31]
    s_waitcnt lgkmcnt(7)
    ds_read_b64_tr_b16 v[54:55], v18 offset:12288
    v_add_u32 v19, 0xfffec000, v19
    v_mfma_f32_16x16x32_bf16 a[32:35], v[32:35], v[128:131], a[32:35]
    ds_read_b64_tr_b16 v[56:57], v19
    ds_read_b64_tr_b16 v[58:59], v19 offset:4096
    s_mov_b32 s48, 4096
    s_mov_b32 s49, 135168
    v_mfma_f32_16x16x32_bf16 a[32:35], v[36:39], v[132:135], a[32:35]
    buffer_load_dwordx4 a[80:83], v27, s[40:43], s48 offen offset:2048 sc1
    v_mfma_f32_16x16x32_bf16 a[36:39], v[32:35], v[136:139], a[36:39]
    ds_read_b64_tr_b16 v[60:61], v19 offset:8192
    v_mfma_f32_16x16x32_bf16 a[36:39], v[36:39], v[140:143], a[36:39]
    s_waitcnt lgkmcnt(7)
    ds_read_b64_tr_b16 v[62:63], v19 offset:12288
    v_mfma_f32_16x16x32_bf16 a[40:43], v[40:43], v[128:131], a[40:43]
    ds_read_b64_tr_b16 v[32:33], v12 offset:16384
    ds_read_b64_tr_b16 v[34:35], v12 offset:20480
    v_mfma_f32_16x16x32_bf16 a[40:43], v[44:47], v[132:135], a[40:43]
    buffer_load_dwordx4 a[84:87], v27, s[40:43], s48 offen offset:3072 sc1
    v_mfma_f32_16x16x32_bf16 a[44:47], v[40:43], v[136:139], a[44:47]
    ds_read_b64_tr_b16 v[36:37], v12 offset:24576
    v_mfma_f32_16x16x32_bf16 a[44:47], v[44:47], v[140:143], a[44:47]
    s_waitcnt lgkmcnt(7)
    ds_read_b64_tr_b16 v[38:39], v12 offset:28672
    v_mfma_f32_16x16x32_bf16 a[48:51], v[48:51], v[128:131], a[48:51]
    ds_read_b64_tr_b16 v[40:41], v13 offset:16384
    ds_read_b64_tr_b16 v[42:43], v13 offset:20480
    v_mfma_f32_16x16x32_bf16 a[48:51], v[52:55], v[132:135], a[48:51]
    buffer_load_dwordx4 a[88:91], v27, s[40:43], s49 offen offset:2048 sc1
    v_mfma_f32_16x16x32_bf16 a[52:55], v[48:51], v[136:139], a[52:55]
    ds_read_b64_tr_b16 v[44:45], v13 offset:24576
    v_mfma_f32_16x16x32_bf16 a[52:55], v[52:55], v[140:143], a[52:55]
    s_waitcnt lgkmcnt(7)
    ds_read_b64_tr_b16 v[46:47], v13 offset:28672
    v_mfma_f32_16x16x32_bf16 a[56:59], v[56:59], v[128:131], a[56:59]
    ds_read_b64_tr_b16 v[48:49], v14 offset:16384
    ds_read_b64_tr_b16 v[50:51], v14 offset:20480
    v_mfma_f32_16x16x32_bf16 a[56:59], v[60:63], v[132:135], a[56:59]
    buffer_load_dwordx4 a[92:95], v27, s[40:43], s49 offen offset:3072 sc1
    v_mfma_f32_16x16x32_bf16 a[60:63], v[56:59], v[136:139], a[60:63]
    s_waitcnt vmcnt(28)
    s_barrier
    ds_read_b64_tr_b16 v[52:53], v14 offset:24576
    v_mfma_f32_16x16x32_bf16 a[60:63], v[60:63], v[140:143], a[60:63]
    s_waitcnt lgkmcnt(7)
    s_waitcnt vmcnt(16)
    ds_read_b64_tr_b16 v[54:55], v14 offset:28672
    v_xor_b32 v5, s3, v20
    v_mfma_f32_16x16x32_bf16 a[0:3], v[32:35], v[144:147], a[0:3]
    ds_read_b64_tr_b16 v[56:57], v15 offset:16384
    ds_read_b64_tr_b16 v[58:59], v15 offset:20480
    v_mfma_f32_16x16x32_bf16 a[0:3], v[36:39], v[148:151], a[0:3]
    v_mfma_f32_16x16x32_bf16 a[4:7], v[32:35], v[152:155], a[4:7]
    ds_read_b64_tr_b16 v[60:61], v15 offset:24576
    v_and_b32 v5, 128, v5
    v_mfma_f32_16x16x32_bf16 a[4:7], v[36:39], v[156:159], a[4:7]
    s_waitcnt lgkmcnt(7)
    ds_read_b64_tr_b16 v[62:63], v15 offset:28672
    v_and_b32 v20, 0xffffff7f, v20
    v_mfma_f32_16x16x32_bf16 a[8:11], v[40:43], v[144:147], a[8:11]
    ds_read_b64_tr_b16 v[32:33], v16 offset:16384
    ds_read_b64_tr_b16 v[34:35], v16 offset:20480
    v_mfma_f32_16x16x32_bf16 a[8:11], v[44:47], v[148:151], a[8:11]
    v_mfma_f32_16x16x32_bf16 a[12:15], v[40:43], v[152:155], a[12:15]
    ds_read_b64_tr_b16 v[36:37], v16 offset:24576
    v_lshl_add_u32 v20, v5, 9, v20
    v_mfma_f32_16x16x32_bf16 a[12:15], v[44:47], v[156:159], a[12:15]
    s_waitcnt lgkmcnt(7)
    ds_read_b64_tr_b16 v[38:39], v16 offset:28672
    v_xor_b32 v5, s3, v21
    v_mfma_f32_16x16x32_bf16 a[16:19], v[48:51], v[144:147], a[16:19]
    ds_read_b64_tr_b16 v[40:41], v17 offset:16384
    ds_read_b64_tr_b16 v[42:43], v17 offset:20480
    v_mfma_f32_16x16x32_bf16 a[16:19], v[52:55], v[148:151], a[16:19]
    v_mfma_f32_16x16x32_bf16 a[20:23], v[48:51], v[152:155], a[20:23]
    ds_read_b64_tr_b16 v[44:45], v17 offset:24576
    v_and_b32 v5, 128, v5
    v_mfma_f32_16x16x32_bf16 a[20:23], v[52:55], v[156:159], a[20:23]
    s_waitcnt lgkmcnt(7)
    ds_read_b64_tr_b16 v[46:47], v17 offset:28672
    v_and_b32 v21, 0xffffff7f, v21
    v_mfma_f32_16x16x32_bf16 a[24:27], v[56:59], v[144:147], a[24:27]
    ds_read_b64_tr_b16 v[48:49], v18 offset:16384
    ds_read_b64_tr_b16 v[50:51], v18 offset:20480
    v_mfma_f32_16x16x32_bf16 a[24:27], v[60:63], v[148:151], a[24:27]
    v_mfma_f32_16x16x32_bf16 a[28:31], v[56:59], v[152:155], a[28:31]
    ds_read_b64_tr_b16 v[52:53], v18 offset:24576
    v_lshl_add_u32 v21, v5, 9, v21
    v_mfma_f32_16x16x32_bf16 a[28:31], v[60:63], v[156:159], a[28:31]
    s_waitcnt lgkmcnt(7)
    ds_read_b64_tr_b16 v[54:55], v18 offset:28672
    v_xor_b32 v5, s3, v22
    v_mfma_f32_16x16x32_bf16 a[32:35], v[32:35], v[144:147], a[32:35]
    ds_read_b64_tr_b16 v[56:57], v19 offset:16384
    ds_read_b64_tr_b16 v[58:59], v19 offset:20480
    v_mfma_f32_16x16x32_bf16 a[32:35], v[36:39], v[148:151], a[32:35]
    v_mfma_f32_16x16x32_bf16 a[36:39], v[32:35], v[152:155], a[36:39]
    ds_read_b64_tr_b16 v[60:61], v19 offset:24576
    v_and_b32 v5, 128, v5
    v_mfma_f32_16x16x32_bf16 a[36:39], v[36:39], v[156:159], a[36:39]
    s_waitcnt lgkmcnt(7)
    ds_read_b64_tr_b16 v[62:63], v19 offset:28672
    v_and_b32 v22, 0xffffff7f, v22
    v_mfma_f32_16x16x32_bf16 a[40:43], v[40:43], v[144:147], a[40:43]
    ds_read_b64_tr_b16 v[32:33], v12 offset:32768
    ds_read_b64_tr_b16 v[34:35], v12 offset:36864
    v_mfma_f32_16x16x32_bf16 a[40:43], v[44:47], v[148:151], a[40:43]
    v_mfma_f32_16x16x32_bf16 a[44:47], v[40:43], v[152:155], a[44:47]
    ds_read_b64_tr_b16 v[36:37], v12 offset:40960
    v_lshl_add_u32 v22, v5, 9, v22
    v_mfma_f32_16x16x32_bf16 a[44:47], v[44:47], v[156:159], a[44:47]
    s_waitcnt lgkmcnt(7)
    ds_read_b64_tr_b16 v[38:39], v12 offset:45056
    v_xor_b32 v5, s3, v23
    v_mfma_f32_16x16x32_bf16 a[48:51], v[48:51], v[144:147], a[48:51]
    ds_read_b64_tr_b16 v[40:41], v13 offset:32768
    ds_read_b64_tr_b16 v[42:43], v13 offset:36864
    v_mfma_f32_16x16x32_bf16 a[48:51], v[52:55], v[148:151], a[48:51]
    v_mfma_f32_16x16x32_bf16 a[52:55], v[48:51], v[152:155], a[52:55]
    ds_read_b64_tr_b16 v[44:45], v13 offset:40960
    v_and_b32 v5, 128, v5
    v_mfma_f32_16x16x32_bf16 a[52:55], v[52:55], v[156:159], a[52:55]
    s_waitcnt lgkmcnt(7)
    ds_read_b64_tr_b16 v[46:47], v13 offset:45056
    v_and_b32 v23, 0xffffff7f, v23
    v_mfma_f32_16x16x32_bf16 a[56:59], v[56:59], v[144:147], a[56:59]
    ds_read_b64_tr_b16 v[48:49], v14 offset:32768
    ds_read_b64_tr_b16 v[50:51], v14 offset:36864
    v_mfma_f32_16x16x32_bf16 a[56:59], v[60:63], v[148:151], a[56:59]
    v_mfma_f32_16x16x32_bf16 a[60:63], v[56:59], v[152:155], a[60:63]
    ds_read_b64_tr_b16 v[52:53], v14 offset:40960
    v_lshl_add_u32 v23, v5, 9, v23
    v_mfma_f32_16x16x32_bf16 a[60:63], v[60:63], v[156:159], a[60:63]
    s_waitcnt lgkmcnt(7)
    s_waitcnt vmcnt(8)
    ds_read_b64_tr_b16 v[54:55], v14 offset:45056
    v_mfma_f32_16x16x32_bf16 a[0:3], v[32:35], v[160:163], a[0:3]
    ds_read_b64_tr_b16 v[56:57], v15 offset:32768
    ds_read_b64_tr_b16 v[58:59], v15 offset:36864
    s_add_u32 m0, s29, 98304
    s_add_u32 s66, s68, 131072
    v_mfma_f32_16x16x32_bf16 a[0:3], v[36:39], v[164:167], a[0:3]
    buffer_load_dwordx4 v20, s[36:39], s66 offen lds
    v_mfma_f32_16x16x32_bf16 a[4:7], v[32:35], v[168:171], a[4:7]
    ds_read_b64_tr_b16 v[60:61], v15 offset:40960
    v_mfma_f32_16x16x32_bf16 a[4:7], v[36:39], v[172:175], a[4:7]
    s_waitcnt lgkmcnt(7)
    ds_read_b64_tr_b16 v[62:63], v15 offset:45056
    buffer_load_dwordx4 v21, s[36:39], s66 offen offset:1024 lds
    v_mfma_f32_16x16x32_bf16 a[8:11], v[40:43], v[160:163], a[8:11]
    ds_read_b64_tr_b16 v[32:33], v16 offset:32768
    ds_read_b64_tr_b16 v[34:35], v16 offset:36864
    v_mfma_f32_16x16x32_bf16 a[8:11], v[44:47], v[164:167], a[8:11]
    buffer_load_dwordx4 v22, s[36:39], s66 offen offset:2048 lds
    v_mfma_f32_16x16x32_bf16 a[12:15], v[40:43], v[168:171], a[12:15]
    ds_read_b64_tr_b16 v[36:37], v16 offset:40960
    v_mfma_f32_16x16x32_bf16 a[12:15], v[44:47], v[172:175], a[12:15]
    s_waitcnt lgkmcnt(7)
    ds_read_b64_tr_b16 v[38:39], v16 offset:45056
    buffer_load_dwordx4 v23, s[36:39], s66 offen offset:3072 lds
    v_mfma_f32_16x16x32_bf16 a[16:19], v[48:51], v[160:163], a[16:19]
    ds_read_b64_tr_b16 v[40:41], v17 offset:32768
    ds_read_b64_tr_b16 v[42:43], v17 offset:36864
    s_mov_b32 s48, 49152
    s_mov_b32 s49, 180224
    v_mfma_f32_16x16x32_bf16 a[16:19], v[52:55], v[164:167], a[16:19]
    buffer_load_dwordx4 v[176:179], v27, s[40:43], s48 offen offset:2048 sc1
    v_mfma_f32_16x16x32_bf16 a[20:23], v[48:51], v[168:171], a[20:23]
    ds_read_b64_tr_b16 v[44:45], v17 offset:40960
    v_mfma_f32_16x16x32_bf16 a[20:23], v[52:55], v[172:175], a[20:23]
    s_waitcnt lgkmcnt(7)
    ds_read_b64_tr_b16 v[46:47], v17 offset:45056
    buffer_load_dwordx4 v[180:183], v27, s[40:43], s48 offen offset:3072 sc1
    v_mfma_f32_16x16x32_bf16 a[24:27], v[56:59], v[160:163], a[24:27]
    ds_read_b64_tr_b16 v[48:49], v18 offset:32768
    ds_read_b64_tr_b16 v[50:51], v18 offset:36864
    v_mfma_f32_16x16x32_bf16 a[24:27], v[60:63], v[164:167], a[24:27]
    buffer_load_dwordx4 v[184:187], v27, s[40:43], s49 offen offset:2048 sc1
    v_mfma_f32_16x16x32_bf16 a[28:31], v[56:59], v[168:171], a[28:31]
    ds_read_b64_tr_b16 v[52:53], v18 offset:40960
    v_mfma_f32_16x16x32_bf16 a[28:31], v[60:63], v[172:175], a[28:31]
    s_waitcnt lgkmcnt(7)
    ds_read_b64_tr_b16 v[54:55], v18 offset:45056
    buffer_load_dwordx4 v[188:191], v27, s[40:43], s49 offen offset:3072 sc1
    v_mfma_f32_16x16x32_bf16 a[32:35], v[32:35], v[160:163], a[32:35]
    ds_read_b64_tr_b16 v[56:57], v19 offset:32768
    ds_read_b64_tr_b16 v[58:59], v19 offset:36864
    s_mov_b32 s48, 12288
    s_mov_b32 s49, 143360
    v_mfma_f32_16x16x32_bf16 a[32:35], v[36:39], v[164:167], a[32:35]
    buffer_load_dwordx4 a[96:99], v27, s[40:43], s48 offen sc1
    v_mfma_f32_16x16x32_bf16 a[36:39], v[32:35], v[168:171], a[36:39]
    ds_read_b64_tr_b16 v[60:61], v19 offset:40960
    v_mfma_f32_16x16x32_bf16 a[36:39], v[36:39], v[172:175], a[36:39]
    s_waitcnt lgkmcnt(7)
    ds_read_b64_tr_b16 v[62:63], v19 offset:45056
    v_add_u32 v12, 0xffff8000, v12
    v_mfma_f32_16x16x32_bf16 a[40:43], v[40:43], v[160:163], a[40:43]
    ds_read_b64_tr_b16 v[32:33], v12
    ds_read_b64_tr_b16 v[34:35], v12 offset:4096
    v_mfma_f32_16x16x32_bf16 a[40:43], v[44:47], v[164:167], a[40:43]
    buffer_load_dwordx4 a[100:103], v27, s[40:43], s48 offen offset:1024 sc1
    v_mfma_f32_16x16x32_bf16 a[44:47], v[40:43], v[168:171], a[44:47]
    ds_read_b64_tr_b16 v[36:37], v12 offset:8192
    v_mfma_f32_16x16x32_bf16 a[44:47], v[44:47], v[172:175], a[44:47]
    s_waitcnt lgkmcnt(7)
    ds_read_b64_tr_b16 v[38:39], v12 offset:12288
    v_add_u32 v13, 0xffff8000, v13
    buffer_load_dwordx4 a[104:107], v27, s[40:43], s49 offen sc1
    v_mfma_f32_16x16x32_bf16 a[48:51], v[48:51], v[160:163], a[48:51]
    ds_read_b64_tr_b16 v[40:41], v13
    ds_read_b64_tr_b16 v[42:43], v13 offset:4096
    v_mfma_f32_16x16x32_bf16 a[48:51], v[52:55], v[164:167], a[48:51]
    buffer_load_dwordx4 a[108:111], v27, s[40:43], s49 offen offset:1024 sc1
    v_mfma_f32_16x16x32_bf16 a[52:55], v[48:51], v[168:171], a[52:55]
    ds_read_b64_tr_b16 v[44:45], v13 offset:8192
    v_mfma_f32_16x16x32_bf16 a[52:55], v[52:55], v[172:175], a[52:55]
    s_waitcnt lgkmcnt(7)
    ds_read_b64_tr_b16 v[46:47], v13 offset:12288
    v_add_u32 v14, 0xffff8000, v14
    v_mfma_f32_16x16x32_bf16 a[56:59], v[56:59], v[160:163], a[56:59]
    ds_read_b64_tr_b16 v[48:49], v14
    ds_read_b64_tr_b16 v[50:51], v14 offset:4096
    s_add_u32 m0, s29, 16384
    s_add_u32 s66, s68, 393216
    v_mfma_f32_16x16x32_bf16 a[56:59], v[60:63], v[164:167], a[56:59]
    buffer_load_dwordx4 v20, s[36:39], s66 offen lds
    v_mfma_f32_16x16x32_bf16 a[60:63], v[56:59], v[168:171], a[60:63]
    s_waitcnt vmcnt(25)
    s_barrier
    ds_read_b64_tr_b16 v[52:53], v14 offset:8192
    v_mfma_f32_16x16x32_bf16 a[60:63], v[60:63], v[172:175], a[60:63]
    s_waitcnt lgkmcnt(7)
    s_waitcnt vmcnt(5)
    ds_read_b64_tr_b16 v[54:55], v14 offset:12288
    v_add_u32 v15, 0xffff8000, v15
    v_mfma_f32_16x16x32_bf16 a[0:3], v[32:35], v[176:179], a[0:3]
    ds_read_b64_tr_b16 v[56:57], v15
    ds_read_b64_tr_b16 v[58:59], v15 offset:4096
    v_mfma_f32_16x16x32_bf16 a[0:3], v[36:39], v[180:183], a[0:3]
    buffer_load_dwordx4 v21, s[36:39], s66 offen offset:1024 lds
    v_mfma_f32_16x16x32_bf16 a[4:7], v[32:35], v[184:187], a[4:7]
    ds_read_b64_tr_b16 v[60:61], v15 offset:8192
    v_mfma_f32_16x16x32_bf16 a[4:7], v[36:39], v[188:191], a[4:7]
    s_waitcnt lgkmcnt(7)
    ds_read_b64_tr_b16 v[62:63], v15 offset:12288
    v_add_u32 v16, 0xffff8000, v16
    buffer_load_dwordx4 v22, s[36:39], s66 offen offset:2048 lds
    v_mfma_f32_16x16x32_bf16 a[8:11], v[40:43], v[176:179], a[8:11]
    ds_read_b64_tr_b16 v[32:33], v16
    ds_read_b64_tr_b16 v[34:35], v16 offset:4096
    v_mfma_f32_16x16x32_bf16 a[8:11], v[44:47], v[180:183], a[8:11]
    buffer_load_dwordx4 v23, s[36:39], s66 offen offset:3072 lds
    v_mfma_f32_16x16x32_bf16 a[12:15], v[40:43], v[184:187], a[12:15]
    ds_read_b64_tr_b16 v[36:37], v16 offset:8192
    s_mov_b32 s48, 57344
    s_mov_b32 s49, 188416
    v_mfma_f32_16x16x32_bf16 a[12:15], v[44:47], v[188:191], a[12:15]
    s_waitcnt lgkmcnt(7)
    ds_read_b64_tr_b16 v[38:39], v16 offset:12288
    v_add_u32 v17, 0xffff8000, v17
    buffer_load_dwordx4 v[192:195], v27, s[40:43], s48 offen sc1
    v_mfma_f32_16x16x32_bf16 a[16:19], v[48:51], v[176:179], a[16:19]
    ds_read_b64_tr_b16 v[40:41], v17
    ds_read_b64_tr_b16 v[42:43], v17 offset:4096
    v_mfma_f32_16x16x32_bf16 a[16:19], v[52:55], v[180:183], a[16:19]
    buffer_load_dwordx4 v[196:199], v27, s[40:43], s48 offen offset:1024 sc1
    v_mfma_f32_16x16x32_bf16 a[20:23], v[48:51], v[184:187], a[20:23]
    ds_read_b64_tr_b16 v[44:45], v17 offset:8192
    v_mfma_f32_16x16x32_bf16 a[20:23], v[52:55], v[188:191], a[20:23]
    s_waitcnt lgkmcnt(7)
    ds_read_b64_tr_b16 v[46:47], v17 offset:12288
    v_add_u32 v18, 0xffff8000, v18
    buffer_load_dwordx4 v[200:203], v27, s[40:43], s49 offen sc1
    v_mfma_f32_16x16x32_bf16 a[24:27], v[56:59], v[176:179], a[24:27]
    ds_read_b64_tr_b16 v[48:49], v18
    ds_read_b64_tr_b16 v[50:51], v18 offset:4096
    v_mfma_f32_16x16x32_bf16 a[24:27], v[60:63], v[180:183], a[24:27]
    buffer_load_dwordx4 v[204:207], v27, s[40:43], s49 offen offset:1024 sc1
    v_mfma_f32_16x16x32_bf16 a[28:31], v[56:59], v[184:187], a[28:31]
    ds_read_b64_tr_b16 v[52:53], v18 offset:8192
    s_mov_b32 s48, 12288
    s_mov_b32 s49, 143360
    v_mfma_f32_16x16x32_bf16 a[28:31], v[60:63], v[188:191], a[28:31]
    s_waitcnt lgkmcnt(7)
    ds_read_b64_tr_b16 v[54:55], v18 offset:12288
    v_add_u32 v19, 0xffff8000, v19
    buffer_load_dwordx4 a[112:115], v27, s[40:43], s48 offen offset:2048 sc1
    v_mfma_f32_16x16x32_bf16 a[32:35], v[32:35], v[176:179], a[32:35]
    ds_read_b64_tr_b16 v[56:57], v19
    ds_read_b64_tr_b16 v[58:59], v19 offset:4096
    v_mfma_f32_16x16x32_bf16 a[32:35], v[36:39], v[180:183], a[32:35]
    buffer_load_dwordx4 a[116:119], v27, s[40:43], s48 offen offset:3072 sc1
    v_mfma_f32_16x16x32_bf16 a[36:39], v[32:35], v[184:187], a[36:39]
    ds_read_b64_tr_b16 v[60:61], v19 offset:8192
    v_mfma_f32_16x16x32_bf16 a[36:39], v[36:39], v[188:191], a[36:39]
    s_waitcnt lgkmcnt(7)
    ds_read_b64_tr_b16 v[62:63], v19 offset:12288
    v_add_u32 v12, 0x24000, v12
    buffer_load_dwordx4 a[120:123], v27, s[40:43], s49 offen offset:2048 sc1
    v_mfma_f32_16x16x32_bf16 a[40:43], v[40:43], v[176:179], a[40:43]
    ds_read_b64_tr_b16 v[32:33], v12
    ds_read_b64_tr_b16 v[34:35], v12 offset:4096
    v_mfma_f32_16x16x32_bf16 a[40:43], v[44:47], v[180:183], a[40:43]
    buffer_load_dwordx4 a[124:127], v27, s[40:43], s49 offen offset:3072 sc1
    v_mfma_f32_16x16x32_bf16 a[44:47], v[40:43], v[184:187], a[44:47]
    ds_read_b64_tr_b16 v[36:37], v12 offset:8192
    v_mfma_f32_16x16x32_bf16 a[44:47], v[44:47], v[188:191], a[44:47]
    s_waitcnt lgkmcnt(7)
    ds_read_b64_tr_b16 v[38:39], v12 offset:12288
    v_add_u32 v13, 0x24000, v13
    v_mfma_f32_16x16x32_bf16 a[48:51], v[48:51], v[176:179], a[48:51]
    ds_read_b64_tr_b16 v[40:41], v13
    ds_read_b64_tr_b16 v[42:43], v13 offset:4096
    s_add_u32 m0, s29, 114688
    s_add_u32 s66, s68, 655360
    v_mfma_f32_16x16x32_bf16 a[48:51], v[52:55], v[180:183], a[48:51]
    buffer_load_dwordx4 v20, s[36:39], s66 offen lds
    v_mfma_f32_16x16x32_bf16 a[52:55], v[48:51], v[184:187], a[52:55]
    ds_read_b64_tr_b16 v[44:45], v13 offset:8192
    v_mfma_f32_16x16x32_bf16 a[52:55], v[52:55], v[188:191], a[52:55]
    s_waitcnt lgkmcnt(7)
    ds_read_b64_tr_b16 v[46:47], v13 offset:12288
    v_add_u32 v14, 0x24000, v14
    v_mfma_f32_16x16x32_bf16 a[56:59], v[56:59], v[176:179], a[56:59]
    ds_read_b64_tr_b16 v[48:49], v14
    ds_read_b64_tr_b16 v[50:51], v14 offset:4096
    v_mfma_f32_16x16x32_bf16 a[56:59], v[60:63], v[180:183], a[56:59]
    buffer_load_dwordx4 v21, s[36:39], s66 offen offset:1024 lds
    v_mfma_f32_16x16x32_bf16 a[60:63], v[56:59], v[184:187], a[60:63]
    ds_read_b64_tr_b16 v[52:53], v14 offset:8192
    v_mfma_f32_16x16x32_bf16 a[60:63], v[60:63], v[188:191], a[60:63]
    s_waitcnt lgkmcnt(7)
    s_waitcnt vmcnt(6)
    ds_read_b64_tr_b16 v[54:55], v14 offset:12288
    v_add_u32 v15, 0x24000, v15
    v_mfma_f32_16x16x32_bf16 a[0:3], v[32:35], v[192:195], a[0:3]
    ds_read_b64_tr_b16 v[56:57], v15
    ds_read_b64_tr_b16 v[58:59], v15 offset:4096
    v_mfma_f32_16x16x32_bf16 a[0:3], v[36:39], v[196:199], a[0:3]
    buffer_load_dwordx4 v22, s[36:39], s66 offen offset:2048 lds
    v_mfma_f32_16x16x32_bf16 a[4:7], v[32:35], v[200:203], a[4:7]
    ds_read_b64_tr_b16 v[60:61], v15 offset:8192
    v_mfma_f32_16x16x32_bf16 a[4:7], v[36:39], v[204:207], a[4:7]
    s_waitcnt lgkmcnt(7)
    ds_read_b64_tr_b16 v[62:63], v15 offset:12288
    v_add_u32 v16, 0x24000, v16
    buffer_load_dwordx4 v23, s[36:39], s66 offen offset:3072 lds
    v_mfma_f32_16x16x32_bf16 a[8:11], v[40:43], v[192:195], a[8:11]
    ds_read_b64_tr_b16 v[32:33], v16
    ds_read_b64_tr_b16 v[34:35], v16 offset:4096
    s_mov_b32 s48, 57344
    s_mov_b32 s49, 188416
    v_mfma_f32_16x16x32_bf16 a[8:11], v[44:47], v[196:199], a[8:11]
    buffer_load_dwordx4 v[208:211], v27, s[40:43], s48 offen offset:2048 sc1
    v_mfma_f32_16x16x32_bf16 a[12:15], v[40:43], v[200:203], a[12:15]
    ds_read_b64_tr_b16 v[36:37], v16 offset:8192
    v_mfma_f32_16x16x32_bf16 a[12:15], v[44:47], v[204:207], a[12:15]
    s_waitcnt lgkmcnt(7)
    ds_read_b64_tr_b16 v[38:39], v16 offset:12288
    v_add_u32 v17, 0x24000, v17
    buffer_load_dwordx4 v[212:215], v27, s[40:43], s48 offen offset:3072 sc1
    v_mfma_f32_16x16x32_bf16 a[16:19], v[48:51], v[192:195], a[16:19]
    ds_read_b64_tr_b16 v[40:41], v17
    ds_read_b64_tr_b16 v[42:43], v17 offset:4096
    v_mfma_f32_16x16x32_bf16 a[16:19], v[52:55], v[196:199], a[16:19]
    buffer_load_dwordx4 v[216:219], v27, s[40:43], s49 offen offset:2048 sc1
    v_mfma_f32_16x16x32_bf16 a[20:23], v[48:51], v[200:203], a[20:23]
    ds_read_b64_tr_b16 v[44:45], v17 offset:8192
    v_mfma_f32_16x16x32_bf16 a[20:23], v[52:55], v[204:207], a[20:23]
    s_waitcnt lgkmcnt(7)
    ds_read_b64_tr_b16 v[46:47], v17 offset:12288
    v_add_u32 v18, 0x24000, v18
    buffer_load_dwordx4 v[220:223], v27, s[40:43], s49 offen offset:3072 sc1
    v_mfma_f32_16x16x32_bf16 a[24:27], v[56:59], v[192:195], a[24:27]
    ds_read_b64_tr_b16 v[48:49], v18
    ds_read_b64_tr_b16 v[50:51], v18 offset:4096
    s_mov_b32 s48, 20480
    s_mov_b32 s49, 151552
    v_mfma_f32_16x16x32_bf16 a[24:27], v[60:63], v[196:199], a[24:27]
    buffer_load_dwordx4 a[128:131], v27, s[40:43], s48 offen sc1
    v_mfma_f32_16x16x32_bf16 a[28:31], v[56:59], v[200:203], a[28:31]
    ds_read_b64_tr_b16 v[52:53], v18 offset:8192
    v_mfma_f32_16x16x32_bf16 a[28:31], v[60:63], v[204:207], a[28:31]
    s_waitcnt lgkmcnt(7)
    ds_read_b64_tr_b16 v[54:55], v18 offset:12288
    v_add_u32 v19, 0x24000, v19
    buffer_load_dwordx4 a[132:135], v27, s[40:43], s48 offen offset:1024 sc1
    v_mfma_f32_16x16x32_bf16 a[32:35], v[32:35], v[192:195], a[32:35]
    ds_read_b64_tr_b16 v[56:57], v19
    ds_read_b64_tr_b16 v[58:59], v19 offset:4096
    v_mfma_f32_16x16x32_bf16 a[32:35], v[36:39], v[196:199], a[32:35]
    buffer_load_dwordx4 a[136:139], v27, s[40:43], s49 offen sc1
    v_mfma_f32_16x16x32_bf16 a[36:39], v[32:35], v[200:203], a[36:39]
    ds_read_b64_tr_b16 v[60:61], v19 offset:8192
    v_mfma_f32_16x16x32_bf16 a[36:39], v[36:39], v[204:207], a[36:39]
    s_waitcnt lgkmcnt(7)
    ds_read_b64_tr_b16 v[62:63], v19 offset:12288
    v_add_u32 v12, 0xffff0000, v12
    buffer_load_dwordx4 a[140:143], v27, s[40:43], s49 offen offset:1024 sc1
    v_mfma_f32_16x16x32_bf16 a[40:43], v[40:43], v[192:195], a[40:43]
    ds_read_b64_tr_b16 v[32:33], v12
    ds_read_b64_tr_b16 v[34:35], v12 offset:4096
    s_mov_b32 s48, 20480
    s_mov_b32 s49, 151552
    v_mfma_f32_16x16x32_bf16 a[40:43], v[44:47], v[196:199], a[40:43]
    buffer_load_dwordx4 a[144:147], v27, s[40:43], s48 offen offset:2048 sc1
    v_mfma_f32_16x16x32_bf16 a[44:47], v[40:43], v[200:203], a[44:47]
    ds_read_b64_tr_b16 v[36:37], v12 offset:8192
    v_mfma_f32_16x16x32_bf16 a[44:47], v[44:47], v[204:207], a[44:47]
    s_waitcnt lgkmcnt(7)
    ds_read_b64_tr_b16 v[38:39], v12 offset:12288
    v_add_u32 v13, 0xffff0000, v13
    v_mfma_f32_16x16x32_bf16 a[48:51], v[48:51], v[192:195], a[48:51]
    ds_read_b64_tr_b16 v[40:41], v13
    ds_read_b64_tr_b16 v[42:43], v13 offset:4096
    v_mfma_f32_16x16x32_bf16 a[48:51], v[52:55], v[196:199], a[48:51]
    buffer_load_dwordx4 a[148:151], v27, s[40:43], s48 offen offset:3072 sc1
    v_mfma_f32_16x16x32_bf16 a[52:55], v[48:51], v[200:203], a[52:55]
    ds_read_b64_tr_b16 v[44:45], v13 offset:8192
    v_mfma_f32_16x16x32_bf16 a[52:55], v[52:55], v[204:207], a[52:55]
L_hop17:
    s_cbranch_execz L_hopret
    s_waitcnt lgkmcnt(7)
    ds_read_b64_tr_b16 v[46:47], v13 offset:12288
    v_add_u32 v14, 0xffff0000, v14
    v_mfma_f32_16x16x32_bf16 a[56:59], v[56:59], v[192:195], a[56:59]
    ds_read_b64_tr_b16 v[48:49], v14
    ds_read_b64_tr_b16 v[50:51], v14 offset:4096
    v_mfma_f32_16x16x32_bf16 a[56:59], v[60:63], v[196:199], a[56:59]
    buffer_load_dwordx4 a[152:155], v27, s[40:43], s49 offen offset:2048 sc1
    v_mfma_f32_16x16x32_bf16 a[60:63], v[56:59], v[200:203], a[60:63]
    s_waitcnt vmcnt(23)
    s_barrier
    ds_read_b64_tr_b16 v[52:53], v14 offset:8192
    v_mfma_f32_16x16x32_bf16 a[60:63], v[60:63], v[204:207], a[60:63]
    s_waitcnt lgkmcnt(7)
    s_waitcnt vmcnt(7)
    ds_read_b64_tr_b16 v[54:55], v14 offset:12288
    v_add_u32 v15, 0xffff0000, v15
    v_mfma_f32_16x16x32_bf16 a[0:3], v[32:35], v[208:211], a[0:3]
    ds_read_b64_tr_b16 v[56:57], v15
    ds_read_b64_tr_b16 v[58:59], v15 offset:4096
    v_mfma_f32_16x16x32_bf16 a[0:3], v[36:39], v[212:215], a[0:3]
    buffer_load_dwordx4 a[156:159], v27, s[40:43], s49 offen offset:3072 sc1
    v_mfma_f32_16x16x32_bf16 a[4:7], v[32:35], v[216:219], a[4:7]
    ds_read_b64_tr_b16 v[60:61], v15 offset:8192
    s_add_u32 m0, s29, 131072
    s_add_u32 s66, s68, 917504
    v_mfma_f32_16x16x32_bf16 a[4:7], v[36:39], v[220:223], a[4:7]
    s_waitcnt lgkmcnt(7)
    ds_read_b64_tr_b16 v[62:63], v15 offset:12288
    v_add_u32 v16, 0xffff0000, v16
    buffer_load_dwordx4 v20, s[36:39], s66 offen lds
    v_mfma_f32_16x16x32_bf16 a[8:11], v[40:43], v[208:211], a[8:11]
    ds_read_b64_tr_b16 v[32:33], v16
    ds_read_b64_tr_b16 v[34:35], v16 offset:4096
    v_mfma_f32_16x16x32_bf16 a[8:11], v[44:47], v[212:215], a[8:11]
    buffer_load_dwordx4 v21, s[36:39], s66 offen offset:1024 lds
    v_mfma_f32_16x16x32_bf16 a[12:15], v[40:43], v[216:219], a[12:15]
    ds_read_b64_tr_b16 v[36:37], v16 offset:8192
    v_mfma_f32_16x16x32_bf16 a[12:15], v[44:47], v[220:223], a[12:15]
    s_waitcnt lgkmcnt(7)
    ds_read_b64_tr_b16 v[38:39], v16 offset:12288
    v_add_u32 v17, 0xffff0000, v17
    buffer_load_dwordx4 v22, s[36:39], s66 offen offset:2048 lds
    v_mfma_f32_16x16x32_bf16 a[16:19], v[48:51], v[208:211], a[16:19]
    ds_read_b64_tr_b16 v[40:41], v17
    ds_read_b64_tr_b16 v[42:43], v17 offset:4096
    v_mfma_f32_16x16x32_bf16 a[16:19], v[52:55], v[212:215], a[16:19]
    buffer_load_dwordx4 v23, s[36:39], s66 offen offset:3072 lds
    v_mfma_f32_16x16x32_bf16 a[20:23], v[48:51], v[216:219], a[20:23]
    ds_read_b64_tr_b16 v[44:45], v17 offset:8192
    v_mfma_f32_16x16x32_bf16 a[20:23], v[52:55], v[220:223], a[20:23]
    s_waitcnt lgkmcnt(7)
    ds_read_b64_tr_b16 v[46:47], v17 offset:12288
    v_add_u32 v18, 0xffff0000, v18
    v_mfma_f32_16x16x32_bf16 a[24:27], v[56:59], v[208:211], a[24:27]
    ds_read_b64_tr_b16 v[48:49], v18
    ds_read_b64_tr_b16 v[50:51], v18 offset:4096
    s_mov_b32 s48, 28672
    s_mov_b32 s49, 159744
    v_mfma_f32_16x16x32_bf16 a[24:27], v[60:63], v[212:215], a[24:27]
    buffer_load_dwordx4 a[160:163], v27, s[40:43], s48 offen sc1
    v_mfma_f32_16x16x32_bf16 a[28:31], v[56:59], v[216:219], a[28:31]
    ds_read_b64_tr_b16 v[52:53], v18 offset:8192
    v_mfma_f32_16x16x32_bf16 a[28:31], v[60:63], v[220:223], a[28:31]
    s_waitcnt lgkmcnt(7)
    ds_read_b64_tr_b16 v[54:55], v18 offset:12288
    v_add_u32 v19, 0xffff0000, v19
    v_mfma_f32_16x16x32_bf16 a[32:35], v[32:35], v[208:211], a[32:35]
    ds_read_b64_tr_b16 v[56:57], v19
    ds_read_b64_tr_b16 v[58:59], v19 offset:4096
    v_mfma_f32_16x16x32_bf16 a[32:35], v[36:39], v[212:215], a[32:35]
    buffer_load_dwordx4 a[164:167], v27, s[40:43], s48 offen offset:1024 sc1
    v_mfma_f32_16x16x32_bf16 a[36:39], v[32:35], v[216:219], a[36:39]
    ds_read_b64_tr_b16 v[60:61], v19 offset:8192
    v_mfma_f32_16x16x32_bf16 a[36:39], v[36:39], v[220:223], a[36:39]
    s_waitcnt lgkmcnt(7)
    ds_read_b64_tr_b16 v[62:63], v19 offset:12288
    v_mfma_f32_16x16x32_bf16 a[40:43], v[40:43], v[208:211], a[40:43]
    ds_read_b64_tr_b16 v[32:33], v12 offset:16384
    ds_read_b64_tr_b16 v[34:35], v12 offset:20480
    v_mfma_f32_16x16x32_bf16 a[40:43], v[44:47], v[212:215], a[40:43]
    buffer_load_dwordx4 a[168:171], v27, s[40:43], s49 offen sc1
    v_mfma_f32_16x16x32_bf16 a[44:47], v[40:43], v[216:219], a[44:47]
    ds_read_b64_tr_b16 v[36:37], v12 offset:24576
    v_mfma_f32_16x16x32_bf16 a[44:47], v[44:47], v[220:223], a[44:47]
    s_waitcnt lgkmcnt(7)
    ds_read_b64_tr_b16 v[38:39], v12 offset:28672
    buffer_load_dwordx4 a[172:175], v27, s[40:43], s49 offen offset:1024 sc1
    v_mfma_f32_16x16x32_bf16 a[48:51], v[48:51], v[208:211], a[48:51]
    ds_read_b64_tr_b16 v[40:41], v13 offset:16384
    ds_read_b64_tr_b16 v[42:43], v13 offset:20480
    s_add_u32 m0, s29, 32768
    s_add_u32 s66, s68, 1179648
    v_mfma_f32_16x16x32_bf16 a[48:51], v[52:55], v[212:215], a[48:51]
    buffer_load_dwordx4 v20, s[36:39], s66 offen lds
    v_mfma_f32_16x16x32_bf16 a[52:55], v[48:51], v[216:219], a[52:55]
    ds_read_b64_tr_b16 v[44:45], v13 offset:24576
    v_mfma_f32_16x16x32_bf16 a[52:55], v[52:55], v[220:223], a[52:55]
    s_waitcnt lgkmcnt(7)
    ds_read_b64_tr_b16 v[46:47], v13 offset:28672
    v_mfma_f32_16x16x32_bf16 a[56:59], v[56:59], v[208:211], a[56:59]
    ds_read_b64_tr_b16 v[48:49], v14 offset:16384
    ds_read_b64_tr_b16 v[50:51], v14 offset:20480
    v_mfma_f32_16x16x32_bf16 a[56:59], v[60:63], v[212:215], a[56:59]
    buffer_load_dwordx4 v21, s[36:39], s66 offen offset:1024 lds
    v_mfma_f32_16x16x32_bf16 a[60:63], v[56:59], v[216:219], a[60:63]
    ds_read_b64_tr_b16 v[52:53], v14 offset:24576
    v_mfma_f32_16x16x32_bf16 a[60:63], v[60:63], v[220:223], a[60:63]
    s_waitcnt lgkmcnt(7)
    s_waitcnt vmcnt(54)
    ds_read_b64_tr_b16 v[54:55], v14 offset:28672
    v_mfma_f32_16x16x32_bf16 a[32:35], v[32:35], a[64:67], a[32:35]
    ds_read_b64_tr_b16 v[56:57], v15 offset:16384
    ds_read_b64_tr_b16 v[58:59], v15 offset:20480
    v_mfma_f32_16x16x32_bf16 a[32:35], v[36:39], a[68:71], a[32:35]
    buffer_load_dwordx4 v22, s[36:39], s66 offen offset:2048 lds
    v_mfma_f32_16x16x32_bf16 a[36:39], v[32:35], a[72:75], a[36:39]
    ds_read_b64_tr_b16 v[60:61], v15 offset:24576
    v_mfma_f32_16x16x32_bf16 a[36:39], v[36:39], a[76:79], a[36:39]
    s_waitcnt lgkmcnt(7)
    ds_read_b64_tr_b16 v[62:63], v15 offset:28672
    buffer_load_dwordx4 v23, s[36:39], s66 offen offset:3072 lds
    v_mfma_f32_16x16x32_bf16 a[40:43], v[40:43], a[64:67], a[40:43]
    ds_read_b64_tr_b16 v[32:33], v16 offset:16384
    ds_read_b64_tr_b16 v[34:35], v16 offset:20480
    s_mov_b32 s48, 28672
    s_mov_b32 s49, 159744
    v_mfma_f32_16x16x32_bf16 a[40:43], v[44:47], a[68:71], a[40:43]
    buffer_load_dwordx4 a[176:179], v27, s[40:43], s48 offen offset:2048 sc1
    v_mfma_f32_16x16x32_bf16 a[44:47], v[40:43], a[72:75], a[44:47]
    ds_read_b64_tr_b16 v[36:37], v16 offset:24576
    v_mfma_f32_16x16x32_bf16 a[44:47], v[44:47], a[76:79], a[44:47]
    s_waitcnt lgkmcnt(7)
    ds_read_b64_tr_b16 v[38:39], v16 offset:28672
    v_mfma_f32_16x16x32_bf16 a[48:51], v[48:51], a[64:67], a[48:51]
    ds_read_b64_tr_b16 v[40:41], v17 offset:16384
    ds_read_b64_tr_b16 v[42:43], v17 offset:20480
    v_mfma_f32_16x16x32_bf16 a[48:51], v[52:55], a[68:71], a[48:51]
    buffer_load_dwordx4 a[180:183], v27, s[40:43], s48 offen offset:3072 sc1
    v_mfma_f32_16x16x32_bf16 a[52:55], v[48:51], a[72:75], a[52:55]
    ds_read_b64_tr_b16 v[44:45], v17 offset:24576
    v_mfma_f32_16x16x32_bf16 a[52:55], v[52:55], a[76:79], a[52:55]
    s_waitcnt lgkmcnt(7)
    ds_read_b64_tr_b16 v[46:47], v17 offset:28672
    v_mfma_f32_16x16x32_bf16 a[56:59], v[56:59], a[64:67], a[56:59]
    ds_read_b64_tr_b16 v[48:49], v18 offset:16384
    ds_read_b64_tr_b16 v[50:51], v18 offset:20480
    v_mfma_f32_16x16x32_bf16 a[56:59], v[60:63], a[68:71], a[56:59]
    buffer_load_dwordx4 a[184:187], v27, s[40:43], s49 offen offset:2048 sc1
    v_mfma_f32_16x16x32_bf16 a[60:63], v[56:59], a[72:75], a[60:63]
    ds_read_b64_tr_b16 v[52:53], v18 offset:24576
    v_mfma_f32_16x16x32_bf16 a[60:63], v[60:63], a[76:79], a[60:63]
    s_waitcnt lgkmcnt(7)
    s_waitcnt vmcnt(55)
    ds_read_b64_tr_b16 v[54:55], v18 offset:28672
    buffer_load_dwordx4 a[188:191], v27, s[40:43], s49 offen offset:3072 sc1
    v_mfma_f32_16x16x32_bf16 a[32:35], v[32:35], a[80:83], a[32:35]
    ds_read_b64_tr_b16 v[56:57], v19 offset:16384
    ds_read_b64_tr_b16 v[58:59], v19 offset:20480
    s_add_u32 m0, s29, 49152
    s_add_u32 s66, s68, 1441792
    v_mfma_f32_16x16x32_bf16 a[32:35], v[36:39], a[84:87], a[32:35]
    buffer_load_dwordx4 v20, s[36:39], s66 offen lds
    v_mfma_f32_16x16x32_bf16 a[36:39], v[32:35], a[88:91], a[36:39]
    ds_read_b64_tr_b16 v[60:61], v19 offset:24576
    v_mfma_f32_16x16x32_bf16 a[36:39], v[36:39], a[92:95], a[36:39]
    s_waitcnt lgkmcnt(7)
    ds_read_b64_tr_b16 v[62:63], v19 offset:28672
    v_add_u32 v12, 0xffff0000, v12
    v_mfma_f32_16x16x32_bf16 a[40:43], v[40:43], a[80:83], a[40:43]
    ds_read_b64_tr_b16 v[32:33], v12
    ds_read_b64_tr_b16 v[34:35], v12 offset:4096
    v_mfma_f32_16x16x32_bf16 a[40:43], v[44:47], a[84:87], a[40:43]
    buffer_load_dwordx4 v21, s[36:39], s66 offen offset:1024 lds
    v_mfma_f32_16x16x32_bf16 a[44:47], v[40:43], a[88:91], a[44:47]
    ds_read_b64_tr_b16 v[36:37], v12 offset:8192
    v_mfma_f32_16x16x32_bf16 a[44:47], v[44:47], a[92:95], a[44:47]
    s_waitcnt lgkmcnt(7)
    ds_read_b64_tr_b16 v[38:39], v12 offset:12288
    v_add_u32 v13, 0xffff0000, v13
    v_mfma_f32_16x16x32_bf16 a[48:51], v[48:51], a[80:83], a[48:51]
    ds_read_b64_tr_b16 v[40:41], v13
    ds_read_b64_tr_b16 v[42:43], v13 offset:4096
    v_mfma_f32_16x16x32_bf16 a[48:51], v[52:55], a[84:87], a[48:51]
    buffer_load_dwordx4 v22, s[36:39], s66 offen offset:2048 lds
    v_mfma_f32_16x16x32_bf16 a[52:55], v[48:51], a[88:91], a[52:55]
    ds_read_b64_tr_b16 v[44:45], v13 offset:8192
    v_mfma_f32_16x16x32_bf16 a[52:55], v[52:55], a[92:95], a[52:55]
    s_waitcnt lgkmcnt(7)
    ds_read_b64_tr_b16 v[46:47], v13 offset:12288
    v_add_u32 v14, 0xffff0000, v14
    v_mfma_f32_16x16x32_bf16 a[56:59], v[56:59], a[80:83], a[56:59]
    ds_read_b64_tr_b16 v[48:49], v14
    ds_read_b64_tr_b16 v[50:51], v14 offset:4096
    v_mfma_f32_16x16x32_bf16 a[56:59], v[60:63], a[84:87], a[56:59]
    buffer_load_dwordx4 v23, s[36:39], s66 offen offset:3072 lds
    v_mfma_f32_16x16x32_bf16 a[60:63], v[56:59], a[88:91], a[60:63]
    s_waitcnt vmcnt(16)
    s_barrier
    ds_read_b64_tr_b16 v[52:53], v14 offset:8192
    v_mfma_f32_16x16x32_bf16 a[60:63], v[60:63], a[92:95], a[60:63]
    s_waitcnt lgkmcnt(7)
    s_waitcnt vmcnt(48)
    ds_read_b64_tr_b16 v[54:55], v14 offset:12288
    v_add_u32 v15, 0xffff0000, v15
    v_mfma_f32_16x16x32_bf16 a[32:35], v[32:35], a[96:99], a[32:35]
    ds_read_b64_tr_b16 v[56:57], v15
    ds_read_b64_tr_b16 v[58:59], v15 offset:4096
    s_add_u32 m0, s29, 65536
    s_add_u32 s66, s68, 1703936
    v_mfma_f32_16x16x32_bf16 a[32:35], v[36:39], a[100:103], a[32:35]
    buffer_load_dwordx4 v20, s[36:39], s66 offen lds
    v_mfma_f32_16x16x32_bf16 a[36:39], v[32:35], a[104:107], a[36:39]
    ds_read_b64_tr_b16 v[60:61], v15 offset:8192
    v_mfma_f32_16x16x32_bf16 a[36:39], v[36:39], a[108:111], a[36:39]
    s_waitcnt lgkmcnt(7)
    ds_read_b64_tr_b16 v[62:63], v15 offset:12288
    v_add_u32 v16, 0xffff0000, v16
    v_mfma_f32_16x16x32_bf16 a[40:43], v[40:43], a[96:99], a[40:43]
    ds_read_b64_tr_b16 v[32:33], v16
    ds_read_b64_tr_b16 v[34:35], v16 offset:4096
    v_mfma_f32_16x16x32_bf16 a[40:43], v[44:47], a[100:103], a[40:43]
    buffer_load_dwordx4 v21, s[36:39], s66 offen offset:1024 lds
    v_mfma_f32_16x16x32_bf16 a[44:47], v[40:43], a[104:107], a[44:47]
    ds_read_b64_tr_b16 v[36:37], v16 offset:8192
    v_mfma_f32_16x16x32_bf16 a[44:47], v[44:47], a[108:111], a[44:47]
    s_waitcnt lgkmcnt(7)
    ds_read_b64_tr_b16 v[38:39], v16 offset:12288
    v_add_u32 v17, 0xffff0000, v17
    v_mfma_f32_16x16x32_bf16 a[48:51], v[48:51], a[96:99], a[48:51]
    ds_read_b64_tr_b16 v[40:41], v17
    ds_read_b64_tr_b16 v[42:43], v17 offset:4096
    v_mfma_f32_16x16x32_bf16 a[48:51], v[52:55], a[100:103], a[48:51]
    buffer_load_dwordx4 v22, s[36:39], s66 offen offset:2048 lds
    v_mfma_f32_16x16x32_bf16 a[52:55], v[48:51], a[104:107], a[52:55]
    ds_read_b64_tr_b16 v[44:45], v17 offset:8192
    v_mfma_f32_16x16x32_bf16 a[52:55], v[52:55], a[108:111], a[52:55]
    s_waitcnt lgkmcnt(7)
    ds_read_b64_tr_b16 v[46:47], v17 offset:12288
    v_add_u32 v18, 0xffff0000, v18
    v_mfma_f32_16x16x32_bf16 a[56:59], v[56:59], a[96:99], a[56:59]
    ds_read_b64_tr_b16 v[48:49], v18
    ds_read_b64_tr_b16 v[50:51], v18 offset:4096
    v_mfma_f32_16x16x32_bf16 a[56:59], v[60:63], a[100:103], a[56:59]
    buffer_load_dwordx4 v23, s[36:39], s66 offen offset:3072 lds
    v_mfma_f32_16x16x32_bf16 a[60:63], v[56:59], a[104:107], a[60:63]
    ds_read_b64_tr_b16 v[52:53], v18 offset:8192
    v_mfma_f32_16x16x32_bf16 a[60:63], v[60:63], a[108:111], a[60:63]
    s_waitcnt lgkmcnt(7)
    s_waitcnt vmcnt(40)
    ds_read_b64_tr_b16 v[54:55], v18 offset:12288
    v_add_u32 v19, 0xffff0000, v19
    v_mfma_f32_16x16x32_bf16 a[32:35], v[32:35], a[112:115], a[32:35]
    ds_read_b64_tr_b16 v[56:57], v19
    ds_read_b64_tr_b16 v[58:59], v19 offset:4096
    s_add_u32 m0, s29, 0
    s_add_u32 s66, s68, 1966080
    v_mfma_f32_16x16x32_bf16 a[32:35], v[36:39], a[116:119], a[32:35]
    buffer_load_dwordx4 v20, s[36:39], s66 offen lds
    v_mfma_f32_16x16x32_bf16 a[36:39], v[32:35], a[120:123], a[36:39]
    ds_read_b64_tr_b16 v[60:61], v19 offset:8192
    v_mfma_f32_16x16x32_bf16 a[36:39], v[36:39], a[124:127], a[36:39]
    s_waitcnt lgkmcnt(7)
    ds_read_b64_tr_b16 v[62:63], v19 offset:12288
    v_add_u32 v12, 0x18000, v12
    v_mfma_f32_16x16x32_bf16 a[40:43], v[40:43], a[112:115], a[40:43]
    ds_read_b64_tr_b16 v[32:33], v12
    ds_read_b64_tr_b16 v[34:35], v12 offset:4096
    v_mfma_f32_16x16x32_bf16 a[40:43], v[44:47], a[116:119], a[40:43]
    buffer_load_dwordx4 v21, s[36:39], s66 offen offset:1024 lds
    v_mfma_f32_16x16x32_bf16 a[44:47], v[40:43], a[120:123], a[44:47]
    ds_read_b64_tr_b16 v[36:37], v12 offset:8192
    v_mfma_f32_16x16x32_bf16 a[44:47], v[44:47], a[124:127], a[44:47]
    s_waitcnt lgkmcnt(7)
    ds_read_b64_tr_b16 v[38:39], v12 offset:12288
    v_add_u32 v13, 0x18000, v13
    v_mfma_f32_16x16x32_bf16 a[48:51], v[48:51], a[112:115], a[48:51]
    ds_read_b64_tr_b16 v[40:41], v13
    ds_read_b64_tr_b16 v[42:43], v13 offset:4096
    v_mfma_f32_16x16x32_bf16 a[48:51], v[52:55], a[116:119], a[48:51]
    buffer_load_dwordx4 v22, s[36:39], s66 offen offset:2048 lds
    v_mfma_f32_16x16x32_bf16 a[52:55], v[48:51], a[120:123], a[52:55]
    ds_read_b64_tr_b16 v[44:45], v13 offset:8192
    v_mfma_f32_16x16x32_bf16 a[52:55], v[52:55], a[124:127], a[52:55]
    s_waitcnt lgkmcnt(7)
    ds_read_b64_tr_b16 v[46:47], v13 offset:12288
    v_add_u32 v14, 0x18000, v14
    v_mfma_f32_16x16x32_bf16 a[56:59], v[56:59], a[112:115], a[56:59]
    ds_read_b64_tr_b16 v[48:49], v14
    ds_read_b64_tr_b16 v[50:51], v14 offset:4096
    v_mfma_f32_16x16x32_bf16 a[56:59], v[60:63], a[116:119], a[56:59]
    buffer_load_dwordx4 v23, s[36:39], s66 offen offset:3072 lds
    v_mfma_f32_16x16x32_bf16 a[60:63], v[56:59], a[120:123], a[60:63]
    ds_read_b64_tr_b16 v[52:53], v14 offset:8192
    v_mfma_f32_16x16x32_bf16 a[60:63], v[60:63], a[124:127], a[60:63]
    s_waitcnt lgkmcnt(7)
    s_waitcnt vmcnt(32)
    ds_read_b64_tr_b16 v[54:55], v14 offset:12288
    v_add_u32 v15, 0x18000, v15
    v_mfma_f32_16x16x32_bf16 a[32:35], v[32:35], a[128:131], a[32:35]
    ds_read_b64_tr_b16 v[56:57], v15
    ds_read_b64_tr_b16 v[58:59], v15 offset:4096
    s_mov_b32 s48, 36864
    s_mov_b32 s49, 167936
    v_mfma_f32_16x16x32_bf16 a[32:35], v[36:39], a[132:135], a[32:35]
    buffer_load_dwordx4 v[96:99], v27, s[40:43], s48 offen sc1
    v_mfma_f32_16x16x32_bf16 a[36:39], v[32:35], a[136:139], a[36:39]
    ds_read_b64_tr_b16 v[60:61], v15 offset:8192
    v_mfma_f32_16x16x32_bf16 a[36:39], v[36:39], a[140:143], a[36:39]
    s_waitcnt lgkmcnt(7)
    ds_read_b64_tr_b16 v[62:63], v15 offset:12288
    v_add_u32 v16, 0x18000, v16
    v_mfma_f32_16x16x32_bf16 a[40:43], v[40:43], a[128:131], a[40:43]
    ds_read_b64_tr_b16 v[32:33], v16
    ds_read_b64_tr_b16 v[34:35], v16 offset:4096
    v_mfma_f32_16x16x32_bf16 a[40:43], v[44:47], a[132:135], a[40:43]
    buffer_load_dwordx4 v[100:103], v27, s[40:43], s48 offen offset:1024 sc1
    v_mfma_f32_16x16x32_bf16 a[44:47], v[40:43], a[136:139], a[44:47]
    ds_read_b64_tr_b16 v[36:37], v16 offset:8192
    v_mfma_f32_16x16x32_bf16 a[44:47], v[44:47], a[140:143], a[44:47]
    s_waitcnt lgkmcnt(7)
    ds_read_b64_tr_b16 v[38:39], v16 offset:12288
    v_add_u32 v17, 0x18000, v17
    v_mfma_f32_16x16x32_bf16 a[48:51], v[48:51], a[128:131], a[48:51]
    ds_read_b64_tr_b16 v[40:41], v17
    ds_read_b64_tr_b16 v[42:43], v17 offset:4096
    v_mfma_f32_16x16x32_bf16 a[48:51], v[52:55], a[132:135], a[48:51]
    buffer_load_dwordx4 v[104:107], v27, s[40:43], s49 offen sc1
    v_mfma_f32_16x16x32_bf16 a[52:55], v[48:51], a[136:139], a[52:55]
    ds_read_b64_tr_b16 v[44:45], v17 offset:8192
    v_mfma_f32_16x16x32_bf16 a[52:55], v[52:55], a[140:143], a[52:55]
    s_waitcnt lgkmcnt(7)
    ds_read_b64_tr_b16 v[46:47], v17 offset:12288
    v_add_u32 v18, 0x18000, v18
    v_mfma_f32_16x16x32_bf16 a[56:59], v[56:59], a[128:131], a[56:59]
    ds_read_b64_tr_b16 v[48:49], v18
    ds_read_b64_tr_b16 v[50:51], v18 offset:4096
    v_mfma_f32_16x16x32_bf16 a[56:59], v[60:63], a[132:135], a[56:59]
    buffer_load_dwordx4 v[108:111], v27, s[40:43], s49 offen offset:1024 sc1
    v_mfma_f32_16x16x32_bf16 a[60:63], v[56:59], a[136:139], a[60:63]
    ds_read_b64_tr_b16 v[52:53], v18 offset:8192
    v_mfma_f32_16x16x32_bf16 a[60:63], v[60:63], a[140:143], a[60:63]
    s_waitcnt lgkmcnt(7)
    s_waitcnt vmcnt(32)
    ds_read_b64_tr_b16 v[54:55], v18 offset:12288
    v_add_u32 v19, 0x18000, v19
    v_mfma_f32_16x16x32_bf16 a[32:35], v[32:35], a[144:147], a[32:35]
    ds_read_b64_tr_b16 v[56:57], v19
    ds_read_b64_tr_b16 v[58:59], v19 offset:4096
    s_mov_b32 s48, 36864
    s_mov_b32 s49, 167936
    v_mfma_f32_16x16x32_bf16 a[32:35], v[36:39], a[148:151], a[32:35]
    buffer_load_dwordx4 v[112:115], v27, s[40:43], s48 offen offset:2048 sc1
    v_mfma_f32_16x16x32_bf16 a[36:39], v[32:35], a[152:155], a[36:39]
    ds_read_b64_tr_b16 v[60:61], v19 offset:8192
    v_mfma_f32_16x16x32_bf16 a[36:39], v[36:39], a[156:159], a[36:39]
    s_waitcnt lgkmcnt(7)
    ds_read_b64_tr_b16 v[62:63], v19 offset:12288
    v_mfma_f32_16x16x32_bf16 a[40:43], v[40:43], a[144:147], a[40:43]
    ds_read_b64_tr_b16 v[32:33], v12 offset:16384
    ds_read_b64_tr_b16 v[34:35], v12 offset:20480
    v_mfma_f32_16x16x32_bf16 a[40:43], v[44:47], a[148:151], a[40:43]
    buffer_load_dwordx4 v[116:119], v27, s[40:43], s48 offen offset:3072 sc1
    v_mfma_f32_16x16x32_bf16 a[44:47], v[40:43], a[152:155], a[44:47]
    ds_read_b64_tr_b16 v[36:37], v12 offset:24576
    v_mfma_f32_16x16x32_bf16 a[44:47], v[44:47], a[156:159], a[44:47]
    s_waitcnt lgkmcnt(7)
    ds_read_b64_tr_b16 v[38:39], v12 offset:28672
    v_mfma_f32_16x16x32_bf16 a[48:51], v[48:51], a[144:147], a[48:51]
    ds_read_b64_tr_b16 v[40:41], v13 offset:16384
    ds_read_b64_tr_b16 v[42:43], v13 offset:20480
    v_mfma_f32_16x16x32_bf16 a[48:51], v[52:55], a[148:151], a[48:51]
    buffer_load_dwordx4 v[120:123], v27, s[40:43], s49 offen offset:2048 sc1
    v_mfma_f32_16x16x32_bf16 a[52:55], v[48:51], a[152:155], a[52:55]
    ds_read_b64_tr_b16 v[44:45], v13 offset:24576
    v_mfma_f32_16x16x32_bf16 a[52:55], v[52:55], a[156:159], a[52:55]
    s_waitcnt lgkmcnt(7)
    ds_read_b64_tr_b16 v[46:47], v13 offset:28672
    v_mfma_f32_16x16x32_bf16 a[56:59], v[56:59], a[144:147], a[56:59]
    ds_read_b64_tr_b16 v[48:49], v14 offset:16384
    ds_read_b64_tr_b16 v[50:51], v14 offset:20480
    v_mfma_f32_16x16x32_bf16 a[56:59], v[60:63], a[148:151], a[56:59]
    buffer_load_dwordx4 v[124:127], v27, s[40:43], s49 offen offset:3072 sc1
    v_mfma_f32_16x16x32_bf16 a[60:63], v[56:59], a[152:155], a[60:63]
    s_waitcnt vmcnt(16)
    s_barrier
    ds_read_b64_tr_b16 v[52:53], v14 offset:24576
    v_mfma_f32_16x16x32_bf16 a[60:63], v[60:63], a[156:159], a[60:63]
    s_waitcnt lgkmcnt(7)
    s_waitcnt vmcnt(28)
    ds_read_b64_tr_b16 v[54:55], v14 offset:28672
    v_mfma_f32_16x16x32_bf16 a[32:35], v[32:35], a[160:163], a[32:35]
    ds_read_b64_tr_b16 v[56:57], v15 offset:16384
    ds_read_b64_tr_b16 v[58:59], v15 offset:20480
    s_mov_b32 s48, 45056
    s_mov_b32 s49, 176128
    v_mfma_f32_16x16x32_bf16 a[32:35], v[36:39], a[164:167], a[32:35]
    buffer_load_dwordx4 v[128:131], v27, s[40:43], s48 offen sc1
    v_mfma_f32_16x16x32_bf16 a[36:39], v[32:35], a[168:171], a[36:39]
    ds_read_b64_tr_b16 v[60:61], v15 offset:24576
    v_mfma_f32_16x16x32_bf16 a[36:39], v[36:39], a[172:175], a[36:39]
    s_waitcnt lgkmcnt(7)
    ds_read_b64_tr_b16 v[62:63], v15 offset:28672
    v_mfma_f32_16x16x32_bf16 a[40:43], v[40:43], a[160:163], a[40:43]
    ds_read_b64_tr_b16 v[32:33], v16 offset:16384
    ds_read_b64_tr_b16 v[34:35], v16 offset:20480
    v_mfma_f32_16x16x32_bf16 a[40:43], v[44:47], a[164:167], a[40:43]
    buffer_load_dwordx4 v[132:135], v27, s[40:43], s48 offen offset:1024 sc1
    v_mfma_f32_16x16x32_bf16 a[44:47], v[40:43], a[168:171], a[44:47]
    ds_read_b64_tr_b16 v[36:37], v16 offset:24576
    v_mfma_f32_16x16x32_bf16 a[44:47], v[44:47], a[172:175], a[44:47]
    s_waitcnt lgkmcnt(7)
    ds_read_b64_tr_b16 v[38:39], v16 offset:28672
    v_mfma_f32_16x16x32_bf16 a[48:51], v[48:51], a[160:163], a[48:51]
    ds_read_b64_tr_b16 v[40:41], v17 offset:16384
    ds_read_b64_tr_b16 v[42:43], v17 offset:20480
    v_mfma_f32_16x16x32_bf16 a[48:51], v[52:55], a[164:167], a[48:51]
    buffer_load_dwordx4 v[136:139], v27, s[40:43], s49 offen sc1
    v_mfma_f32_16x16x32_bf16 a[52:55], v[48:51], a[168:171], a[52:55]
    ds_read_b64_tr_b16 v[44:45], v17 offset:24576
    v_mfma_f32_16x16x32_bf16 a[52:55], v[52:55], a[172:175], a[52:55]
    s_waitcnt lgkmcnt(7)
    ds_read_b64_tr_b16 v[46:47], v17 offset:28672
    v_mfma_f32_16x16x32_bf16 a[56:59], v[56:59], a[160:163], a[56:59]
    ds_read_b64_tr_b16 v[48:49], v18 offset:16384
    ds_read_b64_tr_b16 v[50:51], v18 offset:20480
    v_mfma_f32_16x16x32_bf16 a[56:59], v[60:63], a[164:167], a[56:59]
    buffer_load_dwordx4 v[140:143], v27, s[40:43], s49 offen offset:1024 sc1
    v_mfma_f32_16x16x32_bf16 a[60:63], v[56:59], a[168:171], a[60:63]
    ds_read_b64_tr_b16 v[52:53], v18 offset:24576
    v_mfma_f32_16x16x32_bf16 a[60:63], v[60:63], a[172:175], a[60:63]
    s_waitcnt lgkmcnt(7)
    s_waitcnt vmcnt(24)
    ds_read_b64_tr_b16 v[54:55], v18 offset:28672
    v_mfma_f32_16x16x32_bf16 a[32:35], v[32:35], a[176:179], a[32:35]
    ds_read_b64_tr_b16 v[56:57], v19 offset:16384
    ds_read_b64_tr_b16 v[58:59], v19 offset:20480
    s_mov_b32 s48, 45056
    s_mov_b32 s49, 176128
    v_mfma_f32_16x16x32_bf16 a[32:35], v[36:39], a[180:183], a[32:35]
    buffer_load_dwordx4 v[144:147], v27, s[40:43], s48 offen offset:2048 sc1
    v_mfma_f32_16x16x32_bf16 a[36:39], v[32:35], a[184:187], a[36:39]
    ds_read_b64_tr_b16 v[60:61], v19 offset:24576
    v_mfma_f32_16x16x32_bf16 a[36:39], v[36:39], a[188:191], a[36:39]
    s_waitcnt lgkmcnt(7)
    ds_read_b64_tr_b16 v[62:63], v19 offset:28672
    v_add_u32 v12, 0xfffec000, v12
    v_mfma_f32_16x16x32_bf16 a[40:43], v[40:43], a[176:179], a[40:43]
    ds_read_b64_tr_b16 v[32:33], v12
    ds_read_b64_tr_b16 v[34:35], v12 offset:4096
    v_mfma_f32_16x16x32_bf16 a[40:43], v[44:47], a[180:183], a[40:43]
    buffer_load_dwordx4 v[148:151], v27, s[40:43], s48 offen offset:3072 sc1
    v_mfma_f32_16x16x32_bf16 a[44:47], v[40:43], a[184:187], a[44:47]
    ds_read_b64_tr_b16 v[36:37], v12 offset:8192
    v_mfma_f32_16x16x32_bf16 a[44:47], v[44:47], a[188:191], a[44:47]
    s_waitcnt lgkmcnt(7)
    ds_read_b64_tr_b16 v[38:39], v12 offset:12288
    v_add_u32 v13, 0xfffec000, v13
    v_mfma_f32_16x16x32_bf16 a[48:51], v[48:51], a[176:179], a[48:51]
    ds_read_b64_tr_b16 v[40:41], v13
    ds_read_b64_tr_b16 v[42:43], v13 offset:4096
    v_mfma_f32_16x16x32_bf16 a[48:51], v[52:55], a[180:183], a[48:51]
    buffer_load_dwordx4 v[152:155], v27, s[40:43], s49 offen offset:2048 sc1
    v_mfma_f32_16x16x32_bf16 a[52:55], v[48:51], a[184:187], a[52:55]
    ds_read_b64_tr_b16 v[44:45], v13 offset:8192
    v_mfma_f32_16x16x32_bf16 a[52:55], v[52:55], a[188:191], a[52:55]
    s_waitcnt lgkmcnt(7)
    ds_read_b64_tr_b16 v[46:47], v13 offset:12288
    v_add_u32 v14, 0xfffec000, v14
    v_mfma_f32_16x16x32_bf16 a[56:59], v[56:59], a[176:179], a[56:59]
    ds_read_b64_tr_b16 v[48:49], v14
    ds_read_b64_tr_b16 v[50:51], v14 offset:4096
    v_mfma_f32_16x16x32_bf16 a[56:59], v[60:63], a[180:183], a[56:59]
    buffer_load_dwordx4 v[156:159], v27, s[40:43], s49 offen offset:3072 sc1
    v_mfma_f32_16x16x32_bf16 a[60:63], v[56:59], a[184:187], a[60:63]
    ds_read_b64_tr_b16 v[52:53], v14 offset:8192
    v_mfma_f32_16x16x32_bf16 a[60:63], v[60:63], a[188:191], a[60:63]
    s_waitcnt lgkmcnt(7)
    s_waitcnt vmcnt(12)
    ds_read_b64_tr_b16 v[54:55], v14 offset:12288
    v_add_u32 v15, 0xfffec000, v15
    v_mfma_f32_16x16x32_bf16 a[32:35], v[32:35], v[96:99], a[32:35]
    ds_read_b64_tr_b16 v[56:57], v15
    ds_read_b64_tr_b16 v[58:59], v15 offset:4096
    s_mov_b32 s48, 53248
    s_mov_b32 s49, 184320
    v_mfma_f32_16x16x32_bf16 a[32:35], v[36:39], v[100:103], a[32:35]
    buffer_load_dwordx4 v[160:163], v27, s[40:43], s48 offen sc1
    v_mfma_f32_16x16x32_bf16 a[36:39], v[32:35], v[104:107], a[36:39]
    ds_read_b64_tr_b16 v[60:61], v15 offset:8192
    v_mfma_f32_16x16x32_bf16 a[36:39], v[36:39], v[108:111], a[36:39]
    s_waitcnt lgkmcnt(7)
    ds_read_b64_tr_b16 v[62:63], v15 offset:12288
    v_add_u32 v16, 0xfffec000, v16
    v_mfma_f32_16x16x32_bf16 a[40:43], v[40:43], v[96:99], a[40:43]
    ds_read_b64_tr_b16 v[32:33], v16
    ds_read_b64_tr_b16 v[34:35], v16 offset:4096
    v_mfma_f32_16x16x32_bf16 a[40:43], v[44:47], v[100:103], a[40:43]
    buffer_load_dwordx4 v[164:167], v27, s[40:43], s48 offen offset:1024 sc1
    v_mfma_f32_16x16x32_bf16 a[44:47], v[40:43], v[104:107], a[44:47]
    ds_read_b64_tr_b16 v[36:37], v16 offset:8192
    v_mfma_f32_16x16x32_bf16 a[44:47], v[44:47], v[108:111], a[44:47]
    s_waitcnt lgkmcnt(7)
    ds_read_b64_tr_b16 v[38:39], v16 offset:12288
    v_add_u32 v17, 0xfffec000, v17
    v_mfma_f32_16x16x32_bf16 a[48:51], v[48:51], v[96:99], a[48:51]
    ds_read_b64_tr_b16 v[40:41], v17
    ds_read_b64_tr_b16 v[42:43], v17 offset:4096
    v_mfma_f32_16x16x32_bf16 a[48:51], v[52:55], v[100:103], a[48:51]
    buffer_load_dwordx4 v[168:171], v27, s[40:43], s49 offen sc1
    v_mfma_f32_16x16x32_bf16 a[52:55], v[48:51], v[104:107], a[52:55]
    ds_read_b64_tr_b16 v[44:45], v17 offset:8192
    v_mfma_f32_16x16x32_bf16 a[52:55], v[52:55], v[108:111], a[52:55]
    s_waitcnt lgkmcnt(7)
    ds_read_b64_tr_b16 v[46:47], v17 offset:12288
    v_add_u32 v18, 0xfffec000, v18
    v_mfma_f32_16x16x32_bf16 a[56:59], v[56:59], v[96:99], a[56:59]
    ds_read_b64_tr_b16 v[48:49], v18
    ds_read_b64_tr_b16 v[50:51], v18 offset:4096
    v_mfma_f32_16x16x32_bf16 a[56:59], v[60:63], v[100:103], a[56:59]
    buffer_load_dwordx4 v[172:175], v27, s[40:43], s49 offen offset:1024 sc1
    v_mfma_f32_16x16x32_bf16 a[60:63], v[56:59], v[104:107], a[60:63]
    ds_read_b64_tr_b16 v[52:53], v18 offset:8192
    v_mfma_f32_16x16x32_bf16 a[60:63], v[60:63], v[108:111], a[60:63]
    s_waitcnt lgkmcnt(7)
    s_waitcnt vmcnt(12)
    ds_read_b64_tr_b16 v[54:55], v18 offset:12288
    v_add_u32 v19, 0xfffec000, v19
    v_mfma_f32_16x16x32_bf16 a[32:35], v[32:35], v[112:115], a[32:35]
    ds_read_b64_tr_b16 v[56:57], v19
    ds_read_b64_tr_b16 v[58:59], v19 offset:4096
    s_add_u32 m0, s29, 147456
    s_add_u32 s66, s3, 131072
    v_mfma_f32_16x16x32_bf16 a[32:35], v[36:39], v[116:119], a[32:35]
    buffer_load_dwordx4 v20, s[36:39], s66 offen lds
    v_mfma_f32_16x16x32_bf16 a[36:39], v[32:35], v[120:123], a[36:39]
    ds_read_b64_tr_b16 v[60:61], v19 offset:8192
    v_mfma_f32_16x16x32_bf16 a[36:39], v[36:39], v[124:127], a[36:39]
    s_waitcnt lgkmcnt(7)
    ds_read_b64_tr_b16 v[62:63], v19 offset:12288
    v_mfma_f32_16x16x32_bf16 a[40:43], v[40:43], v[112:115], a[40:43]
    ds_read_b64_tr_b16 v[32:33], v12 offset:16384
    ds_read_b64_tr_b16 v[34:35], v12 offset:20480
    v_mfma_f32_16x16x32_bf16 a[40:43], v[44:47], v[116:119], a[40:43]
L_hop18:
    s_cbranch_execz L_hopret
    buffer_load_dwordx4 v21, s[36:39], s66 offen offset:1024 lds
    v_mfma_f32_16x16x32_bf16 a[44:47], v[40:43], v[120:123], a[44:47]
    ds_read_b64_tr_b16 v[36:37], v12 offset:24576
    v_mfma_f32_16x16x32_bf16 a[44:47], v[44:47], v[124:127], a[44:47]
    s_waitcnt lgkmcnt(7)
    ds_read_b64_tr_b16 v[38:39], v12 offset:28672
    v_mfma_f32_16x16x32_bf16 a[48:51], v[48:51], v[112:115], a[48:51]
    ds_read_b64_tr_b16 v[40:41], v13 offset:16384
    ds_read_b64_tr_b16 v[42:43], v13 offset:20480
    v_mfma_f32_16x16x32_bf16 a[48:51], v[52:55], v[116:119], a[48:51]
    buffer_load_dwordx4 v22, s[36:39], s66 offen offset:2048 lds
    v_mfma_f32_16x16x32_bf16 a[52:55], v[48:51], v[120:123], a[52:55]
    ds_read_b64_tr_b16 v[44:45], v13 offset:24576
    v_mfma_f32_16x16x32_bf16 a[52:55], v[52:55], v[124:127], a[52:55]
    s_waitcnt lgkmcnt(7)
    ds_read_b64_tr_b16 v[46:47], v13 offset:28672
    v_mfma_f32_16x16x32_bf16 a[56:59], v[56:59], v[112:115], a[56:59]
    ds_read_b64_tr_b16 v[48:49], v14 offset:16384
    ds_read_b64_tr_b16 v[50:51], v14 offset:20480
    v_mfma_f32_16x16x32_bf16 a[56:59], v[60:63], v[116:119], a[56:59]
    buffer_load_dwordx4 v23, s[36:39], s66 offen offset:3072 lds
    v_mfma_f32_16x16x32_bf16 a[60:63], v[56:59], v[120:123], a[60:63]
    s_waitcnt vmcnt(24)
    s_barrier
    ds_read_b64_tr_b16 v[52:53], v14 offset:24576
    v_mfma_f32_16x16x32_bf16 a[60:63], v[60:63], v[124:127], a[60:63]
    s_waitcnt lgkmcnt(7)
    s_waitcnt vmcnt(12)
    ds_read_b64_tr_b16 v[54:55], v14 offset:28672
    v_mfma_f32_16x16x32_bf16 a[32:35], v[32:35], v[128:131], a[32:35]
    ds_read_b64_tr_b16 v[56:57], v15 offset:16384
    ds_read_b64_tr_b16 v[58:59], v15 offset:20480
    s_mov_b32 s48, 53248
    s_mov_b32 s49, 184320
    v_mfma_f32_16x16x32_bf16 a[32:35], v[36:39], v[132:135], a[32:35]
    buffer_load_dwordx4 v[176:179], v27, s[40:43], s48 offen offset:2048 sc1
    v_mfma_f32_16x16x32_bf16 a[36:39], v[32:35], v[136:139], a[36:39]
    ds_read_b64_tr_b16 v[60:61], v15 offset:24576
    v_mfma_f32_16x16x32_bf16 a[36:39], v[36:39], v[140:143], a[36:39]
    s_waitcnt lgkmcnt(7)
    ds_read_b64_tr_b16 v[62:63], v15 offset:28672
    v_mfma_f32_16x16x32_bf16 a[40:43], v[40:43], v[128:131], a[40:43]
    ds_read_b64_tr_b16 v[32:33], v16 offset:16384
    ds_read_b64_tr_b16 v[34:35], v16 offset:20480
    v_mfma_f32_16x16x32_bf16 a[40:43], v[44:47], v[132:135], a[40:43]
    buffer_load_dwordx4 v[180:183], v27, s[40:43], s48 offen offset:3072 sc1
    v_mfma_f32_16x16x32_bf16 a[44:47], v[40:43], v[136:139], a[44:47]
    ds_read_b64_tr_b16 v[36:37], v16 offset:24576
    v_mfma_f32_16x16x32_bf16 a[44:47], v[44:47], v[140:143], a[44:47]
    s_waitcnt lgkmcnt(7)
    ds_read_b64_tr_b16 v[38:39], v16 offset:28672
    v_mfma_f32_16x16x32_bf16 a[48:51], v[48:51], v[128:131], a[48:51]
    ds_read_b64_tr_b16 v[40:41], v17 offset:16384
    ds_read_b64_tr_b16 v[42:43], v17 offset:20480
    v_mfma_f32_16x16x32_bf16 a[48:51], v[52:55], v[132:135], a[48:51]
    buffer_load_dwordx4 v[184:187], v27, s[40:43], s49 offen offset:2048 sc1
    v_mfma_f32_16x16x32_bf16 a[52:55], v[48:51], v[136:139], a[52:55]
    ds_read_b64_tr_b16 v[44:45], v17 offset:24576
    v_mfma_f32_16x16x32_bf16 a[52:55], v[52:55], v[140:143], a[52:55]
    s_waitcnt lgkmcnt(7)
    ds_read_b64_tr_b16 v[46:47], v17 offset:28672
    v_mfma_f32_16x16x32_bf16 a[56:59], v[56:59], v[128:131], a[56:59]
    ds_read_b64_tr_b16 v[48:49], v18 offset:16384
    ds_read_b64_tr_b16 v[50:51], v18 offset:20480
    v_mfma_f32_16x16x32_bf16 a[56:59], v[60:63], v[132:135], a[56:59]
    buffer_load_dwordx4 v[188:191], v27, s[40:43], s49 offen offset:3072 sc1
    v_mfma_f32_16x16x32_bf16 a[60:63], v[56:59], v[136:139], a[60:63]
    ds_read_b64_tr_b16 v[52:53], v18 offset:24576
    v_mfma_f32_16x16x32_bf16 a[60:63], v[60:63], v[140:143], a[60:63]
    s_waitcnt lgkmcnt(7)
    s_waitcnt vmcnt(12)
    ds_read_b64_tr_b16 v[54:55], v18 offset:28672
    v_mfma_f32_16x16x32_bf16 a[32:35], v[32:35], v[144:147], a[32:35]
    ds_read_b64_tr_b16 v[56:57], v19 offset:16384
    ds_read_b64_tr_b16 v[58:59], v19 offset:20480
    s_mov_b32 s48, 61440
    s_mov_b32 s49, 192512
    v_mfma_f32_16x16x32_bf16 a[32:35], v[36:39], v[148:151], a[32:35]
    buffer_load_dwordx4 v[192:195], v27, s[40:43], s48 offen sc1
    v_mfma_f32_16x16x32_bf16 a[36:39], v[32:35], v[152:155], a[36:39]
    ds_read_b64_tr_b16 v[60:61], v19 offset:24576
    v_mfma_f32_16x16x32_bf16 a[36:39], v[36:39], v[156:159], a[36:39]
    s_waitcnt lgkmcnt(7)
    ds_read_b64_tr_b16 v[62:63], v19 offset:28672
    v_mfma_f32_16x16x32_bf16 a[40:43], v[40:43], v[144:147], a[40:43]
    ds_read_b64_tr_b16 v[32:33], v12 offset:32768
    ds_read_b64_tr_b16 v[34:35], v12 offset:36864
    v_mfma_f32_16x16x32_bf16 a[40:43], v[44:47], v[148:151], a[40:43]
    buffer_load_dwordx4 v[196:199], v27, s[40:43], s48 offen offset:1024 sc1
    v_mfma_f32_16x16x32_bf16 a[44:47], v[40:43], v[152:155], a[44:47]
    ds_read_b64_tr_b16 v[36:37], v12 offset:40960
    v_mfma_f32_16x16x32_bf16 a[44:47], v[44:47], v[156:159], a[44:47]
    s_waitcnt lgkmcnt(7)
    ds_read_b64_tr_b16 v[38:39], v12 offset:45056
    v_mfma_f32_16x16x32_bf16 a[48:51], v[48:51], v[144:147], a[48:51]
    ds_read_b64_tr_b16 v[40:41], v13 offset:32768
    ds_read_b64_tr_b16 v[42:43], v13 offset:36864
    v_mfma_f32_16x16x32_bf16 a[48:51], v[52:55], v[148:151], a[48:51]
    buffer_load_dwordx4 v[200:203], v27, s[40:43], s49 offen sc1
    v_mfma_f32_16x16x32_bf16 a[52:55], v[48:51], v[152:155], a[52:55]
    ds_read_b64_tr_b16 v[44:45], v13 offset:40960
    v_mfma_f32_16x16x32_bf16 a[52:55], v[52:55], v[156:159], a[52:55]
    s_waitcnt lgkmcnt(7)
    ds_read_b64_tr_b16 v[46:47], v13 offset:45056
    v_mfma_f32_16x16x32_bf16 a[56:59], v[56:59], v[144:147], a[56:59]
    ds_read_b64_tr_b16 v[48:49], v14 offset:32768
    ds_read_b64_tr_b16 v[50:51], v14 offset:36864
    v_mfma_f32_16x16x32_bf16 a[56:59], v[60:63], v[148:151], a[56:59]
    buffer_load_dwordx4 v[204:207], v27, s[40:43], s49 offen offset:1024 sc1
    v_mfma_f32_16x16x32_bf16 a[60:63], v[56:59], v[152:155], a[60:63]
    ds_read_b64_tr_b16 v[52:53], v14 offset:40960
    v_mfma_f32_16x16x32_bf16 a[60:63], v[60:63], v[156:159], a[60:63]
    s_waitcnt lgkmcnt(7)
    s_waitcnt vmcnt(12)
    ds_read_b64_tr_b16 v[54:55], v14 offset:45056
    v_mfma_f32_16x16x32_bf16 a[32:35], v[32:35], v[160:163], a[32:35]
    ds_read_b64_tr_b16 v[56:57], v15 offset:32768
    ds_read_b64_tr_b16 v[58:59], v15 offset:36864
    s_add_u32 m0, s29, 81920
    s_add_u32 s66, s3, 393216
    v_mfma_f32_16x16x32_bf16 a[32:35], v[36:39], v[164:167], a[32:35]
    buffer_load_dwordx4 v20, s[36:39], s66 offen lds
    v_mfma_f32_16x16x32_bf16 a[36:39], v[32:35], v[168:171], a[36:39]
    ds_read_b64_tr_b16 v[60:61], v15 offset:40960
    v_mfma_f32_16x16x32_bf16 a[36:39], v[36:39], v[172:175], a[36:39]
    s_waitcnt lgkmcnt(7)
    ds_read_b64_tr_b16 v[62:63], v15 offset:45056
    v_mfma_f32_16x16x32_bf16 a[40:43], v[40:43], v[160:163], a[40:43]
    ds_read_b64_tr_b16 v[32:33], v16 offset:32768
    ds_read_b64_tr_b16 v[34:35], v16 offset:36864
    v_mfma_f32_16x16x32_bf16 a[40:43], v[44:47], v[164:167], a[40:43]
    buffer_load_dwordx4 v21, s[36:39], s66 offen offset:1024 lds
    v_mfma_f32_16x16x32_bf16 a[44:47], v[40:43], v[168:171], a[44:47]
    ds_read_b64_tr_b16 v[36:37], v16 offset:40960
    v_mfma_f32_16x16x32_bf16 a[44:47], v[44:47], v[172:175], a[44:47]
    s_waitcnt lgkmcnt(7)
    ds_read_b64_tr_b16 v[38:39], v16 offset:45056
    v_mfma_f32_16x16x32_bf16 a[48:51], v[48:51], v[160:163], a[48:51]
    ds_read_b64_tr_b16 v[40:41], v17 offset:32768
    ds_read_b64_tr_b16 v[42:43], v17 offset:36864
    v_mfma_f32_16x16x32_bf16 a[48:51], v[52:55], v[164:167], a[48:51]
    buffer_load_dwordx4 v22, s[36:39], s66 offen offset:2048 lds
    v_mfma_f32_16x16x32_bf16 a[52:55], v[48:51], v[168:171], a[52:55]
    ds_read_b64_tr_b16 v[44:45], v17 offset:40960
    v_mfma_f32_16x16x32_bf16 a[52:55], v[52:55], v[172:175], a[52:55]
    s_waitcnt lgkmcnt(7)
    ds_read_b64_tr_b16 v[46:47], v17 offset:45056
    v_mfma_f32_16x16x32_bf16 a[56:59], v[56:59], v[160:163], a[56:59]
    ds_read_b64_tr_b16 v[48:49], v18 offset:32768
    ds_read_b64_tr_b16 v[50:51], v18 offset:36864
    v_mfma_f32_16x16x32_bf16 a[56:59], v[60:63], v[164:167], a[56:59]
    buffer_load_dwordx4 v23, s[36:39], s66 offen offset:3072 lds
    v_mfma_f32_16x16x32_bf16 a[60:63], v[56:59], v[168:171], a[60:63]
    ds_read_b64_tr_b16 v[52:53], v18 offset:40960
    v_mfma_f32_16x16x32_bf16 a[60:63], v[60:63], v[172:175], a[60:63]
    s_waitcnt lgkmcnt(7)
    s_waitcnt vmcnt(8)
    ds_read_b64_tr_b16 v[54:55], v18 offset:45056
    v_mfma_f32_16x16x32_bf16 a[32:35], v[32:35], v[176:179], a[32:35]
    ds_read_b64_tr_b16 v[56:57], v19 offset:32768
    ds_read_b64_tr_b16 v[58:59], v19 offset:36864
    s_mov_b32 s48, 61440
    s_mov_b32 s49, 192512
    v_mfma_f32_16x16x32_bf16 a[32:35], v[36:39], v[180:183], a[32:35]
    buffer_load_dwordx4 v[208:211], v27, s[40:43], s48 offen offset:2048 sc1
    v_mfma_f32_16x16x32_bf16 a[36:39], v[32:35], v[184:187], a[36:39]
    ds_read_b64_tr_b16 v[60:61], v19 offset:40960
    v_mfma_f32_16x16x32_bf16 a[36:39], v[36:39], v[188:191], a[36:39]
    s_waitcnt lgkmcnt(7)
    ds_read_b64_tr_b16 v[62:63], v19 offset:45056
    v_add_u32 v12, 0xffff8000, v12
    buffer_load_dwordx4 v[212:215], v27, s[40:43], s48 offen offset:3072 sc1
    v_mfma_f32_16x16x32_bf16 a[40:43], v[40:43], v[176:179], a[40:43]
    ds_read_b64_tr_b16 v[32:33], v12
    ds_read_b64_tr_b16 v[34:35], v12 offset:4096
    v_mfma_f32_16x16x32_bf16 a[40:43], v[44:47], v[180:183], a[40:43]
    buffer_load_dwordx4 v[216:219], v27, s[40:43], s49 offen offset:2048 sc1
    v_mfma_f32_16x16x32_bf16 a[44:47], v[40:43], v[184:187], a[44:47]
    ds_read_b64_tr_b16 v[36:37], v12 offset:8192
    v_mfma_f32_16x16x32_bf16 a[44:47], v[44:47], v[188:191], a[44:47]
    s_waitcnt lgkmcnt(7)
    ds_read_b64_tr_b16 v[38:39], v12 offset:12288
    v_add_u32 v13, 0xffff8000, v13
    buffer_load_dwordx4 v[220:223], v27, s[40:43], s49 offen offset:3072 sc1
    v_mfma_f32_16x16x32_bf16 a[48:51], v[48:51], v[176:179], a[48:51]
    ds_read_b64_tr_b16 v[40:41], v13
    ds_read_b64_tr_b16 v[42:43], v13 offset:4096
    s_add_u32 m0, s29, 98304
    s_add_u32 s66, s3, 655360
    v_mfma_f32_16x16x32_bf16 a[48:51], v[52:55], v[180:183], a[48:51]
    buffer_load_dwordx4 v20, s[36:39], s66 offen lds
    v_mfma_f32_16x16x32_bf16 a[52:55], v[48:51], v[184:187], a[52:55]
    ds_read_b64_tr_b16 v[44:45], v13 offset:8192
    v_mfma_f32_16x16x32_bf16 a[52:55], v[52:55], v[188:191], a[52:55]
    s_waitcnt lgkmcnt(7)
    ds_read_b64_tr_b16 v[46:47], v13 offset:12288
    v_add_u32 v14, 0xffff8000, v14
    v_mfma_f32_16x16x32_bf16 a[56:59], v[56:59], v[176:179], a[56:59]
    ds_read_b64_tr_b16 v[48:49], v14
    ds_read_b64_tr_b16 v[50:51], v14 offset:4096
    v_mfma_f32_16x16x32_bf16 a[56:59], v[60:63], v[180:183], a[56:59]
    buffer_load_dwordx4 v21, s[36:39], s66 offen offset:1024 lds
    v_mfma_f32_16x16x32_bf16 a[60:63], v[56:59], v[184:187], a[60:63]
    s_waitcnt vmcnt(6)
    s_barrier
    ds_read_b64_tr_b16 v[52:53], v14 offset:8192
    v_mfma_f32_16x16x32_bf16 a[60:63], v[60:63], v[188:191], a[60:63]
    s_waitcnt lgkmcnt(7)
    s_waitcnt vmcnt(10)
    ds_read_b64_tr_b16 v[54:55], v14 offset:12288
    v_add_u32 v15, 0xffff8000, v15
    v_mfma_f32_16x16x32_bf16 a[32:35], v[32:35], v[192:195], a[32:35]
    ds_read_b64_tr_b16 v[56:57], v15
    ds_read_b64_tr_b16 v[58:59], v15 offset:4096
    v_mfma_f32_16x16x32_bf16 a[32:35], v[36:39], v[196:199], a[32:35]
    buffer_load_dwordx4 v22, s[36:39], s66 offen offset:2048 lds
    v_mfma_f32_16x16x32_bf16 a[36:39], v[32:35], v[200:203], a[36:39]
    ds_read_b64_tr_b16 v[60:61], v15 offset:8192
    v_mfma_f32_16x16x32_bf16 a[36:39], v[36:39], v[204:207], a[36:39]
    s_waitcnt lgkmcnt(7)
    ds_read_b64_tr_b16 v[62:63], v15 offset:12288
    v_add_u32 v16, 0xffff8000, v16
    v_mfma_f32_16x16x32_bf16 a[40:43], v[40:43], v[192:195], a[40:43]
    ds_read_b64_tr_b16 v[32:33], v16
    ds_read_b64_tr_b16 v[34:35], v16 offset:4096
    v_mfma_f32_16x16x32_bf16 a[40:43], v[44:47], v[196:199], a[40:43]
    buffer_load_dwordx4 v23, s[36:39], s66 offen offset:3072 lds
    v_mfma_f32_16x16x32_bf16 a[44:47], v[40:43], v[200:203], a[44:47]
    ds_read_b64_tr_b16 v[36:37], v16 offset:8192
    v_mfma_f32_16x16x32_bf16 a[44:47], v[44:47], v[204:207], a[44:47]
    s_waitcnt lgkmcnt(7)
    ds_read_b64_tr_b16 v[38:39], v16 offset:12288
    v_add_u32 v17, 0xffff8000, v17
    v_mfma_f32_16x16x32_bf16 a[48:51], v[48:51], v[192:195], a[48:51]
    ds_read_b64_tr_b16 v[40:41], v17
    ds_read_b64_tr_b16 v[42:43], v17 offset:4096
    s_add_u32 m0, s29, 16384
    s_add_u32 s66, s3, 917504
    v_mfma_f32_16x16x32_bf16 a[48:51], v[52:55], v[196:199], a[48:51]
    buffer_load_dwordx4 v20, s[36:39], s66 offen lds
    v_mfma_f32_16x16x32_bf16 a[52:55], v[48:51], v[200:203], a[52:55]
    ds_read_b64_tr_b16 v[44:45], v17 offset:8192
    v_mfma_f32_16x16x32_bf16 a[52:55], v[52:55], v[204:207], a[52:55]
    s_waitcnt lgkmcnt(7)
    ds_read_b64_tr_b16 v[46:47], v17 offset:12288
    v_add_u32 v18, 0xffff8000, v18
    v_mfma_f32_16x16x32_bf16 a[56:59], v[56:59], v[192:195], a[56:59]
    ds_read_b64_tr_b16 v[48:49], v18
    ds_read_b64_tr_b16 v[50:51], v18 offset:4096
    v_mfma_f32_16x16x32_bf16 a[56:59], v[60:63], v[196:199], a[56:59]
    buffer_load_dwordx4 v21, s[36:39], s66 offen offset:1024 lds
    v_mfma_f32_16x16x32_bf16 a[60:63], v[56:59], v[200:203], a[60:63]
    ds_read_b64_tr_b16 v[52:53], v18 offset:8192
    v_mfma_f32_16x16x32_bf16 a[60:63], v[60:63], v[204:207], a[60:63]
    s_waitcnt lgkmcnt(7)
    s_waitcnt vmcnt(6)
    ds_read_b64_tr_b16 v[54:55], v18 offset:12288
    v_add_u32 v19, 0xffff8000, v19
    v_mfma_f32_16x16x32_bf16 a[32:35], v[32:35], v[208:211], a[32:35]
    ds_read_b64_tr_b16 v[56:57], v19
    ds_read_b64_tr_b16 v[58:59], v19 offset:4096
    v_mfma_f32_16x16x32_bf16 a[32:35], v[36:39], v[212:215], a[32:35]
    buffer_load_dwordx4 v22, s[36:39], s66 offen offset:2048 lds
    v_mfma_f32_16x16x32_bf16 a[36:39], v[32:35], v[216:219], a[36:39]
    ds_read_b64_tr_b16 v[60:61], v19 offset:8192
    v_mfma_f32_16x16x32_bf16 a[36:39], v[36:39], v[220:223], a[36:39]
    s_waitcnt lgkmcnt(7)
    ds_read_b64_tr_b16 v[62:63], v19 offset:12288
    v_add_u32 v12, 0x24000, v12
    v_mfma_f32_16x16x32_bf16 a[40:43], v[40:43], v[208:211], a[40:43]
    ds_read_b64_tr_b16 v[32:33], v12
    ds_read_b64_tr_b16 v[34:35], v12 offset:4096
    v_mfma_f32_16x16x32_bf16 a[40:43], v[44:47], v[212:215], a[40:43]
    buffer_load_dwordx4 v23, s[36:39], s66 offen offset:3072 lds
    v_mfma_f32_16x16x32_bf16 a[44:47], v[40:43], v[216:219], a[44:47]
    ds_read_b64_tr_b16 v[36:37], v12 offset:8192
    v_mfma_f32_16x16x32_bf16 a[44:47], v[44:47], v[220:223], a[44:47]
    s_waitcnt lgkmcnt(7)
    ds_read_b64_tr_b16 v[38:39], v12 offset:12288
    v_add_u32 v13, 0x24000, v13
    v_mfma_f32_16x16x32_bf16 a[48:51], v[48:51], v[208:211], a[48:51]
    ds_read_b64_tr_b16 v[40:41], v13
    ds_read_b64_tr_b16 v[42:43], v13 offset:4096
    s_add_u32 m0, s29, 114688
    s_add_u32 s66, s3, 1179648
    v_mfma_f32_16x16x32_bf16 a[48:51], v[52:55], v[212:215], a[48:51]
    buffer_load_dwordx4 v20, s[36:39], s66 offen lds
    v_mfma_f32_16x16x32_bf16 a[52:55], v[48:51], v[216:219], a[52:55]
    ds_read_b64_tr_b16 v[44:45], v13 offset:8192
    v_mfma_f32_16x16x32_bf16 a[52:55], v[52:55], v[220:223], a[52:55]
    s_waitcnt lgkmcnt(7)
    ds_read_b64_tr_b16 v[46:47], v13 offset:12288
    v_add_u32 v14, 0x24000, v14
    v_mfma_f32_16x16x32_bf16 a[56:59], v[56:59], v[208:211], a[56:59]
    ds_read_b64_tr_b16 v[48:49], v14
    ds_read_b64_tr_b16 v[50:51], v14 offset:4096
    v_mfma_f32_16x16x32_bf16 a[56:59], v[60:63], v[212:215], a[56:59]
    buffer_load_dwordx4 v21, s[36:39], s66 offen offset:1024 lds
    v_mfma_f32_16x16x32_bf16 a[60:63], v[56:59], v[216:219], a[60:63]
    ds_read_b64_tr_b16 v[52:53], v14 offset:8192
    v_mfma_f32_16x16x32_bf16 a[60:63], v[60:63], v[220:223], a[60:63]
    s_waitcnt lgkmcnt(7)
    ds_read_b64_tr_b16 v[54:55], v14 offset:12288
    v_add_u32 v15, 0x24000, v15
    v_mfma_f32_16x16x32_bf16 a[0:3], v[32:35], a[64:67], a[0:3]
    ds_read_b64_tr_b16 v[56:57], v15
    ds_read_b64_tr_b16 v[58:59], v15 offset:4096
    v_mfma_f32_16x16x32_bf16 a[0:3], v[36:39], a[68:71], a[0:3]
    buffer_load_dwordx4 v22, s[36:39], s66 offen offset:2048 lds
    v_mfma_f32_16x16x32_bf16 a[4:7], v[32:35], a[72:75], a[4:7]
    ds_read_b64_tr_b16 v[60:61], v15 offset:8192
    v_mfma_f32_16x16x32_bf16 a[4:7], v[36:39], a[76:79], a[4:7]
    s_waitcnt lgkmcnt(7)
    ds_read_b64_tr_b16 v[62:63], v15 offset:12288
    v_add_u32 v16, 0x24000, v16
    v_mfma_f32_16x16x32_bf16 a[8:11], v[40:43], a[64:67], a[8:11]
    ds_read_b64_tr_b16 v[32:33], v16
    ds_read_b64_tr_b16 v[34:35], v16 offset:4096
    v_mfma_f32_16x16x32_bf16 a[8:11], v[44:47], a[68:71], a[8:11]
    buffer_load_dwordx4 v23, s[36:39], s66 offen offset:3072 lds
    v_mfma_f32_16x16x32_bf16 a[12:15], v[40:43], a[72:75], a[12:15]
    ds_read_b64_tr_b16 v[36:37], v16 offset:8192
    v_mfma_f32_16x16x32_bf16 a[12:15], v[44:47], a[76:79], a[12:15]
    s_waitcnt lgkmcnt(7)
    ds_read_b64_tr_b16 v[38:39], v16 offset:12288
    v_add_u32 v17, 0x24000, v17
    v_mfma_f32_16x16x32_bf16 a[16:19], v[48:51], a[64:67], a[16:19]
    ds_read_b64_tr_b16 v[40:41], v17
    ds_read_b64_tr_b16 v[42:43], v17 offset:4096
    s_mov_b32 s67, 4096
    v_mfma_f32_16x16x32_bf16 a[16:19], v[52:55], a[68:71], a[16:19]
    buffer_store_dwordx4 a[32:35], v29, s[52:55], s84 offen sc1
    v_mfma_f32_16x16x32_bf16 a[20:23], v[48:51], a[72:75], a[20:23]
    ds_read_b64_tr_b16 v[44:45], v17 offset:8192
    v_mfma_f32_16x16x32_bf16 a[20:23], v[52:55], a[76:79], a[20:23]
    s_waitcnt lgkmcnt(7)
    ds_read_b64_tr_b16 v[46:47], v17 offset:12288
    v_add_u32 v18, 0x24000, v18
    v_mfma_f32_16x16x32_bf16 a[24:27], v[56:59], a[64:67], a[24:27]
    ds_read_b64_tr_b16 v[48:49], v18
    ds_read_b64_tr_b16 v[50:51], v18 offset:4096
    v_mfma_f32_16x16x32_bf16 a[24:27], v[60:63], a[68:71], a[24:27]
    buffer_store_dwordx4 a[36:39], v29, s[52:55], s84 offen offset:1024 sc1
    v_mfma_f32_16x16x32_bf16 a[28:31], v[56:59], a[72:75], a[28:31]
    ds_read_b64_tr_b16 v[52:53], v18 offset:8192
    v_mfma_f32_16x16x32_bf16 a[28:31], v[60:63], a[76:79], a[28:31]
    s_waitcnt lgkmcnt(7)
    ds_read_b64_tr_b16 v[54:55], v18 offset:12288
    v_add_u32 v19, 0x24000, v19
    v_mfma_f32_16x16x32_bf16 a[0:3], v[32:35], a[80:83], a[0:3]
    ds_read_b64_tr_b16 v[56:57], v19
    ds_read_b64_tr_b16 v[58:59], v19 offset:4096
    v_mfma_f32_16x16x32_bf16 a[0:3], v[36:39], a[84:87], a[0:3]
    buffer_store_dwordx4 a[40:43], v29, s[52:55], s84 offen offset:2048 sc1
    v_mfma_f32_16x16x32_bf16 a[4:7], v[32:35], a[88:91], a[4:7]
    ds_read_b64_tr_b16 v[60:61], v19 offset:8192
    v_mfma_f32_16x16x32_bf16 a[4:7], v[36:39], a[92:95], a[4:7]
    s_waitcnt lgkmcnt(7)
    ds_read_b64_tr_b16 v[62:63], v19 offset:12288
    v_add_u32 v12, 0xffff0000, v12
    v_mfma_f32_16x16x32_bf16 a[8:11], v[40:43], a[80:83], a[8:11]
    ds_read_b64_tr_b16 v[32:33], v12
    ds_read_b64_tr_b16 v[34:35], v12 offset:4096
    v_mfma_f32_16x16x32_bf16 a[8:11], v[44:47], a[84:87], a[8:11]
    buffer_store_dwordx4 a[44:47], v29, s[52:55], s84 offen offset:3072 sc1
    v_mfma_f32_16x16x32_bf16 a[12:15], v[40:43], a[88:91], a[12:15]
    ds_read_b64_tr_b16 v[36:37], v12 offset:8192
    v_mfma_f32_16x16x32_bf16 a[12:15], v[44:47], a[92:95], a[12:15]
    s_waitcnt lgkmcnt(7)
    ds_read_b64_tr_b16 v[38:39], v12 offset:12288
    v_add_u32 v13, 0xffff0000, v13
    v_mfma_f32_16x16x32_bf16 a[16:19], v[48:51], a[80:83], a[16:19]
    ds_read_b64_tr_b16 v[40:41], v13
    ds_read_b64_tr_b16 v[42:43], v13 offset:4096
    v_mfma_f32_16x16x32_bf16 a[16:19], v[52:55], a[84:87], a[16:19]
    buffer_store_dwordx4 a[48:51], v29, s[52:55], s67 offen sc1
    v_mfma_f32_16x16x32_bf16 a[20:23], v[48:51], a[88:91], a[20:23]
    ds_read_b64_tr_b16 v[44:45], v13 offset:8192
    v_mfma_f32_16x16x32_bf16 a[20:23], v[52:55], a[92:95], a[20:23]
    s_waitcnt lgkmcnt(7)
    ds_read_b64_tr_b16 v[46:47], v13 offset:12288
    v_add_u32 v14, 0xffff0000, v14
    v_mfma_f32_16x16x32_bf16 a[24:27], v[56:59], a[80:83], a[24:27]
    ds_read_b64_tr_b16 v[48:49], v14
    ds_read_b64_tr_b16 v[50:51], v14 offset:4096
    v_mfma_f32_16x16x32_bf16 a[24:27], v[60:63], a[84:87], a[24:27]
    buffer_store_dwordx4 a[52:55], v29, s[52:55], s67 offen offset:1024 sc1
    v_mfma_f32_16x16x32_bf16 a[28:31], v[56:59], a[88:91], a[28:31]
    s_waitcnt vmcnt(10)
    s_barrier
    ds_read_b64_tr_b16 v[52:53], v14 offset:8192
    v_mfma_f32_16x16x32_bf16 a[28:31], v[60:63], a[92:95], a[28:31]
    s_waitcnt lgkmcnt(7)
    ds_read_b64_tr_b16 v[54:55], v14 offset:12288
    v_add_u32 v15, 0xffff0000, v15
    v_mfma_f32_16x16x32_bf16 a[0:3], v[32:35], a[96:99], a[0:3]
    ds_read_b64_tr_b16 v[56:57], v15
    ds_read_b64_tr_b16 v[58:59], v15 offset:4096
    v_mfma_f32_16x16x32_bf16 a[0:3], v[36:39], a[100:103], a[0:3]
    buffer_store_dwordx4 a[56:59], v29, s[52:55], s67 offen offset:2048 sc1
    v_mfma_f32_16x16x32_bf16 a[4:7], v[32:35], a[104:107], a[4:7]
    ds_read_b64_tr_b16 v[60:61], v15 offset:8192
    v_mfma_f32_16x16x32_bf16 a[4:7], v[36:39], a[108:111], a[4:7]
    s_waitcnt lgkmcnt(7)
    ds_read_b64_tr_b16 v[62:63], v15 offset:12288
    v_add_u32 v16, 0xffff0000, v16
    v_mfma_f32_16x16x32_bf16 a[8:11], v[40:43], a[96:99], a[8:11]
    ds_read_b64_tr_b16 v[32:33], v16
    ds_read_b64_tr_b16 v[34:35], v16 offset:4096
    v_mfma_f32_16x16x32_bf16 a[8:11], v[44:47], a[100:103], a[8:11]
    buffer_store_dwordx4 a[60:63], v29, s[52:55], s67 offen offset:3072 sc1
    v_mfma_f32_16x16x32_bf16 a[12:15], v[40:43], a[104:107], a[12:15]
    ds_read_b64_tr_b16 v[36:37], v16 offset:8192
    v_mfma_f32_16x16x32_bf16 a[12:15], v[44:47], a[108:111], a[12:15]
    s_waitcnt lgkmcnt(7)
    ds_read_b64_tr_b16 v[38:39], v16 offset:12288
    v_add_u32 v17, 0xffff0000, v17
    v_mfma_f32_16x16x32_bf16 a[16:19], v[48:51], a[96:99], a[16:19]
    ds_read_b64_tr_b16 v[40:41], v17
    ds_read_b64_tr_b16 v[42:43], v17 offset:4096
    s_add_u32 m0, s29, 131072
    s_add_u32 s66, s3, 1441792
    v_mfma_f32_16x16x32_bf16 a[16:19], v[52:55], a[100:103], a[16:19]
    buffer_load_dwordx4 v20, s[36:39], s66 offen lds
    v_mfma_f32_16x16x32_bf16 a[20:23], v[48:51], a[104:107], a[20:23]
    ds_read_b64_tr_b16 v[44:45], v17 offset:8192
    v_mfma_f32_16x16x32_bf16 a[20:23], v[52:55], a[108:111], a[20:23]
    s_waitcnt lgkmcnt(7)
    ds_read_b64_tr_b16 v[46:47], v17 offset:12288
    v_add_u32 v18, 0xffff0000, v18
    v_mfma_f32_16x16x32_bf16 a[24:27], v[56:59], a[96:99], a[24:27]
    ds_read_b64_tr_b16 v[48:49], v18
    ds_read_b64_tr_b16 v[50:51], v18 offset:4096
    v_mfma_f32_16x16x32_bf16 a[24:27], v[60:63], a[100:103], a[24:27]
    buffer_load_dwordx4 v21, s[36:39], s66 offen offset:1024 lds
    v_mfma_f32_16x16x32_bf16 a[28:31], v[56:59], a[104:107], a[28:31]
    ds_read_b64_tr_b16 v[52:53], v18 offset:8192
    v_mfma_f32_16x16x32_bf16 a[28:31], v[60:63], a[108:111], a[28:31]
    s_waitcnt lgkmcnt(7)
    ds_read_b64_tr_b16 v[54:55], v18 offset:12288
    v_add_u32 v19, 0xffff0000, v19
    v_mfma_f32_16x16x32_bf16 a[0:3], v[32:35], a[112:115], a[0:3]
    ds_read_b64_tr_b16 v[56:57], v19
    ds_read_b64_tr_b16 v[58:59], v19 offset:4096
    v_mfma_f32_16x16x32_bf16 a[0:3], v[36:39], a[116:119], a[0:3]
    buffer_load_dwordx4 v22, s[36:39], s66 offen offset:2048 lds
    v_mfma_f32_16x16x32_bf16 a[4:7], v[32:35], a[120:123], a[4:7]
    ds_read_b64_tr_b16 v[60:61], v19 offset:8192
    v_mfma_f32_16x16x32_bf16 a[4:7], v[36:39], a[124:127], a[4:7]
    s_waitcnt lgkmcnt(7)
    ds_read_b64_tr_b16 v[62:63], v19 offset:12288
    v_mfma_f32_16x16x32_bf16 a[8:11], v[40:43], a[112:115], a[8:11]
    ds_read_b64_tr_b16 v[32:33], v12 offset:16384
    ds_read_b64_tr_b16 v[34:35], v12 offset:20480
    v_mfma_f32_16x16x32_bf16 a[8:11], v[44:47], a[116:119], a[8:11]
    buffer_load_dwordx4 v23, s[36:39], s66 offen offset:3072 lds
    v_mfma_f32_16x16x32_bf16 a[12:15], v[40:43], a[120:123], a[12:15]
    ds_read_b64_tr_b16 v[36:37], v12 offset:24576
    v_mfma_f32_16x16x32_bf16 a[12:15], v[44:47], a[124:127], a[12:15]
    s_waitcnt lgkmcnt(7)
    ds_read_b64_tr_b16 v[38:39], v12 offset:28672
    v_mfma_f32_16x16x32_bf16 a[16:19], v[48:51], a[112:115], a[16:19]
    ds_read_b64_tr_b16 v[40:41], v13 offset:16384
    ds_read_b64_tr_b16 v[42:43], v13 offset:20480
    s_add_u32 m0, s29, 32768
    s_add_u32 s66, s3, 1703936
    v_mfma_f32_16x16x32_bf16 a[16:19], v[52:55], a[116:119], a[16:19]
    buffer_load_dwordx4 v20, s[36:39], s66 offen lds
    v_mfma_f32_16x16x32_bf16 a[20:23], v[48:51], a[120:123], a[20:23]
    ds_read_b64_tr_b16 v[44:45], v13 offset:24576
    v_mfma_f32_16x16x32_bf16 a[20:23], v[52:55], a[124:127], a[20:23]
    s_waitcnt lgkmcnt(7)
    ds_read_b64_tr_b16 v[46:47], v13 offset:28672
    v_mfma_f32_16x16x32_bf16 a[24:27], v[56:59], a[112:115], a[24:27]
    ds_read_b64_tr_b16 v[48:49], v14 offset:16384
    ds_read_b64_tr_b16 v[50:51], v14 offset:20480
    v_mfma_f32_16x16x32_bf16 a[24:27], v[60:63], a[116:119], a[24:27]
    buffer_load_dwordx4 v21, s[36:39], s66 offen offset:1024 lds
    v_mfma_f32_16x16x32_bf16 a[28:31], v[56:59], a[120:123], a[28:31]
    ds_read_b64_tr_b16 v[52:53], v14 offset:24576
    v_mfma_f32_16x16x32_bf16 a[28:31], v[60:63], a[124:127], a[28:31]
    s_waitcnt lgkmcnt(7)
    ds_read_b64_tr_b16 v[54:55], v14 offset:28672
    v_mfma_f32_16x16x32_bf16 a[0:3], v[32:35], a[128:131], a[0:3]
    ds_read_b64_tr_b16 v[56:57], v15 offset:16384
    ds_read_b64_tr_b16 v[58:59], v15 offset:20480
    v_mfma_f32_16x16x32_bf16 a[0:3], v[36:39], a[132:135], a[0:3]
    buffer_load_dwordx4 v22, s[36:39], s66 offen offset:2048 lds
    v_mfma_f32_16x16x32_bf16 a[4:7], v[32:35], a[136:139], a[4:7]
    ds_read_b64_tr_b16 v[60:61], v15 offset:24576
    v_mfma_f32_16x16x32_bf16 a[4:7], v[36:39], a[140:143], a[4:7]
    s_waitcnt lgkmcnt(7)
    ds_read_b64_tr_b16 v[62:63], v15 offset:28672
    v_mfma_f32_16x16x32_bf16 a[8:11], v[40:43], a[128:131], a[8:11]
    ds_read_b64_tr_b16 v[32:33], v16 offset:16384
    ds_read_b64_tr_b16 v[34:35], v16 offset:20480
    v_mfma_f32_16x16x32_bf16 a[8:11], v[44:47], a[132:135], a[8:11]
    buffer_load_dwordx4 v23, s[36:39], s66 offen offset:3072 lds
    v_mfma_f32_16x16x32_bf16 a[12:15], v[40:43], a[136:139], a[12:15]
    ds_read_b64_tr_b16 v[36:37], v16 offset:24576
    v_mfma_f32_16x16x32_bf16 a[12:15], v[44:47], a[140:143], a[12:15]
    s_waitcnt lgkmcnt(7)
    ds_read_b64_tr_b16 v[38:39], v16 offset:28672
    v_mfma_f32_16x16x32_bf16 a[16:19], v[48:51], a[128:131], a[16:19]
    ds_read_b64_tr_b16 v[40:41], v17 offset:16384
    ds_read_b64_tr_b16 v[42:43], v17 offset:20480
    v_mfma_f32_16x16x32_bf16 a[16:19], v[52:55], a[132:135], a[16:19]
    v_mfma_f32_16x16x32_bf16 a[20:23], v[48:51], a[136:139], a[20:23]
    ds_read_b64_tr_b16 v[44:45], v17 offset:24576
    v_mfma_f32_16x16x32_bf16 a[20:23], v[52:55], a[140:143], a[20:23]
    s_waitcnt lgkmcnt(7)
    ds_read_b64_tr_b16 v[46:47], v17 offset:28672
    v_mfma_f32_16x16x32_bf16 a[24:27], v[56:59], a[128:131], a[24:27]
    ds_read_b64_tr_b16 v[48:49], v18 offset:16384
    ds_read_b64_tr_b16 v[50:51], v18 offset:20480
    v_mfma_f32_16x16x32_bf16 a[24:27], v[60:63], a[132:135], a[24:27]
    v_mfma_f32_16x16x32_bf16 a[28:31], v[56:59], a[136:139], a[28:31]
    ds_read_b64_tr_b16 v[52:53], v18 offset:24576
    v_mfma_f32_16x16x32_bf16 a[28:31], v[60:63], a[140:143], a[28:31]
    s_waitcnt lgkmcnt(7)
    ds_read_b64_tr_b16 v[54:55], v18 offset:28672
    v_mfma_f32_16x16x32_bf16 a[0:3], v[32:35], a[144:147], a[0:3]
    ds_read_b64_tr_b16 v[56:57], v19 offset:16384
    ds_read_b64_tr_b16 v[58:59], v19 offset:20480
    s_add_u32 m0, s29, 49152
    s_add_u32 s66, s3, 1966080
    v_mfma_f32_16x16x32_bf16 a[0:3], v[36:39], a[148:151], a[0:3]
    buffer_load_dwordx4 v20, s[36:39], s66 offen lds
    v_mfma_f32_16x16x32_bf16 a[4:7], v[32:35], a[152:155], a[4:7]
    ds_read_b64_tr_b16 v[60:61], v19 offset:24576
    v_mfma_f32_16x16x32_bf16 a[4:7], v[36:39], a[156:159], a[4:7]
    s_waitcnt lgkmcnt(7)
    ds_read_b64_tr_b16 v[62:63], v19 offset:28672
    v_add_u32 v12, 0xffff0000, v12
    v_mfma_f32_16x16x32_bf16 a[8:11], v[40:43], a[144:147], a[8:11]
    ds_read_b64_tr_b16 v[32:33], v12
    ds_read_b64_tr_b16 v[34:35], v12 offset:4096
    v_mfma_f32_16x16x32_bf16 a[8:11], v[44:47], a[148:151], a[8:11]
    buffer_load_dwordx4 v21, s[36:39], s66 offen offset:1024 lds
    v_mfma_f32_16x16x32_bf16 a[12:15], v[40:43], a[152:155], a[12:15]
L_hop19:
    s_cbranch_execz L_hopret
    ds_read_b64_tr_b16 v[36:37], v12 offset:8192
    v_mfma_f32_16x16x32_bf16 a[12:15], v[44:47], a[156:159], a[12:15]
    s_waitcnt lgkmcnt(7)
    ds_read_b64_tr_b16 v[38:39], v12 offset:12288
    v_add_u32 v13, 0xffff0000, v13
    v_mfma_f32_16x16x32_bf16 a[16:19], v[48:51], a[144:147], a[16:19]
    ds_read_b64_tr_b16 v[40:41], v13
    ds_read_b64_tr_b16 v[42:43], v13 offset:4096
    v_mfma_f32_16x16x32_bf16 a[16:19], v[52:55], a[148:151], a[16:19]
    buffer_load_dwordx4 v22, s[36:39], s66 offen offset:2048 lds
    v_mfma_f32_16x16x32_bf16 a[20:23], v[48:51], a[152:155], a[20:23]
    ds_read_b64_tr_b16 v[44:45], v13 offset:8192
    v_mfma_f32_16x16x32_bf16 a[20:23], v[52:55], a[156:159], a[20:23]
    s_waitcnt lgkmcnt(7)
    ds_read_b64_tr_b16 v[46:47], v13 offset:12288
    v_add_u32 v14, 0xffff0000, v14
    v_mfma_f32_16x16x32_bf16 a[24:27], v[56:59], a[144:147], a[24:27]
    ds_read_b64_tr_b16 v[48:49], v14
    ds_read_b64_tr_b16 v[50:51], v14 offset:4096
    v_mov_b32 v5, s51
    v_mfma_f32_16x16x32_bf16 a[24:27], v[60:63], a[148:151], a[24:27]
    buffer_load_dwordx4 v23, s[36:39], s66 offen offset:3072 lds
    v_mfma_f32_16x16x32_bf16 a[28:31], v[56:59], a[152:155], a[28:31]
    s_waitcnt vmcnt(8)
    s_barrier
    s_cmp_eq_u32 s28, 0
    s_cbranch_scc0 L_noflag
    s_mov_b64 exec, 1
    global_store_dword v5, v7, s[60:61] sc1
    s_mov_b64 exec, -1
L_noflag:
    ds_read_b64_tr_b16 v[52:53], v14 offset:8192
    v_mfma_f32_16x16x32_bf16 a[28:31], v[60:63], a[156:159], a[28:31]
    s_waitcnt lgkmcnt(7)
    ds_read_b64_tr_b16 v[54:55], v14 offset:12288
    v_add_u32 v15, 0xffff0000, v15
    v_mfma_f32_16x16x32_bf16 a[0:3], v[32:35], a[160:163], a[0:3]
    ds_read_b64_tr_b16 v[56:57], v15
    ds_read_b64_tr_b16 v[58:59], v15 offset:4096
    v_mfma_f32_16x16x32_bf16 a[0:3], v[36:39], a[164:167], a[0:3]
    v_mfma_f32_16x16x32_bf16 a[4:7], v[32:35], a[168:171], a[4:7]
    ds_read_b64_tr_b16 v[60:61], v15 offset:8192
    v_mfma_f32_16x16x32_bf16 a[4:7], v[36:39], a[172:175], a[4:7]
    s_waitcnt lgkmcnt(7)
    ds_read_b64_tr_b16 v[62:63], v15 offset:12288
    v_add_u32 v16, 0xffff0000, v16
    v_mfma_f32_16x16x32_bf16 a[8:11], v[40:43], a[160:163], a[8:11]
    ds_read_b64_tr_b16 v[32:33], v16
    ds_read_b64_tr_b16 v[34:35], v16 offset:4096
    v_mfma_f32_16x16x32_bf16 a[8:11], v[44:47], a[164:167], a[8:11]
    v_mfma_f32_16x16x32_bf16 a[12:15], v[40:43], a[168:171], a[12:15]
    ds_read_b64_tr_b16 v[36:37], v16 offset:8192
    v_mfma_f32_16x16x32_bf16 a[12:15], v[44:47], a[172:175], a[12:15]
    s_waitcnt lgkmcnt(7)
    ds_read_b64_tr_b16 v[38:39], v16 offset:12288
    v_add_u32 v17, 0xffff0000, v17
    v_mfma_f32_16x16x32_bf16 a[16:19], v[48:51], a[160:163], a[16:19]
    ds_read_b64_tr_b16 v[40:41], v17
    ds_read_b64_tr_b16 v[42:43], v17 offset:4096
    v_mfma_f32_16x16x32_bf16 a[16:19], v[52:55], a[164:167], a[16:19]
    v_mfma_f32_16x16x32_bf16 a[20:23], v[48:51], a[168:171], a[20:23]
    ds_read_b64_tr_b16 v[44:45], v17 offset:8192
    v_mfma_f32_16x16x32_bf16 a[20:23], v[52:55], a[172:175], a[20:23]
    s_waitcnt lgkmcnt(7)
    ds_read_b64_tr_b16 v[46:47], v17 offset:12288
    v_add_u32 v18, 0xffff0000, v18
    v_mfma_f32_16x16x32_bf16 a[24:27], v[56:59], a[160:163], a[24:27]
    ds_read_b64_tr_b16 v[48:49], v18
    ds_read_b64_tr_b16 v[50:51], v18 offset:4096
    v_mfma_f32_16x16x32_bf16 a[24:27], v[60:63], a[164:167], a[24:27]
    v_mfma_f32_16x16x32_bf16 a[28:31], v[56:59], a[168:171], a[28:31]
    ds_read_b64_tr_b16 v[52:53], v18 offset:8192
    v_mfma_f32_16x16x32_bf16 a[28:31], v[60:63], a[172:175], a[28:31]
    s_waitcnt lgkmcnt(7)
    ds_read_b64_tr_b16 v[54:55], v18 offset:12288
    v_add_u32 v19, 0xffff0000, v19
    v_mfma_f32_16x16x32_bf16 a[0:3], v[32:35], a[176:179], a[0:3]
    ds_read_b64_tr_b16 v[56:57], v19
    ds_read_b64_tr_b16 v[58:59], v19 offset:4096
    v_mfma_f32_16x16x32_bf16 a[0:3], v[36:39], a[180:183], a[0:3]
    v_mfma_f32_16x16x32_bf16 a[4:7], v[32:35], a[184:187], a[4:7]
    ds_read_b64_tr_b16 v[60:61], v19 offset:8192
    v_mfma_f32_16x16x32_bf16 a[4:7], v[36:39], a[188:191], a[4:7]
    s_waitcnt lgkmcnt(7)
    ds_read_b64_tr_b16 v[62:63], v19 offset:12288
    v_add_u32 v12, 0x18000, v12
    v_mfma_f32_16x16x32_bf16 a[8:11], v[40:43], a[176:179], a[8:11]
    ds_read_b64_tr_b16 v[32:33], v12
    ds_read_b64_tr_b16 v[34:35], v12 offset:4096
    v_mfma_f32_16x16x32_bf16 a[8:11], v[44:47], a[180:183], a[8:11]
    v_mfma_f32_16x16x32_bf16 a[12:15], v[40:43], a[184:187], a[12:15]
    ds_read_b64_tr_b16 v[36:37], v12 offset:8192
    v_mfma_f32_16x16x32_bf16 a[12:15], v[44:47], a[188:191], a[12:15]
    s_waitcnt lgkmcnt(7)
    ds_read_b64_tr_b16 v[38:39], v12 offset:12288
    v_add_u32 v13, 0x18000, v13
    v_mfma_f32_16x16x32_bf16 a[16:19], v[48:51], a[176:179], a[16:19]
    ds_read_b64_tr_b16 v[40:41], v13
    ds_read_b64_tr_b16 v[42:43], v13 offset:4096
    v_mfma_f32_16x16x32_bf16 a[16:19], v[52:55], a[180:183], a[16:19]
    v_mfma_f32_16x16x32_bf16 a[20:23], v[48:51], a[184:187], a[20:23]
    ds_read_b64_tr_b16 v[44:45], v13 offset:8192
    v_mfma_f32_16x16x32_bf16 a[20:23], v[52:55], a[188:191], a[20:23]
    s_waitcnt lgkmcnt(7)
    ds_read_b64_tr_b16 v[46:47], v13 offset:12288
    v_add_u32 v14, 0x18000, v14
    v_mfma_f32_16x16x32_bf16 a[24:27], v[56:59], a[176:179], a[24:27]
    ds_read_b64_tr_b16 v[48:49], v14
    ds_read_b64_tr_b16 v[50:51], v14 offset:4096
    v_mfma_f32_16x16x32_bf16 a[24:27], v[60:63], a[180:183], a[24:27]
    v_mfma_f32_16x16x32_bf16 a[28:31], v[56:59], a[184:187], a[28:31]
    ds_read_b64_tr_b16 v[52:53], v14 offset:8192
    v_and_b32 v24, 7, v3
    v_mfma_f32_16x16x32_bf16 a[28:31], v[60:63], a[188:191], a[28:31]
    s_waitcnt lgkmcnt(7)
    ds_read_b64_tr_b16 v[54:55], v14 offset:12288
    v_add_u32 v15, 0x18000, v15
    v_lshrrev_b32 v8, 1, v4
    v_mfma_f32_16x16x32_bf16 a[0:3], v[32:35], v[96:99], a[0:3]
    ds_read_b64_tr_b16 v[56:57], v15
    ds_read_b64_tr_b16 v[58:59], v15 offset:4096
    v_mfma_f32_16x16x32_bf16 a[0:3], v[36:39], v[100:103], a[0:3]
    v_mfma_f32_16x16x32_bf16 a[4:7], v[32:35], v[104:107], a[4:7]
    ds_read_b64_tr_b16 v[60:61], v15 offset:8192
    v_xor_b32 v24, v24, v8
    v_mfma_f32_16x16x32_bf16 a[4:7], v[36:39], v[108:111], a[4:7]
    s_waitcnt lgkmcnt(7)
    ds_read_b64_tr_b16 v[62:63], v15 offset:12288
    v_add_u32 v16, 0x18000, v16
    v_lshlrev_b32 v24, 4, v24
    v_mfma_f32_16x16x32_bf16 a[8:11], v[40:43], v[96:99], a[8:11]
    ds_read_b64_tr_b16 v[32:33], v16
    ds_read_b64_tr_b16 v[34:35], v16 offset:4096
    v_mfma_f32_16x16x32_bf16 a[8:11], v[44:47], v[100:103], a[8:11]
    v_mfma_f32_16x16x32_bf16 a[12:15], v[40:43], v[104:107], a[12:15]
    ds_read_b64_tr_b16 v[36:37], v16 offset:8192
    v_lshl_add_u32 v24, v3, 7, v24
    v_mfma_f32_16x16x32_bf16 a[12:15], v[44:47], v[108:111], a[12:15]
    s_waitcnt lgkmcnt(7)
    ds_read_b64_tr_b16 v[38:39], v16 offset:12288
    v_add_u32 v17, 0x18000, v17
    v_and_b32 v8, 1, v4
    v_mfma_f32_16x16x32_bf16 a[16:19], v[48:51], v[96:99], a[16:19]
    ds_read_b64_tr_b16 v[40:41], v17
    ds_read_b64_tr_b16 v[42:43], v17 offset:4096
    v_mfma_f32_16x16x32_bf16 a[16:19], v[52:55], v[100:103], a[16:19]
    v_mfma_f32_16x16x32_bf16 a[20:23], v[48:51], v[104:107], a[20:23]
    ds_read_b64_tr_b16 v[44:45], v17 offset:8192
    v_lshl_add_u32 v24, v8, 3, v24
    v_mfma_f32_16x16x32_bf16 a[20:23], v[52:55], v[108:111], a[20:23]
    s_waitcnt lgkmcnt(7)
    ds_read_b64_tr_b16 v[46:47], v17 offset:12288
    v_add_u32 v18, 0x18000, v18
    v_lshl_add_u32 v24, v2, 12, v24
    v_mfma_f32_16x16x32_bf16 a[24:27], v[56:59], v[96:99], a[24:27]
    ds_read_b64_tr_b16 v[48:49], v18
    ds_read_b64_tr_b16 v[50:51], v18 offset:4096
    v_mfma_f32_16x16x32_bf16 a[24:27], v[60:63], v[100:103], a[24:27]
    v_mfma_f32_16x16x32_bf16 a[28:31], v[56:59], v[104:107], a[28:31]
    ds_read_b64_tr_b16 v[52:53], v18 offset:8192
    v_add_u32 v24, 147456, v24
    v_mfma_f32_16x16x32_bf16 a[28:31], v[60:63], v[108:111], a[28:31]
    s_waitcnt lgkmcnt(7)
    ds_read_b64_tr_b16 v[54:55], v18 offset:12288
    v_add_u32 v19, 0x18000, v19
    v_xor_b32 v8, 0, v24
    v_mfma_f32_16x16x32_bf16 a[0:3], v[32:35], v[112:115], a[0:3]
    ds_read_b64_tr_b16 v[56:57], v19
    ds_read_b64_tr_b16 v[58:59], v19 offset:4096
    v_mfma_f32_16x16x32_bf16 a[0:3], v[36:39], v[116:119], a[0:3]
    v_mfma_f32_16x16x32_bf16 a[4:7], v[32:35], v[120:123], a[4:7]
    ds_read_b64_tr_b16 v[60:61], v19 offset:8192
    v_xor_b32 v9, 32, v24
    v_mfma_f32_16x16x32_bf16 a[4:7], v[36:39], v[124:127], a[4:7]
    s_waitcnt lgkmcnt(7)
    ds_read_b64_tr_b16 v[62:63], v19 offset:12288
    v_xor_b32 v10, 64, v24
    v_mfma_f32_16x16x32_bf16 a[8:11], v[40:43], v[112:115], a[8:11]
    ds_read_b64_tr_b16 v[32:33], v12 offset:16384
    ds_read_b64_tr_b16 v[34:35], v12 offset:20480
    v_mfma_f32_16x16x32_bf16 a[8:11], v[44:47], v[116:119], a[8:11]
    v_mfma_f32_16x16x32_bf16 a[12:15], v[40:43], v[120:123], a[12:15]
    ds_read_b64_tr_b16 v[36:37], v12 offset:24576
    v_xor_b32 v11, 96, v24
    v_mfma_f32_16x16x32_bf16 a[12:15], v[44:47], v[124:127], a[12:15]
    s_waitcnt lgkmcnt(7)
    ds_read_b64_tr_b16 v[38:39], v12 offset:28672
    v_lshrrev_b32 v25, 3, v1
    v_mfma_f32_16x16x32_bf16 a[16:19], v[48:51], v[112:115], a[16:19]
    ds_read_b64_tr_b16 v[40:41], v13 offset:16384
    ds_read_b64_tr_b16 v[42:43], v13 offset:20480
    v_mfma_f32_16x16x32_bf16 a[16:19], v[52:55], v[116:119], a[16:19]
    v_mfma_f32_16x16x32_bf16 a[20:23], v[48:51], v[120:123], a[20:23]
    ds_read_b64_tr_b16 v[44:45], v13 offset:24576
    v_and_b32 v26, 7, v1
    v_mfma_f32_16x16x32_bf16 a[20:23], v[52:55], v[124:127], a[20:23]
    s_waitcnt lgkmcnt(7)
    ds_read_b64_tr_b16 v[46:47], v13 offset:28672
    v_xor_b32 v24, v25, v26
    v_mfma_f32_16x16x32_bf16 a[24:27], v[56:59], v[112:115], a[24:27]
    ds_read_b64_tr_b16 v[48:49], v14 offset:16384
    ds_read_b64_tr_b16 v[50:51], v14 offset:20480
    v_mfma_f32_16x16x32_bf16 a[24:27], v[60:63], v[116:119], a[24:27]
    v_mfma_f32_16x16x32_bf16 a[28:31], v[56:59], v[120:123], a[28:31]
    s_waitcnt vmcnt(0)
    s_barrier
    ds_read_b64_tr_b16 v[52:53], v14 offset:24576
    v_mfma_f32_16x16x32_bf16 a[28:31], v[60:63], v[124:127], a[28:31]
    s_waitcnt lgkmcnt(7)
    ds_read_b64_tr_b16 v[54:55], v14 offset:28672
    v_lshlrev_b32 v24, 4, v24
    v_mfma_f32_16x16x32_bf16 a[0:3], v[32:35], v[128:131], a[0:3]
    ds_read_b64_tr_b16 v[56:57], v15 offset:16384
    ds_read_b64_tr_b16 v[58:59], v15 offset:20480
    v_mfma_f32_16x16x32_bf16 a[0:3], v[36:39], v[132:135], a[0:3]
    v_mfma_f32_16x16x32_bf16 a[4:7], v[32:35], v[136:139], a[4:7]
    ds_read_b64_tr_b16 v[60:61], v15 offset:24576
    v_lshl_add_u32 v24, v25, 7, v24
    v_mfma_f32_16x16x32_bf16 a[4:7], v[36:39], v[140:143], a[4:7]
    s_waitcnt lgkmcnt(7)
    ds_read_b64_tr_b16 v[62:63], v15 offset:28672
    v_lshl_add_u32 v24, v2, 12, v24
    v_mfma_f32_16x16x32_bf16 a[8:11], v[40:43], v[128:131], a[8:11]
    ds_read_b64_tr_b16 v[32:33], v16 offset:16384
    ds_read_b64_tr_b16 v[34:35], v16 offset:20480
    v_mfma_f32_16x16x32_bf16 a[8:11], v[44:47], v[132:135], a[8:11]
    v_mfma_f32_16x16x32_bf16 a[12:15], v[40:43], v[136:139], a[12:15]
    ds_read_b64_tr_b16 v[36:37], v16 offset:24576
    v_add_u32 v24, 147456, v24
    v_mfma_f32_16x16x32_bf16 a[12:15], v[44:47], v[140:143], a[12:15]
    s_waitcnt lgkmcnt(7)
    ds_read_b64_tr_b16 v[38:39], v16 offset:28672
    v_lshl_add_u32 v25, v2, 5, v25
    v_mfma_f32_16x16x32_bf16 a[16:19], v[48:51], v[128:131], a[16:19]
    ds_read_b64_tr_b16 v[40:41], v17 offset:16384
    ds_read_b64_tr_b16 v[42:43], v17 offset:20480
    v_mfma_f32_16x16x32_bf16 a[16:19], v[52:55], v[132:135], a[16:19]
    v_mfma_f32_16x16x32_bf16 a[20:23], v[48:51], v[136:139], a[20:23]
    ds_read_b64_tr_b16 v[44:45], v17 offset:24576
    v_lshlrev_b32 v25, 11, v25
    v_mfma_f32_16x16x32_bf16 a[20:23], v[52:55], v[140:143], a[20:23]
    s_waitcnt lgkmcnt(7)
    ds_read_b64_tr_b16 v[46:47], v17 offset:28672
    v_lshl_add_u32 v25, v26, 4, v25
    v_mfma_f32_16x16x32_bf16 a[24:27], v[56:59], v[128:131], a[24:27]
    ds_read_b64_tr_b16 v[48:49], v18 offset:16384
    ds_read_b64_tr_b16 v[50:51], v18 offset:20480
    v_mfma_f32_16x16x32_bf16 a[24:27], v[60:63], v[132:135], a[24:27]
    v_mfma_f32_16x16x32_bf16 a[28:31], v[56:59], v[136:139], a[28:31]
    ds_read_b64_tr_b16 v[52:53], v18 offset:24576
    s_mov_b32 s48, 16384
    v_mfma_f32_16x16x32_bf16 a[28:31], v[60:63], v[140:143], a[28:31]
    s_waitcnt lgkmcnt(7)
    ds_read_b64_tr_b16 v[54:55], v18 offset:28672
    s_mov_b32 s49, 32768
    v_mfma_f32_16x16x32_bf16 a[0:3], v[32:35], v[144:147], a[0:3]
    ds_read_b64_tr_b16 v[56:57], v19 offset:16384
    ds_read_b64_tr_b16 v[58:59], v19 offset:20480
    v_mfma_f32_16x16x32_bf16 a[0:3], v[36:39], v[148:151], a[0:3]
    global_load_dword v6, v31, s[60:61] sc1
    v_mfma_f32_16x16x32_bf16 a[4:7], v[32:35], v[152:155], a[4:7]
    ds_read_b64_tr_b16 v[60:61], v19 offset:24576
    s_mov_b32 s68, 49152
    v_mfma_f32_16x16x32_bf16 a[4:7], v[36:39], v[156:159], a[4:7]
    s_waitcnt lgkmcnt(7)
    ds_read_b64_tr_b16 v[62:63], v19 offset:28672
    v_add_u32 v12, 0xfffec000, v12
    v_mfma_f32_16x16x32_bf16 a[8:11], v[40:43], v[144:147], a[8:11]
    ds_read_b64_tr_b16 v[32:33], v12
    ds_read_b64_tr_b16 v[34:35], v12 offset:4096
    v_mfma_f32_16x16x32_bf16 a[8:11], v[44:47], v[148:151], a[8:11]
    v_mfma_f32_16x16x32_bf16 a[12:15], v[40:43], v[152:155], a[12:15]
    ds_read_b64_tr_b16 v[36:37], v12 offset:8192
    v_mfma_f32_16x16x32_bf16 a[12:15], v[44:47], v[156:159], a[12:15]
    s_waitcnt lgkmcnt(7)
    ds_read_b64_tr_b16 v[38:39], v12 offset:12288
    v_add_u32 v13, 0xfffec000, v13
    v_mfma_f32_16x16x32_bf16 a[16:19], v[48:51], v[144:147], a[16:19]
    ds_read_b64_tr_b16 v[40:41], v13
    ds_read_b64_tr_b16 v[42:43], v13 offset:4096
    v_mfma_f32_16x16x32_bf16 a[16:19], v[52:55], v[148:151], a[16:19]
    v_mfma_f32_16x16x32_bf16 a[20:23], v[48:51], v[152:155], a[20:23]
    ds_read_b64_tr_b16 v[44:45], v13 offset:8192
    v_mfma_f32_16x16x32_bf16 a[20:23], v[52:55], v[156:159], a[20:23]
    s_waitcnt lgkmcnt(7)
    ds_read_b64_tr_b16 v[46:47], v13 offset:12288
    v_add_u32 v14, 0xfffec000, v14
    v_mfma_f32_16x16x32_bf16 a[24:27], v[56:59], v[144:147], a[24:27]
    ds_read_b64_tr_b16 v[48:49], v14
    ds_read_b64_tr_b16 v[50:51], v14 offset:4096
    v_mfma_f32_16x16x32_bf16 a[24:27], v[60:63], v[148:151], a[24:27]
    v_mfma_f32_16x16x32_bf16 a[28:31], v[56:59], v[152:155], a[28:31]
    ds_read_b64_tr_b16 v[52:53], v14 offset:8192
    v_mfma_f32_16x16x32_bf16 a[28:31], v[60:63], v[156:159], a[28:31]
    s_waitcnt lgkmcnt(7)
    ds_read_b64_tr_b16 v[54:55], v14 offset:12288
    v_add_u32 v15, 0xfffec000, v15
    v_mfma_f32_16x16x32_bf16 a[0:3], v[32:35], v[160:163], a[0:3]
    ds_read_b64_tr_b16 v[56:57], v15
    ds_read_b64_tr_b16 v[58:59], v15 offset:4096
    v_mfma_f32_16x16x32_bf16 a[0:3], v[36:39], v[164:167], a[0:3]
    v_mfma_f32_16x16x32_bf16 a[4:7], v[32:35], v[168:171], a[4:7]
    ds_read_b64_tr_b16 v[60:61], v15 offset:8192
    v_mfma_f32_16x16x32_bf16 a[4:7], v[36:39], v[172:175], a[4:7]
    s_waitcnt lgkmcnt(7)
    ds_read_b64_tr_b16 v[62:63], v15 offset:12288
    v_add_u32 v16, 0xfffec000, v16
    v_mfma_f32_16x16x32_bf16 a[8:11], v[40:43], v[160:163], a[8:11]
    ds_read_b64_tr_b16 v[32:33], v16
    ds_read_b64_tr_b16 v[34:35], v16 offset:4096
    v_mfma_f32_16x16x32_bf16 a[8:11], v[44:47], v[164:167], a[8:11]
    v_mfma_f32_16x16x32_bf16 a[12:15], v[40:43], v[168:171], a[12:15]
    ds_read_b64_tr_b16 v[36:37], v16 offset:8192
    v_mfma_f32_16x16x32_bf16 a[12:15], v[44:47], v[172:175], a[12:15]
    s_waitcnt lgkmcnt(7)
    ds_read_b64_tr_b16 v[38:39], v16 offset:12288
    v_add_u32 v17, 0xfffec000, v17
    v_mfma_f32_16x16x32_bf16 a[16:19], v[48:51], v[160:163], a[16:19]
    ds_read_b64_tr_b16 v[40:41], v17
    ds_read_b64_tr_b16 v[42:43], v17 offset:4096
    v_mfma_f32_16x16x32_bf16 a[16:19], v[52:55], v[164:167], a[16:19]
    v_mfma_f32_16x16x32_bf16 a[20:23], v[48:51], v[168:171], a[20:23]
    ds_read_b64_tr_b16 v[44:45], v17 offset:8192
    v_mfma_f32_16x16x32_bf16 a[20:23], v[52:55], v[172:175], a[20:23]
    s_waitcnt lgkmcnt(7)
    ds_read_b64_tr_b16 v[46:47], v17 offset:12288
    v_add_u32 v18, 0xfffec000, v18
    v_mfma_f32_16x16x32_bf16 a[24:27], v[56:59], v[160:163], a[24:27]
    ds_read_b64_tr_b16 v[48:49], v18
    ds_read_b64_tr_b16 v[50:51], v18 offset:4096
    v_mfma_f32_16x16x32_bf16 a[24:27], v[60:63], v[164:167], a[24:27]
    v_mfma_f32_16x16x32_bf16 a[28:31], v[56:59], v[168:171], a[28:31]
    ds_read_b64_tr_b16 v[52:53], v18 offset:8192
    v_mfma_f32_16x16x32_bf16 a[28:31], v[60:63], v[172:175], a[28:31]
    s_waitcnt lgkmcnt(7)
    ds_read_b64_tr_b16 v[54:55], v18 offset:12288
    v_add_u32 v19, 0xfffec000, v19
    v_mfma_f32_16x16x32_bf16 a[0:3], v[32:35], v[176:179], a[0:3]
    ds_read_b64_tr_b16 v[56:57], v19
    ds_read_b64_tr_b16 v[58:59], v19 offset:4096
    v_mfma_f32_16x16x32_bf16 a[0:3], v[36:39], v[180:183], a[0:3]
    v_mfma_f32_16x16x32_bf16 a[4:7], v[32:35], v[184:187], a[4:7]
    ds_read_b64_tr_b16 v[60:61], v19 offset:8192
    v_mfma_f32_16x16x32_bf16 a[4:7], v[36:39], v[188:191], a[4:7]
    s_waitcnt lgkmcnt(7)
    ds_read_b64_tr_b16 v[62:63], v19 offset:12288
    v_mfma_f32_16x16x32_bf16 a[8:11], v[40:43], v[176:179], a[8:11]
    ds_read_b64_tr_b16 v[32:33], v12 offset:16384
    ds_read_b64_tr_b16 v[34:35], v12 offset:20480
    v_mfma_f32_16x16x32_bf16 a[8:11], v[44:47], v[180:183], a[8:11]
    v_mfma_f32_16x16x32_bf16 a[12:15], v[40:43], v[184:187], a[12:15]
    s_waitcnt vmcnt(0)
    ds_read_b64_tr_b16 v[36:37], v12 offset:24576
    v_readfirstlane_b32 s56, v6
    v_mfma_f32_16x16x32_bf16 a[12:15], v[44:47], v[188:191], a[12:15]
    s_waitcnt lgkmcnt(7)
    ds_read_b64_tr_b16 v[38:39], v12 offset:28672
    v_mfma_f32_16x16x32_bf16 a[16:19], v[48:51], v[176:179], a[16:19]
    s_cmp_ge_u32 s56, 1
    ds_read_b64_tr_b16 v[40:41], v13 offset:16384
    ds_read_b64_tr_b16 v[42:43], v13 offset:20480
    s_cbranch_scc0 L_spin3
L_back3:
    v_mfma_f32_16x16x32_bf16 a[16:19], v[52:55], v[180:183], a[16:19]
    buffer_load_dwordx4 v[64:67], v29, s[4:7], s84 offen sc1
    v_mfma_f32_16x16x32_bf16 a[20:23], v[48:51], v[184:187], a[20:23]
    ds_read_b64_tr_b16 v[44:45], v13 offset:24576
    v_mfma_f32_16x16x32_bf16 a[20:23], v[52:55], v[188:191], a[20:23]
    s_waitcnt lgkmcnt(7)
    ds_read_b64_tr_b16 v[46:47], v13 offset:28672
    buffer_load_dwordx4 v[68:71], v29, s[4:7], s84 offen offset:1024 sc1
    v_mfma_f32_16x16x32_bf16 a[24:27], v[56:59], v[176:179], a[24:27]
    ds_read_b64_tr_b16 v[48:49], v14 offset:16384
    ds_read_b64_tr_b16 v[50:51], v14 offset:20480
    v_mfma_f32_16x16x32_bf16 a[24:27], v[60:63], v[180:183], a[24:27]
    buffer_load_dwordx4 v[72:75], v29, s[4:7], s84 offen offset:2048 sc1
    v_mfma_f32_16x16x32_bf16 a[28:31], v[56:59], v[184:187], a[28:31]
    s_waitcnt vmcnt(63)
    s_barrier
    ds_read_b64_tr_b16 v[52:53], v14 offset:24576
    v_mfma_f32_16x16x32_bf16 a[28:31], v[60:63], v[188:191], a[28:31]
    s_waitcnt lgkmcnt(7)
    ds_read_b64_tr_b16 v[54:55], v14 offset:28672
    v_mfma_f32_16x16x32_bf16 a[0:3], v[32:35], v[192:195], a[0:3]
    ds_read_b64_tr_b16 v[56:57], v15 offset:16384
    ds_read_b64_tr_b16 v[58:59], v15 offset:20480
    v_mfma_f32_16x16x32_bf16 a[0:3], v[36:39], v[196:199], a[0:3]
    buffer_load_dwordx4 v[76:79], v29, s[4:7], s84 offen offset:3072 sc1
    v_mfma_f32_16x16x32_bf16 a[4:7], v[32:35], v[200:203], a[4:7]
    ds_read_b64_tr_b16 v[60:61], v15 offset:24576
    v_mfma_f32_16x16x32_bf16 a[4:7], v[36:39], v[204:207], a[4:7]
    s_waitcnt lgkmcnt(7)
    ds_read_b64_tr_b16 v[62:63], v15 offset:28672
    buffer_load_dwordx4 v[80:83], v29, s[4:7], s67 offen sc1
    v_mfma_f32_16x16x32_bf16 a[8:11], v[40:43], v[192:195], a[8:11]
    ds_read_b64_tr_b16 v[32:33], v16 offset:16384
    ds_read_b64_tr_b16 v[34:35], v16 offset:20480
    v_mfma_f32_16x16x32_bf16 a[8:11], v[44:47], v[196:199], a[8:11]
    buffer_load_dwordx4 v[84:87], v29, s[4:7], s67 offen offset:1024 sc1
    v_mfma_f32_16x16x32_bf16 a[12:15], v[40:43], v[200:203], a[12:15]
    ds_read_b64_tr_b16 v[36:37], v16 offset:24576
    v_mfma_f32_16x16x32_bf16 a[12:15], v[44:47], v[204:207], a[12:15]
    s_waitcnt lgkmcnt(7)
    ds_read_b64_tr_b16 v[38:39], v16 offset:28672
    buffer_load_dwordx4 v[88:91], v29, s[4:7], s67 offen offset:2048 sc1
    v_mfma_f32_16x16x32_bf16 a[16:19], v[48:51], v[192:195], a[16:19]
    ds_read_b64_tr_b16 v[40:41], v17 offset:16384
    ds_read_b64_tr_b16 v[42:43], v17 offset:20480
    v_mfma_f32_16x16x32_bf16 a[16:19], v[52:55], v[196:199], a[16:19]
    buffer_load_dwordx4 v[92:95], v29, s[4:7], s67 offen offset:3072 sc1
    v_mfma_f32_16x16x32_bf16 a[20:23], v[48:51], v[200:203], a[20:23]
    ds_read_b64_tr_b16 v[44:45], v17 offset:24576
    v_mfma_f32_16x16x32_bf16 a[20:23], v[52:55], v[204:207], a[20:23]
    s_waitcnt lgkmcnt(7)
    ds_read_b64_tr_b16 v[46:47], v17 offset:28672
    v_mfma_f32_16x16x32_bf16 a[24:27], v[56:59], v[192:195], a[24:27]
    ds_read_b64_tr_b16 v[48:49], v18 offset:16384
    ds_read_b64_tr_b16 v[50:51], v18 offset:20480
    v_mfma_f32_16x16x32_bf16 a[24:27], v[60:63], v[196:199], a[24:27]
    v_mfma_f32_16x16x32_bf16 a[28:31], v[56:59], v[200:203], a[28:31]
    ds_read_b64_tr_b16 v[52:53], v18 offset:24576
    v_mfma_f32_16x16x32_bf16 a[28:31], v[60:63], v[204:207], a[28:31]
    s_waitcnt lgkmcnt(7)
    ds_read_b64_tr_b16 v[54:55], v18 offset:28672
    v_mfma_f32_16x16x32_bf16 a[0:3], v[32:35], v[208:211], a[0:3]
    ds_read_b64_tr_b16 v[56:57], v19 offset:16384
    ds_read_b64_tr_b16 v[58:59], v19 offset:20480
    v_mfma_f32_16x16x32_bf16 a[0:3], v[36:39], v[212:215], a[0:3]
    v_mfma_f32_16x16x32_bf16 a[4:7], v[32:35], v[216:219], a[4:7]
    ds_read_b64_tr_b16 v[60:61], v19 offset:24576
    v_mfma_f32_16x16x32_bf16 a[4:7], v[36:39], v[220:223], a[4:7]
    s_waitcnt lgkmcnt(7)
    ds_read_b64_tr_b16 v[62:63], v19 offset:28672
    v_mfma_f32_16x16x32_bf16 a[8:11], v[40:43], v[208:211], a[8:11]
    v_mfma_f32_16x16x32_bf16 a[8:11], v[44:47], v[212:215], a[8:11]
    v_mfma_f32_16x16x32_bf16 a[12:15], v[40:43], v[216:219], a[12:15]
    v_mfma_f32_16x16x32_bf16 a[12:15], v[44:47], v[220:223], a[12:15]
    s_waitcnt lgkmcnt(4)
    v_mfma_f32_16x16x32_bf16 a[16:19], v[48:51], v[208:211], a[16:19]
    v_mfma_f32_16x16x32_bf16 a[16:19], v[52:55], v[212:215], a[16:19]
    v_mfma_f32_16x16x32_bf16 a[20:23], v[48:51], v[216:219], a[20:23]
    v_mfma_f32_16x16x32_bf16 a[20:23], v[52:55], v[220:223], a[20:23]
    s_waitcnt lgkmcnt(0)
    v_mfma_f32_16x16x32_bf16 a[24:27], v[56:59], v[208:211], a[24:27]
    v_mfma_f32_16x16x32_bf16 a[24:27], v[60:63], v[212:215], a[24:27]
    v_mfma_f32_16x16x32_bf16 a[28:31], v[56:59], v[216:219], a[28:31]
    v_mfma_f32_16x16x32_bf16 a[28:31], v[60:63], v[220:223], a[28:31]

    v_accvgpr_read_b32 v32, a0
    v_accvgpr_read_b32 v33, a1
    v_accvgpr_read_b32 v34, a2
    v_accvgpr_read_b32 v35, a3
    v_accvgpr_read_b32 v36, a4
    v_accvgpr_read_b32 v37, a5
    v_accvgpr_read_b32 v38, a6
    v_accvgpr_read_b32 v39, a7
    v_accvgpr_read_b32 v40, a8
    v_accvgpr_read_b32 v41, a9
    v_accvgpr_read_b32 v42, a10
    v_accvgpr_read_b32 v43, a11
    v_accvgpr_read_b32 v44, a12
    v_accvgpr_read_b32 v45, a13
    v_accvgpr_read_b32 v46, a14
    v_accvgpr_read_b32 v47, a15
    v_accvgpr_read_b32 v48, a16
    v_accvgpr_read_b32 v49, a17
    v_accvgpr_read_b32 v50, a18
    v_accvgpr_read_b32 v51, a19
    v_accvgpr_read_b32 v52, a20
    v_accvgpr_read_b32 v53, a21
    v_accvgpr_read_b32 v54, a22
    v_accvgpr_read_b32 v55, a23
    v_accvgpr_read_b32 v56, a24
    v_accvgpr_read_b32 v57, a25
    v_accvgpr_read_b32 v58, a26
    v_accvgpr_read_b32 v59, a27
    v_accvgpr_read_b32 v60, a28
    v_accvgpr_read_b32 v61, a29
    v_accvgpr_read_b32 v62, a30
    v_accvgpr_read_b32 v63, a31
    s_waitcnt vmcnt(7)
    v_add_f32 v32, v32, v64
    v_add_f32 v33, v33, v65
    v_add_f32 v34, v34, v66
    v_add_f32 v35, v35, v67
    v_cvt_pk_bf16_f32 v96, v32, v33
    v_cvt_pk_bf16_f32 v97, v34, v35
    ds_write_b64 v8, v[96:97]
    s_waitcnt vmcnt(6)
    v_add_f32 v36, v36, v68
    v_add_f32 v37, v37, v69
    v_add_f32 v38, v38, v70
    v_add_f32 v39, v39, v71
    v_cvt_pk_bf16_f32 v98, v36, v37
    v_cvt_pk_bf16_f32 v99, v38, v39
    ds_write_b64 v8, v[98:99] offset:2048
    s_waitcnt vmcnt(5)
    v_add_f32 v40, v40, v72
    v_add_f32 v41, v41, v73
    v_add_f32 v42, v42, v74
    v_add_f32 v43, v43, v75
    v_cvt_pk_bf16_f32 v100, v40, v41
    v_cvt_pk_bf16_f32 v101, v42, v43
    ds_write_b64 v9, v[100:101]
    s_waitcnt vmcnt(4)
    v_add_f32 v44, v44, v76
    v_add_f32 v45, v45, v77
    v_add_f32 v46, v46, v78
    v_add_f32 v47, v47, v79
    v_cvt_pk_bf16_f32 v102, v44, v45
    v_cvt_pk_bf16_f32 v103, v46, v47
    ds_write_b64 v9, v[102:103] offset:2048
    s_waitcnt vmcnt(3)
    v_add_f32 v48, v48, v80
    v_add_f32 v49, v49, v81
    v_add_f32 v50, v50, v82
    v_add_f32 v51, v51, v83
    v_cvt_pk_bf16_f32 v104, v48, v49
    v_cvt_pk_bf16_f32 v105, v50, v51
    ds_write_b64 v10, v[104:105]
    s_waitcnt vmcnt(2)
    v_add_f32 v52, v52, v84
    v_add_f32 v53, v53, v85
    v_add_f32 v54, v54, v86
    v_add_f32 v55, v55, v87
    v_cvt_pk_bf16_f32 v106, v52, v53
    v_cvt_pk_bf16_f32 v107, v54, v55
    ds_write_b64 v10, v[106:107] offset:2048
    s_waitcnt vmcnt(1)
    v_add_f32 v56, v56, v88
    v_add_f32 v57, v57, v89
    v_add_f32 v58, v58, v90
    v_add_f32 v59, v59, v91
    v_cvt_pk_bf16_f32 v108, v56, v57
    v_cvt_pk_bf16_f32 v109, v58, v59
    ds_write_b64 v11, v[108:109]
    s_waitcnt vmcnt(0)
    v_add_f32 v60, v60, v92
    v_add_f32 v61, v61, v93
    v_add_f32 v62, v62, v94
    v_add_f32 v63, v63, v95
    v_cvt_pk_bf16_f32 v110, v60, v61
    v_cvt_pk_bf16_f32 v111, v62, v63
    ds_write_b64 v11, v[110:111] offset:2048
    s_waitcnt lgkmcnt(0)
    ds_read_b128 v[128:131], v24
    ds_read_b128 v[132:135], v24 offset:1024
    ds_read_b128 v[136:139], v24 offset:2048
    ds_read_b128 v[140:143], v24 offset:3072
    s_waitcnt lgkmcnt(3)
    buffer_store_dwordx4 v[128:131], v25, s[44:47], s84 offen
    s_waitcnt lgkmcnt(2)
    buffer_store_dwordx4 v[132:135], v25, s[44:47], s48 offen
    s_waitcnt lgkmcnt(1)
    buffer_store_dwordx4 v[136:139], v25, s[44:47], s49 offen
    s_waitcnt lgkmcnt(0)
    buffer_store_dwordx4 v[140:143], v25, s[44:47], s68 offen

L_k1_end:
    s_endpgm
.section .rodata,"a"
.p2align 6
.amdhsa_kernel concat_heads__mha_block_cached__gqa_block_cached__near_ridge_kernel
  .amdhsa_next_free_vgpr 512
  .amdhsa_next_free_sgpr 102
  .amdhsa_accum_offset 256
  .amdhsa_group_segment_fixed_size 0
  .amdhsa_kernarg_size 104
  .amdhsa_user_sgpr_count 2
  .amdhsa_user_sgpr_kernarg_segment_ptr 1
  .amdhsa_system_sgpr_workgroup_id_x 1
.end_amdhsa_kernel
```
